```python
import torch

def _softmax(x, axis=-1):
    return torch.softmax(x, dim=axis)

def _gelu(x):
    return torch.nn.functional.gelu(x, approximate='tanh')

def _silu(x):
    return torch.nn.functional.silu(x)

def _sigmoid(x):
    return torch.sigmoid(x)

def _layernorm(x, axis=-1, eps=1e-05):
    m = x.mean(dim=axis, keepdim=True)
    v = x.var(dim=axis, keepdim=True, unbiased=False)
    return (x - m) / torch.sqrt(v + eps)

def _scatter_add(tgt, idx, src, axis=0):
    return tgt.clone().index_add_(axis, idx, src)

def _segment_sum(src, seg, n):
    out = torch.zeros((n,) + src.shape[1:], dtype=src.dtype)
    return out.index_add_(0, seg, src)

def _pad(x, pw):
    flat = tuple((v for pair in reversed(pw) for v in pair))
    return torch.nn.functional.pad(x, flat)
kernel_name = 'adaLN_cond__gqa_block_cached__swiglu_ffn__prompt'

def setup_inputs():

    _w = lambda a: (lambda t: t.to(torch.bfloat16) if t.is_floating_point() else t)(torch.as_tensor(a))

    def _A_setup():
        B, Sq, D = (1, 2048, 576)
        Hq, Hkv, Sk, Dh = (32, 16, 2048, 128)
        assert Hq % Hkv == 0, (Hq, Hkv)
        return {'x': _w((lambda *s: torch.randn(*s, dtype=torch.bfloat16) * 0.05)(B, Sq, D)), 'k_cache': _w((lambda *s: torch.randn(*s, dtype=torch.bfloat16) * 3.2)(B, Hkv, Sk, Dh)), 'v_cache': _w((lambda *s: torch.randn(*s, dtype=torch.bfloat16) * 0.4)(B, Hkv, Sk, Dh)), 'wq': _w((lambda *s: torch.randn(*s, dtype=torch.bfloat16) * 3.2)(D, Hq * Dh) * D ** (-0.5)), 'wo': _w((lambda *s: torch.randn(*s, dtype=torch.bfloat16) * 0.4)(Hq * Dh, D) * (Hq * Dh) ** (-0.5))}
    _A_in = _A_setup()

    def _B_setup():
        B, S, D, F = (1, 2048, 576, 4608)
        return {'x': _w((lambda *s: torch.randn(*s, dtype=torch.bfloat16) * 0.05)(B, S, D)), 'w_gate': _w((lambda *s: torch.randn(*s, dtype=torch.bfloat16) * 0.05)(D, F)), 'w_up': _w((lambda *s: torch.randn(*s, dtype=torch.bfloat16) * 0.05)(D, F)), 'w_down': _w((lambda *s: torch.randn(*s, dtype=torch.bfloat16) * 0.05)(F, D))}
    _B_in = _B_setup()
    return {'A_x': _A_in['x'], 'A_k_cache': _A_in['k_cache'], 'A_v_cache': _A_in['v_cache'], 'A_wq': _A_in['wq'], 'A_wo': _A_in['wo'], 'B_x': _B_in['x'], 'B_w_gate': _B_in['w_gate'], 'B_w_up': _B_in['w_up'], 'B_w_down': _B_in['w_down'], 'c': _w((lambda *s: torch.randn(*s, dtype=torch.bfloat16) * 0.1)(1, 576) * 8.0), 'w_mod': _w((lambda *s: torch.randn(*s, dtype=torch.bfloat16) * 0.1)(576, 6 * 576) * 576 ** (-0.5) * 8.0)}

def reference(A_x, A_k_cache, A_v_cache, A_wq, A_wo, B_x, B_w_gate, B_w_up, B_w_down, c, w_mod):

    def _A_ref(x, k_cache, v_cache, wq, wo):
        B, Sq, D = x.shape
        Hq, Dh = (32, 128)
        Hkv = k_cache.shape[1]
        rep = Hq // Hkv
        q = (lambda x, *d: x.permute(*d))((x @ wq).reshape(B, Sq, Hq, Dh), 0, 2, 1, 3)
        k = (lambda x, n, axis: torch.repeat_interleave(x, n, dim=axis))(k_cache, rep, axis=1)
        v = (lambda x, n, axis: torch.repeat_interleave(x, n, dim=axis))(v_cache, rep, axis=1)
        scores = torch.einsum('bhqd,bhkd->bhqk', q, k) * Dh ** (-0.5)
        p = _softmax(scores, axis=-1)
        o = torch.einsum('bhqk,bhkd->bhqd', p, v)
        return (lambda x, *d: x.permute(*d))(o, 0, 2, 1, 3).reshape(B, Sq, Hq * Dh) @ wo

    def _B_ref(x, w_gate, w_up, w_down):
        g = _silu(x @ w_gate)
        u = x @ w_up
        return g * u @ w_down
    x = A_x
    mod = (_silu(c) @ w_mod).reshape(c.shape[0], 6, 1, -1)
    sa, ca, ga, sb, cb, gb = (mod[:, 0].clone(), mod[:, 1].clone(), mod[:, 2].clone(), mod[:, 3].clone(), mod[:, 4].clone(), mod[:, 5].clone())
    h = _layernorm(x, axis=-1) * (1 + ca) + sa
    x = x + ga * _A_ref(h, A_k_cache, A_v_cache, A_wq, A_wo)
    h = _layernorm(x, axis=-1) * (1 + cb) + sb
    x = x + gb * _B_ref(h, B_w_gate, B_w_up, B_w_down)
    return x
```

```asm
; @launch kernel=k1_ln_kernel grid=(364,1,1) block=(576,1,1) lds=24576
; @launch kernel=k2_attn_kernel grid=(256,1,1) block=(256,1,1) lds=163840
; @launch kernel=k3_oproj_kernel grid=(240,1,1) block=(512,1,1) lds=163840
; @launch kernel=k4_mid_kernel grid=(256,1,1) block=(576,1,1) lds=1024
; @launch kernel=k5_gateup_kernel grid=(256,1,1) block=(512,1,1) lds=148480
; @launch kernel=k6_down_kernel grid=(240,1,1) block=(512,1,1) lds=163840
; @launch kernel=k7_final_kernel grid=(256,1,1) block=(576,1,1) lds=1024
.amdgcn_target "amdgcn-amd-amdhsa--gfx950"
.text
.globl k1_ln_kernel
.p2align 8
.type k1_ln_kernel,@function
k1_ln_kernel:
    s_cmp_ge_u32 s2, 364
    s_cbranch_scc1 k1_ln_kernel_end
    s_mov_b32 s95, s2
    s_sub_u32 s2, s2, 108
    s_cselect_b32 s2, 0, s2
    s_load_dwordx2 s[4:5], s[0:1], 0
    s_load_dwordx2 s[6:7], s[0:1], 104
    s_load_dwordx2 s[8:9], s[0:1], 88
    s_load_dwordx2 s[44:45], s[0:1], 72
    s_load_dwordx2 s[48:49], s[0:1], 80
    s_load_dwordx2 s[56:57], s[0:1], 24
    s_load_dwordx2 s[72:73], s[0:1], 8
    s_load_dwordx2 s[76:77], s[0:1], 16
    v_and_b32 v1, 63, v0
    v_lshrrev_b32 v2, 6, v0
    v_and_b32 v3, 7, v1
    v_bfe_u32 v4, v1, 3, 1
    v_bfe_u32 v5, v1, 4, 1
    v_lshrrev_b32 v6, 5, v1
    v_lshl_add_u32 v6, v2, 1, v6
    s_lshr_b32 s10, s2, 2
    s_and_b32 s11, s2, 3
    s_lshl_b32 s11, s11, 3
    v_lshlrev_b32 v7, 5, v6
    v_lshl_add_u32 v7, v5, 4, v7
    v_lshl_add_u32 v7, v4, 3, v7
    s_lshl_b32 s3, s2, 3
    v_add_u32 v8, s3, v3
    v_mul_u32_u24 v8, 1152, v8
    v_lshl_add_u32 v8, v7, 1, v8
    v_lshlrev_b32 v9, 5, v4
    v_add_u32 v9, s11, v9
    v_add_u32 v9, v9, v3
    v_lshlrev_b32 v10, 5, v2
    v_lshl_add_u32 v10, v3, 2, v10
    v_lshlrev_b32 v11, 2, v3
    v_lshlrev_b32 v12, 2, v7
    s_mul_i32 s12, s10, 18
    v_add_u32 v13, s12, v6
    v_lshlrev_b32 v13, 2, v13
    v_lshl_add_u32 v13, v5, 1, v13
    v_lshlrev_b32 v13, 10, v13
    v_lshl_add_u32 v13, v9, 4, v13
    s_mul_i32 s12, s10, 36
    v_lshl_add_u32 v14, v6, 1, v5
    v_add_u32 v14, s12, v14
    v_lshlrev_b32 v14, 10, v14
    v_lshl_add_u32 v14, v9, 4, v14
    s_waitcnt lgkmcnt(0)
    s_add_u32 s16, s6, 0
    s_addc_u32 s17, s7, 0
    s_mov_b32 s18, 13824
    s_mov_b32 s19, 0x20000
    s_add_u32 s20, s6, 67108864
    s_addc_u32 s21, s7, 0
    s_mov_b32 s22, 11796480
    s_mov_b32 s23, 0x20000
    s_add_u32 s24, s6, 6291456
    s_addc_u32 s25, s7, 0
    s_mov_b32 s26, 2359296
    s_mov_b32 s27, 0x20000
    s_add_u32 s28, s6, 65536
    s_addc_u32 s29, s7, 0
    s_mov_b32 s30, 2359296
    s_mov_b32 s31, 0x20000
    s_add_u32 s32, s4, 0
    s_addc_u32 s33, s5, 0
    s_mov_b32 s34, 2359296
    s_mov_b32 s35, 0x20000
    buffer_load_dwordx4 v[16:19], v8, s[32:35], 0 offen
    s_add_u32 s44, s44, 0
    s_addc_u32 s45, s45, 0
    s_mov_b32 s46, 1152
    s_mov_b32 s47, 0x20000
    s_add_u32 s48, s48, 0
    s_addc_u32 s49, s49, 0
    s_mov_b32 s50, 3981312
    s_mov_b32 s51, 0x20000
    s_add_u32 s56, s56, 0
    s_addc_u32 s57, s57, 0
    s_mov_b32 s58, 4718592
    s_mov_b32 s59, 0x20000
    s_add_u32 s72, s72, 0
    s_addc_u32 s73, s73, 0
    s_mov_b32 s74, 8388608
    s_mov_b32 s75, 0x20000
    s_add_u32 s76, s76, 0
    s_addc_u32 s77, s77, 0
    s_mov_b32 s78, 8388608
    s_mov_b32 s79, 0x20000
    s_cmp_ge_u32 s95, 108
    s_cbranch_scc1 gemv_done
    s_mov_b32 s2, s95
    v_and_b32 v41, 3, v0
    v_lshrrev_b32 v42, 2, v0
    s_lshl_b32 s3, s2, 6
    v_mul_u32_u24 v43, 6912, v42
    v_lshl_add_u32 v43, v41, 4, v43
    v_add_u32 v43, s3, v43
    v_lshlrev_b32 v44, 1, v42
    buffer_load_ushort v45, v44, s[44:47], 0 offen offset:0
    buffer_load_ushort v46, v44, s[44:47], 0 offen offset:288
    buffer_load_ushort v47, v44, s[44:47], 0 offen offset:576
    buffer_load_ushort v48, v44, s[44:47], 0 offen offset:864
    s_mov_b32 s38, 0
    buffer_load_dwordx4 v[64:67], v43, s[48:51], s38 offen
    s_mov_b32 s38, 995328
    buffer_load_dwordx4 v[68:71], v43, s[48:51], s38 offen
    s_mov_b32 s38, 1990656
    buffer_load_dwordx4 v[72:75], v43, s[48:51], s38 offen
    s_mov_b32 s38, 2985984
    buffer_load_dwordx4 v[76:79], v43, s[48:51], s38 offen
    v_mov_b32 v52, 0
    v_mov_b32 v53, 0
    v_mov_b32 v54, 0
    v_mov_b32 v55, 0
    v_mov_b32 v56, 0
    v_mov_b32 v57, 0
    v_mov_b32 v58, 0
    v_mov_b32 v59, 0
    s_waitcnt vmcnt(4)
    v_lshlrev_b32 v45, 16, v45
    v_mul_f32 v50, 0xbfb8aa3b, v45
    v_exp_f32 v50, v50
    s_nop 0
    v_add_f32 v50, 1.0, v50
    v_rcp_f32 v50, v50
    s_nop 0
    v_mul_f32 v50, v50, v45
    v_cvt_pk_bf16_f32 v50, v50, v50
    v_lshlrev_b32 v45, 16, v50
    v_lshlrev_b32 v46, 16, v46
    v_mul_f32 v50, 0xbfb8aa3b, v46
    v_exp_f32 v50, v50
    s_nop 0
    v_add_f32 v50, 1.0, v50
    v_rcp_f32 v50, v50
    s_nop 0
    v_mul_f32 v50, v50, v46
    v_cvt_pk_bf16_f32 v50, v50, v50
    v_lshlrev_b32 v46, 16, v50
    v_lshlrev_b32 v47, 16, v47
    v_mul_f32 v50, 0xbfb8aa3b, v47
    v_exp_f32 v50, v50
    s_nop 0
    v_add_f32 v50, 1.0, v50
    v_rcp_f32 v50, v50
    s_nop 0
    v_mul_f32 v50, v50, v47
    v_cvt_pk_bf16_f32 v50, v50, v50
    v_lshlrev_b32 v47, 16, v50
    v_lshlrev_b32 v48, 16, v48
    v_mul_f32 v50, 0xbfb8aa3b, v48
    v_exp_f32 v50, v50
    s_nop 0
    v_add_f32 v50, 1.0, v50
    v_rcp_f32 v50, v50
    s_nop 0
    v_mul_f32 v50, v50, v48
    v_cvt_pk_bf16_f32 v50, v50, v50
    v_lshlrev_b32 v48, 16, v50
    s_waitcnt vmcnt(3)
    v_lshlrev_b32 v50, 16, v64
    v_and_b32 v51, 0xffff0000, v64
    v_fmac_f32 v52, v50, v45
    v_fmac_f32 v53, v51, v45
    v_lshlrev_b32 v50, 16, v65
    v_and_b32 v51, 0xffff0000, v65
    v_fmac_f32 v54, v50, v45
    v_fmac_f32 v55, v51, v45
    v_lshlrev_b32 v50, 16, v66
    v_and_b32 v51, 0xffff0000, v66
    v_fmac_f32 v56, v50, v45
    v_fmac_f32 v57, v51, v45
    v_lshlrev_b32 v50, 16, v67
    v_and_b32 v51, 0xffff0000, v67
    v_fmac_f32 v58, v50, v45
    v_fmac_f32 v59, v51, v45
    s_waitcnt vmcnt(2)
    v_lshlrev_b32 v50, 16, v68
    v_and_b32 v51, 0xffff0000, v68
    v_fmac_f32 v52, v50, v46
    v_fmac_f32 v53, v51, v46
    v_lshlrev_b32 v50, 16, v69
    v_and_b32 v51, 0xffff0000, v69
    v_fmac_f32 v54, v50, v46
    v_fmac_f32 v55, v51, v46
    v_lshlrev_b32 v50, 16, v70
    v_and_b32 v51, 0xffff0000, v70
    v_fmac_f32 v56, v50, v46
    v_fmac_f32 v57, v51, v46
    v_lshlrev_b32 v50, 16, v71
    v_and_b32 v51, 0xffff0000, v71
    v_fmac_f32 v58, v50, v46
    v_fmac_f32 v59, v51, v46
    s_waitcnt vmcnt(1)
    v_lshlrev_b32 v50, 16, v72
    v_and_b32 v51, 0xffff0000, v72
    v_fmac_f32 v52, v50, v47
    v_fmac_f32 v53, v51, v47
    v_lshlrev_b32 v50, 16, v73
    v_and_b32 v51, 0xffff0000, v73
    v_fmac_f32 v54, v50, v47
    v_fmac_f32 v55, v51, v47
    v_lshlrev_b32 v50, 16, v74
    v_and_b32 v51, 0xffff0000, v74
    v_fmac_f32 v56, v50, v47
    v_fmac_f32 v57, v51, v47
    v_lshlrev_b32 v50, 16, v75
    v_and_b32 v51, 0xffff0000, v75
    v_fmac_f32 v58, v50, v47
    v_fmac_f32 v59, v51, v47
    s_waitcnt vmcnt(0)
    v_lshlrev_b32 v50, 16, v76
    v_and_b32 v51, 0xffff0000, v76
    v_fmac_f32 v52, v50, v48
    v_fmac_f32 v53, v51, v48
    v_lshlrev_b32 v50, 16, v77
    v_and_b32 v51, 0xffff0000, v77
    v_fmac_f32 v54, v50, v48
    v_fmac_f32 v55, v51, v48
    v_lshlrev_b32 v50, 16, v78
    v_and_b32 v51, 0xffff0000, v78
    v_fmac_f32 v56, v50, v48
    v_fmac_f32 v57, v51, v48
    v_lshlrev_b32 v50, 16, v79
    v_and_b32 v51, 0xffff0000, v79
    v_fmac_f32 v58, v50, v48
    v_fmac_f32 v59, v51, v48
    v_lshlrev_b32 v41, 5, v0
    ds_write_b128 v41, v[52:55] offset:2048
    ds_write_b128 v41, v[56:59] offset:2064
    s_waitcnt lgkmcnt(0)
    s_barrier
    v_and_b32 v42, 31, v0
    v_lshrrev_b32 v43, 5, v0
    v_lshrrev_b32 v44, 3, v42
    v_and_b32 v45, 7, v42
    v_lshlrev_b32 v44, 5, v44
    v_lshl_add_u32 v44, v45, 2, v44
    v_lshl_add_u32 v44, v43, 10, v44
    ds_read_b32 v64, v44 offset:2048
    ds_read_b32 v65, v44 offset:2176
    ds_read_b32 v66, v44 offset:2304
    ds_read_b32 v67, v44 offset:2432
    ds_read_b32 v68, v44 offset:2560
    ds_read_b32 v69, v44 offset:2688
    ds_read_b32 v70, v44 offset:2816
    ds_read_b32 v71, v44 offset:2944
    s_waitcnt lgkmcnt(0)
    v_add_f32 v64, v64, v65
    v_add_f32 v64, v64, v66
    v_add_f32 v64, v64, v67
    v_add_f32 v64, v64, v68
    v_add_f32 v64, v64, v69
    v_add_f32 v64, v64, v70
    v_add_f32 v64, v64, v71
    v_lshlrev_b32 v46, 2, v0
    ds_write_b32 v46, v64 offset:20480
    s_waitcnt lgkmcnt(0)
    s_barrier
    v_lshlrev_b32 v46, 2, v42
    ds_read_b32 v50, v46 offset:20480
    ds_read_b32 v51, v46 offset:20608
    ds_read_b32 v52, v46 offset:20736
    ds_read_b32 v53, v46 offset:20864
    ds_read_b32 v54, v46 offset:20992
    ds_read_b32 v55, v46 offset:21120
    ds_read_b32 v56, v46 offset:21248
    ds_read_b32 v57, v46 offset:21376
    ds_read_b32 v58, v46 offset:21504
    ds_read_b32 v59, v46 offset:21632
    ds_read_b32 v60, v46 offset:21760
    ds_read_b32 v61, v46 offset:21888
    ds_read_b32 v62, v46 offset:22016
    ds_read_b32 v63, v46 offset:22144
    ds_read_b32 v64, v46 offset:22272
    ds_read_b32 v65, v46 offset:22400
    ds_read_b32 v66, v46 offset:22528
    ds_read_b32 v67, v46 offset:22656
    s_waitcnt lgkmcnt(0)
    v_add_f32 v50, v50, v51
    v_add_f32 v50, v50, v52
    v_add_f32 v50, v50, v53
    v_add_f32 v50, v50, v54
    v_add_f32 v50, v50, v55
    v_add_f32 v50, v50, v56
    v_add_f32 v50, v50, v57
    v_add_f32 v50, v50, v58
    v_add_f32 v50, v50, v59
    v_add_f32 v50, v50, v60
    v_add_f32 v50, v50, v61
    v_add_f32 v50, v50, v62
    v_add_f32 v50, v50, v63
    v_add_f32 v50, v50, v64
    v_add_f32 v50, v50, v65
    v_add_f32 v50, v50, v66
    v_add_f32 v50, v50, v67
    v_cvt_pk_bf16_f32 v64, v50, v50
    v_lshlrev_b32 v64, 16, v64
    s_lshl_b32 s3, s2, 7
    v_add_u32 v46, s3, v46
    v_cmp_gt_u32 vcc, 32, v0
    s_and_saveexec_b64 s[40:41], vcc
    s_cbranch_execz gemv_skip
    buffer_store_dword v64, v46, s[16:19], 0 offen
    s_waitcnt vmcnt(0)
gemv_skip:
    s_endpgm
gemv_done:
    s_waitcnt vmcnt(0)
    v_lshlrev_b32 v20, 16, v16
    v_and_b32 v21, 0xffff0000, v16
    v_lshlrev_b32 v22, 16, v17
    v_and_b32 v23, 0xffff0000, v17
    v_lshlrev_b32 v24, 16, v18
    v_and_b32 v25, 0xffff0000, v18
    v_lshlrev_b32 v26, 16, v19
    v_and_b32 v27, 0xffff0000, v19
    v_add_f32 v32, v20, v21
    v_add_f32 v32, v32, v22
    v_add_f32 v32, v32, v23
    v_add_f32 v32, v32, v24
    v_add_f32 v32, v32, v25
    v_add_f32 v32, v32, v26
    v_add_f32 v32, v32, v27
    s_nop 1
    v_add_f32_dpp v32, v32, v32 row_ror:8 row_mask:0xf bank_mask:0xf
    ds_swizzle_b32 v36, v32 offset:0x401F
    s_waitcnt lgkmcnt(0)
    v_add_f32 v32, v32, v36
    v_mov_b32 v36, v32
    s_nop 1
    v_permlane32_swap_b32 v32, v36
    s_nop 1
    v_add_f32 v32, v32, v36
    ds_write_b32 v10, v32 offset:0
    s_waitcnt lgkmcnt(0)
    s_barrier
    ds_read_b32 v36, v11 offset:0
    ds_read_b32 v37, v11 offset:32
    ds_read_b32 v38, v11 offset:64
    ds_read_b32 v39, v11 offset:96
    ds_read_b32 v40, v11 offset:128
    ds_read_b32 v41, v11 offset:160
    ds_read_b32 v42, v11 offset:192
    ds_read_b32 v43, v11 offset:224
    ds_read_b32 v44, v11 offset:256
    s_waitcnt lgkmcnt(0)
    v_add_f32 v36, v36, v37
    v_add_f32 v36, v36, v38
    v_add_f32 v36, v36, v39
    v_add_f32 v36, v36, v40
    v_add_f32 v36, v36, v41
    v_add_f32 v36, v36, v42
    v_add_f32 v36, v36, v43
    v_add_f32 v36, v36, v44
    v_mov_b32 v32, v36
    v_mul_f32 v32, 0x3ae38e39, v32
    v_sub_f32 v20, v20, v32
    v_sub_f32 v21, v21, v32
    v_sub_f32 v22, v22, v32
    v_sub_f32 v23, v23, v32
    v_sub_f32 v24, v24, v32
    v_sub_f32 v25, v25, v32
    v_sub_f32 v26, v26, v32
    v_sub_f32 v27, v27, v32
    v_mul_f32 v33, v20, v20
    v_fmac_f32 v33, v21, v21
    v_fmac_f32 v33, v22, v22
    v_fmac_f32 v33, v23, v23
    v_fmac_f32 v33, v24, v24
    v_fmac_f32 v33, v25, v25
    v_fmac_f32 v33, v26, v26
    v_fmac_f32 v33, v27, v27
    s_nop 1
    v_add_f32_dpp v33, v33, v33 row_ror:8 row_mask:0xf bank_mask:0xf
    ds_swizzle_b32 v36, v33 offset:0x401F
    s_waitcnt lgkmcnt(0)
    v_add_f32 v33, v33, v36
    v_mov_b32 v36, v33
    s_nop 1
    v_permlane32_swap_b32 v33, v36
    s_nop 1
    v_add_f32 v33, v33, v36
    ds_write_b32 v10, v33 offset:512
    s_waitcnt lgkmcnt(0)
    s_barrier
    ds_read_b32 v36, v11 offset:512
    ds_read_b32 v37, v11 offset:544
    ds_read_b32 v38, v11 offset:576
    ds_read_b32 v39, v11 offset:608
    ds_read_b32 v40, v11 offset:640
    ds_read_b32 v41, v11 offset:672
    ds_read_b32 v42, v11 offset:704
    ds_read_b32 v43, v11 offset:736
    ds_read_b32 v44, v11 offset:768
    s_waitcnt lgkmcnt(0)
    v_add_f32 v36, v36, v37
    v_add_f32 v36, v36, v38
    v_add_f32 v36, v36, v39
    v_add_f32 v36, v36, v40
    v_add_f32 v36, v36, v41
    v_add_f32 v36, v36, v42
    v_add_f32 v36, v36, v43
    v_add_f32 v36, v36, v44
    v_mov_b32 v33, v36
    v_mov_b32 v34, 0x3727c5ac
    v_fmac_f32 v34, 0x3ae38e39, v33
    v_rsq_f32 v34, v34
    s_nop 0
    v_mul_f32 v20, v20, v34
    v_mul_f32 v21, v21, v34
    v_mul_f32 v22, v22, v34
    v_mul_f32 v23, v23, v34
    v_mul_f32 v24, v24, v34
    v_mul_f32 v25, v25, v34
    v_mul_f32 v26, v26, v34
    v_mul_f32 v27, v27, v34
    v_cvt_pk_bf16_f32 v36, v20, v21
    v_cvt_pk_bf16_f32 v37, v22, v23
    v_cvt_pk_bf16_f32 v38, v24, v25
    v_cvt_pk_bf16_f32 v39, v26, v27
    buffer_store_dwordx4 v[36:39], v14, s[28:31], 0 offen sc1
    s_mov_b32 s40, s94
k1_ln_kernel_end:
    s_endpgm
.section .rodata,"a"
.p2align 6
.amdhsa_kernel k1_ln_kernel
  .amdhsa_next_free_vgpr 80
  .amdhsa_next_free_sgpr 96
  .amdhsa_accum_offset 80
  .amdhsa_group_segment_fixed_size 0
  .amdhsa_kernarg_size 112
  .amdhsa_user_sgpr_count 2
  .amdhsa_user_sgpr_kernarg_segment_ptr 1
  .amdhsa_system_sgpr_workgroup_id_x 1
.end_amdhsa_kernel
.text
.globl k2_attn_kernel
.p2align 8
.type k2_attn_kernel,@function
k2_attn_kernel:
    s_cmp_ge_u32 s2, 256
    s_cbranch_scc1 k2_attn_kernel_end
    s_load_dwordx2 s[4:5], s[0:1], 8
    s_load_dwordx2 s[6:7], s[0:1], 16
    s_load_dwordx2 s[8:9], s[0:1], 24
    s_load_dwordx2 s[10:11], s[0:1], 104
    v_and_b32 v1, 63, v0
    v_lshrrev_b32 v6, 6, v0
    s_nop 0
    v_readfirstlane_b32 s40, v6
    v_lshrrev_b32 v2, 5, v1
    v_bfe_u32 v3, v1, 2, 2
    v_bfe_u32 v4, v1, 4, 1
    v_and_b32 v5, 1, v1
    v_lshlrev_b32 v5, 4, v5
    v_bfe_u32 v6, v1, 1, 1
    v_lshl_add_u32 v5, v6, 3, v5
    s_and_b32 s12, s2, 7
    s_lshl_b32 s12, s12, 1
    s_bfe_u32 s13, s2, 0x10003
    s_add_u32 s12, s12, s13
    s_lshr_b32 s13, s2, 4
    s_lshl_b32 s14, s13, 2
    s_add_u32 s14, s14, s40
    s_lshl_b32 s15, s12, 19
    s_sub_u32 s16, 8388608, s15
    s_lshl_b32 s17, s12, 9
    s_and_b32 s18, s40, 1
    s_lshr_b32 s19, s40, 1
    s_lshl_b32 s19, s19, 2
    s_add_u32 s18, s18, s19
    s_lshl_b32 s41, s18, 10
    s_mov_b32 s44, 0x67800000
    v_and_b32 v6, 31, v1
    v_and_b32 v7, 15, v1
    v_xor_b32 v7, v7, v2
    v_lshlrev_b32 v8, 8, v6
    v_xor_b32 v9, 0, v7
    v_lshl_add_u32 v144, v9, 4, v8
    v_xor_b32 v9, 2, v7
    v_lshl_add_u32 v145, v9, 4, v8
    v_xor_b32 v9, 4, v7
    v_lshl_add_u32 v146, v9, 4, v8
    v_xor_b32 v9, 6, v7
    v_lshl_add_u32 v147, v9, 4, v8
    v_xor_b32 v9, 8, v7
    v_lshl_add_u32 v148, v9, 4, v8
    v_xor_b32 v9, 10, v7
    v_lshl_add_u32 v149, v9, 4, v8
    v_xor_b32 v9, 12, v7
    v_lshl_add_u32 v150, v9, 4, v8
    v_xor_b32 v9, 14, v7
    v_lshl_add_u32 v151, v9, 4, v8
    v_lshl_add_u32 v6, v2, 2, v3
    v_lshlrev_b32 v6, 8, v6
    v_lshl_add_u32 v6, v4, 5, v6
    v_add_u32 v6, v6, v5
    v_add_u32 v6, 32768, v6
    v_xor_b32 v9, 0, v3
    v_lshl_add_u32 v152, v9, 6, v6
    v_xor_b32 v9, 1, v3
    v_lshl_add_u32 v153, v9, 6, v6
    v_xor_b32 v9, 2, v3
    v_lshl_add_u32 v154, v9, 6, v6
    v_xor_b32 v9, 3, v3
    v_lshl_add_u32 v155, v9, 6, v6
    v_lshrrev_b32 v6, 4, v1
    v_and_b32 v7, 15, v1
    s_add_u32 s19, s18, 0
    s_lshl_b32 s19, s19, 2
    v_add_u32 v8, s19, v6
    v_and_b32 v9, 15, v8
    v_xor_b32 v9, v9, v7
    v_lshlrev_b32 v9, 4, v9
    v_lshl_add_u32 v156, v8, 8, v9
    s_add_u32 s19, s18, 2
    s_lshl_b32 s19, s19, 2
    v_add_u32 v8, s19, v6
    v_and_b32 v9, 15, v8
    v_xor_b32 v9, v9, v7
    v_lshlrev_b32 v9, 4, v9
    v_lshl_add_u32 v157, v8, 8, v9
    v_subrev_u32 v157, 2048, v157
    s_lshl_b32 s19, s18, 2
    v_add_u32 v8, s19, v6
    v_lshlrev_b32 v9, 2, v6
    v_xor_b32 v9, v9, v7
    v_lshlrev_b32 v9, 4, v9
    v_lshl_add_u32 v158, v8, 8, v9
    v_lshrrev_b32 v6, 5, v1
    s_lshl_b32 s19, s40, 1
    v_add_u32 v6, s19, v6
    v_and_b32 v7, 3, v6
    v_lshlrev_b32 v7, 2, v7
    v_and_b32 v8, 31, v1
    v_xor_b32 v7, v7, v8
    v_lshlrev_b32 v7, 4, v7
    v_lshlrev_b32 v6, 13, v6
    v_add3_u32 v159, v6, v7, s17
    s_lshl_b32 s45, s40, 10
    v_lshl_add_u32 v6, v2, 3, v3
    v_lshlrev_b32 v6, 9, v6
    v_lshl_add_u32 v6, v4, 5, v6
    v_add_u32 v6, v6, v5
    v_add_u32 v6, 65536, v6
    v_xor_b32 v9, 0, v3
    v_lshl_add_u32 v188, v9, 6, v6
    v_add_u32 v192, 49152, v188
    v_xor_b32 v9, 1, v3
    v_lshl_add_u32 v189, v9, 6, v6
    v_add_u32 v193, 49152, v189
    v_xor_b32 v9, 2, v3
    v_lshl_add_u32 v190, v9, 6, v6
    v_add_u32 v194, 49152, v190
    v_xor_b32 v9, 3, v3
    v_lshl_add_u32 v191, v9, 6, v6
    v_add_u32 v195, 49152, v191
    s_mul_i32 s19, s14, 36864
    v_lshlrev_b32 v160, 4, v1
    v_add_u32 v160, s19, v160
    v_lshlrev_b32 v161, 4, v1
    v_mov_b32 v253, v0
    v_lshlrev_b32 v252, 5, v2
    v_add_u32 v252, 49152, v252
    s_waitcnt lgkmcnt(0)
    s_add_u32 s52, s10, 0
    s_addc_u32 s53, s11, 0
    s_mov_b32 s54, 4608
    s_mov_b32 s55, 0x20000
    s_add_u32 s20, s4, s15
    s_addc_u32 s21, s5, 0
    s_mov_b32 s22, s16
    s_mov_b32 s23, 0x20000
    s_add_u32 s24, s6, s15
    s_addc_u32 s25, s7, 0
    s_mov_b32 s26, s16
    s_mov_b32 s27, 0x20000
    s_add_u32 s28, s8, 0
    s_addc_u32 s29, s9, 0
    s_mov_b32 s30, 4718592
    s_mov_b32 s31, 0x20000
    s_add_u32 s32, s10, 65536
    s_addc_u32 s33, s11, 0
    s_mov_b32 s34, 2359296
    s_mov_b32 s35, 0x20000
    s_add_u32 s36, s10, 16777216
    s_addc_u32 s37, s11, 0
    s_mov_b32 s38, 16777216
    s_mov_b32 s39, 0x20000
    v_lshlrev_b32 v254, 4, v253
    buffer_load_dwordx4 v[228:231], v254, s[52:55], 0 offen
    buffer_load_dwordx4 v[232:235], v254, s[52:55], 0 offen offset:2304
    s_add_u32 m0, s45, 65536
    s_mov_b32 s46, 0
    buffer_load_dwordx4 v159, s[28:31], s46 offen lds
    s_add_u32 m0, s45, 69632
    s_mov_b32 s46, 65536
    buffer_load_dwordx4 v159, s[28:31], s46 offen lds
    s_add_u32 m0, s45, 73728
    s_mov_b32 s46, 131072
    buffer_load_dwordx4 v159, s[28:31], s46 offen lds
    s_add_u32 m0, s45, 77824
    s_mov_b32 s46, 196608
    buffer_load_dwordx4 v159, s[28:31], s46 offen lds
    s_mov_b32 s47, 0
    buffer_load_dwordx4 v[0:3], v160, s[32:35], s47 offen offset:0
    s_mov_b32 s47, 0
    buffer_load_dwordx4 v[4:7], v160, s[32:35], s47 offen offset:1024
    s_add_u32 m0, s45, 81920
    s_mov_b32 s46, 262144
    buffer_load_dwordx4 v159, s[28:31], s46 offen lds
    s_add_u32 m0, s45, 86016
    s_mov_b32 s46, 327680
    buffer_load_dwordx4 v159, s[28:31], s46 offen lds
    s_add_u32 m0, s45, 90112
    s_mov_b32 s46, 393216
    buffer_load_dwordx4 v159, s[28:31], s46 offen lds
    s_add_u32 m0, s45, 94208
    s_mov_b32 s46, 458752
    buffer_load_dwordx4 v159, s[28:31], s46 offen lds
    s_mov_b32 s47, 0
    buffer_load_dwordx4 v[8:11], v160, s[32:35], s47 offen offset:2048
    s_mov_b32 s47, 0
    buffer_load_dwordx4 v[12:15], v160, s[32:35], s47 offen offset:3072
    s_add_u32 m0, s45, 98304
    s_mov_b32 s46, 524288
    buffer_load_dwordx4 v159, s[28:31], s46 offen lds
    s_add_u32 m0, s45, 102400
    s_mov_b32 s46, 589824
    buffer_load_dwordx4 v159, s[28:31], s46 offen lds
    s_add_u32 m0, s45, 106496
    s_mov_b32 s46, 655360
    buffer_load_dwordx4 v159, s[28:31], s46 offen lds
    s_add_u32 m0, s45, 110592
    s_mov_b32 s46, 720896
    buffer_load_dwordx4 v159, s[28:31], s46 offen lds
    s_mov_b32 s47, 4096
    buffer_load_dwordx4 v[16:19], v160, s[32:35], s47 offen offset:0
    s_mov_b32 s47, 4096
    buffer_load_dwordx4 v[20:23], v160, s[32:35], s47 offen offset:1024
    v_cmp_gt_u32 vcc, 144, v253
    s_and_saveexec_b64 s[50:51], vcc
    s_waitcnt vmcnt(18)
    s_cbranch_execz att_tb_done
    v_add_f32 v232, 1.0, v232
    v_add_f32 v233, 1.0, v233
    v_add_f32 v234, 1.0, v234
    v_add_f32 v235, 1.0, v235
    v_cvt_pk_bf16_f32 v236, v232, v233
    v_cvt_pk_bf16_f32 v237, v234, v235
    v_lshlrev_b32 v232, 16, v236
    v_and_b32 v233, 0xffff0000, v236
    v_lshlrev_b32 v234, 16, v237
    v_and_b32 v235, 0xffff0000, v237
    v_lshlrev_b32 v254, 4, v253
    v_add_u32 v254, 49152, v254
    ds_write_b128 v254, v[232:235]
    ds_write_b128 v254, v[228:231] offset:2304
att_tb_done:
    s_mov_b64 exec, s[50:51]
    s_waitcnt lgkmcnt(0)
    s_barrier
    ds_read_b128 v[228:231], v252 offset:0
    ds_read_b128 v[232:235], v252 offset:16
    ds_read_b128 v[236:239], v252 offset:2304
    ds_read_b128 v[240:243], v252 offset:2320
    s_waitcnt vmcnt(13)
    v_lshlrev_b32 v244, 16, v0
    v_and_b32 v245, 0xffff0000, v0
    v_lshlrev_b32 v246, 16, v1
    v_and_b32 v247, 0xffff0000, v1
    v_lshlrev_b32 v248, 16, v2
    v_and_b32 v249, 0xffff0000, v2
    v_lshlrev_b32 v250, 16, v3
    v_and_b32 v251, 0xffff0000, v3
    s_waitcnt lgkmcnt(0)
    v_fma_f32 v244, v244, v228, v236
    v_fma_f32 v245, v245, v229, v237
    v_fma_f32 v246, v246, v230, v238
    v_fma_f32 v247, v247, v231, v239
    v_fma_f32 v248, v248, v232, v240
    v_fma_f32 v249, v249, v233, v241
    v_fma_f32 v250, v250, v234, v242
    v_fma_f32 v251, v251, v235, v243
    v_cvt_pk_bf16_f32 v0, v244, v245
    v_cvt_pk_bf16_f32 v1, v246, v247
    v_cvt_pk_bf16_f32 v2, v248, v249
    v_cvt_pk_bf16_f32 v3, v250, v251
    s_nop 1
    s_barrier
    ds_read_b64_tr_b16 v[196:197], v188 offset:0
    ds_read_b64_tr_b16 v[198:199], v188 offset:2048
    ds_read_b64_tr_b16 v[200:201], v189 offset:0
    ds_read_b64_tr_b16 v[202:203], v189 offset:2048
    ds_read_b64_tr_b16 v[204:205], v190 offset:0
    ds_read_b64_tr_b16 v[206:207], v190 offset:2048
    ds_read_b64_tr_b16 v[208:209], v191 offset:0
    ds_read_b64_tr_b16 v[210:211], v191 offset:2048
    ds_read_b64_tr_b16 v[212:213], v188 offset:256
    ds_read_b64_tr_b16 v[214:215], v188 offset:2304
    ds_read_b64_tr_b16 v[216:217], v189 offset:256
    ds_read_b64_tr_b16 v[218:219], v189 offset:2304
    s_add_u32 m0, s45, 114688
    s_mov_b32 s46, 786432
    buffer_load_dwordx4 v159, s[28:31], s46 offen lds
    ds_read_b128 v[228:231], v252 offset:64
    ds_read_b128 v[232:235], v252 offset:80
    ds_read_b128 v[236:239], v252 offset:2368
    ds_read_b128 v[240:243], v252 offset:2384
    s_waitcnt vmcnt(13)
    s_waitcnt lgkmcnt(14)
    v_mfma_f32_32x32x16_bf16 a[0:15], v[196:199], v[0:3], 0
    ds_read_b64_tr_b16 v[220:221], v190 offset:256
    ds_read_b64_tr_b16 v[222:223], v190 offset:2304
    s_add_u32 m0, s45, 118784
    s_mov_b32 s46, 851968
    buffer_load_dwordx4 v159, s[28:31], s46 offen lds
    s_waitcnt lgkmcnt(14)
    v_mfma_f32_32x32x16_bf16 a[16:31], v[200:203], v[0:3], 0
    ds_read_b64_tr_b16 v[224:225], v191 offset:256
    ds_read_b64_tr_b16 v[226:227], v191 offset:2304
    s_add_u32 m0, s45, 122880
    s_mov_b32 s46, 917504
    buffer_load_dwordx4 v159, s[28:31], s46 offen lds
    v_lshlrev_b32 v244, 16, v4
    v_and_b32 v245, 0xffff0000, v4
    v_lshlrev_b32 v246, 16, v5
    v_and_b32 v247, 0xffff0000, v5
    v_lshlrev_b32 v248, 16, v6
    v_and_b32 v249, 0xffff0000, v6
    v_lshlrev_b32 v250, 16, v7
    v_and_b32 v251, 0xffff0000, v7
    s_waitcnt lgkmcnt(14)
    v_mfma_f32_32x32x16_bf16 a[32:47], v[204:207], v[0:3], 0
    ds_read_b64_tr_b16 v[196:197], v188 offset:8192
    ds_read_b64_tr_b16 v[198:199], v188 offset:10240
    s_add_u32 m0, s45, 126976
    s_mov_b32 s46, 983040
    buffer_load_dwordx4 v159, s[28:31], s46 offen lds
    s_waitcnt lgkmcnt(14)
    v_mfma_f32_32x32x16_bf16 a[48:63], v[208:211], v[0:3], 0
    ds_read_b64_tr_b16 v[200:201], v189 offset:8192
    ds_read_b64_tr_b16 v[202:203], v189 offset:10240
    s_mov_b32 s47, 4096
    buffer_load_dwordx4 v[24:27], v160, s[32:35], s47 offen offset:2048
    s_waitcnt lgkmcnt(8)
    v_fma_f32 v244, v244, v228, v236
    v_fma_f32 v245, v245, v229, v237
    v_fma_f32 v246, v246, v230, v238
    v_fma_f32 v247, v247, v231, v239
    v_fma_f32 v248, v248, v232, v240
    v_fma_f32 v249, v249, v233, v241
    v_fma_f32 v250, v250, v234, v242
    v_fma_f32 v251, v251, v235, v243
    v_mfma_f32_32x32x16_bf16 a[64:79], v[212:215], v[0:3], 0
    ds_read_b64_tr_b16 v[204:205], v190 offset:8192
    ds_read_b64_tr_b16 v[206:207], v190 offset:10240
    s_mov_b32 s47, 4096
    buffer_load_dwordx4 v[28:31], v160, s[32:35], s47 offen offset:3072
    v_mfma_f32_32x32x16_bf16 a[80:95], v[216:219], v[0:3], 0
    ds_read_b64_tr_b16 v[208:209], v191 offset:8192
    ds_read_b64_tr_b16 v[210:211], v191 offset:10240
    s_mov_b32 s47, 8192
    buffer_load_dwordx4 v[32:35], v160, s[32:35], s47 offen offset:0
    v_cvt_pk_bf16_f32 v4, v244, v245
    v_cvt_pk_bf16_f32 v5, v246, v247
    v_cvt_pk_bf16_f32 v6, v248, v249
    v_cvt_pk_bf16_f32 v7, v250, v251
    s_waitcnt lgkmcnt(10)
    v_mfma_f32_32x32x16_bf16 a[96:111], v[220:223], v[0:3], 0
    ds_read_b64_tr_b16 v[212:213], v188 offset:8448
    ds_read_b64_tr_b16 v[214:215], v188 offset:10496
    s_mov_b32 s47, 8192
    buffer_load_dwordx4 v[36:39], v160, s[32:35], s47 offen offset:1024
    s_waitcnt lgkmcnt(10)
    v_mfma_f32_32x32x16_bf16 a[112:127], v[224:227], v[0:3], 0
    ds_read_b64_tr_b16 v[216:217], v189 offset:8448
    ds_read_b64_tr_b16 v[218:219], v189 offset:10496
    s_mov_b32 s47, 8192
    buffer_load_dwordx4 v[40:43], v160, s[32:35], s47 offen offset:2048
    ds_read_b128 v[228:231], v252 offset:128
    ds_read_b128 v[232:235], v252 offset:144
    ds_read_b128 v[236:239], v252 offset:2432
    ds_read_b128 v[240:243], v252 offset:2448
    s_waitcnt vmcnt(16)
    s_waitcnt lgkmcnt(14)
    v_mfma_f32_32x32x16_bf16 a[0:15], v[196:199], v[4:7], a[0:15]
    ds_read_b64_tr_b16 v[220:221], v190 offset:8448
    ds_read_b64_tr_b16 v[222:223], v190 offset:10496
    s_mov_b32 s47, 8192
    buffer_load_dwordx4 v[44:47], v160, s[32:35], s47 offen offset:3072
    s_waitcnt lgkmcnt(14)
    v_mfma_f32_32x32x16_bf16 a[16:31], v[200:203], v[4:7], a[16:31]
    ds_read_b64_tr_b16 v[224:225], v191 offset:8448
    ds_read_b64_tr_b16 v[226:227], v191 offset:10496
    s_mov_b32 s47, 12288
    buffer_load_dwordx4 v[48:51], v160, s[32:35], s47 offen offset:0
    v_lshlrev_b32 v244, 16, v8
    v_and_b32 v245, 0xffff0000, v8
    v_lshlrev_b32 v246, 16, v9
    v_and_b32 v247, 0xffff0000, v9
    v_lshlrev_b32 v248, 16, v10
    v_and_b32 v249, 0xffff0000, v10
    v_lshlrev_b32 v250, 16, v11
    v_and_b32 v251, 0xffff0000, v11
    s_waitcnt lgkmcnt(14)
    v_mfma_f32_32x32x16_bf16 a[32:47], v[204:207], v[4:7], a[32:47]
    s_barrier
    ds_read_b64_tr_b16 v[196:197], v188 offset:16384
    ds_read_b64_tr_b16 v[198:199], v188 offset:18432
    s_mov_b32 s47, 12288
    buffer_load_dwordx4 v[52:55], v160, s[32:35], s47 offen offset:1024
    s_waitcnt lgkmcnt(14)
    v_mfma_f32_32x32x16_bf16 a[48:63], v[208:211], v[4:7], a[48:63]
    ds_read_b64_tr_b16 v[200:201], v189 offset:16384
    ds_read_b64_tr_b16 v[202:203], v189 offset:18432
    s_mov_b32 s47, 12288
    buffer_load_dwordx4 v[56:59], v160, s[32:35], s47 offen offset:2048
    s_waitcnt lgkmcnt(8)
    v_fma_f32 v244, v244, v228, v236
    v_fma_f32 v245, v245, v229, v237
    v_fma_f32 v246, v246, v230, v238
    v_fma_f32 v247, v247, v231, v239
    v_fma_f32 v248, v248, v232, v240
    v_fma_f32 v249, v249, v233, v241
    v_fma_f32 v250, v250, v234, v242
    v_fma_f32 v251, v251, v235, v243
    v_mfma_f32_32x32x16_bf16 a[64:79], v[212:215], v[4:7], a[64:79]
    ds_read_b64_tr_b16 v[204:205], v190 offset:16384
    ds_read_b64_tr_b16 v[206:207], v190 offset:18432
    s_mov_b32 s47, 12288
    buffer_load_dwordx4 v[60:63], v160, s[32:35], s47 offen offset:3072
    v_mfma_f32_32x32x16_bf16 a[80:95], v[216:219], v[4:7], a[80:95]
    ds_read_b64_tr_b16 v[208:209], v191 offset:16384
    ds_read_b64_tr_b16 v[210:211], v191 offset:18432
    s_mov_b32 s47, 16384
    buffer_load_dwordx4 v[64:67], v160, s[32:35], s47 offen offset:0
    v_cvt_pk_bf16_f32 v8, v244, v245
    v_cvt_pk_bf16_f32 v9, v246, v247
    v_cvt_pk_bf16_f32 v10, v248, v249
    v_cvt_pk_bf16_f32 v11, v250, v251
    s_waitcnt lgkmcnt(10)
    v_mfma_f32_32x32x16_bf16 a[96:111], v[220:223], v[4:7], a[96:111]
    ds_read_b64_tr_b16 v[212:213], v188 offset:16640
    ds_read_b64_tr_b16 v[214:215], v188 offset:18688
    s_mov_b32 s47, 16384
    buffer_load_dwordx4 v[68:71], v160, s[32:35], s47 offen offset:1024
    s_waitcnt lgkmcnt(10)
    v_mfma_f32_32x32x16_bf16 a[112:127], v[224:227], v[4:7], a[112:127]
    ds_read_b64_tr_b16 v[216:217], v189 offset:16640
    ds_read_b64_tr_b16 v[218:219], v189 offset:18688
    s_mov_b32 s47, 16384
    buffer_load_dwordx4 v[72:75], v160, s[32:35], s47 offen offset:2048
    ds_read_b128 v[228:231], v252 offset:192
    ds_read_b128 v[232:235], v252 offset:208
    ds_read_b128 v[236:239], v252 offset:2496
    ds_read_b128 v[240:243], v252 offset:2512
    s_waitcnt vmcnt(23)
    s_waitcnt lgkmcnt(14)
    v_mfma_f32_32x32x16_bf16 a[0:15], v[196:199], v[8:11], a[0:15]
    ds_read_b64_tr_b16 v[220:221], v190 offset:16640
    ds_read_b64_tr_b16 v[222:223], v190 offset:18688
    s_mov_b32 s47, 16384
    buffer_load_dwordx4 v[76:79], v160, s[32:35], s47 offen offset:3072
    s_waitcnt lgkmcnt(14)
    v_mfma_f32_32x32x16_bf16 a[16:31], v[200:203], v[8:11], a[16:31]
    ds_read_b64_tr_b16 v[224:225], v191 offset:16640
    ds_read_b64_tr_b16 v[226:227], v191 offset:18688
    s_mov_b32 s47, 20480
    buffer_load_dwordx4 v[80:83], v160, s[32:35], s47 offen offset:0
    v_lshlrev_b32 v244, 16, v12
    v_and_b32 v245, 0xffff0000, v12
    v_lshlrev_b32 v246, 16, v13
    v_and_b32 v247, 0xffff0000, v13
    v_lshlrev_b32 v248, 16, v14
    v_and_b32 v249, 0xffff0000, v14
    v_lshlrev_b32 v250, 16, v15
    v_and_b32 v251, 0xffff0000, v15
    s_waitcnt lgkmcnt(14)
    v_mfma_f32_32x32x16_bf16 a[32:47], v[204:207], v[8:11], a[32:47]
    ds_read_b64_tr_b16 v[196:197], v188 offset:24576
    ds_read_b64_tr_b16 v[198:199], v188 offset:26624
    s_mov_b32 s47, 20480
    buffer_load_dwordx4 v[84:87], v160, s[32:35], s47 offen offset:1024
    s_waitcnt lgkmcnt(14)
    v_mfma_f32_32x32x16_bf16 a[48:63], v[208:211], v[8:11], a[48:63]
    ds_read_b64_tr_b16 v[200:201], v189 offset:24576
    ds_read_b64_tr_b16 v[202:203], v189 offset:26624
    s_mov_b32 s47, 20480
    buffer_load_dwordx4 v[88:91], v160, s[32:35], s47 offen offset:2048
    s_waitcnt lgkmcnt(8)
    v_fma_f32 v244, v244, v228, v236
    v_fma_f32 v245, v245, v229, v237
    v_fma_f32 v246, v246, v230, v238
    v_fma_f32 v247, v247, v231, v239
    v_fma_f32 v248, v248, v232, v240
    v_fma_f32 v249, v249, v233, v241
    v_fma_f32 v250, v250, v234, v242
    v_fma_f32 v251, v251, v235, v243
    v_mfma_f32_32x32x16_bf16 a[64:79], v[212:215], v[8:11], a[64:79]
    ds_read_b64_tr_b16 v[204:205], v190 offset:24576
    ds_read_b64_tr_b16 v[206:207], v190 offset:26624
    s_mov_b32 s47, 20480
    buffer_load_dwordx4 v[92:95], v160, s[32:35], s47 offen offset:3072
    v_mfma_f32_32x32x16_bf16 a[80:95], v[216:219], v[8:11], a[80:95]
    ds_read_b64_tr_b16 v[208:209], v191 offset:24576
    ds_read_b64_tr_b16 v[210:211], v191 offset:26624
    s_mov_b32 s47, 24576
    buffer_load_dwordx4 v[96:99], v160, s[32:35], s47 offen offset:0
    v_cvt_pk_bf16_f32 v12, v244, v245
    v_cvt_pk_bf16_f32 v13, v246, v247
    v_cvt_pk_bf16_f32 v14, v248, v249
    v_cvt_pk_bf16_f32 v15, v250, v251
    s_waitcnt lgkmcnt(10)
    v_mfma_f32_32x32x16_bf16 a[96:111], v[220:223], v[8:11], a[96:111]
    ds_read_b64_tr_b16 v[212:213], v188 offset:24832
    ds_read_b64_tr_b16 v[214:215], v188 offset:26880
    s_mov_b32 s47, 24576
    buffer_load_dwordx4 v[100:103], v160, s[32:35], s47 offen offset:1024
    s_waitcnt lgkmcnt(10)
    v_mfma_f32_32x32x16_bf16 a[112:127], v[224:227], v[8:11], a[112:127]
    ds_read_b64_tr_b16 v[216:217], v189 offset:24832
    ds_read_b64_tr_b16 v[218:219], v189 offset:26880
    s_mov_b32 s47, 24576
    buffer_load_dwordx4 v[104:107], v160, s[32:35], s47 offen offset:2048
    ds_read_b128 v[228:231], v252 offset:256
    ds_read_b128 v[232:235], v252 offset:272
    ds_read_b128 v[236:239], v252 offset:2560
    ds_read_b128 v[240:243], v252 offset:2576
    s_waitcnt vmcnt(26)
    s_waitcnt lgkmcnt(14)
    v_mfma_f32_32x32x16_bf16 a[0:15], v[196:199], v[12:15], a[0:15]
    ds_read_b64_tr_b16 v[220:221], v190 offset:24832
    ds_read_b64_tr_b16 v[222:223], v190 offset:26880
    s_mov_b32 s47, 24576
    buffer_load_dwordx4 v[108:111], v160, s[32:35], s47 offen offset:3072
    s_waitcnt lgkmcnt(14)
    v_mfma_f32_32x32x16_bf16 a[16:31], v[200:203], v[12:15], a[16:31]
    ds_read_b64_tr_b16 v[224:225], v191 offset:24832
    ds_read_b64_tr_b16 v[226:227], v191 offset:26880
    s_mov_b32 s47, 28672
    buffer_load_dwordx4 v[112:115], v160, s[32:35], s47 offen offset:0
    v_lshlrev_b32 v244, 16, v16
    v_and_b32 v245, 0xffff0000, v16
    v_lshlrev_b32 v246, 16, v17
    v_and_b32 v247, 0xffff0000, v17
    v_lshlrev_b32 v248, 16, v18
    v_and_b32 v249, 0xffff0000, v18
    v_lshlrev_b32 v250, 16, v19
    v_and_b32 v251, 0xffff0000, v19
    s_waitcnt lgkmcnt(14)
    v_mfma_f32_32x32x16_bf16 a[32:47], v[204:207], v[12:15], a[32:47]
    s_barrier
    ds_read_b64_tr_b16 v[196:197], v188 offset:32768
    ds_read_b64_tr_b16 v[198:199], v188 offset:34816
    s_mov_b32 s47, 28672
    buffer_load_dwordx4 v[116:119], v160, s[32:35], s47 offen offset:1024
    s_waitcnt lgkmcnt(14)
    v_mfma_f32_32x32x16_bf16 a[48:63], v[208:211], v[12:15], a[48:63]
    ds_read_b64_tr_b16 v[200:201], v189 offset:32768
    ds_read_b64_tr_b16 v[202:203], v189 offset:34816
    s_mov_b32 s47, 28672
    buffer_load_dwordx4 v[120:123], v160, s[32:35], s47 offen offset:2048
    s_waitcnt lgkmcnt(8)
    v_fma_f32 v244, v244, v228, v236
    v_fma_f32 v245, v245, v229, v237
    v_fma_f32 v246, v246, v230, v238
    v_fma_f32 v247, v247, v231, v239
    v_fma_f32 v248, v248, v232, v240
    v_fma_f32 v249, v249, v233, v241
    v_fma_f32 v250, v250, v234, v242
    v_fma_f32 v251, v251, v235, v243
    v_mfma_f32_32x32x16_bf16 a[64:79], v[212:215], v[12:15], a[64:79]
    ds_read_b64_tr_b16 v[204:205], v190 offset:32768
    ds_read_b64_tr_b16 v[206:207], v190 offset:34816
    s_mov_b32 s47, 28672
    buffer_load_dwordx4 v[124:127], v160, s[32:35], s47 offen offset:3072
    v_mfma_f32_32x32x16_bf16 a[80:95], v[216:219], v[12:15], a[80:95]
    ds_read_b64_tr_b16 v[208:209], v191 offset:32768
    ds_read_b64_tr_b16 v[210:211], v191 offset:34816
    s_mov_b32 s47, 32768
    buffer_load_dwordx4 v[128:131], v160, s[32:35], s47 offen offset:0
    v_cvt_pk_bf16_f32 v16, v244, v245
    v_cvt_pk_bf16_f32 v17, v246, v247
    v_cvt_pk_bf16_f32 v18, v248, v249
    v_cvt_pk_bf16_f32 v19, v250, v251
    s_waitcnt lgkmcnt(10)
    v_mfma_f32_32x32x16_bf16 a[96:111], v[220:223], v[12:15], a[96:111]
    ds_read_b64_tr_b16 v[212:213], v188 offset:33024
    ds_read_b64_tr_b16 v[214:215], v188 offset:35072
    s_mov_b32 s47, 32768
    buffer_load_dwordx4 v[132:135], v160, s[32:35], s47 offen offset:1024
    s_waitcnt lgkmcnt(10)
    v_mfma_f32_32x32x16_bf16 a[112:127], v[224:227], v[12:15], a[112:127]
    ds_read_b64_tr_b16 v[216:217], v189 offset:33024
    ds_read_b64_tr_b16 v[218:219], v189 offset:35072
    s_mov_b32 s47, 32768
    buffer_load_dwordx4 v[136:139], v160, s[32:35], s47 offen offset:2048
    ds_read_b128 v[228:231], v252 offset:320
    ds_read_b128 v[232:235], v252 offset:336
    ds_read_b128 v[236:239], v252 offset:2624
    ds_read_b128 v[240:243], v252 offset:2640
    s_waitcnt vmcnt(33)
    s_waitcnt lgkmcnt(14)
    v_mfma_f32_32x32x16_bf16 a[0:15], v[196:199], v[16:19], a[0:15]
    ds_read_b64_tr_b16 v[220:221], v190 offset:33024
    ds_read_b64_tr_b16 v[222:223], v190 offset:35072
    s_mov_b32 s47, 32768
    buffer_load_dwordx4 v[140:143], v160, s[32:35], s47 offen offset:3072
    s_waitcnt lgkmcnt(14)
    v_mfma_f32_32x32x16_bf16 a[16:31], v[200:203], v[16:19], a[16:31]
    ds_read_b64_tr_b16 v[224:225], v191 offset:33024
    ds_read_b64_tr_b16 v[226:227], v191 offset:35072
    s_add_u32 m0, s45, 131072
    s_mov_b32 s46, 1048576
    buffer_load_dwordx4 v159, s[28:31], s46 offen lds
    v_lshlrev_b32 v244, 16, v20
    v_and_b32 v245, 0xffff0000, v20
    v_lshlrev_b32 v246, 16, v21
    v_and_b32 v247, 0xffff0000, v21
    v_lshlrev_b32 v248, 16, v22
    v_and_b32 v249, 0xffff0000, v22
    v_lshlrev_b32 v250, 16, v23
    v_and_b32 v251, 0xffff0000, v23
    s_waitcnt lgkmcnt(14)
    v_mfma_f32_32x32x16_bf16 a[32:47], v[204:207], v[16:19], a[32:47]
    ds_read_b64_tr_b16 v[196:197], v188 offset:40960
    ds_read_b64_tr_b16 v[198:199], v188 offset:43008
    s_add_u32 m0, s45, 135168
    s_mov_b32 s46, 1114112
    buffer_load_dwordx4 v159, s[28:31], s46 offen lds
    s_waitcnt lgkmcnt(14)
    v_mfma_f32_32x32x16_bf16 a[48:63], v[208:211], v[16:19], a[48:63]
    ds_read_b64_tr_b16 v[200:201], v189 offset:40960
    ds_read_b64_tr_b16 v[202:203], v189 offset:43008
    s_add_u32 m0, s45, 139264
    s_mov_b32 s46, 1179648
    buffer_load_dwordx4 v159, s[28:31], s46 offen lds
    s_waitcnt lgkmcnt(8)
    v_fma_f32 v244, v244, v228, v236
    v_fma_f32 v245, v245, v229, v237
    v_fma_f32 v246, v246, v230, v238
    v_fma_f32 v247, v247, v231, v239
    v_fma_f32 v248, v248, v232, v240
    v_fma_f32 v249, v249, v233, v241
    v_fma_f32 v250, v250, v234, v242
    v_fma_f32 v251, v251, v235, v243
    v_mfma_f32_32x32x16_bf16 a[64:79], v[212:215], v[16:19], a[64:79]
    ds_read_b64_tr_b16 v[204:205], v190 offset:40960
    ds_read_b64_tr_b16 v[206:207], v190 offset:43008
    s_add_u32 m0, s45, 143360
    s_mov_b32 s46, 1245184
    buffer_load_dwordx4 v159, s[28:31], s46 offen lds
    v_mfma_f32_32x32x16_bf16 a[80:95], v[216:219], v[16:19], a[80:95]
    ds_read_b64_tr_b16 v[208:209], v191 offset:40960
    ds_read_b64_tr_b16 v[210:211], v191 offset:43008
    s_add_u32 m0, s45, 147456
    s_mov_b32 s46, 1310720
    buffer_load_dwordx4 v159, s[28:31], s46 offen lds
    v_cvt_pk_bf16_f32 v20, v244, v245
    v_cvt_pk_bf16_f32 v21, v246, v247
    v_cvt_pk_bf16_f32 v22, v248, v249
    v_cvt_pk_bf16_f32 v23, v250, v251
    s_waitcnt lgkmcnt(10)
    v_mfma_f32_32x32x16_bf16 a[96:111], v[220:223], v[16:19], a[96:111]
    ds_read_b64_tr_b16 v[212:213], v188 offset:41216
    ds_read_b64_tr_b16 v[214:215], v188 offset:43264
    s_add_u32 m0, s45, 151552
    s_mov_b32 s46, 1376256
    buffer_load_dwordx4 v159, s[28:31], s46 offen lds
    s_waitcnt lgkmcnt(10)
    v_mfma_f32_32x32x16_bf16 a[112:127], v[224:227], v[16:19], a[112:127]
    ds_read_b64_tr_b16 v[216:217], v189 offset:41216
    ds_read_b64_tr_b16 v[218:219], v189 offset:43264
    s_add_u32 m0, s45, 155648
    s_mov_b32 s46, 1441792
    buffer_load_dwordx4 v159, s[28:31], s46 offen lds
    ds_read_b128 v[228:231], v252 offset:384
    ds_read_b128 v[232:235], v252 offset:400
    ds_read_b128 v[236:239], v252 offset:2688
    ds_read_b128 v[240:243], v252 offset:2704
    s_waitcnt vmcnt(36)
    s_waitcnt lgkmcnt(14)
    v_mfma_f32_32x32x16_bf16 a[0:15], v[196:199], v[20:23], a[0:15]
    ds_read_b64_tr_b16 v[220:221], v190 offset:41216
    ds_read_b64_tr_b16 v[222:223], v190 offset:43264
    s_add_u32 m0, s45, 159744
    s_mov_b32 s46, 1507328
    buffer_load_dwordx4 v159, s[28:31], s46 offen lds
    s_waitcnt lgkmcnt(14)
    v_mfma_f32_32x32x16_bf16 a[16:31], v[200:203], v[20:23], a[16:31]
    ds_read_b64_tr_b16 v[224:225], v191 offset:41216
    ds_read_b64_tr_b16 v[226:227], v191 offset:43264
    s_add_u32 m0, s45, 65536
    s_mov_b32 s46, 1572864
    buffer_load_dwordx4 v159, s[28:31], s46 offen lds
    v_lshlrev_b32 v244, 16, v24
    v_and_b32 v245, 0xffff0000, v24
    v_lshlrev_b32 v246, 16, v25
    v_and_b32 v247, 0xffff0000, v25
    v_lshlrev_b32 v248, 16, v26
    v_and_b32 v249, 0xffff0000, v26
    v_lshlrev_b32 v250, 16, v27
    v_and_b32 v251, 0xffff0000, v27
    s_waitcnt lgkmcnt(14)
    v_mfma_f32_32x32x16_bf16 a[32:47], v[204:207], v[20:23], a[32:47]
    s_barrier
    ds_read_b64_tr_b16 v[196:197], v192 offset:0
    ds_read_b64_tr_b16 v[198:199], v192 offset:2048
    s_add_u32 m0, s45, 69632
    s_mov_b32 s46, 1638400
    buffer_load_dwordx4 v159, s[28:31], s46 offen lds
    s_waitcnt lgkmcnt(14)
    v_mfma_f32_32x32x16_bf16 a[48:63], v[208:211], v[20:23], a[48:63]
    ds_read_b64_tr_b16 v[200:201], v193 offset:0
    ds_read_b64_tr_b16 v[202:203], v193 offset:2048
    s_add_u32 m0, s45, 73728
    s_mov_b32 s46, 1703936
    buffer_load_dwordx4 v159, s[28:31], s46 offen lds
    s_waitcnt lgkmcnt(8)
    v_fma_f32 v244, v244, v228, v236
    v_fma_f32 v245, v245, v229, v237
    v_fma_f32 v246, v246, v230, v238
    v_fma_f32 v247, v247, v231, v239
    v_fma_f32 v248, v248, v232, v240
    v_fma_f32 v249, v249, v233, v241
    v_fma_f32 v250, v250, v234, v242
    v_fma_f32 v251, v251, v235, v243
    v_mfma_f32_32x32x16_bf16 a[64:79], v[212:215], v[20:23], a[64:79]
    ds_read_b64_tr_b16 v[204:205], v194 offset:0
    ds_read_b64_tr_b16 v[206:207], v194 offset:2048
    s_add_u32 m0, s45, 77824
    s_mov_b32 s46, 1769472
    buffer_load_dwordx4 v159, s[28:31], s46 offen lds
    v_mfma_f32_32x32x16_bf16 a[80:95], v[216:219], v[20:23], a[80:95]
    ds_read_b64_tr_b16 v[208:209], v195 offset:0
    ds_read_b64_tr_b16 v[210:211], v195 offset:2048
    s_add_u32 m0, s45, 81920
    s_mov_b32 s46, 1835008
    buffer_load_dwordx4 v159, s[28:31], s46 offen lds
    v_cvt_pk_bf16_f32 v24, v244, v245
    v_cvt_pk_bf16_f32 v25, v246, v247
    v_cvt_pk_bf16_f32 v26, v248, v249
    v_cvt_pk_bf16_f32 v27, v250, v251
    s_waitcnt lgkmcnt(10)
    v_mfma_f32_32x32x16_bf16 a[96:111], v[220:223], v[20:23], a[96:111]
    ds_read_b64_tr_b16 v[212:213], v192 offset:256
    ds_read_b64_tr_b16 v[214:215], v192 offset:2304
    s_add_u32 m0, s45, 86016
    s_mov_b32 s46, 1900544
    buffer_load_dwordx4 v159, s[28:31], s46 offen lds
    s_waitcnt lgkmcnt(10)
    v_mfma_f32_32x32x16_bf16 a[112:127], v[224:227], v[20:23], a[112:127]
    ds_read_b64_tr_b16 v[216:217], v193 offset:256
    ds_read_b64_tr_b16 v[218:219], v193 offset:2304
    s_add_u32 m0, s45, 90112
    s_mov_b32 s46, 1966080
    buffer_load_dwordx4 v159, s[28:31], s46 offen lds
    ds_read_b128 v[228:231], v252 offset:448
    ds_read_b128 v[232:235], v252 offset:464
    ds_read_b128 v[236:239], v252 offset:2752
    ds_read_b128 v[240:243], v252 offset:2768
    s_waitcnt vmcnt(43)
    s_waitcnt lgkmcnt(14)
    v_mfma_f32_32x32x16_bf16 a[0:15], v[196:199], v[24:27], a[0:15]
    ds_read_b64_tr_b16 v[220:221], v194 offset:256
    ds_read_b64_tr_b16 v[222:223], v194 offset:2304
    s_add_u32 m0, s45, 94208
    s_mov_b32 s46, 2031616
    buffer_load_dwordx4 v159, s[28:31], s46 offen lds
    s_waitcnt lgkmcnt(14)
    v_mfma_f32_32x32x16_bf16 a[16:31], v[200:203], v[24:27], a[16:31]
    ds_read_b64_tr_b16 v[224:225], v195 offset:256
    ds_read_b64_tr_b16 v[226:227], v195 offset:2304
    v_lshlrev_b32 v244, 16, v28
    v_and_b32 v245, 0xffff0000, v28
    v_lshlrev_b32 v246, 16, v29
    v_and_b32 v247, 0xffff0000, v29
    v_lshlrev_b32 v248, 16, v30
    v_and_b32 v249, 0xffff0000, v30
    v_lshlrev_b32 v250, 16, v31
    v_and_b32 v251, 0xffff0000, v31
    s_waitcnt lgkmcnt(14)
    v_mfma_f32_32x32x16_bf16 a[32:47], v[204:207], v[24:27], a[32:47]
    ds_read_b64_tr_b16 v[196:197], v192 offset:8192
    ds_read_b64_tr_b16 v[198:199], v192 offset:10240
    s_waitcnt lgkmcnt(14)
    v_mfma_f32_32x32x16_bf16 a[48:63], v[208:211], v[24:27], a[48:63]
    ds_read_b64_tr_b16 v[200:201], v193 offset:8192
    ds_read_b64_tr_b16 v[202:203], v193 offset:10240
    s_waitcnt lgkmcnt(8)
    v_fma_f32 v244, v244, v228, v236
    v_fma_f32 v245, v245, v229, v237
    v_fma_f32 v246, v246, v230, v238
    v_fma_f32 v247, v247, v231, v239
    v_fma_f32 v248, v248, v232, v240
    v_fma_f32 v249, v249, v233, v241
    v_fma_f32 v250, v250, v234, v242
    v_fma_f32 v251, v251, v235, v243
    v_mfma_f32_32x32x16_bf16 a[64:79], v[212:215], v[24:27], a[64:79]
    ds_read_b64_tr_b16 v[204:205], v194 offset:8192
    ds_read_b64_tr_b16 v[206:207], v194 offset:10240
    v_mfma_f32_32x32x16_bf16 a[80:95], v[216:219], v[24:27], a[80:95]
    ds_read_b64_tr_b16 v[208:209], v195 offset:8192
    ds_read_b64_tr_b16 v[210:211], v195 offset:10240
    v_cvt_pk_bf16_f32 v28, v244, v245
    v_cvt_pk_bf16_f32 v29, v246, v247
    v_cvt_pk_bf16_f32 v30, v248, v249
    v_cvt_pk_bf16_f32 v31, v250, v251
    s_waitcnt lgkmcnt(10)
    v_mfma_f32_32x32x16_bf16 a[96:111], v[220:223], v[24:27], a[96:111]
    ds_read_b64_tr_b16 v[212:213], v192 offset:8448
    ds_read_b64_tr_b16 v[214:215], v192 offset:10496
    s_waitcnt lgkmcnt(10)
    v_mfma_f32_32x32x16_bf16 a[112:127], v[224:227], v[24:27], a[112:127]
    ds_read_b64_tr_b16 v[216:217], v193 offset:8448
    ds_read_b64_tr_b16 v[218:219], v193 offset:10496
    ds_read_b128 v[228:231], v252 offset:512
    ds_read_b128 v[232:235], v252 offset:528
    ds_read_b128 v[236:239], v252 offset:2816
    ds_read_b128 v[240:243], v252 offset:2832
    s_waitcnt vmcnt(43)
    s_waitcnt lgkmcnt(14)
    v_mfma_f32_32x32x16_bf16 a[0:15], v[196:199], v[28:31], a[0:15]
    ds_read_b64_tr_b16 v[220:221], v194 offset:8448
    ds_read_b64_tr_b16 v[222:223], v194 offset:10496
    s_waitcnt lgkmcnt(14)
    v_mfma_f32_32x32x16_bf16 a[16:31], v[200:203], v[28:31], a[16:31]
    ds_read_b64_tr_b16 v[224:225], v195 offset:8448
    ds_read_b64_tr_b16 v[226:227], v195 offset:10496
    v_lshlrev_b32 v244, 16, v32
    v_and_b32 v245, 0xffff0000, v32
    v_lshlrev_b32 v246, 16, v33
    v_and_b32 v247, 0xffff0000, v33
    v_lshlrev_b32 v248, 16, v34
    v_and_b32 v249, 0xffff0000, v34
    v_lshlrev_b32 v250, 16, v35
    v_and_b32 v251, 0xffff0000, v35
    s_waitcnt lgkmcnt(14)
    v_mfma_f32_32x32x16_bf16 a[32:47], v[204:207], v[28:31], a[32:47]
    s_waitcnt vmcnt(12)
    s_barrier
    ds_read_b64_tr_b16 v[196:197], v192 offset:16384
    ds_read_b64_tr_b16 v[198:199], v192 offset:18432
    s_add_u32 m0, s45, 98304
    s_mov_b32 s46, 2097152
    buffer_load_dwordx4 v159, s[28:31], s46 offen lds
    s_waitcnt lgkmcnt(14)
    v_mfma_f32_32x32x16_bf16 a[48:63], v[208:211], v[28:31], a[48:63]
    ds_read_b64_tr_b16 v[200:201], v193 offset:16384
    ds_read_b64_tr_b16 v[202:203], v193 offset:18432
    s_add_u32 m0, s45, 102400
    s_mov_b32 s46, 2162688
    buffer_load_dwordx4 v159, s[28:31], s46 offen lds
    s_waitcnt lgkmcnt(8)
    v_fma_f32 v244, v244, v228, v236
    v_fma_f32 v245, v245, v229, v237
    v_fma_f32 v246, v246, v230, v238
    v_fma_f32 v247, v247, v231, v239
    v_fma_f32 v248, v248, v232, v240
    v_fma_f32 v249, v249, v233, v241
    v_fma_f32 v250, v250, v234, v242
    v_fma_f32 v251, v251, v235, v243
    v_mfma_f32_32x32x16_bf16 a[64:79], v[212:215], v[28:31], a[64:79]
    ds_read_b64_tr_b16 v[204:205], v194 offset:16384
    ds_read_b64_tr_b16 v[206:207], v194 offset:18432
    s_add_u32 m0, s45, 106496
    s_mov_b32 s46, 2228224
    buffer_load_dwordx4 v159, s[28:31], s46 offen lds
    v_mfma_f32_32x32x16_bf16 a[80:95], v[216:219], v[28:31], a[80:95]
    ds_read_b64_tr_b16 v[208:209], v195 offset:16384
    ds_read_b64_tr_b16 v[210:211], v195 offset:18432
    s_add_u32 m0, s45, 110592
    s_mov_b32 s46, 2293760
    buffer_load_dwordx4 v159, s[28:31], s46 offen lds
    v_cvt_pk_bf16_f32 v32, v244, v245
    v_cvt_pk_bf16_f32 v33, v246, v247
    v_cvt_pk_bf16_f32 v34, v248, v249
    v_cvt_pk_bf16_f32 v35, v250, v251
    s_waitcnt lgkmcnt(10)
    v_mfma_f32_32x32x16_bf16 a[96:111], v[220:223], v[28:31], a[96:111]
    ds_read_b64_tr_b16 v[212:213], v192 offset:16640
    ds_read_b64_tr_b16 v[214:215], v192 offset:18688
    s_waitcnt lgkmcnt(10)
    v_mfma_f32_32x32x16_bf16 a[112:127], v[224:227], v[28:31], a[112:127]
    ds_read_b64_tr_b16 v[216:217], v193 offset:16640
    ds_read_b64_tr_b16 v[218:219], v193 offset:18688
    ds_read_b128 v[228:231], v252 offset:576
    ds_read_b128 v[232:235], v252 offset:592
    ds_read_b128 v[236:239], v252 offset:2880
    ds_read_b128 v[240:243], v252 offset:2896
    s_waitcnt lgkmcnt(14)
    v_mfma_f32_32x32x16_bf16 a[0:15], v[196:199], v[32:35], a[0:15]
    ds_read_b64_tr_b16 v[220:221], v194 offset:16640
    ds_read_b64_tr_b16 v[222:223], v194 offset:18688
    s_waitcnt lgkmcnt(14)
    v_mfma_f32_32x32x16_bf16 a[16:31], v[200:203], v[32:35], a[16:31]
    ds_read_b64_tr_b16 v[224:225], v195 offset:16640
    ds_read_b64_tr_b16 v[226:227], v195 offset:18688
    v_lshlrev_b32 v244, 16, v36
    v_and_b32 v245, 0xffff0000, v36
    v_lshlrev_b32 v246, 16, v37
    v_and_b32 v247, 0xffff0000, v37
    v_lshlrev_b32 v248, 16, v38
    v_and_b32 v249, 0xffff0000, v38
    v_lshlrev_b32 v250, 16, v39
    v_and_b32 v251, 0xffff0000, v39
    s_waitcnt lgkmcnt(14)
    v_mfma_f32_32x32x16_bf16 a[32:47], v[204:207], v[32:35], a[32:47]
    ds_read_b64_tr_b16 v[196:197], v192 offset:24576
    ds_read_b64_tr_b16 v[198:199], v192 offset:26624
    s_waitcnt lgkmcnt(14)
    v_mfma_f32_32x32x16_bf16 a[48:63], v[208:211], v[32:35], a[48:63]
    ds_read_b64_tr_b16 v[200:201], v193 offset:24576
    ds_read_b64_tr_b16 v[202:203], v193 offset:26624
    s_waitcnt lgkmcnt(8)
    v_fma_f32 v244, v244, v228, v236
    v_fma_f32 v245, v245, v229, v237
    v_fma_f32 v246, v246, v230, v238
    v_fma_f32 v247, v247, v231, v239
    v_fma_f32 v248, v248, v232, v240
    v_fma_f32 v249, v249, v233, v241
    v_fma_f32 v250, v250, v234, v242
    v_fma_f32 v251, v251, v235, v243
    v_mfma_f32_32x32x16_bf16 a[64:79], v[212:215], v[32:35], a[64:79]
    ds_read_b64_tr_b16 v[204:205], v194 offset:24576
    ds_read_b64_tr_b16 v[206:207], v194 offset:26624
    v_mfma_f32_32x32x16_bf16 a[80:95], v[216:219], v[32:35], a[80:95]
    ds_read_b64_tr_b16 v[208:209], v195 offset:24576
    ds_read_b64_tr_b16 v[210:211], v195 offset:26624
    v_cvt_pk_bf16_f32 v36, v244, v245
    v_cvt_pk_bf16_f32 v37, v246, v247
    v_cvt_pk_bf16_f32 v38, v248, v249
    v_cvt_pk_bf16_f32 v39, v250, v251
    s_waitcnt lgkmcnt(10)
    v_mfma_f32_32x32x16_bf16 a[96:111], v[220:223], v[32:35], a[96:111]
    ds_read_b64_tr_b16 v[212:213], v192 offset:24832
    ds_read_b64_tr_b16 v[214:215], v192 offset:26880
    s_waitcnt lgkmcnt(10)
    v_mfma_f32_32x32x16_bf16 a[112:127], v[224:227], v[32:35], a[112:127]
    ds_read_b64_tr_b16 v[216:217], v193 offset:24832
    ds_read_b64_tr_b16 v[218:219], v193 offset:26880
    ds_read_b128 v[228:231], v252 offset:640
    ds_read_b128 v[232:235], v252 offset:656
    ds_read_b128 v[236:239], v252 offset:2944
    ds_read_b128 v[240:243], v252 offset:2960
    s_waitcnt lgkmcnt(14)
    v_mfma_f32_32x32x16_bf16 a[0:15], v[196:199], v[36:39], a[0:15]
    ds_read_b64_tr_b16 v[220:221], v194 offset:24832
    ds_read_b64_tr_b16 v[222:223], v194 offset:26880
    s_waitcnt lgkmcnt(14)
    v_mfma_f32_32x32x16_bf16 a[16:31], v[200:203], v[36:39], a[16:31]
    ds_read_b64_tr_b16 v[224:225], v195 offset:24832
    ds_read_b64_tr_b16 v[226:227], v195 offset:26880
    v_lshlrev_b32 v244, 16, v40
    v_and_b32 v245, 0xffff0000, v40
    v_lshlrev_b32 v246, 16, v41
    v_and_b32 v247, 0xffff0000, v41
    v_lshlrev_b32 v248, 16, v42
    v_and_b32 v249, 0xffff0000, v42
    v_lshlrev_b32 v250, 16, v43
    v_and_b32 v251, 0xffff0000, v43
    s_waitcnt lgkmcnt(14)
    v_mfma_f32_32x32x16_bf16 a[32:47], v[204:207], v[36:39], a[32:47]
    s_waitcnt vmcnt(12)
    s_barrier
    ds_read_b64_tr_b16 v[196:197], v192 offset:32768
    ds_read_b64_tr_b16 v[198:199], v192 offset:34816
    s_add_u32 m0, s45, 114688
    s_mov_b32 s46, 2359296
    buffer_load_dwordx4 v159, s[28:31], s46 offen lds
    s_waitcnt lgkmcnt(14)
    v_mfma_f32_32x32x16_bf16 a[48:63], v[208:211], v[36:39], a[48:63]
    ds_read_b64_tr_b16 v[200:201], v193 offset:32768
    ds_read_b64_tr_b16 v[202:203], v193 offset:34816
    s_add_u32 m0, s45, 118784
    s_mov_b32 s46, 2424832
    buffer_load_dwordx4 v159, s[28:31], s46 offen lds
    s_waitcnt lgkmcnt(8)
    v_fma_f32 v244, v244, v228, v236
    v_fma_f32 v245, v245, v229, v237
    v_fma_f32 v246, v246, v230, v238
    v_fma_f32 v247, v247, v231, v239
    v_fma_f32 v248, v248, v232, v240
    v_fma_f32 v249, v249, v233, v241
    v_fma_f32 v250, v250, v234, v242
    v_fma_f32 v251, v251, v235, v243
    v_mfma_f32_32x32x16_bf16 a[64:79], v[212:215], v[36:39], a[64:79]
    ds_read_b64_tr_b16 v[204:205], v194 offset:32768
    ds_read_b64_tr_b16 v[206:207], v194 offset:34816
    s_add_u32 m0, s45, 122880
    s_mov_b32 s46, 2490368
    buffer_load_dwordx4 v159, s[28:31], s46 offen lds
    v_mfma_f32_32x32x16_bf16 a[80:95], v[216:219], v[36:39], a[80:95]
    ds_read_b64_tr_b16 v[208:209], v195 offset:32768
    ds_read_b64_tr_b16 v[210:211], v195 offset:34816
    s_add_u32 m0, s45, 126976
    s_mov_b32 s46, 2555904
    buffer_load_dwordx4 v159, s[28:31], s46 offen lds
    v_cvt_pk_bf16_f32 v40, v244, v245
    v_cvt_pk_bf16_f32 v41, v246, v247
    v_cvt_pk_bf16_f32 v42, v248, v249
    v_cvt_pk_bf16_f32 v43, v250, v251
    s_waitcnt lgkmcnt(10)
    v_mfma_f32_32x32x16_bf16 a[96:111], v[220:223], v[36:39], a[96:111]
    ds_read_b64_tr_b16 v[212:213], v192 offset:33024
    ds_read_b64_tr_b16 v[214:215], v192 offset:35072
    s_waitcnt lgkmcnt(10)
    v_mfma_f32_32x32x16_bf16 a[112:127], v[224:227], v[36:39], a[112:127]
    ds_read_b64_tr_b16 v[216:217], v193 offset:33024
    ds_read_b64_tr_b16 v[218:219], v193 offset:35072
    ds_read_b128 v[228:231], v252 offset:704
    ds_read_b128 v[232:235], v252 offset:720
    ds_read_b128 v[236:239], v252 offset:3008
    ds_read_b128 v[240:243], v252 offset:3024
    s_waitcnt lgkmcnt(14)
    v_mfma_f32_32x32x16_bf16 a[0:15], v[196:199], v[40:43], a[0:15]
    ds_read_b64_tr_b16 v[220:221], v194 offset:33024
    ds_read_b64_tr_b16 v[222:223], v194 offset:35072
    s_waitcnt lgkmcnt(14)
    v_mfma_f32_32x32x16_bf16 a[16:31], v[200:203], v[40:43], a[16:31]
    ds_read_b64_tr_b16 v[224:225], v195 offset:33024
    ds_read_b64_tr_b16 v[226:227], v195 offset:35072
    v_lshlrev_b32 v244, 16, v44
    v_and_b32 v245, 0xffff0000, v44
    v_lshlrev_b32 v246, 16, v45
    v_and_b32 v247, 0xffff0000, v45
    v_lshlrev_b32 v248, 16, v46
    v_and_b32 v249, 0xffff0000, v46
    v_lshlrev_b32 v250, 16, v47
    v_and_b32 v251, 0xffff0000, v47
    s_waitcnt lgkmcnt(14)
    v_mfma_f32_32x32x16_bf16 a[32:47], v[204:207], v[40:43], a[32:47]
    ds_read_b64_tr_b16 v[196:197], v192 offset:40960
    ds_read_b64_tr_b16 v[198:199], v192 offset:43008
    s_waitcnt lgkmcnt(14)
    v_mfma_f32_32x32x16_bf16 a[48:63], v[208:211], v[40:43], a[48:63]
    ds_read_b64_tr_b16 v[200:201], v193 offset:40960
    ds_read_b64_tr_b16 v[202:203], v193 offset:43008
    s_waitcnt lgkmcnt(8)
    v_fma_f32 v244, v244, v228, v236
    v_fma_f32 v245, v245, v229, v237
    v_fma_f32 v246, v246, v230, v238
    v_fma_f32 v247, v247, v231, v239
    v_fma_f32 v248, v248, v232, v240
    v_fma_f32 v249, v249, v233, v241
    v_fma_f32 v250, v250, v234, v242
    v_fma_f32 v251, v251, v235, v243
    v_mfma_f32_32x32x16_bf16 a[64:79], v[212:215], v[40:43], a[64:79]
    ds_read_b64_tr_b16 v[204:205], v194 offset:40960
    ds_read_b64_tr_b16 v[206:207], v194 offset:43008
    v_mfma_f32_32x32x16_bf16 a[80:95], v[216:219], v[40:43], a[80:95]
    ds_read_b64_tr_b16 v[208:209], v195 offset:40960
    ds_read_b64_tr_b16 v[210:211], v195 offset:43008
    v_cvt_pk_bf16_f32 v44, v244, v245
    v_cvt_pk_bf16_f32 v45, v246, v247
    v_cvt_pk_bf16_f32 v46, v248, v249
    v_cvt_pk_bf16_f32 v47, v250, v251
    s_waitcnt lgkmcnt(10)
    v_mfma_f32_32x32x16_bf16 a[96:111], v[220:223], v[40:43], a[96:111]
    ds_read_b64_tr_b16 v[212:213], v192 offset:41216
    ds_read_b64_tr_b16 v[214:215], v192 offset:43264
    s_waitcnt lgkmcnt(10)
    v_mfma_f32_32x32x16_bf16 a[112:127], v[224:227], v[40:43], a[112:127]
    ds_read_b64_tr_b16 v[216:217], v193 offset:41216
    ds_read_b64_tr_b16 v[218:219], v193 offset:43264
    ds_read_b128 v[228:231], v252 offset:768
    ds_read_b128 v[232:235], v252 offset:784
    ds_read_b128 v[236:239], v252 offset:3072
    ds_read_b128 v[240:243], v252 offset:3088
    s_waitcnt lgkmcnt(14)
    v_mfma_f32_32x32x16_bf16 a[0:15], v[196:199], v[44:47], a[0:15]
    ds_read_b64_tr_b16 v[220:221], v194 offset:41216
    ds_read_b64_tr_b16 v[222:223], v194 offset:43264
    s_waitcnt lgkmcnt(14)
    v_mfma_f32_32x32x16_bf16 a[16:31], v[200:203], v[44:47], a[16:31]
    ds_read_b64_tr_b16 v[224:225], v195 offset:41216
    ds_read_b64_tr_b16 v[226:227], v195 offset:43264
    v_lshlrev_b32 v244, 16, v48
    v_and_b32 v245, 0xffff0000, v48
    v_lshlrev_b32 v246, 16, v49
    v_and_b32 v247, 0xffff0000, v49
    v_lshlrev_b32 v248, 16, v50
    v_and_b32 v249, 0xffff0000, v50
    v_lshlrev_b32 v250, 16, v51
    v_and_b32 v251, 0xffff0000, v51
    s_waitcnt lgkmcnt(14)
    v_mfma_f32_32x32x16_bf16 a[32:47], v[204:207], v[44:47], a[32:47]
    s_waitcnt vmcnt(12)
    s_barrier
    ds_read_b64_tr_b16 v[196:197], v188 offset:0
    ds_read_b64_tr_b16 v[198:199], v188 offset:2048
    s_add_u32 m0, s45, 131072
    s_mov_b32 s46, 2621440
    buffer_load_dwordx4 v159, s[28:31], s46 offen lds
    s_waitcnt lgkmcnt(14)
    v_mfma_f32_32x32x16_bf16 a[48:63], v[208:211], v[44:47], a[48:63]
    ds_read_b64_tr_b16 v[200:201], v189 offset:0
    ds_read_b64_tr_b16 v[202:203], v189 offset:2048
    s_add_u32 m0, s45, 135168
    s_mov_b32 s46, 2686976
    buffer_load_dwordx4 v159, s[28:31], s46 offen lds
    s_waitcnt lgkmcnt(8)
    v_fma_f32 v244, v244, v228, v236
    v_fma_f32 v245, v245, v229, v237
    v_fma_f32 v246, v246, v230, v238
    v_fma_f32 v247, v247, v231, v239
    v_fma_f32 v248, v248, v232, v240
    v_fma_f32 v249, v249, v233, v241
    v_fma_f32 v250, v250, v234, v242
    v_fma_f32 v251, v251, v235, v243
    v_mfma_f32_32x32x16_bf16 a[64:79], v[212:215], v[44:47], a[64:79]
    ds_read_b64_tr_b16 v[204:205], v190 offset:0
    ds_read_b64_tr_b16 v[206:207], v190 offset:2048
    s_add_u32 m0, s45, 139264
    s_mov_b32 s46, 2752512
    buffer_load_dwordx4 v159, s[28:31], s46 offen lds
    v_mfma_f32_32x32x16_bf16 a[80:95], v[216:219], v[44:47], a[80:95]
    ds_read_b64_tr_b16 v[208:209], v191 offset:0
    ds_read_b64_tr_b16 v[210:211], v191 offset:2048
    s_add_u32 m0, s45, 143360
    s_mov_b32 s46, 2818048
    buffer_load_dwordx4 v159, s[28:31], s46 offen lds
    v_cvt_pk_bf16_f32 v48, v244, v245
    v_cvt_pk_bf16_f32 v49, v246, v247
    v_cvt_pk_bf16_f32 v50, v248, v249
    v_cvt_pk_bf16_f32 v51, v250, v251
    s_waitcnt lgkmcnt(10)
    v_mfma_f32_32x32x16_bf16 a[96:111], v[220:223], v[44:47], a[96:111]
    ds_read_b64_tr_b16 v[212:213], v188 offset:256
    ds_read_b64_tr_b16 v[214:215], v188 offset:2304
    s_waitcnt lgkmcnt(10)
    v_mfma_f32_32x32x16_bf16 a[112:127], v[224:227], v[44:47], a[112:127]
    ds_read_b64_tr_b16 v[216:217], v189 offset:256
    ds_read_b64_tr_b16 v[218:219], v189 offset:2304
    ds_read_b128 v[228:231], v252 offset:832
    ds_read_b128 v[232:235], v252 offset:848
    ds_read_b128 v[236:239], v252 offset:3136
    ds_read_b128 v[240:243], v252 offset:3152
    s_waitcnt lgkmcnt(14)
    v_mfma_f32_32x32x16_bf16 a[0:15], v[196:199], v[48:51], a[0:15]
    ds_read_b64_tr_b16 v[220:221], v190 offset:256
    ds_read_b64_tr_b16 v[222:223], v190 offset:2304
    s_waitcnt lgkmcnt(14)
    v_mfma_f32_32x32x16_bf16 a[16:31], v[200:203], v[48:51], a[16:31]
    ds_read_b64_tr_b16 v[224:225], v191 offset:256
    ds_read_b64_tr_b16 v[226:227], v191 offset:2304
    v_lshlrev_b32 v244, 16, v52
    v_and_b32 v245, 0xffff0000, v52
    v_lshlrev_b32 v246, 16, v53
    v_and_b32 v247, 0xffff0000, v53
    v_lshlrev_b32 v248, 16, v54
    v_and_b32 v249, 0xffff0000, v54
    v_lshlrev_b32 v250, 16, v55
    v_and_b32 v251, 0xffff0000, v55
    s_waitcnt lgkmcnt(14)
    v_mfma_f32_32x32x16_bf16 a[32:47], v[204:207], v[48:51], a[32:47]
    ds_read_b64_tr_b16 v[196:197], v188 offset:8192
    ds_read_b64_tr_b16 v[198:199], v188 offset:10240
    s_waitcnt lgkmcnt(14)
    v_mfma_f32_32x32x16_bf16 a[48:63], v[208:211], v[48:51], a[48:63]
    ds_read_b64_tr_b16 v[200:201], v189 offset:8192
    ds_read_b64_tr_b16 v[202:203], v189 offset:10240
    s_waitcnt lgkmcnt(8)
    v_fma_f32 v244, v244, v228, v236
    v_fma_f32 v245, v245, v229, v237
    v_fma_f32 v246, v246, v230, v238
    v_fma_f32 v247, v247, v231, v239
    v_fma_f32 v248, v248, v232, v240
    v_fma_f32 v249, v249, v233, v241
    v_fma_f32 v250, v250, v234, v242
    v_fma_f32 v251, v251, v235, v243
    v_mfma_f32_32x32x16_bf16 a[64:79], v[212:215], v[48:51], a[64:79]
    ds_read_b64_tr_b16 v[204:205], v190 offset:8192
    ds_read_b64_tr_b16 v[206:207], v190 offset:10240
    v_mfma_f32_32x32x16_bf16 a[80:95], v[216:219], v[48:51], a[80:95]
    ds_read_b64_tr_b16 v[208:209], v191 offset:8192
    ds_read_b64_tr_b16 v[210:211], v191 offset:10240
    v_cvt_pk_bf16_f32 v52, v244, v245
    v_cvt_pk_bf16_f32 v53, v246, v247
    v_cvt_pk_bf16_f32 v54, v248, v249
    v_cvt_pk_bf16_f32 v55, v250, v251
    s_waitcnt lgkmcnt(10)
    v_mfma_f32_32x32x16_bf16 a[96:111], v[220:223], v[48:51], a[96:111]
    ds_read_b64_tr_b16 v[212:213], v188 offset:8448
    ds_read_b64_tr_b16 v[214:215], v188 offset:10496
    s_waitcnt lgkmcnt(10)
    v_mfma_f32_32x32x16_bf16 a[112:127], v[224:227], v[48:51], a[112:127]
    ds_read_b64_tr_b16 v[216:217], v189 offset:8448
    ds_read_b64_tr_b16 v[218:219], v189 offset:10496
    ds_read_b128 v[228:231], v252 offset:896
    ds_read_b128 v[232:235], v252 offset:912
    ds_read_b128 v[236:239], v252 offset:3200
    ds_read_b128 v[240:243], v252 offset:3216
    s_waitcnt lgkmcnt(14)
    v_mfma_f32_32x32x16_bf16 a[0:15], v[196:199], v[52:55], a[0:15]
    ds_read_b64_tr_b16 v[220:221], v190 offset:8448
    ds_read_b64_tr_b16 v[222:223], v190 offset:10496
    s_waitcnt lgkmcnt(14)
    v_mfma_f32_32x32x16_bf16 a[16:31], v[200:203], v[52:55], a[16:31]
    ds_read_b64_tr_b16 v[224:225], v191 offset:8448
    ds_read_b64_tr_b16 v[226:227], v191 offset:10496
    v_lshlrev_b32 v244, 16, v56
    v_and_b32 v245, 0xffff0000, v56
    v_lshlrev_b32 v246, 16, v57
    v_and_b32 v247, 0xffff0000, v57
    v_lshlrev_b32 v248, 16, v58
    v_and_b32 v249, 0xffff0000, v58
    v_lshlrev_b32 v250, 16, v59
    v_and_b32 v251, 0xffff0000, v59
    s_waitcnt lgkmcnt(14)
    v_mfma_f32_32x32x16_bf16 a[32:47], v[204:207], v[52:55], a[32:47]
    s_waitcnt vmcnt(12)
    s_barrier
    ds_read_b64_tr_b16 v[196:197], v188 offset:16384
    ds_read_b64_tr_b16 v[198:199], v188 offset:18432
    s_add_u32 m0, s45, 147456
    s_mov_b32 s46, 2883584
    buffer_load_dwordx4 v159, s[28:31], s46 offen lds
    s_waitcnt lgkmcnt(14)
    v_mfma_f32_32x32x16_bf16 a[48:63], v[208:211], v[52:55], a[48:63]
    ds_read_b64_tr_b16 v[200:201], v189 offset:16384
    ds_read_b64_tr_b16 v[202:203], v189 offset:18432
    s_add_u32 m0, s45, 151552
    s_mov_b32 s46, 2949120
    buffer_load_dwordx4 v159, s[28:31], s46 offen lds
    s_waitcnt lgkmcnt(8)
    v_fma_f32 v244, v244, v228, v236
    v_fma_f32 v245, v245, v229, v237
    v_fma_f32 v246, v246, v230, v238
    v_fma_f32 v247, v247, v231, v239
    v_fma_f32 v248, v248, v232, v240
    v_fma_f32 v249, v249, v233, v241
    v_fma_f32 v250, v250, v234, v242
    v_fma_f32 v251, v251, v235, v243
    v_mfma_f32_32x32x16_bf16 a[64:79], v[212:215], v[52:55], a[64:79]
    ds_read_b64_tr_b16 v[204:205], v190 offset:16384
    ds_read_b64_tr_b16 v[206:207], v190 offset:18432
    s_add_u32 m0, s45, 155648
    s_mov_b32 s46, 3014656
    buffer_load_dwordx4 v159, s[28:31], s46 offen lds
    v_mfma_f32_32x32x16_bf16 a[80:95], v[216:219], v[52:55], a[80:95]
    ds_read_b64_tr_b16 v[208:209], v191 offset:16384
    ds_read_b64_tr_b16 v[210:211], v191 offset:18432
    s_add_u32 m0, s45, 159744
    s_mov_b32 s46, 3080192
    buffer_load_dwordx4 v159, s[28:31], s46 offen lds
    v_cvt_pk_bf16_f32 v56, v244, v245
    v_cvt_pk_bf16_f32 v57, v246, v247
    v_cvt_pk_bf16_f32 v58, v248, v249
    v_cvt_pk_bf16_f32 v59, v250, v251
    s_waitcnt lgkmcnt(10)
    v_mfma_f32_32x32x16_bf16 a[96:111], v[220:223], v[52:55], a[96:111]
    ds_read_b64_tr_b16 v[212:213], v188 offset:16640
    ds_read_b64_tr_b16 v[214:215], v188 offset:18688
    s_waitcnt lgkmcnt(10)
    v_mfma_f32_32x32x16_bf16 a[112:127], v[224:227], v[52:55], a[112:127]
    ds_read_b64_tr_b16 v[216:217], v189 offset:16640
    ds_read_b64_tr_b16 v[218:219], v189 offset:18688
    ds_read_b128 v[228:231], v252 offset:960
    ds_read_b128 v[232:235], v252 offset:976
    ds_read_b128 v[236:239], v252 offset:3264
    ds_read_b128 v[240:243], v252 offset:3280
    s_waitcnt lgkmcnt(14)
    v_mfma_f32_32x32x16_bf16 a[0:15], v[196:199], v[56:59], a[0:15]
    ds_read_b64_tr_b16 v[220:221], v190 offset:16640
    ds_read_b64_tr_b16 v[222:223], v190 offset:18688
    s_waitcnt lgkmcnt(14)
    v_mfma_f32_32x32x16_bf16 a[16:31], v[200:203], v[56:59], a[16:31]
    ds_read_b64_tr_b16 v[224:225], v191 offset:16640
    ds_read_b64_tr_b16 v[226:227], v191 offset:18688
    v_lshlrev_b32 v244, 16, v60
    v_and_b32 v245, 0xffff0000, v60
    v_lshlrev_b32 v246, 16, v61
    v_and_b32 v247, 0xffff0000, v61
    v_lshlrev_b32 v248, 16, v62
    v_and_b32 v249, 0xffff0000, v62
    v_lshlrev_b32 v250, 16, v63
    v_and_b32 v251, 0xffff0000, v63
    s_waitcnt lgkmcnt(14)
    v_mfma_f32_32x32x16_bf16 a[32:47], v[204:207], v[56:59], a[32:47]
    ds_read_b64_tr_b16 v[196:197], v188 offset:24576
    ds_read_b64_tr_b16 v[198:199], v188 offset:26624
    s_waitcnt lgkmcnt(14)
    v_mfma_f32_32x32x16_bf16 a[48:63], v[208:211], v[56:59], a[48:63]
    ds_read_b64_tr_b16 v[200:201], v189 offset:24576
    ds_read_b64_tr_b16 v[202:203], v189 offset:26624
    s_waitcnt lgkmcnt(8)
    v_fma_f32 v244, v244, v228, v236
    v_fma_f32 v245, v245, v229, v237
    v_fma_f32 v246, v246, v230, v238
    v_fma_f32 v247, v247, v231, v239
    v_fma_f32 v248, v248, v232, v240
    v_fma_f32 v249, v249, v233, v241
    v_fma_f32 v250, v250, v234, v242
    v_fma_f32 v251, v251, v235, v243
    v_mfma_f32_32x32x16_bf16 a[64:79], v[212:215], v[56:59], a[64:79]
    ds_read_b64_tr_b16 v[204:205], v190 offset:24576
    ds_read_b64_tr_b16 v[206:207], v190 offset:26624
    v_mfma_f32_32x32x16_bf16 a[80:95], v[216:219], v[56:59], a[80:95]
    ds_read_b64_tr_b16 v[208:209], v191 offset:24576
    ds_read_b64_tr_b16 v[210:211], v191 offset:26624
    v_cvt_pk_bf16_f32 v60, v244, v245
    v_cvt_pk_bf16_f32 v61, v246, v247
    v_cvt_pk_bf16_f32 v62, v248, v249
    v_cvt_pk_bf16_f32 v63, v250, v251
    s_waitcnt lgkmcnt(10)
    v_mfma_f32_32x32x16_bf16 a[96:111], v[220:223], v[56:59], a[96:111]
    ds_read_b64_tr_b16 v[212:213], v188 offset:24832
    ds_read_b64_tr_b16 v[214:215], v188 offset:26880
    s_waitcnt lgkmcnt(10)
    v_mfma_f32_32x32x16_bf16 a[112:127], v[224:227], v[56:59], a[112:127]
    ds_read_b64_tr_b16 v[216:217], v189 offset:24832
    ds_read_b64_tr_b16 v[218:219], v189 offset:26880
    ds_read_b128 v[228:231], v252 offset:1024
    ds_read_b128 v[232:235], v252 offset:1040
    ds_read_b128 v[236:239], v252 offset:3328
    ds_read_b128 v[240:243], v252 offset:3344
    s_waitcnt lgkmcnt(14)
    v_mfma_f32_32x32x16_bf16 a[0:15], v[196:199], v[60:63], a[0:15]
    ds_read_b64_tr_b16 v[220:221], v190 offset:24832
    ds_read_b64_tr_b16 v[222:223], v190 offset:26880
    s_waitcnt lgkmcnt(14)
    v_mfma_f32_32x32x16_bf16 a[16:31], v[200:203], v[60:63], a[16:31]
    ds_read_b64_tr_b16 v[224:225], v191 offset:24832
    ds_read_b64_tr_b16 v[226:227], v191 offset:26880
    v_lshlrev_b32 v244, 16, v64
    v_and_b32 v245, 0xffff0000, v64
    v_lshlrev_b32 v246, 16, v65
    v_and_b32 v247, 0xffff0000, v65
    v_lshlrev_b32 v248, 16, v66
    v_and_b32 v249, 0xffff0000, v66
    v_lshlrev_b32 v250, 16, v67
    v_and_b32 v251, 0xffff0000, v67
    s_waitcnt lgkmcnt(14)
    v_mfma_f32_32x32x16_bf16 a[32:47], v[204:207], v[60:63], a[32:47]
    s_waitcnt vmcnt(12)
    s_barrier
    ds_read_b64_tr_b16 v[196:197], v188 offset:32768
    ds_read_b64_tr_b16 v[198:199], v188 offset:34816
    s_add_u32 m0, s45, 65536
    s_mov_b32 s46, 3145728
    buffer_load_dwordx4 v159, s[28:31], s46 offen lds
    s_waitcnt lgkmcnt(14)
    v_mfma_f32_32x32x16_bf16 a[48:63], v[208:211], v[60:63], a[48:63]
    ds_read_b64_tr_b16 v[200:201], v189 offset:32768
    ds_read_b64_tr_b16 v[202:203], v189 offset:34816
    s_add_u32 m0, s45, 69632
    s_mov_b32 s46, 3211264
    buffer_load_dwordx4 v159, s[28:31], s46 offen lds
    s_waitcnt lgkmcnt(8)
    v_fma_f32 v244, v244, v228, v236
    v_fma_f32 v245, v245, v229, v237
    v_fma_f32 v246, v246, v230, v238
    v_fma_f32 v247, v247, v231, v239
    v_fma_f32 v248, v248, v232, v240
    v_fma_f32 v249, v249, v233, v241
    v_fma_f32 v250, v250, v234, v242
    v_fma_f32 v251, v251, v235, v243
    v_mfma_f32_32x32x16_bf16 a[64:79], v[212:215], v[60:63], a[64:79]
    ds_read_b64_tr_b16 v[204:205], v190 offset:32768
    ds_read_b64_tr_b16 v[206:207], v190 offset:34816
    s_add_u32 m0, s45, 73728
    s_mov_b32 s46, 3276800
    buffer_load_dwordx4 v159, s[28:31], s46 offen lds
    v_mfma_f32_32x32x16_bf16 a[80:95], v[216:219], v[60:63], a[80:95]
    ds_read_b64_tr_b16 v[208:209], v191 offset:32768
    ds_read_b64_tr_b16 v[210:211], v191 offset:34816
    s_add_u32 m0, s45, 77824
    s_mov_b32 s46, 3342336
    buffer_load_dwordx4 v159, s[28:31], s46 offen lds
    v_cvt_pk_bf16_f32 v64, v244, v245
    v_cvt_pk_bf16_f32 v65, v246, v247
    v_cvt_pk_bf16_f32 v66, v248, v249
    v_cvt_pk_bf16_f32 v67, v250, v251
    s_waitcnt lgkmcnt(10)
    v_mfma_f32_32x32x16_bf16 a[96:111], v[220:223], v[60:63], a[96:111]
    ds_read_b64_tr_b16 v[212:213], v188 offset:33024
    ds_read_b64_tr_b16 v[214:215], v188 offset:35072
    s_waitcnt lgkmcnt(10)
    v_mfma_f32_32x32x16_bf16 a[112:127], v[224:227], v[60:63], a[112:127]
    ds_read_b64_tr_b16 v[216:217], v189 offset:33024
    ds_read_b64_tr_b16 v[218:219], v189 offset:35072
    ds_read_b128 v[228:231], v252 offset:1088
    ds_read_b128 v[232:235], v252 offset:1104
    ds_read_b128 v[236:239], v252 offset:3392
    ds_read_b128 v[240:243], v252 offset:3408
    s_waitcnt lgkmcnt(14)
    v_mfma_f32_32x32x16_bf16 a[0:15], v[196:199], v[64:67], a[0:15]
    ds_read_b64_tr_b16 v[220:221], v190 offset:33024
    ds_read_b64_tr_b16 v[222:223], v190 offset:35072
    s_waitcnt lgkmcnt(14)
    v_mfma_f32_32x32x16_bf16 a[16:31], v[200:203], v[64:67], a[16:31]
    ds_read_b64_tr_b16 v[224:225], v191 offset:33024
    ds_read_b64_tr_b16 v[226:227], v191 offset:35072
    v_lshlrev_b32 v244, 16, v68
    v_and_b32 v245, 0xffff0000, v68
    v_lshlrev_b32 v246, 16, v69
    v_and_b32 v247, 0xffff0000, v69
    v_lshlrev_b32 v248, 16, v70
    v_and_b32 v249, 0xffff0000, v70
    v_lshlrev_b32 v250, 16, v71
    v_and_b32 v251, 0xffff0000, v71
    s_waitcnt lgkmcnt(14)
    v_mfma_f32_32x32x16_bf16 a[32:47], v[204:207], v[64:67], a[32:47]
    ds_read_b64_tr_b16 v[196:197], v188 offset:40960
    ds_read_b64_tr_b16 v[198:199], v188 offset:43008
    s_waitcnt lgkmcnt(14)
    v_mfma_f32_32x32x16_bf16 a[48:63], v[208:211], v[64:67], a[48:63]
    ds_read_b64_tr_b16 v[200:201], v189 offset:40960
    ds_read_b64_tr_b16 v[202:203], v189 offset:43008
    s_waitcnt lgkmcnt(8)
    v_fma_f32 v244, v244, v228, v236
    v_fma_f32 v245, v245, v229, v237
    v_fma_f32 v246, v246, v230, v238
    v_fma_f32 v247, v247, v231, v239
    v_fma_f32 v248, v248, v232, v240
    v_fma_f32 v249, v249, v233, v241
    v_fma_f32 v250, v250, v234, v242
    v_fma_f32 v251, v251, v235, v243
    v_mfma_f32_32x32x16_bf16 a[64:79], v[212:215], v[64:67], a[64:79]
    ds_read_b64_tr_b16 v[204:205], v190 offset:40960
    ds_read_b64_tr_b16 v[206:207], v190 offset:43008
    v_mfma_f32_32x32x16_bf16 a[80:95], v[216:219], v[64:67], a[80:95]
    ds_read_b64_tr_b16 v[208:209], v191 offset:40960
    ds_read_b64_tr_b16 v[210:211], v191 offset:43008
    v_cvt_pk_bf16_f32 v68, v244, v245
    v_cvt_pk_bf16_f32 v69, v246, v247
    v_cvt_pk_bf16_f32 v70, v248, v249
    v_cvt_pk_bf16_f32 v71, v250, v251
    s_waitcnt lgkmcnt(10)
    v_mfma_f32_32x32x16_bf16 a[96:111], v[220:223], v[64:67], a[96:111]
    ds_read_b64_tr_b16 v[212:213], v188 offset:41216
    ds_read_b64_tr_b16 v[214:215], v188 offset:43264
    s_waitcnt lgkmcnt(10)
    v_mfma_f32_32x32x16_bf16 a[112:127], v[224:227], v[64:67], a[112:127]
    ds_read_b64_tr_b16 v[216:217], v189 offset:41216
    ds_read_b64_tr_b16 v[218:219], v189 offset:43264
    ds_read_b128 v[228:231], v252 offset:1152
    ds_read_b128 v[232:235], v252 offset:1168
    ds_read_b128 v[236:239], v252 offset:3456
    ds_read_b128 v[240:243], v252 offset:3472
    s_waitcnt lgkmcnt(14)
    v_mfma_f32_32x32x16_bf16 a[0:15], v[196:199], v[68:71], a[0:15]
    ds_read_b64_tr_b16 v[220:221], v190 offset:41216
    ds_read_b64_tr_b16 v[222:223], v190 offset:43264
    s_waitcnt lgkmcnt(14)
    v_mfma_f32_32x32x16_bf16 a[16:31], v[200:203], v[68:71], a[16:31]
    ds_read_b64_tr_b16 v[224:225], v191 offset:41216
    ds_read_b64_tr_b16 v[226:227], v191 offset:43264
    v_lshlrev_b32 v244, 16, v72
    v_and_b32 v245, 0xffff0000, v72
    v_lshlrev_b32 v246, 16, v73
    v_and_b32 v247, 0xffff0000, v73
    v_lshlrev_b32 v248, 16, v74
    v_and_b32 v249, 0xffff0000, v74
    v_lshlrev_b32 v250, 16, v75
    v_and_b32 v251, 0xffff0000, v75
    s_waitcnt lgkmcnt(14)
    v_mfma_f32_32x32x16_bf16 a[32:47], v[204:207], v[68:71], a[32:47]
    s_waitcnt vmcnt(12)
    s_barrier
    ds_read_b64_tr_b16 v[196:197], v192 offset:0
    ds_read_b64_tr_b16 v[198:199], v192 offset:2048
    s_add_u32 m0, s45, 81920
    s_mov_b32 s46, 3407872
    buffer_load_dwordx4 v159, s[28:31], s46 offen lds
    s_waitcnt lgkmcnt(14)
    v_mfma_f32_32x32x16_bf16 a[48:63], v[208:211], v[68:71], a[48:63]
    ds_read_b64_tr_b16 v[200:201], v193 offset:0
    ds_read_b64_tr_b16 v[202:203], v193 offset:2048
    s_add_u32 m0, s45, 86016
    s_mov_b32 s46, 3473408
    buffer_load_dwordx4 v159, s[28:31], s46 offen lds
    s_waitcnt lgkmcnt(8)
    v_fma_f32 v244, v244, v228, v236
    v_fma_f32 v245, v245, v229, v237
    v_fma_f32 v246, v246, v230, v238
    v_fma_f32 v247, v247, v231, v239
    v_fma_f32 v248, v248, v232, v240
    v_fma_f32 v249, v249, v233, v241
    v_fma_f32 v250, v250, v234, v242
    v_fma_f32 v251, v251, v235, v243
    v_mfma_f32_32x32x16_bf16 a[64:79], v[212:215], v[68:71], a[64:79]
    ds_read_b64_tr_b16 v[204:205], v194 offset:0
    ds_read_b64_tr_b16 v[206:207], v194 offset:2048
    s_add_u32 m0, s45, 90112
    s_mov_b32 s46, 3538944
    buffer_load_dwordx4 v159, s[28:31], s46 offen lds
    v_mfma_f32_32x32x16_bf16 a[80:95], v[216:219], v[68:71], a[80:95]
    ds_read_b64_tr_b16 v[208:209], v195 offset:0
    ds_read_b64_tr_b16 v[210:211], v195 offset:2048
    s_add_u32 m0, s45, 94208
    s_mov_b32 s46, 3604480
    buffer_load_dwordx4 v159, s[28:31], s46 offen lds
    v_cvt_pk_bf16_f32 v72, v244, v245
    v_cvt_pk_bf16_f32 v73, v246, v247
    v_cvt_pk_bf16_f32 v74, v248, v249
    v_cvt_pk_bf16_f32 v75, v250, v251
    s_waitcnt lgkmcnt(10)
    v_mfma_f32_32x32x16_bf16 a[96:111], v[220:223], v[68:71], a[96:111]
    ds_read_b64_tr_b16 v[212:213], v192 offset:256
    ds_read_b64_tr_b16 v[214:215], v192 offset:2304
    s_waitcnt lgkmcnt(10)
    v_mfma_f32_32x32x16_bf16 a[112:127], v[224:227], v[68:71], a[112:127]
    ds_read_b64_tr_b16 v[216:217], v193 offset:256
    ds_read_b64_tr_b16 v[218:219], v193 offset:2304
    s_mov_b32 s42, 0
    s_add_u32 m0, s41, 0
    s_nop 0
    buffer_load_dwordx4 v156, s[20:23], s42 offen lds
    ds_read_b128 v[228:231], v252 offset:1216
    ds_read_b128 v[232:235], v252 offset:1232
    ds_read_b128 v[236:239], v252 offset:3520
    ds_read_b128 v[240:243], v252 offset:3536
    s_waitcnt lgkmcnt(14)
    v_mfma_f32_32x32x16_bf16 a[0:15], v[196:199], v[72:75], a[0:15]
    ds_read_b64_tr_b16 v[220:221], v194 offset:256
    ds_read_b64_tr_b16 v[222:223], v194 offset:2304
    s_mov_b32 s42, 0
    buffer_load_dwordx4 v157, s[20:23], s42 offen offset:2048 lds
    s_waitcnt lgkmcnt(14)
    v_mfma_f32_32x32x16_bf16 a[16:31], v[200:203], v[72:75], a[16:31]
    ds_read_b64_tr_b16 v[224:225], v195 offset:256
    ds_read_b64_tr_b16 v[226:227], v195 offset:2304
    s_mov_b32 s42, 8192
    s_add_u32 m0, s41, 8192
    s_nop 0
    buffer_load_dwordx4 v156, s[20:23], s42 offen lds
    v_lshlrev_b32 v244, 16, v76
    v_and_b32 v245, 0xffff0000, v76
    v_lshlrev_b32 v246, 16, v77
    v_and_b32 v247, 0xffff0000, v77
    v_lshlrev_b32 v248, 16, v78
    v_and_b32 v249, 0xffff0000, v78
    v_lshlrev_b32 v250, 16, v79
    v_and_b32 v251, 0xffff0000, v79
    s_waitcnt lgkmcnt(14)
    v_mfma_f32_32x32x16_bf16 a[32:47], v[204:207], v[72:75], a[32:47]
    ds_read_b64_tr_b16 v[196:197], v192 offset:8192
    ds_read_b64_tr_b16 v[198:199], v192 offset:10240
    s_mov_b32 s42, 8192
    buffer_load_dwordx4 v157, s[20:23], s42 offen offset:2048 lds
    s_waitcnt lgkmcnt(14)
    v_mfma_f32_32x32x16_bf16 a[48:63], v[208:211], v[72:75], a[48:63]
    ds_read_b64_tr_b16 v[200:201], v193 offset:8192
    ds_read_b64_tr_b16 v[202:203], v193 offset:10240
    s_mov_b32 s42, 16384
    s_add_u32 m0, s41, 16384
    s_nop 0
    buffer_load_dwordx4 v156, s[20:23], s42 offen lds
    s_waitcnt lgkmcnt(8)
    v_fma_f32 v244, v244, v228, v236
    v_fma_f32 v245, v245, v229, v237
    v_fma_f32 v246, v246, v230, v238
    v_fma_f32 v247, v247, v231, v239
    v_fma_f32 v248, v248, v232, v240
    v_fma_f32 v249, v249, v233, v241
    v_fma_f32 v250, v250, v234, v242
    v_fma_f32 v251, v251, v235, v243
    v_mfma_f32_32x32x16_bf16 a[64:79], v[212:215], v[72:75], a[64:79]
    ds_read_b64_tr_b16 v[204:205], v194 offset:8192
    ds_read_b64_tr_b16 v[206:207], v194 offset:10240
    s_mov_b32 s42, 16384
    buffer_load_dwordx4 v157, s[20:23], s42 offen offset:2048 lds
    v_mfma_f32_32x32x16_bf16 a[80:95], v[216:219], v[72:75], a[80:95]
    ds_read_b64_tr_b16 v[208:209], v195 offset:8192
    ds_read_b64_tr_b16 v[210:211], v195 offset:10240
    s_mov_b32 s42, 24576
    s_add_u32 m0, s41, 24576
    s_nop 0
    buffer_load_dwordx4 v156, s[20:23], s42 offen lds
    v_cvt_pk_bf16_f32 v76, v244, v245
    v_cvt_pk_bf16_f32 v77, v246, v247
    v_cvt_pk_bf16_f32 v78, v248, v249
    v_cvt_pk_bf16_f32 v79, v250, v251
    s_waitcnt lgkmcnt(10)
    v_mfma_f32_32x32x16_bf16 a[96:111], v[220:223], v[72:75], a[96:111]
    ds_read_b64_tr_b16 v[212:213], v192 offset:8448
    ds_read_b64_tr_b16 v[214:215], v192 offset:10496
    s_mov_b32 s42, 24576
    buffer_load_dwordx4 v157, s[20:23], s42 offen offset:2048 lds
    s_waitcnt lgkmcnt(10)
    v_mfma_f32_32x32x16_bf16 a[112:127], v[224:227], v[72:75], a[112:127]
    ds_read_b64_tr_b16 v[216:217], v193 offset:8448
    ds_read_b64_tr_b16 v[218:219], v193 offset:10496
    s_mov_b32 s43, 0
    s_add_u32 m0, s41, 32768
    s_nop 0
    buffer_load_dwordx4 v158, s[24:27], s43 offen lds
    ds_read_b128 v[228:231], v252 offset:1280
    ds_read_b128 v[232:235], v252 offset:1296
    ds_read_b128 v[236:239], v252 offset:3584
    ds_read_b128 v[240:243], v252 offset:3600
    s_waitcnt lgkmcnt(14)
    v_mfma_f32_32x32x16_bf16 a[0:15], v[196:199], v[76:79], a[0:15]
    ds_read_b64_tr_b16 v[220:221], v194 offset:8448
    ds_read_b64_tr_b16 v[222:223], v194 offset:10496
    s_mov_b32 s43, 0
    buffer_load_dwordx4 v158, s[24:27], s43 offen offset:2048 lds
    s_waitcnt lgkmcnt(14)
    v_mfma_f32_32x32x16_bf16 a[16:31], v[200:203], v[76:79], a[16:31]
    ds_read_b64_tr_b16 v[224:225], v195 offset:8448
    ds_read_b64_tr_b16 v[226:227], v195 offset:10496
    s_mov_b32 s43, 8192
    s_add_u32 m0, s41, 40960
    s_nop 0
    buffer_load_dwordx4 v158, s[24:27], s43 offen lds
    v_lshlrev_b32 v244, 16, v80
    v_and_b32 v245, 0xffff0000, v80
    v_lshlrev_b32 v246, 16, v81
    v_and_b32 v247, 0xffff0000, v81
    v_lshlrev_b32 v248, 16, v82
    v_and_b32 v249, 0xffff0000, v82
    v_lshlrev_b32 v250, 16, v83
    v_and_b32 v251, 0xffff0000, v83
    s_waitcnt lgkmcnt(14)
    v_mfma_f32_32x32x16_bf16 a[32:47], v[204:207], v[76:79], a[32:47]
    s_waitcnt vmcnt(23)
    s_barrier
    ds_read_b64_tr_b16 v[196:197], v192 offset:16384
    ds_read_b64_tr_b16 v[198:199], v192 offset:18432
    s_mov_b32 s43, 8192
    buffer_load_dwordx4 v158, s[24:27], s43 offen offset:2048 lds
    s_waitcnt lgkmcnt(14)
    v_mfma_f32_32x32x16_bf16 a[48:63], v[208:211], v[76:79], a[48:63]
    ds_read_b64_tr_b16 v[200:201], v193 offset:16384
    ds_read_b64_tr_b16 v[202:203], v193 offset:18432
    s_add_u32 m0, s45, 98304
    s_mov_b32 s46, 3670016
    buffer_load_dwordx4 v159, s[28:31], s46 offen lds
    s_waitcnt lgkmcnt(8)
    v_fma_f32 v244, v244, v228, v236
    v_fma_f32 v245, v245, v229, v237
    v_fma_f32 v246, v246, v230, v238
    v_fma_f32 v247, v247, v231, v239
    v_fma_f32 v248, v248, v232, v240
    v_fma_f32 v249, v249, v233, v241
    v_fma_f32 v250, v250, v234, v242
    v_fma_f32 v251, v251, v235, v243
    v_mfma_f32_32x32x16_bf16 a[64:79], v[212:215], v[76:79], a[64:79]
    ds_read_b64_tr_b16 v[204:205], v194 offset:16384
    ds_read_b64_tr_b16 v[206:207], v194 offset:18432
    s_add_u32 m0, s45, 102400
    s_mov_b32 s46, 3735552
    buffer_load_dwordx4 v159, s[28:31], s46 offen lds
    v_mfma_f32_32x32x16_bf16 a[80:95], v[216:219], v[76:79], a[80:95]
    ds_read_b64_tr_b16 v[208:209], v195 offset:16384
    ds_read_b64_tr_b16 v[210:211], v195 offset:18432
    s_add_u32 m0, s45, 106496
    s_mov_b32 s46, 3801088
    buffer_load_dwordx4 v159, s[28:31], s46 offen lds
    v_cvt_pk_bf16_f32 v80, v244, v245
    v_cvt_pk_bf16_f32 v81, v246, v247
    v_cvt_pk_bf16_f32 v82, v248, v249
    v_cvt_pk_bf16_f32 v83, v250, v251
    s_waitcnt lgkmcnt(10)
    v_mfma_f32_32x32x16_bf16 a[96:111], v[220:223], v[76:79], a[96:111]
    ds_read_b64_tr_b16 v[212:213], v192 offset:16640
    ds_read_b64_tr_b16 v[214:215], v192 offset:18688
    s_add_u32 m0, s45, 110592
    s_mov_b32 s46, 3866624
    buffer_load_dwordx4 v159, s[28:31], s46 offen lds
    s_waitcnt lgkmcnt(10)
    v_mfma_f32_32x32x16_bf16 a[112:127], v[224:227], v[76:79], a[112:127]
    ds_read_b64_tr_b16 v[216:217], v193 offset:16640
    ds_read_b64_tr_b16 v[218:219], v193 offset:18688
    ds_read_b128 v[228:231], v252 offset:1344
    ds_read_b128 v[232:235], v252 offset:1360
    ds_read_b128 v[236:239], v252 offset:3648
    ds_read_b128 v[240:243], v252 offset:3664
    s_waitcnt lgkmcnt(14)
    v_mfma_f32_32x32x16_bf16 a[0:15], v[196:199], v[80:83], a[0:15]
    ds_read_b64_tr_b16 v[220:221], v194 offset:16640
    ds_read_b64_tr_b16 v[222:223], v194 offset:18688
    s_waitcnt lgkmcnt(14)
    v_mfma_f32_32x32x16_bf16 a[16:31], v[200:203], v[80:83], a[16:31]
    ds_read_b64_tr_b16 v[224:225], v195 offset:16640
    ds_read_b64_tr_b16 v[226:227], v195 offset:18688
    v_lshlrev_b32 v244, 16, v84
    v_and_b32 v245, 0xffff0000, v84
    v_lshlrev_b32 v246, 16, v85
    v_and_b32 v247, 0xffff0000, v85
    v_lshlrev_b32 v248, 16, v86
    v_and_b32 v249, 0xffff0000, v86
    v_lshlrev_b32 v250, 16, v87
    v_and_b32 v251, 0xffff0000, v87
    s_waitcnt lgkmcnt(14)
    v_mfma_f32_32x32x16_bf16 a[32:47], v[204:207], v[80:83], a[32:47]
    ds_read_b64_tr_b16 v[196:197], v192 offset:24576
    ds_read_b64_tr_b16 v[198:199], v192 offset:26624
    s_waitcnt lgkmcnt(14)
    v_mfma_f32_32x32x16_bf16 a[48:63], v[208:211], v[80:83], a[48:63]
    ds_read_b64_tr_b16 v[200:201], v193 offset:24576
    ds_read_b64_tr_b16 v[202:203], v193 offset:26624
    s_waitcnt lgkmcnt(8)
    v_fma_f32 v244, v244, v228, v236
    v_fma_f32 v245, v245, v229, v237
    v_fma_f32 v246, v246, v230, v238
    v_fma_f32 v247, v247, v231, v239
    v_fma_f32 v248, v248, v232, v240
    v_fma_f32 v249, v249, v233, v241
    v_fma_f32 v250, v250, v234, v242
    v_fma_f32 v251, v251, v235, v243
    v_mfma_f32_32x32x16_bf16 a[64:79], v[212:215], v[80:83], a[64:79]
    ds_read_b64_tr_b16 v[204:205], v194 offset:24576
    ds_read_b64_tr_b16 v[206:207], v194 offset:26624
    v_mfma_f32_32x32x16_bf16 a[80:95], v[216:219], v[80:83], a[80:95]
    ds_read_b64_tr_b16 v[208:209], v195 offset:24576
    ds_read_b64_tr_b16 v[210:211], v195 offset:26624
    v_cvt_pk_bf16_f32 v84, v244, v245
    v_cvt_pk_bf16_f32 v85, v246, v247
    v_cvt_pk_bf16_f32 v86, v248, v249
    v_cvt_pk_bf16_f32 v87, v250, v251
    s_waitcnt lgkmcnt(10)
    v_mfma_f32_32x32x16_bf16 a[96:111], v[220:223], v[80:83], a[96:111]
    ds_read_b64_tr_b16 v[212:213], v192 offset:24832
    ds_read_b64_tr_b16 v[214:215], v192 offset:26880
    s_waitcnt lgkmcnt(10)
    v_mfma_f32_32x32x16_bf16 a[112:127], v[224:227], v[80:83], a[112:127]
    ds_read_b64_tr_b16 v[216:217], v193 offset:24832
    ds_read_b64_tr_b16 v[218:219], v193 offset:26880
    ds_read_b128 v[228:231], v252 offset:1408
    ds_read_b128 v[232:235], v252 offset:1424
    ds_read_b128 v[236:239], v252 offset:3712
    ds_read_b128 v[240:243], v252 offset:3728
    s_waitcnt lgkmcnt(14)
    v_mfma_f32_32x32x16_bf16 a[0:15], v[196:199], v[84:87], a[0:15]
    ds_read_b64_tr_b16 v[220:221], v194 offset:24832
    ds_read_b64_tr_b16 v[222:223], v194 offset:26880
    s_waitcnt lgkmcnt(14)
    v_mfma_f32_32x32x16_bf16 a[16:31], v[200:203], v[84:87], a[16:31]
    ds_read_b64_tr_b16 v[224:225], v195 offset:24832
    ds_read_b64_tr_b16 v[226:227], v195 offset:26880
    v_lshlrev_b32 v244, 16, v88
    v_and_b32 v245, 0xffff0000, v88
    v_lshlrev_b32 v246, 16, v89
    v_and_b32 v247, 0xffff0000, v89
    v_lshlrev_b32 v248, 16, v90
    v_and_b32 v249, 0xffff0000, v90
    v_lshlrev_b32 v250, 16, v91
    v_and_b32 v251, 0xffff0000, v91
    s_waitcnt lgkmcnt(14)
    v_mfma_f32_32x32x16_bf16 a[32:47], v[204:207], v[84:87], a[32:47]
    s_waitcnt vmcnt(24)
    s_barrier
    ds_read_b64_tr_b16 v[196:197], v192 offset:32768
    ds_read_b64_tr_b16 v[198:199], v192 offset:34816
    s_add_u32 m0, s45, 114688
    s_mov_b32 s46, 3932160
    buffer_load_dwordx4 v159, s[28:31], s46 offen lds
    s_waitcnt lgkmcnt(14)
    v_mfma_f32_32x32x16_bf16 a[48:63], v[208:211], v[84:87], a[48:63]
    ds_read_b64_tr_b16 v[200:201], v193 offset:32768
    ds_read_b64_tr_b16 v[202:203], v193 offset:34816
    s_add_u32 m0, s45, 118784
    s_mov_b32 s46, 3997696
    buffer_load_dwordx4 v159, s[28:31], s46 offen lds
    s_waitcnt lgkmcnt(8)
    v_fma_f32 v244, v244, v228, v236
    v_fma_f32 v245, v245, v229, v237
    v_fma_f32 v246, v246, v230, v238
    v_fma_f32 v247, v247, v231, v239
    v_fma_f32 v248, v248, v232, v240
    v_fma_f32 v249, v249, v233, v241
    v_fma_f32 v250, v250, v234, v242
    v_fma_f32 v251, v251, v235, v243
    v_mfma_f32_32x32x16_bf16 a[64:79], v[212:215], v[84:87], a[64:79]
    ds_read_b64_tr_b16 v[204:205], v194 offset:32768
    ds_read_b64_tr_b16 v[206:207], v194 offset:34816
    s_add_u32 m0, s45, 122880
    s_mov_b32 s46, 4063232
    buffer_load_dwordx4 v159, s[28:31], s46 offen lds
    v_mfma_f32_32x32x16_bf16 a[80:95], v[216:219], v[84:87], a[80:95]
    ds_read_b64_tr_b16 v[208:209], v195 offset:32768
    ds_read_b64_tr_b16 v[210:211], v195 offset:34816
    s_add_u32 m0, s45, 126976
    s_mov_b32 s46, 4128768
    buffer_load_dwordx4 v159, s[28:31], s46 offen lds
    v_cvt_pk_bf16_f32 v88, v244, v245
    v_cvt_pk_bf16_f32 v89, v246, v247
    v_cvt_pk_bf16_f32 v90, v248, v249
    v_cvt_pk_bf16_f32 v91, v250, v251
    s_waitcnt lgkmcnt(10)
    v_mfma_f32_32x32x16_bf16 a[96:111], v[220:223], v[84:87], a[96:111]
    ds_read_b64_tr_b16 v[212:213], v192 offset:33024
    ds_read_b64_tr_b16 v[214:215], v192 offset:35072
    s_waitcnt lgkmcnt(10)
    v_mfma_f32_32x32x16_bf16 a[112:127], v[224:227], v[84:87], a[112:127]
    ds_read_b64_tr_b16 v[216:217], v193 offset:33024
    ds_read_b64_tr_b16 v[218:219], v193 offset:35072
    ds_read_b128 v[228:231], v252 offset:1472
    ds_read_b128 v[232:235], v252 offset:1488
    ds_read_b128 v[236:239], v252 offset:3776
    ds_read_b128 v[240:243], v252 offset:3792
    s_waitcnt lgkmcnt(14)
    v_mfma_f32_32x32x16_bf16 a[0:15], v[196:199], v[88:91], a[0:15]
    ds_read_b64_tr_b16 v[220:221], v194 offset:33024
    ds_read_b64_tr_b16 v[222:223], v194 offset:35072
    s_waitcnt lgkmcnt(14)
    v_mfma_f32_32x32x16_bf16 a[16:31], v[200:203], v[88:91], a[16:31]
    ds_read_b64_tr_b16 v[224:225], v195 offset:33024
    ds_read_b64_tr_b16 v[226:227], v195 offset:35072
    v_lshlrev_b32 v244, 16, v92
    v_and_b32 v245, 0xffff0000, v92
    v_lshlrev_b32 v246, 16, v93
    v_and_b32 v247, 0xffff0000, v93
    v_lshlrev_b32 v248, 16, v94
    v_and_b32 v249, 0xffff0000, v94
    v_lshlrev_b32 v250, 16, v95
    v_and_b32 v251, 0xffff0000, v95
    s_waitcnt lgkmcnt(14)
    v_mfma_f32_32x32x16_bf16 a[32:47], v[204:207], v[88:91], a[32:47]
    ds_read_b64_tr_b16 v[196:197], v192 offset:40960
    ds_read_b64_tr_b16 v[198:199], v192 offset:43008
    s_waitcnt lgkmcnt(14)
    v_mfma_f32_32x32x16_bf16 a[48:63], v[208:211], v[88:91], a[48:63]
    ds_read_b64_tr_b16 v[200:201], v193 offset:40960
    ds_read_b64_tr_b16 v[202:203], v193 offset:43008
    s_waitcnt lgkmcnt(8)
    v_fma_f32 v244, v244, v228, v236
    v_fma_f32 v245, v245, v229, v237
    v_fma_f32 v246, v246, v230, v238
    v_fma_f32 v247, v247, v231, v239
    v_fma_f32 v248, v248, v232, v240
    v_fma_f32 v249, v249, v233, v241
    v_fma_f32 v250, v250, v234, v242
    v_fma_f32 v251, v251, v235, v243
    v_mfma_f32_32x32x16_bf16 a[64:79], v[212:215], v[88:91], a[64:79]
    ds_read_b64_tr_b16 v[204:205], v194 offset:40960
    ds_read_b64_tr_b16 v[206:207], v194 offset:43008
    v_mfma_f32_32x32x16_bf16 a[80:95], v[216:219], v[88:91], a[80:95]
    ds_read_b64_tr_b16 v[208:209], v195 offset:40960
    ds_read_b64_tr_b16 v[210:211], v195 offset:43008
    v_cvt_pk_bf16_f32 v92, v244, v245
    v_cvt_pk_bf16_f32 v93, v246, v247
    v_cvt_pk_bf16_f32 v94, v248, v249
    v_cvt_pk_bf16_f32 v95, v250, v251
    s_waitcnt lgkmcnt(10)
    v_mfma_f32_32x32x16_bf16 a[96:111], v[220:223], v[88:91], a[96:111]
    ds_read_b64_tr_b16 v[212:213], v192 offset:41216
    ds_read_b64_tr_b16 v[214:215], v192 offset:43264
    s_waitcnt lgkmcnt(10)
    v_mfma_f32_32x32x16_bf16 a[112:127], v[224:227], v[88:91], a[112:127]
    ds_read_b64_tr_b16 v[216:217], v193 offset:41216
    ds_read_b64_tr_b16 v[218:219], v193 offset:43264
    ds_read_b128 v[228:231], v252 offset:1536
    ds_read_b128 v[232:235], v252 offset:1552
    ds_read_b128 v[236:239], v252 offset:3840
    ds_read_b128 v[240:243], v252 offset:3856
    s_waitcnt lgkmcnt(14)
    v_mfma_f32_32x32x16_bf16 a[0:15], v[196:199], v[92:95], a[0:15]
    ds_read_b64_tr_b16 v[220:221], v194 offset:41216
    ds_read_b64_tr_b16 v[222:223], v194 offset:43264
    s_waitcnt lgkmcnt(14)
    v_mfma_f32_32x32x16_bf16 a[16:31], v[200:203], v[92:95], a[16:31]
    ds_read_b64_tr_b16 v[224:225], v195 offset:41216
    ds_read_b64_tr_b16 v[226:227], v195 offset:43264
    v_lshlrev_b32 v244, 16, v96
    v_and_b32 v245, 0xffff0000, v96
    v_lshlrev_b32 v246, 16, v97
    v_and_b32 v247, 0xffff0000, v97
    v_lshlrev_b32 v248, 16, v98
    v_and_b32 v249, 0xffff0000, v98
    v_lshlrev_b32 v250, 16, v99
    v_and_b32 v251, 0xffff0000, v99
    s_waitcnt lgkmcnt(14)
    v_mfma_f32_32x32x16_bf16 a[32:47], v[204:207], v[92:95], a[32:47]
    s_waitcnt vmcnt(24)
    s_barrier
    ds_read_b64_tr_b16 v[196:197], v188 offset:0
    ds_read_b64_tr_b16 v[198:199], v188 offset:2048
    s_add_u32 m0, s45, 131072
    s_mov_b32 s46, 4194304
    buffer_load_dwordx4 v159, s[28:31], s46 offen lds
    s_waitcnt lgkmcnt(14)
    v_mfma_f32_32x32x16_bf16 a[48:63], v[208:211], v[92:95], a[48:63]
    ds_read_b64_tr_b16 v[200:201], v189 offset:0
    ds_read_b64_tr_b16 v[202:203], v189 offset:2048
    s_add_u32 m0, s45, 135168
    s_mov_b32 s46, 4259840
    buffer_load_dwordx4 v159, s[28:31], s46 offen lds
    s_waitcnt lgkmcnt(8)
    v_fma_f32 v244, v244, v228, v236
    v_fma_f32 v245, v245, v229, v237
    v_fma_f32 v246, v246, v230, v238
    v_fma_f32 v247, v247, v231, v239
    v_fma_f32 v248, v248, v232, v240
    v_fma_f32 v249, v249, v233, v241
    v_fma_f32 v250, v250, v234, v242
    v_fma_f32 v251, v251, v235, v243
    v_mfma_f32_32x32x16_bf16 a[64:79], v[212:215], v[92:95], a[64:79]
    ds_read_b64_tr_b16 v[204:205], v190 offset:0
    ds_read_b64_tr_b16 v[206:207], v190 offset:2048
    s_add_u32 m0, s45, 139264
    s_mov_b32 s46, 4325376
    buffer_load_dwordx4 v159, s[28:31], s46 offen lds
    v_mfma_f32_32x32x16_bf16 a[80:95], v[216:219], v[92:95], a[80:95]
    ds_read_b64_tr_b16 v[208:209], v191 offset:0
    ds_read_b64_tr_b16 v[210:211], v191 offset:2048
    s_add_u32 m0, s45, 143360
    s_mov_b32 s46, 4390912
    buffer_load_dwordx4 v159, s[28:31], s46 offen lds
    v_cvt_pk_bf16_f32 v96, v244, v245
    v_cvt_pk_bf16_f32 v97, v246, v247
    v_cvt_pk_bf16_f32 v98, v248, v249
    v_cvt_pk_bf16_f32 v99, v250, v251
    s_waitcnt lgkmcnt(10)
    v_mfma_f32_32x32x16_bf16 a[96:111], v[220:223], v[92:95], a[96:111]
    ds_read_b64_tr_b16 v[212:213], v188 offset:256
    ds_read_b64_tr_b16 v[214:215], v188 offset:2304
    s_waitcnt lgkmcnt(10)
    v_mfma_f32_32x32x16_bf16 a[112:127], v[224:227], v[92:95], a[112:127]
    ds_read_b64_tr_b16 v[216:217], v189 offset:256
    ds_read_b64_tr_b16 v[218:219], v189 offset:2304
    ds_read_b128 v[228:231], v252 offset:1600
    ds_read_b128 v[232:235], v252 offset:1616
    ds_read_b128 v[236:239], v252 offset:3904
    ds_read_b128 v[240:243], v252 offset:3920
    s_waitcnt lgkmcnt(14)
    v_mfma_f32_32x32x16_bf16 a[0:15], v[196:199], v[96:99], a[0:15]
    ds_read_b64_tr_b16 v[220:221], v190 offset:256
    ds_read_b64_tr_b16 v[222:223], v190 offset:2304
    s_waitcnt lgkmcnt(14)
    v_mfma_f32_32x32x16_bf16 a[16:31], v[200:203], v[96:99], a[16:31]
    ds_read_b64_tr_b16 v[224:225], v191 offset:256
    ds_read_b64_tr_b16 v[226:227], v191 offset:2304
    v_lshlrev_b32 v244, 16, v100
    v_and_b32 v245, 0xffff0000, v100
    v_lshlrev_b32 v246, 16, v101
    v_and_b32 v247, 0xffff0000, v101
    v_lshlrev_b32 v248, 16, v102
    v_and_b32 v249, 0xffff0000, v102
    v_lshlrev_b32 v250, 16, v103
    v_and_b32 v251, 0xffff0000, v103
    s_waitcnt lgkmcnt(14)
    v_mfma_f32_32x32x16_bf16 a[32:47], v[204:207], v[96:99], a[32:47]
    ds_read_b64_tr_b16 v[196:197], v188 offset:8192
    ds_read_b64_tr_b16 v[198:199], v188 offset:10240
    s_waitcnt lgkmcnt(14)
    v_mfma_f32_32x32x16_bf16 a[48:63], v[208:211], v[96:99], a[48:63]
    ds_read_b64_tr_b16 v[200:201], v189 offset:8192
    ds_read_b64_tr_b16 v[202:203], v189 offset:10240
    s_waitcnt lgkmcnt(8)
    v_fma_f32 v244, v244, v228, v236
    v_fma_f32 v245, v245, v229, v237
    v_fma_f32 v246, v246, v230, v238
    v_fma_f32 v247, v247, v231, v239
    v_fma_f32 v248, v248, v232, v240
    v_fma_f32 v249, v249, v233, v241
    v_fma_f32 v250, v250, v234, v242
    v_fma_f32 v251, v251, v235, v243
    v_mfma_f32_32x32x16_bf16 a[64:79], v[212:215], v[96:99], a[64:79]
    ds_read_b64_tr_b16 v[204:205], v190 offset:8192
    ds_read_b64_tr_b16 v[206:207], v190 offset:10240
    v_mfma_f32_32x32x16_bf16 a[80:95], v[216:219], v[96:99], a[80:95]
    ds_read_b64_tr_b16 v[208:209], v191 offset:8192
    ds_read_b64_tr_b16 v[210:211], v191 offset:10240
    v_cvt_pk_bf16_f32 v100, v244, v245
    v_cvt_pk_bf16_f32 v101, v246, v247
    v_cvt_pk_bf16_f32 v102, v248, v249
    v_cvt_pk_bf16_f32 v103, v250, v251
    s_waitcnt lgkmcnt(10)
    v_mfma_f32_32x32x16_bf16 a[96:111], v[220:223], v[96:99], a[96:111]
    ds_read_b64_tr_b16 v[212:213], v188 offset:8448
    ds_read_b64_tr_b16 v[214:215], v188 offset:10496
    s_waitcnt lgkmcnt(10)
    v_mfma_f32_32x32x16_bf16 a[112:127], v[224:227], v[96:99], a[112:127]
    ds_read_b64_tr_b16 v[216:217], v189 offset:8448
    ds_read_b64_tr_b16 v[218:219], v189 offset:10496
    ds_read_b128 v[228:231], v252 offset:1664
    ds_read_b128 v[232:235], v252 offset:1680
    ds_read_b128 v[236:239], v252 offset:3968
    ds_read_b128 v[240:243], v252 offset:3984
    s_waitcnt lgkmcnt(14)
    v_mfma_f32_32x32x16_bf16 a[0:15], v[196:199], v[100:103], a[0:15]
    ds_read_b64_tr_b16 v[220:221], v190 offset:8448
    ds_read_b64_tr_b16 v[222:223], v190 offset:10496
    s_waitcnt lgkmcnt(14)
    v_mfma_f32_32x32x16_bf16 a[16:31], v[200:203], v[100:103], a[16:31]
    ds_read_b64_tr_b16 v[224:225], v191 offset:8448
    ds_read_b64_tr_b16 v[226:227], v191 offset:10496
    v_lshlrev_b32 v244, 16, v104
    v_and_b32 v245, 0xffff0000, v104
    v_lshlrev_b32 v246, 16, v105
    v_and_b32 v247, 0xffff0000, v105
    v_lshlrev_b32 v248, 16, v106
    v_and_b32 v249, 0xffff0000, v106
    v_lshlrev_b32 v250, 16, v107
    v_and_b32 v251, 0xffff0000, v107
    s_waitcnt lgkmcnt(14)
    v_mfma_f32_32x32x16_bf16 a[32:47], v[204:207], v[100:103], a[32:47]
    s_waitcnt vmcnt(24)
    s_barrier
    ds_read_b64_tr_b16 v[196:197], v188 offset:16384
    ds_read_b64_tr_b16 v[198:199], v188 offset:18432
    s_add_u32 m0, s45, 147456
    s_mov_b32 s46, 4456448
    buffer_load_dwordx4 v159, s[28:31], s46 offen lds
    s_waitcnt lgkmcnt(14)
    v_mfma_f32_32x32x16_bf16 a[48:63], v[208:211], v[100:103], a[48:63]
    ds_read_b64_tr_b16 v[200:201], v189 offset:16384
    ds_read_b64_tr_b16 v[202:203], v189 offset:18432
    s_add_u32 m0, s45, 151552
    s_mov_b32 s46, 4521984
    buffer_load_dwordx4 v159, s[28:31], s46 offen lds
    s_waitcnt lgkmcnt(8)
    v_fma_f32 v244, v244, v228, v236
    v_fma_f32 v245, v245, v229, v237
    v_fma_f32 v246, v246, v230, v238
    v_fma_f32 v247, v247, v231, v239
    v_fma_f32 v248, v248, v232, v240
    v_fma_f32 v249, v249, v233, v241
    v_fma_f32 v250, v250, v234, v242
    v_fma_f32 v251, v251, v235, v243
    v_mfma_f32_32x32x16_bf16 a[64:79], v[212:215], v[100:103], a[64:79]
    ds_read_b64_tr_b16 v[204:205], v190 offset:16384
    ds_read_b64_tr_b16 v[206:207], v190 offset:18432
    s_add_u32 m0, s45, 155648
    s_mov_b32 s46, 4587520
    buffer_load_dwordx4 v159, s[28:31], s46 offen lds
    v_mfma_f32_32x32x16_bf16 a[80:95], v[216:219], v[100:103], a[80:95]
    ds_read_b64_tr_b16 v[208:209], v191 offset:16384
    ds_read_b64_tr_b16 v[210:211], v191 offset:18432
    s_add_u32 m0, s45, 159744
    s_mov_b32 s46, 4653056
    buffer_load_dwordx4 v159, s[28:31], s46 offen lds
    v_cvt_pk_bf16_f32 v104, v244, v245
    v_cvt_pk_bf16_f32 v105, v246, v247
    v_cvt_pk_bf16_f32 v106, v248, v249
    v_cvt_pk_bf16_f32 v107, v250, v251
    s_waitcnt lgkmcnt(10)
    v_mfma_f32_32x32x16_bf16 a[96:111], v[220:223], v[100:103], a[96:111]
    ds_read_b64_tr_b16 v[212:213], v188 offset:16640
    ds_read_b64_tr_b16 v[214:215], v188 offset:18688
    s_waitcnt lgkmcnt(10)
    v_mfma_f32_32x32x16_bf16 a[112:127], v[224:227], v[100:103], a[112:127]
    ds_read_b64_tr_b16 v[216:217], v189 offset:16640
    ds_read_b64_tr_b16 v[218:219], v189 offset:18688
    ds_read_b128 v[228:231], v252 offset:1728
    ds_read_b128 v[232:235], v252 offset:1744
    ds_read_b128 v[236:239], v252 offset:4032
    ds_read_b128 v[240:243], v252 offset:4048
    s_waitcnt lgkmcnt(14)
    v_mfma_f32_32x32x16_bf16 a[0:15], v[196:199], v[104:107], a[0:15]
    ds_read_b64_tr_b16 v[220:221], v190 offset:16640
    ds_read_b64_tr_b16 v[222:223], v190 offset:18688
    s_waitcnt lgkmcnt(14)
    v_mfma_f32_32x32x16_bf16 a[16:31], v[200:203], v[104:107], a[16:31]
    ds_read_b64_tr_b16 v[224:225], v191 offset:16640
    ds_read_b64_tr_b16 v[226:227], v191 offset:18688
    v_lshlrev_b32 v244, 16, v108
    v_and_b32 v245, 0xffff0000, v108
    v_lshlrev_b32 v246, 16, v109
    v_and_b32 v247, 0xffff0000, v109
    v_lshlrev_b32 v248, 16, v110
    v_and_b32 v249, 0xffff0000, v110
    v_lshlrev_b32 v250, 16, v111
    v_and_b32 v251, 0xffff0000, v111
    s_waitcnt lgkmcnt(14)
    v_mfma_f32_32x32x16_bf16 a[32:47], v[204:207], v[104:107], a[32:47]
    ds_read_b64_tr_b16 v[196:197], v188 offset:24576
    ds_read_b64_tr_b16 v[198:199], v188 offset:26624
    s_waitcnt lgkmcnt(14)
    v_mfma_f32_32x32x16_bf16 a[48:63], v[208:211], v[104:107], a[48:63]
    ds_read_b64_tr_b16 v[200:201], v189 offset:24576
    ds_read_b64_tr_b16 v[202:203], v189 offset:26624
    s_waitcnt lgkmcnt(8)
    v_fma_f32 v244, v244, v228, v236
    v_fma_f32 v245, v245, v229, v237
    v_fma_f32 v246, v246, v230, v238
    v_fma_f32 v247, v247, v231, v239
    v_fma_f32 v248, v248, v232, v240
    v_fma_f32 v249, v249, v233, v241
    v_fma_f32 v250, v250, v234, v242
    v_fma_f32 v251, v251, v235, v243
    v_mfma_f32_32x32x16_bf16 a[64:79], v[212:215], v[104:107], a[64:79]
    ds_read_b64_tr_b16 v[204:205], v190 offset:24576
    ds_read_b64_tr_b16 v[206:207], v190 offset:26624
    v_mfma_f32_32x32x16_bf16 a[80:95], v[216:219], v[104:107], a[80:95]
    ds_read_b64_tr_b16 v[208:209], v191 offset:24576
    ds_read_b64_tr_b16 v[210:211], v191 offset:26624
    v_cvt_pk_bf16_f32 v108, v244, v245
    v_cvt_pk_bf16_f32 v109, v246, v247
    v_cvt_pk_bf16_f32 v110, v248, v249
    v_cvt_pk_bf16_f32 v111, v250, v251
    s_waitcnt lgkmcnt(10)
    v_mfma_f32_32x32x16_bf16 a[96:111], v[220:223], v[104:107], a[96:111]
    ds_read_b64_tr_b16 v[212:213], v188 offset:24832
    ds_read_b64_tr_b16 v[214:215], v188 offset:26880
    s_waitcnt lgkmcnt(10)
    v_mfma_f32_32x32x16_bf16 a[112:127], v[224:227], v[104:107], a[112:127]
    ds_read_b64_tr_b16 v[216:217], v189 offset:24832
    ds_read_b64_tr_b16 v[218:219], v189 offset:26880
    ds_read_b128 v[228:231], v252 offset:1792
    ds_read_b128 v[232:235], v252 offset:1808
    ds_read_b128 v[236:239], v252 offset:4096
    ds_read_b128 v[240:243], v252 offset:4112
    s_waitcnt lgkmcnt(14)
    v_mfma_f32_32x32x16_bf16 a[0:15], v[196:199], v[108:111], a[0:15]
    ds_read_b64_tr_b16 v[220:221], v190 offset:24832
    ds_read_b64_tr_b16 v[222:223], v190 offset:26880
    s_waitcnt lgkmcnt(14)
    v_mfma_f32_32x32x16_bf16 a[16:31], v[200:203], v[108:111], a[16:31]
    ds_read_b64_tr_b16 v[224:225], v191 offset:24832
    ds_read_b64_tr_b16 v[226:227], v191 offset:26880
    v_lshlrev_b32 v244, 16, v112
    v_and_b32 v245, 0xffff0000, v112
    v_lshlrev_b32 v246, 16, v113
    v_and_b32 v247, 0xffff0000, v113
    v_lshlrev_b32 v248, 16, v114
    v_and_b32 v249, 0xffff0000, v114
    v_lshlrev_b32 v250, 16, v115
    v_and_b32 v251, 0xffff0000, v115
    s_waitcnt lgkmcnt(14)
    v_mfma_f32_32x32x16_bf16 a[32:47], v[204:207], v[108:111], a[32:47]
    s_waitcnt vmcnt(12)
    s_barrier
    ds_read_b64_tr_b16 v[196:197], v188 offset:32768
    ds_read_b64_tr_b16 v[198:199], v188 offset:34816
    s_waitcnt lgkmcnt(14)
    v_mfma_f32_32x32x16_bf16 a[48:63], v[208:211], v[108:111], a[48:63]
    ds_read_b64_tr_b16 v[200:201], v189 offset:32768
    ds_read_b64_tr_b16 v[202:203], v189 offset:34816
    s_waitcnt lgkmcnt(8)
    v_fma_f32 v244, v244, v228, v236
    v_fma_f32 v245, v245, v229, v237
    v_fma_f32 v246, v246, v230, v238
    v_fma_f32 v247, v247, v231, v239
    v_fma_f32 v248, v248, v232, v240
    v_fma_f32 v249, v249, v233, v241
    v_fma_f32 v250, v250, v234, v242
    v_fma_f32 v251, v251, v235, v243
    v_mfma_f32_32x32x16_bf16 a[64:79], v[212:215], v[108:111], a[64:79]
    ds_read_b64_tr_b16 v[204:205], v190 offset:32768
    ds_read_b64_tr_b16 v[206:207], v190 offset:34816
    v_mfma_f32_32x32x16_bf16 a[80:95], v[216:219], v[108:111], a[80:95]
    ds_read_b64_tr_b16 v[208:209], v191 offset:32768
    ds_read_b64_tr_b16 v[210:211], v191 offset:34816
    v_cvt_pk_bf16_f32 v112, v244, v245
    v_cvt_pk_bf16_f32 v113, v246, v247
    v_cvt_pk_bf16_f32 v114, v248, v249
    v_cvt_pk_bf16_f32 v115, v250, v251
    s_waitcnt lgkmcnt(10)
    v_mfma_f32_32x32x16_bf16 a[96:111], v[220:223], v[108:111], a[96:111]
    ds_read_b64_tr_b16 v[212:213], v188 offset:33024
    ds_read_b64_tr_b16 v[214:215], v188 offset:35072
    s_waitcnt lgkmcnt(10)
    v_mfma_f32_32x32x16_bf16 a[112:127], v[224:227], v[108:111], a[112:127]
    ds_read_b64_tr_b16 v[216:217], v189 offset:33024
    ds_read_b64_tr_b16 v[218:219], v189 offset:35072
    ds_read_b128 v[228:231], v252 offset:1856
    ds_read_b128 v[232:235], v252 offset:1872
    ds_read_b128 v[236:239], v252 offset:4160
    ds_read_b128 v[240:243], v252 offset:4176
    s_waitcnt lgkmcnt(14)
    v_mfma_f32_32x32x16_bf16 a[0:15], v[196:199], v[112:115], a[0:15]
    ds_read_b64_tr_b16 v[220:221], v190 offset:33024
    ds_read_b64_tr_b16 v[222:223], v190 offset:35072
    s_waitcnt lgkmcnt(14)
    v_mfma_f32_32x32x16_bf16 a[16:31], v[200:203], v[112:115], a[16:31]
    ds_read_b64_tr_b16 v[224:225], v191 offset:33024
    ds_read_b64_tr_b16 v[226:227], v191 offset:35072
    v_lshlrev_b32 v244, 16, v116
    v_and_b32 v245, 0xffff0000, v116
    v_lshlrev_b32 v246, 16, v117
    v_and_b32 v247, 0xffff0000, v117
    v_lshlrev_b32 v248, 16, v118
    v_and_b32 v249, 0xffff0000, v118
    v_lshlrev_b32 v250, 16, v119
    v_and_b32 v251, 0xffff0000, v119
    s_waitcnt lgkmcnt(14)
    v_mfma_f32_32x32x16_bf16 a[32:47], v[204:207], v[112:115], a[32:47]
    ds_read_b64_tr_b16 v[196:197], v188 offset:40960
    ds_read_b64_tr_b16 v[198:199], v188 offset:43008
    s_waitcnt lgkmcnt(14)
    v_mfma_f32_32x32x16_bf16 a[48:63], v[208:211], v[112:115], a[48:63]
    ds_read_b64_tr_b16 v[200:201], v189 offset:40960
    ds_read_b64_tr_b16 v[202:203], v189 offset:43008
    s_waitcnt lgkmcnt(8)
    v_fma_f32 v244, v244, v228, v236
    v_fma_f32 v245, v245, v229, v237
    v_fma_f32 v246, v246, v230, v238
    v_fma_f32 v247, v247, v231, v239
    v_fma_f32 v248, v248, v232, v240
    v_fma_f32 v249, v249, v233, v241
    v_fma_f32 v250, v250, v234, v242
    v_fma_f32 v251, v251, v235, v243
    v_mfma_f32_32x32x16_bf16 a[64:79], v[212:215], v[112:115], a[64:79]
    ds_read_b64_tr_b16 v[204:205], v190 offset:40960
    ds_read_b64_tr_b16 v[206:207], v190 offset:43008
    v_mfma_f32_32x32x16_bf16 a[80:95], v[216:219], v[112:115], a[80:95]
    ds_read_b64_tr_b16 v[208:209], v191 offset:40960
    ds_read_b64_tr_b16 v[210:211], v191 offset:43008
    v_cvt_pk_bf16_f32 v116, v244, v245
    v_cvt_pk_bf16_f32 v117, v246, v247
    v_cvt_pk_bf16_f32 v118, v248, v249
    v_cvt_pk_bf16_f32 v119, v250, v251
    s_waitcnt lgkmcnt(10)
    v_mfma_f32_32x32x16_bf16 a[96:111], v[220:223], v[112:115], a[96:111]
    ds_read_b64_tr_b16 v[212:213], v188 offset:41216
    ds_read_b64_tr_b16 v[214:215], v188 offset:43264
    s_waitcnt lgkmcnt(10)
    v_mfma_f32_32x32x16_bf16 a[112:127], v[224:227], v[112:115], a[112:127]
    ds_read_b64_tr_b16 v[216:217], v189 offset:41216
    ds_read_b64_tr_b16 v[218:219], v189 offset:43264
    ds_read_b128 v[228:231], v252 offset:1920
    ds_read_b128 v[232:235], v252 offset:1936
    ds_read_b128 v[236:239], v252 offset:4224
    ds_read_b128 v[240:243], v252 offset:4240
    s_waitcnt lgkmcnt(14)
    v_mfma_f32_32x32x16_bf16 a[0:15], v[196:199], v[116:119], a[0:15]
    ds_read_b64_tr_b16 v[220:221], v190 offset:41216
    ds_read_b64_tr_b16 v[222:223], v190 offset:43264
    s_waitcnt lgkmcnt(14)
    v_mfma_f32_32x32x16_bf16 a[16:31], v[200:203], v[116:119], a[16:31]
    ds_read_b64_tr_b16 v[224:225], v191 offset:41216
    ds_read_b64_tr_b16 v[226:227], v191 offset:43264
    v_lshlrev_b32 v244, 16, v120
    v_and_b32 v245, 0xffff0000, v120
    v_lshlrev_b32 v246, 16, v121
    v_and_b32 v247, 0xffff0000, v121
    v_lshlrev_b32 v248, 16, v122
    v_and_b32 v249, 0xffff0000, v122
    v_lshlrev_b32 v250, 16, v123
    v_and_b32 v251, 0xffff0000, v123
    s_waitcnt lgkmcnt(14)
    v_mfma_f32_32x32x16_bf16 a[32:47], v[204:207], v[116:119], a[32:47]
    s_waitcnt vmcnt(8)
    s_barrier
    ds_read_b64_tr_b16 v[196:197], v192 offset:0
    ds_read_b64_tr_b16 v[198:199], v192 offset:2048
    s_waitcnt lgkmcnt(14)
    v_mfma_f32_32x32x16_bf16 a[48:63], v[208:211], v[116:119], a[48:63]
    ds_read_b64_tr_b16 v[200:201], v193 offset:0
    ds_read_b64_tr_b16 v[202:203], v193 offset:2048
    s_waitcnt lgkmcnt(8)
    v_fma_f32 v244, v244, v228, v236
    v_fma_f32 v245, v245, v229, v237
    v_fma_f32 v246, v246, v230, v238
    v_fma_f32 v247, v247, v231, v239
    v_fma_f32 v248, v248, v232, v240
    v_fma_f32 v249, v249, v233, v241
    v_fma_f32 v250, v250, v234, v242
    v_fma_f32 v251, v251, v235, v243
    v_mfma_f32_32x32x16_bf16 a[64:79], v[212:215], v[116:119], a[64:79]
    ds_read_b64_tr_b16 v[204:205], v194 offset:0
    ds_read_b64_tr_b16 v[206:207], v194 offset:2048
    v_mfma_f32_32x32x16_bf16 a[80:95], v[216:219], v[116:119], a[80:95]
    ds_read_b64_tr_b16 v[208:209], v195 offset:0
    ds_read_b64_tr_b16 v[210:211], v195 offset:2048
    v_cvt_pk_bf16_f32 v120, v244, v245
    v_cvt_pk_bf16_f32 v121, v246, v247
    v_cvt_pk_bf16_f32 v122, v248, v249
    v_cvt_pk_bf16_f32 v123, v250, v251
    s_waitcnt lgkmcnt(10)
    v_mfma_f32_32x32x16_bf16 a[96:111], v[220:223], v[116:119], a[96:111]
    ds_read_b64_tr_b16 v[212:213], v192 offset:256
    ds_read_b64_tr_b16 v[214:215], v192 offset:2304
    s_waitcnt lgkmcnt(10)
    v_mfma_f32_32x32x16_bf16 a[112:127], v[224:227], v[116:119], a[112:127]
    ds_read_b64_tr_b16 v[216:217], v193 offset:256
    ds_read_b64_tr_b16 v[218:219], v193 offset:2304
    ds_read_b128 v[228:231], v252 offset:1984
    ds_read_b128 v[232:235], v252 offset:2000
    ds_read_b128 v[236:239], v252 offset:4288
    ds_read_b128 v[240:243], v252 offset:4304
    s_waitcnt lgkmcnt(14)
    v_mfma_f32_32x32x16_bf16 a[0:15], v[196:199], v[120:123], a[0:15]
    ds_read_b64_tr_b16 v[220:221], v194 offset:256
    ds_read_b64_tr_b16 v[222:223], v194 offset:2304
    s_waitcnt lgkmcnt(14)
    v_mfma_f32_32x32x16_bf16 a[16:31], v[200:203], v[120:123], a[16:31]
    ds_read_b64_tr_b16 v[224:225], v195 offset:256
    ds_read_b64_tr_b16 v[226:227], v195 offset:2304
    v_lshlrev_b32 v244, 16, v124
    v_and_b32 v245, 0xffff0000, v124
    v_lshlrev_b32 v246, 16, v125
    v_and_b32 v247, 0xffff0000, v125
    v_lshlrev_b32 v248, 16, v126
    v_and_b32 v249, 0xffff0000, v126
    v_lshlrev_b32 v250, 16, v127
    v_and_b32 v251, 0xffff0000, v127
    s_waitcnt lgkmcnt(14)
    v_mfma_f32_32x32x16_bf16 a[32:47], v[204:207], v[120:123], a[32:47]
    ds_read_b64_tr_b16 v[196:197], v192 offset:8192
    ds_read_b64_tr_b16 v[198:199], v192 offset:10240
    s_waitcnt lgkmcnt(14)
    v_mfma_f32_32x32x16_bf16 a[48:63], v[208:211], v[120:123], a[48:63]
    ds_read_b64_tr_b16 v[200:201], v193 offset:8192
    ds_read_b64_tr_b16 v[202:203], v193 offset:10240
    s_waitcnt lgkmcnt(8)
    v_fma_f32 v244, v244, v228, v236
    v_fma_f32 v245, v245, v229, v237
    v_fma_f32 v246, v246, v230, v238
    v_fma_f32 v247, v247, v231, v239
    v_fma_f32 v248, v248, v232, v240
    v_fma_f32 v249, v249, v233, v241
    v_fma_f32 v250, v250, v234, v242
    v_fma_f32 v251, v251, v235, v243
    v_mfma_f32_32x32x16_bf16 a[64:79], v[212:215], v[120:123], a[64:79]
    ds_read_b64_tr_b16 v[204:205], v194 offset:8192
    ds_read_b64_tr_b16 v[206:207], v194 offset:10240
    v_mfma_f32_32x32x16_bf16 a[80:95], v[216:219], v[120:123], a[80:95]
    ds_read_b64_tr_b16 v[208:209], v195 offset:8192
    ds_read_b64_tr_b16 v[210:211], v195 offset:10240
    v_cvt_pk_bf16_f32 v124, v244, v245
    v_cvt_pk_bf16_f32 v125, v246, v247
    v_cvt_pk_bf16_f32 v126, v248, v249
    v_cvt_pk_bf16_f32 v127, v250, v251
    s_waitcnt lgkmcnt(10)
    v_mfma_f32_32x32x16_bf16 a[96:111], v[220:223], v[120:123], a[96:111]
    ds_read_b64_tr_b16 v[212:213], v192 offset:8448
    ds_read_b64_tr_b16 v[214:215], v192 offset:10496
    s_waitcnt lgkmcnt(10)
    v_mfma_f32_32x32x16_bf16 a[112:127], v[224:227], v[120:123], a[112:127]
    ds_read_b64_tr_b16 v[216:217], v193 offset:8448
    ds_read_b64_tr_b16 v[218:219], v193 offset:10496
    ds_read_b128 v[228:231], v252 offset:2048
    ds_read_b128 v[232:235], v252 offset:2064
    ds_read_b128 v[236:239], v252 offset:4352
    ds_read_b128 v[240:243], v252 offset:4368
    s_waitcnt lgkmcnt(14)
    v_mfma_f32_32x32x16_bf16 a[0:15], v[196:199], v[124:127], a[0:15]
    ds_read_b64_tr_b16 v[220:221], v194 offset:8448
    ds_read_b64_tr_b16 v[222:223], v194 offset:10496
    s_waitcnt lgkmcnt(14)
    v_mfma_f32_32x32x16_bf16 a[16:31], v[200:203], v[124:127], a[16:31]
    ds_read_b64_tr_b16 v[224:225], v195 offset:8448
    ds_read_b64_tr_b16 v[226:227], v195 offset:10496
    v_lshlrev_b32 v244, 16, v128
    v_and_b32 v245, 0xffff0000, v128
    v_lshlrev_b32 v246, 16, v129
    v_and_b32 v247, 0xffff0000, v129
    v_lshlrev_b32 v248, 16, v130
    v_and_b32 v249, 0xffff0000, v130
    v_lshlrev_b32 v250, 16, v131
    v_and_b32 v251, 0xffff0000, v131
    s_waitcnt lgkmcnt(14)
    v_mfma_f32_32x32x16_bf16 a[32:47], v[204:207], v[124:127], a[32:47]
    s_waitcnt vmcnt(4)
    s_barrier
    ds_read_b64_tr_b16 v[196:197], v192 offset:16384
    ds_read_b64_tr_b16 v[198:199], v192 offset:18432
    s_waitcnt lgkmcnt(14)
    v_mfma_f32_32x32x16_bf16 a[48:63], v[208:211], v[124:127], a[48:63]
    ds_read_b64_tr_b16 v[200:201], v193 offset:16384
    ds_read_b64_tr_b16 v[202:203], v193 offset:18432
    s_waitcnt lgkmcnt(8)
    v_fma_f32 v244, v244, v228, v236
    v_fma_f32 v245, v245, v229, v237
    v_fma_f32 v246, v246, v230, v238
    v_fma_f32 v247, v247, v231, v239
    v_fma_f32 v248, v248, v232, v240
    v_fma_f32 v249, v249, v233, v241
    v_fma_f32 v250, v250, v234, v242
    v_fma_f32 v251, v251, v235, v243
    v_mfma_f32_32x32x16_bf16 a[64:79], v[212:215], v[124:127], a[64:79]
    ds_read_b64_tr_b16 v[204:205], v194 offset:16384
    ds_read_b64_tr_b16 v[206:207], v194 offset:18432
    v_mfma_f32_32x32x16_bf16 a[80:95], v[216:219], v[124:127], a[80:95]
    ds_read_b64_tr_b16 v[208:209], v195 offset:16384
    ds_read_b64_tr_b16 v[210:211], v195 offset:18432
    v_cvt_pk_bf16_f32 v128, v244, v245
    v_cvt_pk_bf16_f32 v129, v246, v247
    v_cvt_pk_bf16_f32 v130, v248, v249
    v_cvt_pk_bf16_f32 v131, v250, v251
    s_waitcnt lgkmcnt(10)
    v_mfma_f32_32x32x16_bf16 a[96:111], v[220:223], v[124:127], a[96:111]
    ds_read_b64_tr_b16 v[212:213], v192 offset:16640
    ds_read_b64_tr_b16 v[214:215], v192 offset:18688
    s_waitcnt lgkmcnt(10)
    v_mfma_f32_32x32x16_bf16 a[112:127], v[224:227], v[124:127], a[112:127]
    ds_read_b64_tr_b16 v[216:217], v193 offset:16640
    ds_read_b64_tr_b16 v[218:219], v193 offset:18688
    ds_read_b128 v[228:231], v252 offset:2112
    ds_read_b128 v[232:235], v252 offset:2128
    ds_read_b128 v[236:239], v252 offset:4416
    ds_read_b128 v[240:243], v252 offset:4432
    s_waitcnt lgkmcnt(14)
    v_mfma_f32_32x32x16_bf16 a[0:15], v[196:199], v[128:131], a[0:15]
    ds_read_b64_tr_b16 v[220:221], v194 offset:16640
    ds_read_b64_tr_b16 v[222:223], v194 offset:18688
    s_waitcnt lgkmcnt(14)
    v_mfma_f32_32x32x16_bf16 a[16:31], v[200:203], v[128:131], a[16:31]
    ds_read_b64_tr_b16 v[224:225], v195 offset:16640
    ds_read_b64_tr_b16 v[226:227], v195 offset:18688
    v_lshlrev_b32 v244, 16, v132
    v_and_b32 v245, 0xffff0000, v132
    v_lshlrev_b32 v246, 16, v133
    v_and_b32 v247, 0xffff0000, v133
    v_lshlrev_b32 v248, 16, v134
    v_and_b32 v249, 0xffff0000, v134
    v_lshlrev_b32 v250, 16, v135
    v_and_b32 v251, 0xffff0000, v135
    s_waitcnt lgkmcnt(14)
    v_mfma_f32_32x32x16_bf16 a[32:47], v[204:207], v[128:131], a[32:47]
    ds_read_b64_tr_b16 v[196:197], v192 offset:24576
    ds_read_b64_tr_b16 v[198:199], v192 offset:26624
    s_waitcnt lgkmcnt(14)
    v_mfma_f32_32x32x16_bf16 a[48:63], v[208:211], v[128:131], a[48:63]
    ds_read_b64_tr_b16 v[200:201], v193 offset:24576
    ds_read_b64_tr_b16 v[202:203], v193 offset:26624
    s_waitcnt lgkmcnt(8)
    v_fma_f32 v244, v244, v228, v236
    v_fma_f32 v245, v245, v229, v237
    v_fma_f32 v246, v246, v230, v238
    v_fma_f32 v247, v247, v231, v239
    v_fma_f32 v248, v248, v232, v240
    v_fma_f32 v249, v249, v233, v241
    v_fma_f32 v250, v250, v234, v242
    v_fma_f32 v251, v251, v235, v243
    v_mfma_f32_32x32x16_bf16 a[64:79], v[212:215], v[128:131], a[64:79]
    ds_read_b64_tr_b16 v[204:205], v194 offset:24576
    ds_read_b64_tr_b16 v[206:207], v194 offset:26624
    v_mfma_f32_32x32x16_bf16 a[80:95], v[216:219], v[128:131], a[80:95]
    ds_read_b64_tr_b16 v[208:209], v195 offset:24576
    ds_read_b64_tr_b16 v[210:211], v195 offset:26624
    v_cvt_pk_bf16_f32 v132, v244, v245
    v_cvt_pk_bf16_f32 v133, v246, v247
    v_cvt_pk_bf16_f32 v134, v248, v249
    v_cvt_pk_bf16_f32 v135, v250, v251
    s_waitcnt lgkmcnt(10)
    v_mfma_f32_32x32x16_bf16 a[96:111], v[220:223], v[128:131], a[96:111]
    ds_read_b64_tr_b16 v[212:213], v192 offset:24832
    ds_read_b64_tr_b16 v[214:215], v192 offset:26880
    s_waitcnt lgkmcnt(10)
    v_mfma_f32_32x32x16_bf16 a[112:127], v[224:227], v[128:131], a[112:127]
    ds_read_b64_tr_b16 v[216:217], v193 offset:24832
    ds_read_b64_tr_b16 v[218:219], v193 offset:26880
    ds_read_b128 v[228:231], v252 offset:2176
    ds_read_b128 v[232:235], v252 offset:2192
    ds_read_b128 v[236:239], v252 offset:4480
    ds_read_b128 v[240:243], v252 offset:4496
    s_waitcnt lgkmcnt(14)
    v_mfma_f32_32x32x16_bf16 a[0:15], v[196:199], v[132:135], a[0:15]
    ds_read_b64_tr_b16 v[220:221], v194 offset:24832
    ds_read_b64_tr_b16 v[222:223], v194 offset:26880
    s_waitcnt lgkmcnt(14)
    v_mfma_f32_32x32x16_bf16 a[16:31], v[200:203], v[132:135], a[16:31]
    ds_read_b64_tr_b16 v[224:225], v195 offset:24832
    ds_read_b64_tr_b16 v[226:227], v195 offset:26880
    v_lshlrev_b32 v244, 16, v136
    v_and_b32 v245, 0xffff0000, v136
    v_lshlrev_b32 v246, 16, v137
    v_and_b32 v247, 0xffff0000, v137
    v_lshlrev_b32 v248, 16, v138
    v_and_b32 v249, 0xffff0000, v138
    v_lshlrev_b32 v250, 16, v139
    v_and_b32 v251, 0xffff0000, v139
    s_waitcnt lgkmcnt(14)
    v_mfma_f32_32x32x16_bf16 a[32:47], v[204:207], v[132:135], a[32:47]
    s_waitcnt vmcnt(0)
    s_barrier
    ds_read_b64_tr_b16 v[196:197], v192 offset:32768
    ds_read_b64_tr_b16 v[198:199], v192 offset:34816
    s_waitcnt lgkmcnt(14)
    v_mfma_f32_32x32x16_bf16 a[48:63], v[208:211], v[132:135], a[48:63]
    ds_read_b64_tr_b16 v[200:201], v193 offset:32768
    ds_read_b64_tr_b16 v[202:203], v193 offset:34816
    s_waitcnt lgkmcnt(8)
    v_fma_f32 v244, v244, v228, v236
    v_fma_f32 v245, v245, v229, v237
    v_fma_f32 v246, v246, v230, v238
    v_fma_f32 v247, v247, v231, v239
    v_fma_f32 v248, v248, v232, v240
    v_fma_f32 v249, v249, v233, v241
    v_fma_f32 v250, v250, v234, v242
    v_fma_f32 v251, v251, v235, v243
    v_mfma_f32_32x32x16_bf16 a[64:79], v[212:215], v[132:135], a[64:79]
    ds_read_b64_tr_b16 v[204:205], v194 offset:32768
    ds_read_b64_tr_b16 v[206:207], v194 offset:34816
    v_mfma_f32_32x32x16_bf16 a[80:95], v[216:219], v[132:135], a[80:95]
    ds_read_b64_tr_b16 v[208:209], v195 offset:32768
    ds_read_b64_tr_b16 v[210:211], v195 offset:34816
    v_cvt_pk_bf16_f32 v136, v244, v245
    v_cvt_pk_bf16_f32 v137, v246, v247
    v_cvt_pk_bf16_f32 v138, v248, v249
    v_cvt_pk_bf16_f32 v139, v250, v251
    s_waitcnt lgkmcnt(10)
    v_mfma_f32_32x32x16_bf16 a[96:111], v[220:223], v[132:135], a[96:111]
    ds_read_b64_tr_b16 v[212:213], v192 offset:33024
    ds_read_b64_tr_b16 v[214:215], v192 offset:35072
    s_waitcnt lgkmcnt(10)
    v_mfma_f32_32x32x16_bf16 a[112:127], v[224:227], v[132:135], a[112:127]
    ds_read_b64_tr_b16 v[216:217], v193 offset:33024
    ds_read_b64_tr_b16 v[218:219], v193 offset:35072
    ds_read_b128 v[228:231], v252 offset:2240
    ds_read_b128 v[232:235], v252 offset:2256
    ds_read_b128 v[236:239], v252 offset:4544
    ds_read_b128 v[240:243], v252 offset:4560
    s_waitcnt lgkmcnt(14)
    v_mfma_f32_32x32x16_bf16 a[0:15], v[196:199], v[136:139], a[0:15]
    ds_read_b64_tr_b16 v[220:221], v194 offset:33024
    ds_read_b64_tr_b16 v[222:223], v194 offset:35072
    s_waitcnt lgkmcnt(14)
    v_mfma_f32_32x32x16_bf16 a[16:31], v[200:203], v[136:139], a[16:31]
    ds_read_b64_tr_b16 v[224:225], v195 offset:33024
    ds_read_b64_tr_b16 v[226:227], v195 offset:35072
    v_lshlrev_b32 v244, 16, v140
    v_and_b32 v245, 0xffff0000, v140
    v_lshlrev_b32 v246, 16, v141
    v_and_b32 v247, 0xffff0000, v141
    v_lshlrev_b32 v248, 16, v142
    v_and_b32 v249, 0xffff0000, v142
    v_lshlrev_b32 v250, 16, v143
    v_and_b32 v251, 0xffff0000, v143
    s_waitcnt lgkmcnt(14)
    v_mfma_f32_32x32x16_bf16 a[32:47], v[204:207], v[136:139], a[32:47]
    ds_read_b64_tr_b16 v[196:197], v192 offset:40960
    ds_read_b64_tr_b16 v[198:199], v192 offset:43008
    s_waitcnt lgkmcnt(14)
    v_mfma_f32_32x32x16_bf16 a[48:63], v[208:211], v[136:139], a[48:63]
    ds_read_b64_tr_b16 v[200:201], v193 offset:40960
    ds_read_b64_tr_b16 v[202:203], v193 offset:43008
    s_waitcnt lgkmcnt(8)
    v_fma_f32 v244, v244, v228, v236
    v_fma_f32 v245, v245, v229, v237
    v_fma_f32 v246, v246, v230, v238
    v_fma_f32 v247, v247, v231, v239
    v_fma_f32 v248, v248, v232, v240
    v_fma_f32 v249, v249, v233, v241
    v_fma_f32 v250, v250, v234, v242
    v_fma_f32 v251, v251, v235, v243
    v_mfma_f32_32x32x16_bf16 a[64:79], v[212:215], v[136:139], a[64:79]
    ds_read_b64_tr_b16 v[204:205], v194 offset:40960
    ds_read_b64_tr_b16 v[206:207], v194 offset:43008
    v_mfma_f32_32x32x16_bf16 a[80:95], v[216:219], v[136:139], a[80:95]
    ds_read_b64_tr_b16 v[208:209], v195 offset:40960
    ds_read_b64_tr_b16 v[210:211], v195 offset:43008
    v_cvt_pk_bf16_f32 v140, v244, v245
    v_cvt_pk_bf16_f32 v141, v246, v247
    v_cvt_pk_bf16_f32 v142, v248, v249
    v_cvt_pk_bf16_f32 v143, v250, v251
    s_waitcnt lgkmcnt(10)
    v_mfma_f32_32x32x16_bf16 a[96:111], v[220:223], v[136:139], a[96:111]
    ds_read_b64_tr_b16 v[212:213], v192 offset:41216
    ds_read_b64_tr_b16 v[214:215], v192 offset:43264
    s_waitcnt lgkmcnt(10)
    v_mfma_f32_32x32x16_bf16 a[112:127], v[224:227], v[136:139], a[112:127]
    ds_read_b64_tr_b16 v[216:217], v193 offset:41216
    ds_read_b64_tr_b16 v[218:219], v193 offset:43264
    s_waitcnt lgkmcnt(10)
    v_mfma_f32_32x32x16_bf16 a[0:15], v[196:199], v[140:143], a[0:15]
    ds_read_b64_tr_b16 v[220:221], v194 offset:41216
    ds_read_b64_tr_b16 v[222:223], v194 offset:43264
    s_waitcnt lgkmcnt(10)
    v_mfma_f32_32x32x16_bf16 a[16:31], v[200:203], v[140:143], a[16:31]
    ds_read_b64_tr_b16 v[224:225], v195 offset:41216
    ds_read_b64_tr_b16 v[226:227], v195 offset:43264
    s_waitcnt lgkmcnt(10)
    v_mfma_f32_32x32x16_bf16 a[32:47], v[204:207], v[140:143], a[32:47]
    s_waitcnt lgkmcnt(8)
    v_mfma_f32_32x32x16_bf16 a[48:63], v[208:211], v[140:143], a[48:63]
    s_waitcnt lgkmcnt(6)
    v_mfma_f32_32x32x16_bf16 a[64:79], v[212:215], v[140:143], a[64:79]
    s_waitcnt lgkmcnt(4)
    v_mfma_f32_32x32x16_bf16 a[80:95], v[216:219], v[140:143], a[80:95]
    s_waitcnt lgkmcnt(2)
    v_mfma_f32_32x32x16_bf16 a[96:111], v[220:223], v[140:143], a[96:111]
    s_waitcnt lgkmcnt(0)
    v_mfma_f32_32x32x16_bf16 a[112:127], v[224:227], v[140:143], a[112:127]
    s_nop 15
    s_mov_b32 s46, 0x3e0293ee
    v_mov_b32 v12, s46
    v_mov_b32 v13, s46
    v_accvgpr_read_b32 v0, a0
    v_accvgpr_read_b32 v1, a1
    v_accvgpr_read_b32 v2, a2
    v_accvgpr_read_b32 v3, a3
    v_accvgpr_read_b32 v4, a4
    v_accvgpr_read_b32 v5, a5
    v_accvgpr_read_b32 v6, a6
    v_accvgpr_read_b32 v7, a7
    v_pk_mul_f32 v[0:1], v[0:1], v[12:13]
    v_pk_mul_f32 v[2:3], v[2:3], v[12:13]
    v_pk_mul_f32 v[4:5], v[4:5], v[12:13]
    v_pk_mul_f32 v[6:7], v[6:7], v[12:13]
    v_cvt_pk_bf16_f32 v8, v0, v1
    v_cvt_pk_bf16_f32 v9, v2, v3
    v_cvt_pk_bf16_f32 v10, v4, v5
    v_cvt_pk_bf16_f32 v11, v6, v7
    v_accvgpr_write_b32 a128, v8
    v_accvgpr_write_b32 a129, v9
    v_accvgpr_write_b32 a130, v10
    v_accvgpr_write_b32 a131, v11
    v_accvgpr_read_b32 v0, a8
    v_accvgpr_read_b32 v1, a9
    v_accvgpr_read_b32 v2, a10
    v_accvgpr_read_b32 v3, a11
    v_accvgpr_read_b32 v4, a12
    v_accvgpr_read_b32 v5, a13
    v_accvgpr_read_b32 v6, a14
    v_accvgpr_read_b32 v7, a15
    v_pk_mul_f32 v[0:1], v[0:1], v[12:13]
    v_pk_mul_f32 v[2:3], v[2:3], v[12:13]
    v_pk_mul_f32 v[4:5], v[4:5], v[12:13]
    v_pk_mul_f32 v[6:7], v[6:7], v[12:13]
    v_cvt_pk_bf16_f32 v8, v0, v1
    v_cvt_pk_bf16_f32 v9, v2, v3
    v_cvt_pk_bf16_f32 v10, v4, v5
    v_cvt_pk_bf16_f32 v11, v6, v7
    v_accvgpr_write_b32 a132, v8
    v_accvgpr_write_b32 a133, v9
    v_accvgpr_write_b32 a134, v10
    v_accvgpr_write_b32 a135, v11
    v_accvgpr_read_b32 v0, a16
    v_accvgpr_read_b32 v1, a17
    v_accvgpr_read_b32 v2, a18
    v_accvgpr_read_b32 v3, a19
    v_accvgpr_read_b32 v4, a20
    v_accvgpr_read_b32 v5, a21
    v_accvgpr_read_b32 v6, a22
    v_accvgpr_read_b32 v7, a23
    v_pk_mul_f32 v[0:1], v[0:1], v[12:13]
    v_pk_mul_f32 v[2:3], v[2:3], v[12:13]
    v_pk_mul_f32 v[4:5], v[4:5], v[12:13]
    v_pk_mul_f32 v[6:7], v[6:7], v[12:13]
    v_cvt_pk_bf16_f32 v8, v0, v1
    v_cvt_pk_bf16_f32 v9, v2, v3
    v_cvt_pk_bf16_f32 v10, v4, v5
    v_cvt_pk_bf16_f32 v11, v6, v7
    v_accvgpr_write_b32 a136, v8
    v_accvgpr_write_b32 a137, v9
    v_accvgpr_write_b32 a138, v10
    v_accvgpr_write_b32 a139, v11
    v_accvgpr_read_b32 v0, a24
    v_accvgpr_read_b32 v1, a25
    v_accvgpr_read_b32 v2, a26
    v_accvgpr_read_b32 v3, a27
    v_accvgpr_read_b32 v4, a28
    v_accvgpr_read_b32 v5, a29
    v_accvgpr_read_b32 v6, a30
    v_accvgpr_read_b32 v7, a31
    v_pk_mul_f32 v[0:1], v[0:1], v[12:13]
    v_pk_mul_f32 v[2:3], v[2:3], v[12:13]
    v_pk_mul_f32 v[4:5], v[4:5], v[12:13]
    v_pk_mul_f32 v[6:7], v[6:7], v[12:13]
    v_cvt_pk_bf16_f32 v8, v0, v1
    v_cvt_pk_bf16_f32 v9, v2, v3
    v_cvt_pk_bf16_f32 v10, v4, v5
    v_cvt_pk_bf16_f32 v11, v6, v7
    v_accvgpr_write_b32 a140, v8
    v_accvgpr_write_b32 a141, v9
    v_accvgpr_write_b32 a142, v10
    v_accvgpr_write_b32 a143, v11
    v_accvgpr_read_b32 v0, a32
    v_accvgpr_read_b32 v1, a33
    v_accvgpr_read_b32 v2, a34
    v_accvgpr_read_b32 v3, a35
    v_accvgpr_read_b32 v4, a36
    v_accvgpr_read_b32 v5, a37
    v_accvgpr_read_b32 v6, a38
    v_accvgpr_read_b32 v7, a39
    v_pk_mul_f32 v[0:1], v[0:1], v[12:13]
    v_pk_mul_f32 v[2:3], v[2:3], v[12:13]
    v_pk_mul_f32 v[4:5], v[4:5], v[12:13]
    v_pk_mul_f32 v[6:7], v[6:7], v[12:13]
    v_cvt_pk_bf16_f32 v8, v0, v1
    v_cvt_pk_bf16_f32 v9, v2, v3
    v_cvt_pk_bf16_f32 v10, v4, v5
    v_cvt_pk_bf16_f32 v11, v6, v7
    v_accvgpr_write_b32 a144, v8
    v_accvgpr_write_b32 a145, v9
    v_accvgpr_write_b32 a146, v10
    v_accvgpr_write_b32 a147, v11
    v_accvgpr_read_b32 v0, a40
    v_accvgpr_read_b32 v1, a41
    v_accvgpr_read_b32 v2, a42
    v_accvgpr_read_b32 v3, a43
    v_accvgpr_read_b32 v4, a44
    v_accvgpr_read_b32 v5, a45
    v_accvgpr_read_b32 v6, a46
    v_accvgpr_read_b32 v7, a47
    v_pk_mul_f32 v[0:1], v[0:1], v[12:13]
    v_pk_mul_f32 v[2:3], v[2:3], v[12:13]
    v_pk_mul_f32 v[4:5], v[4:5], v[12:13]
    v_pk_mul_f32 v[6:7], v[6:7], v[12:13]
    v_cvt_pk_bf16_f32 v8, v0, v1
    v_cvt_pk_bf16_f32 v9, v2, v3
    v_cvt_pk_bf16_f32 v10, v4, v5
    v_cvt_pk_bf16_f32 v11, v6, v7
    v_accvgpr_write_b32 a148, v8
    v_accvgpr_write_b32 a149, v9
    v_accvgpr_write_b32 a150, v10
    v_accvgpr_write_b32 a151, v11
    v_accvgpr_read_b32 v0, a48
    v_accvgpr_read_b32 v1, a49
    v_accvgpr_read_b32 v2, a50
    v_accvgpr_read_b32 v3, a51
    v_accvgpr_read_b32 v4, a52
    v_accvgpr_read_b32 v5, a53
    v_accvgpr_read_b32 v6, a54
    v_accvgpr_read_b32 v7, a55
    v_pk_mul_f32 v[0:1], v[0:1], v[12:13]
    v_pk_mul_f32 v[2:3], v[2:3], v[12:13]
    v_pk_mul_f32 v[4:5], v[4:5], v[12:13]
    v_pk_mul_f32 v[6:7], v[6:7], v[12:13]
    v_cvt_pk_bf16_f32 v8, v0, v1
    v_cvt_pk_bf16_f32 v9, v2, v3
    v_cvt_pk_bf16_f32 v10, v4, v5
    v_cvt_pk_bf16_f32 v11, v6, v7
    v_accvgpr_write_b32 a152, v8
    v_accvgpr_write_b32 a153, v9
    v_accvgpr_write_b32 a154, v10
    v_accvgpr_write_b32 a155, v11
    v_accvgpr_read_b32 v0, a56
    v_accvgpr_read_b32 v1, a57
    v_accvgpr_read_b32 v2, a58
    v_accvgpr_read_b32 v3, a59
    v_accvgpr_read_b32 v4, a60
    v_accvgpr_read_b32 v5, a61
    v_accvgpr_read_b32 v6, a62
    v_accvgpr_read_b32 v7, a63
    v_pk_mul_f32 v[0:1], v[0:1], v[12:13]
    v_pk_mul_f32 v[2:3], v[2:3], v[12:13]
    v_pk_mul_f32 v[4:5], v[4:5], v[12:13]
    v_pk_mul_f32 v[6:7], v[6:7], v[12:13]
    v_cvt_pk_bf16_f32 v8, v0, v1
    v_cvt_pk_bf16_f32 v9, v2, v3
    v_cvt_pk_bf16_f32 v10, v4, v5
    v_cvt_pk_bf16_f32 v11, v6, v7
    v_accvgpr_write_b32 a156, v8
    v_accvgpr_write_b32 a157, v9
    v_accvgpr_write_b32 a158, v10
    v_accvgpr_write_b32 a159, v11
    v_accvgpr_read_b32 v0, a64
    v_accvgpr_read_b32 v1, a65
    v_accvgpr_read_b32 v2, a66
    v_accvgpr_read_b32 v3, a67
    v_accvgpr_read_b32 v4, a68
    v_accvgpr_read_b32 v5, a69
    v_accvgpr_read_b32 v6, a70
    v_accvgpr_read_b32 v7, a71
    v_pk_mul_f32 v[0:1], v[0:1], v[12:13]
    v_pk_mul_f32 v[2:3], v[2:3], v[12:13]
    v_pk_mul_f32 v[4:5], v[4:5], v[12:13]
    v_pk_mul_f32 v[6:7], v[6:7], v[12:13]
    v_cvt_pk_bf16_f32 v8, v0, v1
    v_cvt_pk_bf16_f32 v9, v2, v3
    v_cvt_pk_bf16_f32 v10, v4, v5
    v_cvt_pk_bf16_f32 v11, v6, v7
    v_accvgpr_write_b32 a160, v8
    v_accvgpr_write_b32 a161, v9
    v_accvgpr_write_b32 a162, v10
    v_accvgpr_write_b32 a163, v11
    v_accvgpr_read_b32 v0, a72
    v_accvgpr_read_b32 v1, a73
    v_accvgpr_read_b32 v2, a74
    v_accvgpr_read_b32 v3, a75
    v_accvgpr_read_b32 v4, a76
    v_accvgpr_read_b32 v5, a77
    v_accvgpr_read_b32 v6, a78
    v_accvgpr_read_b32 v7, a79
    v_pk_mul_f32 v[0:1], v[0:1], v[12:13]
    v_pk_mul_f32 v[2:3], v[2:3], v[12:13]
    v_pk_mul_f32 v[4:5], v[4:5], v[12:13]
    v_pk_mul_f32 v[6:7], v[6:7], v[12:13]
    v_cvt_pk_bf16_f32 v8, v0, v1
    v_cvt_pk_bf16_f32 v9, v2, v3
    v_cvt_pk_bf16_f32 v10, v4, v5
    v_cvt_pk_bf16_f32 v11, v6, v7
    v_accvgpr_write_b32 a164, v8
    v_accvgpr_write_b32 a165, v9
    v_accvgpr_write_b32 a166, v10
    v_accvgpr_write_b32 a167, v11
    v_accvgpr_read_b32 v0, a80
    v_accvgpr_read_b32 v1, a81
    v_accvgpr_read_b32 v2, a82
    v_accvgpr_read_b32 v3, a83
    v_accvgpr_read_b32 v4, a84
    v_accvgpr_read_b32 v5, a85
    v_accvgpr_read_b32 v6, a86
    v_accvgpr_read_b32 v7, a87
    v_pk_mul_f32 v[0:1], v[0:1], v[12:13]
    v_pk_mul_f32 v[2:3], v[2:3], v[12:13]
    v_pk_mul_f32 v[4:5], v[4:5], v[12:13]
    v_pk_mul_f32 v[6:7], v[6:7], v[12:13]
    v_cvt_pk_bf16_f32 v8, v0, v1
    v_cvt_pk_bf16_f32 v9, v2, v3
    v_cvt_pk_bf16_f32 v10, v4, v5
    v_cvt_pk_bf16_f32 v11, v6, v7
    v_accvgpr_write_b32 a168, v8
    v_accvgpr_write_b32 a169, v9
    v_accvgpr_write_b32 a170, v10
    v_accvgpr_write_b32 a171, v11
    v_accvgpr_read_b32 v0, a88
    v_accvgpr_read_b32 v1, a89
    v_accvgpr_read_b32 v2, a90
    v_accvgpr_read_b32 v3, a91
    v_accvgpr_read_b32 v4, a92
    v_accvgpr_read_b32 v5, a93
    v_accvgpr_read_b32 v6, a94
    v_accvgpr_read_b32 v7, a95
    v_pk_mul_f32 v[0:1], v[0:1], v[12:13]
    v_pk_mul_f32 v[2:3], v[2:3], v[12:13]
    v_pk_mul_f32 v[4:5], v[4:5], v[12:13]
    v_pk_mul_f32 v[6:7], v[6:7], v[12:13]
    v_cvt_pk_bf16_f32 v8, v0, v1
    v_cvt_pk_bf16_f32 v9, v2, v3
    v_cvt_pk_bf16_f32 v10, v4, v5
    v_cvt_pk_bf16_f32 v11, v6, v7
    v_accvgpr_write_b32 a172, v8
    v_accvgpr_write_b32 a173, v9
    v_accvgpr_write_b32 a174, v10
    v_accvgpr_write_b32 a175, v11
    v_accvgpr_read_b32 v0, a96
    v_accvgpr_read_b32 v1, a97
    v_accvgpr_read_b32 v2, a98
    v_accvgpr_read_b32 v3, a99
    v_accvgpr_read_b32 v4, a100
    v_accvgpr_read_b32 v5, a101
    v_accvgpr_read_b32 v6, a102
    v_accvgpr_read_b32 v7, a103
    v_pk_mul_f32 v[0:1], v[0:1], v[12:13]
    v_pk_mul_f32 v[2:3], v[2:3], v[12:13]
    v_pk_mul_f32 v[4:5], v[4:5], v[12:13]
    v_pk_mul_f32 v[6:7], v[6:7], v[12:13]
    v_cvt_pk_bf16_f32 v8, v0, v1
    v_cvt_pk_bf16_f32 v9, v2, v3
    v_cvt_pk_bf16_f32 v10, v4, v5
    v_cvt_pk_bf16_f32 v11, v6, v7
    v_accvgpr_write_b32 a176, v8
    v_accvgpr_write_b32 a177, v9
    v_accvgpr_write_b32 a178, v10
    v_accvgpr_write_b32 a179, v11
    v_accvgpr_read_b32 v0, a104
    v_accvgpr_read_b32 v1, a105
    v_accvgpr_read_b32 v2, a106
    v_accvgpr_read_b32 v3, a107
    v_accvgpr_read_b32 v4, a108
    v_accvgpr_read_b32 v5, a109
    v_accvgpr_read_b32 v6, a110
    v_accvgpr_read_b32 v7, a111
    v_pk_mul_f32 v[0:1], v[0:1], v[12:13]
    v_pk_mul_f32 v[2:3], v[2:3], v[12:13]
    v_pk_mul_f32 v[4:5], v[4:5], v[12:13]
    v_pk_mul_f32 v[6:7], v[6:7], v[12:13]
    v_cvt_pk_bf16_f32 v8, v0, v1
    v_cvt_pk_bf16_f32 v9, v2, v3
    v_cvt_pk_bf16_f32 v10, v4, v5
    v_cvt_pk_bf16_f32 v11, v6, v7
    v_accvgpr_write_b32 a180, v8
    v_accvgpr_write_b32 a181, v9
    v_accvgpr_write_b32 a182, v10
    v_accvgpr_write_b32 a183, v11
    v_accvgpr_read_b32 v0, a112
    v_accvgpr_read_b32 v1, a113
    v_accvgpr_read_b32 v2, a114
    v_accvgpr_read_b32 v3, a115
    v_accvgpr_read_b32 v4, a116
    v_accvgpr_read_b32 v5, a117
    v_accvgpr_read_b32 v6, a118
    v_accvgpr_read_b32 v7, a119
    v_pk_mul_f32 v[0:1], v[0:1], v[12:13]
    v_pk_mul_f32 v[2:3], v[2:3], v[12:13]
    v_pk_mul_f32 v[4:5], v[4:5], v[12:13]
    v_pk_mul_f32 v[6:7], v[6:7], v[12:13]
    v_cvt_pk_bf16_f32 v8, v0, v1
    v_cvt_pk_bf16_f32 v9, v2, v3
    v_cvt_pk_bf16_f32 v10, v4, v5
    v_cvt_pk_bf16_f32 v11, v6, v7
    v_accvgpr_write_b32 a184, v8
    v_accvgpr_write_b32 a185, v9
    v_accvgpr_write_b32 a186, v10
    v_accvgpr_write_b32 a187, v11
    v_accvgpr_read_b32 v0, a120
    v_accvgpr_read_b32 v1, a121
    v_accvgpr_read_b32 v2, a122
    v_accvgpr_read_b32 v3, a123
    v_accvgpr_read_b32 v4, a124
    v_accvgpr_read_b32 v5, a125
    v_accvgpr_read_b32 v6, a126
    v_accvgpr_read_b32 v7, a127
    v_pk_mul_f32 v[0:1], v[0:1], v[12:13]
    v_pk_mul_f32 v[2:3], v[2:3], v[12:13]
    v_pk_mul_f32 v[4:5], v[4:5], v[12:13]
    v_pk_mul_f32 v[6:7], v[6:7], v[12:13]
    v_cvt_pk_bf16_f32 v8, v0, v1
    v_cvt_pk_bf16_f32 v9, v2, v3
    v_cvt_pk_bf16_f32 v10, v4, v5
    v_cvt_pk_bf16_f32 v11, v6, v7
    v_accvgpr_write_b32 a188, v8
    v_accvgpr_write_b32 a189, v9
    v_accvgpr_write_b32 a190, v10
    v_accvgpr_write_b32 a191, v11
    v_mov_b32 v96, 0
    v_mov_b32 v97, 0
    v_mov_b32 v98, 0
    v_mov_b32 v99, 0
    v_mov_b32 v100, 0
    v_mov_b32 v101, 0
    v_mov_b32 v102, 0
    v_mov_b32 v103, 0
    v_mov_b32 v104, 0
    v_mov_b32 v105, 0
    v_mov_b32 v106, 0
    v_mov_b32 v107, 0
    v_mov_b32 v108, 0
    v_mov_b32 v109, 0
    v_mov_b32 v110, 0
    v_mov_b32 v111, 0
    v_mov_b32 v112, 0
    v_mov_b32 v113, 0
    v_mov_b32 v114, 0
    v_mov_b32 v115, 0
    v_mov_b32 v116, 0
    v_mov_b32 v117, 0
    v_mov_b32 v118, 0
    v_mov_b32 v119, 0
    v_mov_b32 v120, 0
    v_mov_b32 v121, 0
    v_mov_b32 v122, 0
    v_mov_b32 v123, 0
    v_mov_b32 v124, 0
    v_mov_b32 v125, 0
    v_mov_b32 v126, 0
    v_mov_b32 v127, 0
    v_mov_b32 v136, 0
    v_mov_b32 v137, 0
    s_waitcnt vmcnt(0) lgkmcnt(0)
    s_barrier
    ds_read_b128 a[192:195], v144 offset:0
    ds_read_b128 a[196:199], v145 offset:0
    ds_read_b128 a[200:203], v146 offset:0
    ds_read_b128 a[204:207], v147 offset:0
    ds_read_b128 a[208:211], v148 offset:0
    ds_read_b128 a[212:215], v149 offset:0
    ds_read_b128 a[216:219], v150 offset:0
    ds_read_b128 a[220:223], v151 offset:0
    ds_read_b128 a[224:227], v144 offset:8192
    ds_read_b128 a[228:231], v145 offset:8192
    ds_read_b128 a[232:235], v146 offset:8192
    ds_read_b128 a[236:239], v147 offset:8192
    ds_read_b128 a[240:243], v148 offset:8192
    ds_read_b128 a[244:247], v149 offset:8192
    ds_read_b128 a[248:251], v150 offset:8192
    ds_read_b128 a[252:255], v151 offset:8192
    s_waitcnt lgkmcnt(8)
    v_mfma_f32_32x32x16_bf16 v[0:15], a[192:195], a[128:131], v[96:111]
    v_accvgpr_write_b32 a0, 0
    v_accvgpr_write_b32 a1, 0
    v_accvgpr_write_b32 a2, 0
    v_accvgpr_write_b32 a3, 0
    v_mfma_f32_32x32x16_bf16 v[16:31], a[192:195], a[160:163], v[112:127]
    v_accvgpr_write_b32 a4, 0
    v_accvgpr_write_b32 a5, 0
    v_accvgpr_write_b32 a6, 0
    v_accvgpr_write_b32 a7, 0
    v_mfma_f32_32x32x16_bf16 v[0:15], a[196:199], a[132:135], v[0:15]
    v_accvgpr_write_b32 a8, 0
    v_accvgpr_write_b32 a9, 0
    v_accvgpr_write_b32 a10, 0
    v_accvgpr_write_b32 a11, 0
    v_mfma_f32_32x32x16_bf16 v[16:31], a[196:199], a[164:167], v[16:31]
    v_accvgpr_write_b32 a12, 0
    v_accvgpr_write_b32 a13, 0
    v_accvgpr_write_b32 a14, 0
    v_accvgpr_write_b32 a15, 0
    v_mfma_f32_32x32x16_bf16 v[0:15], a[200:203], a[136:139], v[0:15]
    v_accvgpr_write_b32 a16, 0
    v_accvgpr_write_b32 a17, 0
    v_accvgpr_write_b32 a18, 0
    v_accvgpr_write_b32 a19, 0
    v_mfma_f32_32x32x16_bf16 v[16:31], a[200:203], a[168:171], v[16:31]
    v_accvgpr_write_b32 a20, 0
    v_accvgpr_write_b32 a21, 0
    v_accvgpr_write_b32 a22, 0
    v_accvgpr_write_b32 a23, 0
    v_mfma_f32_32x32x16_bf16 v[0:15], a[204:207], a[140:143], v[0:15]
    v_accvgpr_write_b32 a24, 0
    v_accvgpr_write_b32 a25, 0
    v_accvgpr_write_b32 a26, 0
    v_accvgpr_write_b32 a27, 0
    v_mfma_f32_32x32x16_bf16 v[16:31], a[204:207], a[172:175], v[16:31]
    v_accvgpr_write_b32 a28, 0
    v_accvgpr_write_b32 a29, 0
    v_accvgpr_write_b32 a30, 0
    v_accvgpr_write_b32 a31, 0
    v_mfma_f32_32x32x16_bf16 v[0:15], a[208:211], a[144:147], v[0:15]
    v_accvgpr_write_b32 a32, 0
    v_accvgpr_write_b32 a33, 0
    v_accvgpr_write_b32 a34, 0
    v_accvgpr_write_b32 a35, 0
    v_mfma_f32_32x32x16_bf16 v[16:31], a[208:211], a[176:179], v[16:31]
    v_accvgpr_write_b32 a36, 0
    v_accvgpr_write_b32 a37, 0
    v_accvgpr_write_b32 a38, 0
    v_accvgpr_write_b32 a39, 0
    v_mfma_f32_32x32x16_bf16 v[0:15], a[212:215], a[148:151], v[0:15]
    v_accvgpr_write_b32 a40, 0
    v_accvgpr_write_b32 a41, 0
    v_accvgpr_write_b32 a42, 0
    v_accvgpr_write_b32 a43, 0
    v_mfma_f32_32x32x16_bf16 v[16:31], a[212:215], a[180:183], v[16:31]
    v_accvgpr_write_b32 a44, 0
    v_accvgpr_write_b32 a45, 0
    v_accvgpr_write_b32 a46, 0
    v_accvgpr_write_b32 a47, 0
    v_mfma_f32_32x32x16_bf16 v[0:15], a[216:219], a[152:155], v[0:15]
    v_accvgpr_write_b32 a48, 0
    v_accvgpr_write_b32 a49, 0
    v_accvgpr_write_b32 a50, 0
    v_accvgpr_write_b32 a51, 0
    v_mfma_f32_32x32x16_bf16 v[16:31], a[216:219], a[184:187], v[16:31]
    v_accvgpr_write_b32 a52, 0
    v_accvgpr_write_b32 a53, 0
    v_accvgpr_write_b32 a54, 0
    v_accvgpr_write_b32 a55, 0
    v_mfma_f32_32x32x16_bf16 v[0:15], a[220:223], a[156:159], v[0:15]
    v_accvgpr_write_b32 a56, 0
    v_accvgpr_write_b32 a57, 0
    v_accvgpr_write_b32 a58, 0
    v_accvgpr_write_b32 a59, 0
    v_mfma_f32_32x32x16_bf16 v[16:31], a[220:223], a[188:191], v[16:31]
    v_accvgpr_write_b32 a60, 0
    v_accvgpr_write_b32 a61, 0
    v_accvgpr_write_b32 a62, 0
    v_accvgpr_write_b32 a63, 0
    s_waitcnt lgkmcnt(0)
    v_mfma_f32_32x32x16_bf16 v[32:47], a[224:227], a[128:131], v[96:111]
    v_accvgpr_write_b32 a64, 0
    v_accvgpr_write_b32 a65, 0
    v_accvgpr_write_b32 a66, 0
    v_accvgpr_write_b32 a67, 0
    v_mfma_f32_32x32x16_bf16 v[48:63], a[224:227], a[160:163], v[112:127]
    v_accvgpr_write_b32 a68, 0
    v_accvgpr_write_b32 a69, 0
    v_accvgpr_write_b32 a70, 0
    v_accvgpr_write_b32 a71, 0
    v_mfma_f32_32x32x16_bf16 v[32:47], a[228:231], a[132:135], v[32:47]
    v_accvgpr_write_b32 a72, 0
    v_accvgpr_write_b32 a73, 0
    v_accvgpr_write_b32 a74, 0
    v_accvgpr_write_b32 a75, 0
    v_mfma_f32_32x32x16_bf16 v[48:63], a[228:231], a[164:167], v[48:63]
    v_accvgpr_write_b32 a76, 0
    v_accvgpr_write_b32 a77, 0
    v_accvgpr_write_b32 a78, 0
    v_accvgpr_write_b32 a79, 0
    v_mfma_f32_32x32x16_bf16 v[32:47], a[232:235], a[136:139], v[32:47]
    v_accvgpr_write_b32 a80, 0
    v_accvgpr_write_b32 a81, 0
    v_accvgpr_write_b32 a82, 0
    v_accvgpr_write_b32 a83, 0
    v_mfma_f32_32x32x16_bf16 v[48:63], a[232:235], a[168:171], v[48:63]
    v_accvgpr_write_b32 a84, 0
    v_accvgpr_write_b32 a85, 0
    v_accvgpr_write_b32 a86, 0
    v_accvgpr_write_b32 a87, 0
    v_mfma_f32_32x32x16_bf16 v[32:47], a[236:239], a[140:143], v[32:47]
    v_accvgpr_write_b32 a88, 0
    v_accvgpr_write_b32 a89, 0
    v_accvgpr_write_b32 a90, 0
    v_accvgpr_write_b32 a91, 0
    v_mfma_f32_32x32x16_bf16 v[48:63], a[236:239], a[172:175], v[48:63]
    v_accvgpr_write_b32 a92, 0
    v_accvgpr_write_b32 a93, 0
    v_accvgpr_write_b32 a94, 0
    v_accvgpr_write_b32 a95, 0
    v_mfma_f32_32x32x16_bf16 v[32:47], a[240:243], a[144:147], v[32:47]
    v_accvgpr_write_b32 a96, 0
    v_accvgpr_write_b32 a97, 0
    v_accvgpr_write_b32 a98, 0
    v_accvgpr_write_b32 a99, 0
    v_mfma_f32_32x32x16_bf16 v[48:63], a[240:243], a[176:179], v[48:63]
    v_accvgpr_write_b32 a100, 0
    v_accvgpr_write_b32 a101, 0
    v_accvgpr_write_b32 a102, 0
    v_accvgpr_write_b32 a103, 0
    v_mfma_f32_32x32x16_bf16 v[32:47], a[244:247], a[148:151], v[32:47]
    v_accvgpr_write_b32 a104, 0
    v_accvgpr_write_b32 a105, 0
    v_accvgpr_write_b32 a106, 0
    v_accvgpr_write_b32 a107, 0
    v_mfma_f32_32x32x16_bf16 v[48:63], a[244:247], a[180:183], v[48:63]
    v_accvgpr_write_b32 a108, 0
    v_accvgpr_write_b32 a109, 0
    v_accvgpr_write_b32 a110, 0
    v_accvgpr_write_b32 a111, 0
    v_mfma_f32_32x32x16_bf16 v[32:47], a[248:251], a[152:155], v[32:47]
    v_accvgpr_write_b32 a112, 0
    v_accvgpr_write_b32 a113, 0
    v_accvgpr_write_b32 a114, 0
    v_accvgpr_write_b32 a115, 0
    v_mfma_f32_32x32x16_bf16 v[48:63], a[248:251], a[184:187], v[48:63]
    v_accvgpr_write_b32 a116, 0
    v_accvgpr_write_b32 a117, 0
    v_accvgpr_write_b32 a118, 0
    v_accvgpr_write_b32 a119, 0
    v_mfma_f32_32x32x16_bf16 v[32:47], a[252:255], a[156:159], v[32:47]
    v_accvgpr_write_b32 a120, 0
    v_accvgpr_write_b32 a121, 0
    v_accvgpr_write_b32 a122, 0
    v_accvgpr_write_b32 a123, 0
    v_mfma_f32_32x32x16_bf16 v[48:63], a[252:255], a[188:191], v[48:63]
    v_accvgpr_write_b32 a124, 0
    v_accvgpr_write_b32 a125, 0
    v_accvgpr_write_b32 a126, 0
    v_accvgpr_write_b32 a127, 0
    s_nop 7
    s_barrier
    s_mov_b32 s42, 32768
    s_add_u32 m0, s41, 0
    s_nop 0
    buffer_load_dwordx4 v156, s[20:23], s42 offen lds
    buffer_load_dwordx4 v157, s[20:23], s42 offen offset:2048 lds
    ds_read_b128 a[192:195], v144 offset:16384
    ds_read_b128 a[196:199], v145 offset:16384
    ds_read_b128 a[200:203], v146 offset:16384
    ds_read_b128 a[204:207], v147 offset:16384
    ds_read_b128 a[208:211], v148 offset:16384
    ds_read_b128 a[212:215], v149 offset:16384
    ds_read_b128 a[216:219], v150 offset:16384
    ds_read_b128 a[220:223], v151 offset:16384
    s_nop 15
    s_nop 7
    v_max3_f32 v140, v0, v1, v2
    v_max3_f32 v140, v140, v3, v4
    v_max3_f32 v140, v140, v5, v6
    v_max3_f32 v140, v140, v7, v8
    v_max3_f32 v140, v140, v9, v10
    v_max3_f32 v140, v140, v11, v12
    v_max3_f32 v140, v140, v13, v14
    v_max_f32 v140, v140, v15
    v_mov_b32 v141, v140
    s_nop 1
    v_permlane32_swap_b32 v140, v141
    s_nop 1
    v_max_f32 v140, v140, v141
    v_sub_f32 v0, v0, v140
    v_sub_f32 v32, v32, v140
    v_sub_f32 v96, v96, v140
    v_sub_f32 v1, v1, v140
    v_sub_f32 v33, v33, v140
    v_sub_f32 v97, v97, v140
    v_sub_f32 v2, v2, v140
    v_sub_f32 v34, v34, v140
    v_sub_f32 v98, v98, v140
    v_sub_f32 v3, v3, v140
    v_sub_f32 v35, v35, v140
    v_sub_f32 v99, v99, v140
    v_sub_f32 v4, v4, v140
    v_sub_f32 v36, v36, v140
    v_sub_f32 v100, v100, v140
    v_sub_f32 v5, v5, v140
    v_sub_f32 v37, v37, v140
    v_sub_f32 v101, v101, v140
    v_sub_f32 v6, v6, v140
    v_sub_f32 v38, v38, v140
    v_sub_f32 v102, v102, v140
    v_sub_f32 v7, v7, v140
    v_sub_f32 v39, v39, v140
    v_sub_f32 v103, v103, v140
    v_sub_f32 v8, v8, v140
    v_sub_f32 v40, v40, v140
    v_sub_f32 v104, v104, v140
    v_sub_f32 v9, v9, v140
    v_sub_f32 v41, v41, v140
    v_sub_f32 v105, v105, v140
    v_sub_f32 v10, v10, v140
    v_sub_f32 v42, v42, v140
    v_sub_f32 v106, v106, v140
    v_sub_f32 v11, v11, v140
    v_sub_f32 v43, v43, v140
    v_sub_f32 v107, v107, v140
    v_sub_f32 v12, v12, v140
    v_sub_f32 v44, v44, v140
    v_sub_f32 v108, v108, v140
    v_sub_f32 v13, v13, v140
    v_sub_f32 v45, v45, v140
    v_sub_f32 v109, v109, v140
    v_sub_f32 v14, v14, v140
    v_sub_f32 v46, v46, v140
    v_sub_f32 v110, v110, v140
    v_sub_f32 v15, v15, v140
    v_sub_f32 v47, v47, v140
    v_sub_f32 v111, v111, v140
    v_max3_f32 v140, v16, v17, v18
    v_max3_f32 v140, v140, v19, v20
    v_max3_f32 v140, v140, v21, v22
    v_max3_f32 v140, v140, v23, v24
    v_max3_f32 v140, v140, v25, v26
    v_max3_f32 v140, v140, v27, v28
    v_max3_f32 v140, v140, v29, v30
    v_max_f32 v140, v140, v31
    v_mov_b32 v141, v140
    s_nop 1
    v_permlane32_swap_b32 v140, v141
    s_nop 1
    v_max_f32 v140, v140, v141
    v_sub_f32 v16, v16, v140
    v_sub_f32 v48, v48, v140
    v_sub_f32 v112, v112, v140
    v_sub_f32 v17, v17, v140
    v_sub_f32 v49, v49, v140
    v_sub_f32 v113, v113, v140
    v_sub_f32 v18, v18, v140
    v_sub_f32 v50, v50, v140
    v_sub_f32 v114, v114, v140
    v_sub_f32 v19, v19, v140
    v_sub_f32 v51, v51, v140
    v_sub_f32 v115, v115, v140
    v_sub_f32 v20, v20, v140
    v_sub_f32 v52, v52, v140
    v_sub_f32 v116, v116, v140
    v_sub_f32 v21, v21, v140
    v_sub_f32 v53, v53, v140
    v_sub_f32 v117, v117, v140
    v_sub_f32 v22, v22, v140
    v_sub_f32 v54, v54, v140
    v_sub_f32 v118, v118, v140
    v_sub_f32 v23, v23, v140
    v_sub_f32 v55, v55, v140
    v_sub_f32 v119, v119, v140
    v_sub_f32 v24, v24, v140
    v_sub_f32 v56, v56, v140
    v_sub_f32 v120, v120, v140
    v_sub_f32 v25, v25, v140
    v_sub_f32 v57, v57, v140
    v_sub_f32 v121, v121, v140
    v_sub_f32 v26, v26, v140
    v_sub_f32 v58, v58, v140
    v_sub_f32 v122, v122, v140
    v_sub_f32 v27, v27, v140
    v_sub_f32 v59, v59, v140
    v_sub_f32 v123, v123, v140
    v_sub_f32 v28, v28, v140
    v_sub_f32 v60, v60, v140
    v_sub_f32 v124, v124, v140
    v_sub_f32 v29, v29, v140
    v_sub_f32 v61, v61, v140
    v_sub_f32 v125, v125, v140
    v_sub_f32 v30, v30, v140
    v_sub_f32 v62, v62, v140
    v_sub_f32 v126, v126, v140
    v_sub_f32 v31, v31, v140
    v_sub_f32 v63, v63, v140
    v_sub_f32 v127, v127, v140
    v_exp_f32 v128, v0
    s_nop 0
    v_exp_f32 v129, v1
    s_nop 0
    v_exp_f32 v130, v2
    v_add_f32 v138, v128, v129
    v_cvt_pk_bf16_f32 v64, v128, v129
    s_nop 0
    v_exp_f32 v131, v3
    v_add_f32 v138, v138, v130
    s_nop 0
    v_exp_f32 v132, v4
    v_add_f32 v138, v138, v131
    v_cvt_pk_bf16_f32 v65, v130, v131
    s_nop 0
    v_exp_f32 v133, v5
    v_add_f32 v138, v138, v132
    s_nop 0
    v_exp_f32 v134, v6
    v_add_f32 v138, v138, v133
    v_cvt_pk_bf16_f32 v66, v132, v133
    s_nop 0
    v_exp_f32 v135, v7
    v_add_f32 v138, v138, v134
    s_nop 0
    v_exp_f32 v128, v8
    v_add_f32 v138, v138, v135
    v_cvt_pk_bf16_f32 v67, v134, v135
    s_nop 0
    v_exp_f32 v129, v9
    v_add_f32 v138, v138, v128
    s_nop 0
    v_exp_f32 v130, v10
    v_add_f32 v138, v138, v129
    v_cvt_pk_bf16_f32 v68, v128, v129
    s_nop 0
    v_exp_f32 v131, v11
    v_add_f32 v138, v138, v130
    s_nop 0
    v_exp_f32 v132, v12
    v_add_f32 v138, v138, v131
    v_cvt_pk_bf16_f32 v69, v130, v131
    s_nop 0
    v_exp_f32 v133, v13
    v_add_f32 v138, v138, v132
    s_nop 0
    v_exp_f32 v134, v14
    v_add_f32 v138, v138, v133
    v_cvt_pk_bf16_f32 v70, v132, v133
    s_nop 0
    v_exp_f32 v135, v15
    v_add_f32 v138, v138, v134
    s_nop 0
    v_exp_f32 v128, v16
    v_add_f32 v138, v138, v135
    v_cvt_pk_bf16_f32 v71, v134, v135
    s_nop 0
    v_exp_f32 v129, v17
    s_nop 0
    v_exp_f32 v130, v18
    v_add_f32 v139, v128, v129
    v_cvt_pk_bf16_f32 v72, v128, v129
    s_nop 0
    v_exp_f32 v131, v19
    v_add_f32 v139, v139, v130
    s_nop 0
    v_exp_f32 v132, v20
    v_add_f32 v139, v139, v131
    v_cvt_pk_bf16_f32 v73, v130, v131
    s_nop 0
    v_exp_f32 v133, v21
    v_add_f32 v139, v139, v132
    s_nop 0
    v_exp_f32 v134, v22
    v_add_f32 v139, v139, v133
    v_cvt_pk_bf16_f32 v74, v132, v133
    s_nop 0
    v_exp_f32 v135, v23
    v_add_f32 v139, v139, v134
    s_nop 0
    v_exp_f32 v128, v24
    v_add_f32 v139, v139, v135
    v_cvt_pk_bf16_f32 v75, v134, v135
    s_nop 0
    v_exp_f32 v129, v25
    v_add_f32 v139, v139, v128
    s_nop 0
    v_exp_f32 v130, v26
    v_add_f32 v139, v139, v129
    v_cvt_pk_bf16_f32 v76, v128, v129
    s_nop 0
    v_exp_f32 v131, v27
    v_add_f32 v139, v139, v130
    s_nop 0
    v_exp_f32 v132, v28
    v_add_f32 v139, v139, v131
    v_cvt_pk_bf16_f32 v77, v130, v131
    s_nop 0
    v_exp_f32 v133, v29
    v_add_f32 v139, v139, v132
    s_nop 0
    v_exp_f32 v134, v30
    v_add_f32 v139, v139, v133
    v_cvt_pk_bf16_f32 v78, v132, v133
    s_nop 0
    v_exp_f32 v135, v31
    v_add_f32 v139, v139, v134
    s_nop 0
    v_add_f32 v139, v139, v135
    v_cvt_pk_bf16_f32 v79, v134, v135
    s_nop 0
    s_nop 1
    s_mov_b32 s42, 40960
    s_mov_b32 s43, 16384
    s_mov_b32 s47, 14
    .p2align 3
att_loop:
    s_waitcnt vmcnt(4) lgkmcnt(0)
    s_barrier
    v_mfma_f32_32x32x16_bf16 v[0:15], a[192:195], a[128:131], v[96:111]
    v_add_f32 v136, v136, v138
    v_add_f32 v137, v137, v139
    v_exp_f32 v128, v32
    ds_read_b64_tr_b16 a[224:225], v152 offset:0
    ds_read_b64_tr_b16 a[226:227], v152 offset:2048
    v_mfma_f32_32x32x16_bf16 v[16:31], a[192:195], a[160:163], v[112:127]
    v_exp_f32 v129, v33
    v_exp_f32 v130, v34
    v_add_f32 v138, v128, v129
    ds_read_b64_tr_b16 a[228:229], v153 offset:0
    v_mfma_f32_32x32x16_bf16 v[0:15], a[196:199], a[132:135], v[0:15]
    v_cvt_pk_bf16_f32 v80, v128, v129
    v_exp_f32 v131, v35
    v_add_f32 v138, v138, v130
    ds_read_b64_tr_b16 a[230:231], v153 offset:2048
    v_mfma_f32_32x32x16_bf16 v[16:31], a[196:199], a[164:167], v[16:31]
    v_exp_f32 v132, v36
    v_add_f32 v138, v138, v131
    v_cvt_pk_bf16_f32 v81, v130, v131
    ds_read_b64_tr_b16 a[232:233], v154 offset:0
    ds_read_b64_tr_b16 a[234:235], v154 offset:2048
    v_mfma_f32_32x32x16_bf16 v[0:15], a[200:203], a[136:139], v[0:15]
    v_exp_f32 v133, v37
    v_add_f32 v138, v138, v132
    v_exp_f32 v134, v38
    ds_read_b64_tr_b16 a[236:237], v155 offset:0
    v_mfma_f32_32x32x16_bf16 v[16:31], a[200:203], a[168:171], v[16:31]
    v_add_f32 v138, v138, v133
    v_cvt_pk_bf16_f32 v82, v132, v133
    v_exp_f32 v135, v39
    v_add_f32 v138, v138, v134
    ds_read_b64_tr_b16 a[238:239], v155 offset:2048
    v_mfma_f32_32x32x16_bf16 v[0:15], a[204:207], a[140:143], v[0:15]
    v_exp_f32 v128, v40
    v_add_f32 v138, v138, v135
    v_cvt_pk_bf16_f32 v83, v134, v135
    ds_read_b64_tr_b16 a[240:241], v152 offset:4096
    ds_read_b64_tr_b16 a[242:243], v152 offset:6144
    v_mfma_f32_32x32x16_bf16 v[16:31], a[204:207], a[172:175], v[16:31]
    v_exp_f32 v129, v41
    v_add_f32 v138, v138, v128
    v_exp_f32 v130, v42
    ds_read_b64_tr_b16 a[244:245], v153 offset:4096
    v_mfma_f32_32x32x16_bf16 v[0:15], a[208:211], a[144:147], v[0:15]
    v_add_f32 v138, v138, v129
    v_cvt_pk_bf16_f32 v84, v128, v129
    v_exp_f32 v131, v43
    v_add_f32 v138, v138, v130
    ds_read_b64_tr_b16 a[246:247], v153 offset:6144
    v_mfma_f32_32x32x16_bf16 v[16:31], a[208:211], a[176:179], v[16:31]
    v_exp_f32 v132, v44
    v_add_f32 v138, v138, v131
    v_cvt_pk_bf16_f32 v85, v130, v131
    ds_read_b64_tr_b16 a[248:249], v154 offset:4096
    ds_read_b64_tr_b16 a[250:251], v154 offset:6144
    v_mfma_f32_32x32x16_bf16 v[0:15], a[212:215], a[148:151], v[0:15]
    v_exp_f32 v133, v45
    v_add_f32 v138, v138, v132
    v_exp_f32 v134, v46
    ds_read_b64_tr_b16 a[252:253], v155 offset:4096
    v_mfma_f32_32x32x16_bf16 v[16:31], a[212:215], a[180:183], v[16:31]
    v_add_f32 v138, v138, v133
    v_cvt_pk_bf16_f32 v86, v132, v133
    v_exp_f32 v135, v47
    v_add_f32 v138, v138, v134
    ds_read_b64_tr_b16 a[254:255], v155 offset:6144
    v_mfma_f32_32x32x16_bf16 v[0:15], a[216:219], a[152:155], v[0:15]
    s_add_u32 m0, s41, 8192
    s_nop 0
    buffer_load_dwordx4 v156, s[20:23], s42 offen lds
    v_mfma_f32_32x32x16_bf16 v[16:31], a[216:219], a[184:187], v[16:31]
    v_exp_f32 v128, v48
    v_add_f32 v138, v138, v135
    v_cvt_pk_bf16_f32 v87, v134, v135
    v_exp_f32 v129, v49
    v_mfma_f32_32x32x16_bf16 v[0:15], a[220:223], a[156:159], v[0:15]
    v_exp_f32 v130, v50
    buffer_load_dwordx4 v157, s[20:23], s42 offen offset:2048 lds
    v_mfma_f32_32x32x16_bf16 v[16:31], a[220:223], a[188:191], v[16:31]
    v_add_f32 v139, v128, v129
    v_cvt_pk_bf16_f32 v88, v128, v129
    v_exp_f32 v131, v51
    v_add_f32 v139, v139, v130
    s_waitcnt lgkmcnt(0)
    v_mfma_f32_32x32x16_bf16 a[0:15], a[224:227], v[64:67], a[0:15]
    v_exp_f32 v132, v52
    v_add_f32 v139, v139, v131
    v_cvt_pk_bf16_f32 v89, v130, v131
    v_exp_f32 v133, v53
    v_mfma_f32_32x32x16_bf16 a[64:79], a[224:227], v[72:75], a[64:79]
    v_add_f32 v139, v139, v132
    v_exp_f32 v134, v54
    v_add_f32 v139, v139, v133
    v_cvt_pk_bf16_f32 v90, v132, v133
    ds_read_b128 a[192:195], v144 offset:24576
    v_mfma_f32_32x32x16_bf16 a[16:31], a[228:231], v[64:67], a[16:31]
    v_exp_f32 v135, v55
    v_add_f32 v139, v139, v134
    v_exp_f32 v128, v56
    ds_read_b128 a[196:199], v145 offset:24576
    v_mfma_f32_32x32x16_bf16 a[80:95], a[228:231], v[72:75], a[80:95]
    v_add_f32 v139, v139, v135
    v_cvt_pk_bf16_f32 v91, v134, v135
    v_exp_f32 v129, v57
    v_add_f32 v139, v139, v128
    ds_read_b128 a[200:203], v146 offset:24576
    v_mfma_f32_32x32x16_bf16 a[32:47], a[232:235], v[64:67], a[32:47]
    v_exp_f32 v130, v58
    v_add_f32 v139, v139, v129
    v_cvt_pk_bf16_f32 v92, v128, v129
    ds_read_b128 a[204:207], v147 offset:24576
    v_mfma_f32_32x32x16_bf16 a[96:111], a[232:235], v[72:75], a[96:111]
    v_exp_f32 v131, v59
    v_add_f32 v139, v139, v130
    v_exp_f32 v132, v60
    v_add_f32 v139, v139, v131
    v_mfma_f32_32x32x16_bf16 a[48:63], a[236:239], v[64:67], a[48:63]
    v_cvt_pk_bf16_f32 v93, v130, v131
    v_exp_f32 v133, v61
    v_add_f32 v139, v139, v132
    ds_read_b128 a[208:211], v148 offset:24576
    v_mfma_f32_32x32x16_bf16 a[112:127], a[236:239], v[72:75], a[112:127]
    v_exp_f32 v134, v62
    v_add_f32 v139, v139, v133
    v_cvt_pk_bf16_f32 v94, v132, v133
    ds_read_b128 a[212:215], v149 offset:24576
    v_mfma_f32_32x32x16_bf16 a[0:15], a[240:243], v[68:71], a[0:15]
    v_exp_f32 v135, v63
    v_add_f32 v139, v139, v134
    v_add_f32 v139, v139, v135
    s_nop 0
    ds_read_b128 a[216:219], v150 offset:24576
    v_mfma_f32_32x32x16_bf16 a[64:79], a[240:243], v[76:79], a[64:79]
    v_cvt_pk_bf16_f32 v95, v134, v135
    v_max_f32 v140, v138, v139
    v_cmp_nge_f32 vcc, s44, v140
    ds_read_b128 a[220:223], v151 offset:24576
    v_mfma_f32_32x32x16_bf16 a[16:31], a[244:247], v[68:71], a[16:31]
    s_add_u32 m0, s41, 49152
    s_nop 0
    buffer_load_dwordx4 v158, s[24:27], s43 offen lds
    v_mfma_f32_32x32x16_bf16 a[80:95], a[244:247], v[76:79], a[80:95]
    v_mfma_f32_32x32x16_bf16 a[32:47], a[248:251], v[68:71], a[32:47]
    buffer_load_dwordx4 v158, s[24:27], s43 offen offset:2048 lds
    v_mfma_f32_32x32x16_bf16 a[96:111], a[248:251], v[76:79], a[96:111]
    s_add_u32 s42, s42, 8192
    s_add_u32 s43, s43, 8192
    v_mfma_f32_32x32x16_bf16 a[48:63], a[252:255], v[68:71], a[48:63]
    v_mfma_f32_32x32x16_bf16 a[112:127], a[252:255], v[76:79], a[112:127]
    s_cbranch_vccnz att_L0_slow
att_L0_back:
    s_waitcnt vmcnt(4) lgkmcnt(0)
    s_barrier
    v_mfma_f32_32x32x16_bf16 v[32:47], a[192:195], a[128:131], v[96:111]
    v_add_f32 v136, v136, v138
    v_add_f32 v137, v137, v139
    v_exp_f32 v128, v0
    ds_read_b64_tr_b16 a[224:225], v152 offset:8192
    ds_read_b64_tr_b16 a[226:227], v152 offset:10240
    v_mfma_f32_32x32x16_bf16 v[48:63], a[192:195], a[160:163], v[112:127]
    v_exp_f32 v129, v1
    v_exp_f32 v130, v2
    v_add_f32 v138, v128, v129
    ds_read_b64_tr_b16 a[228:229], v153 offset:8192
    v_mfma_f32_32x32x16_bf16 v[32:47], a[196:199], a[132:135], v[32:47]
    v_cvt_pk_bf16_f32 v64, v128, v129
    v_exp_f32 v131, v3
    v_add_f32 v138, v138, v130
    ds_read_b64_tr_b16 a[230:231], v153 offset:10240
    v_mfma_f32_32x32x16_bf16 v[48:63], a[196:199], a[164:167], v[48:63]
    v_exp_f32 v132, v4
    v_add_f32 v138, v138, v131
    v_cvt_pk_bf16_f32 v65, v130, v131
    ds_read_b64_tr_b16 a[232:233], v154 offset:8192
    ds_read_b64_tr_b16 a[234:235], v154 offset:10240
    v_mfma_f32_32x32x16_bf16 v[32:47], a[200:203], a[136:139], v[32:47]
    v_exp_f32 v133, v5
    v_add_f32 v138, v138, v132
    v_exp_f32 v134, v6
    ds_read_b64_tr_b16 a[236:237], v155 offset:8192
    v_mfma_f32_32x32x16_bf16 v[48:63], a[200:203], a[168:171], v[48:63]
    v_add_f32 v138, v138, v133
    v_cvt_pk_bf16_f32 v66, v132, v133
    v_exp_f32 v135, v7
    v_add_f32 v138, v138, v134
    ds_read_b64_tr_b16 a[238:239], v155 offset:10240
    v_mfma_f32_32x32x16_bf16 v[32:47], a[204:207], a[140:143], v[32:47]
    v_exp_f32 v128, v8
    v_add_f32 v138, v138, v135
    v_cvt_pk_bf16_f32 v67, v134, v135
    ds_read_b64_tr_b16 a[240:241], v152 offset:12288
    ds_read_b64_tr_b16 a[242:243], v152 offset:14336
    v_mfma_f32_32x32x16_bf16 v[48:63], a[204:207], a[172:175], v[48:63]
    v_exp_f32 v129, v9
    v_add_f32 v138, v138, v128
    v_exp_f32 v130, v10
    ds_read_b64_tr_b16 a[244:245], v153 offset:12288
    v_mfma_f32_32x32x16_bf16 v[32:47], a[208:211], a[144:147], v[32:47]
    v_add_f32 v138, v138, v129
    v_cvt_pk_bf16_f32 v68, v128, v129
    v_exp_f32 v131, v11
    v_add_f32 v138, v138, v130
    ds_read_b64_tr_b16 a[246:247], v153 offset:14336
    v_mfma_f32_32x32x16_bf16 v[48:63], a[208:211], a[176:179], v[48:63]
    v_exp_f32 v132, v12
    v_add_f32 v138, v138, v131
    v_cvt_pk_bf16_f32 v69, v130, v131
    ds_read_b64_tr_b16 a[248:249], v154 offset:12288
    ds_read_b64_tr_b16 a[250:251], v154 offset:14336
    v_mfma_f32_32x32x16_bf16 v[32:47], a[212:215], a[148:151], v[32:47]
    v_exp_f32 v133, v13
    v_add_f32 v138, v138, v132
    v_exp_f32 v134, v14
    ds_read_b64_tr_b16 a[252:253], v155 offset:12288
    v_mfma_f32_32x32x16_bf16 v[48:63], a[212:215], a[180:183], v[48:63]
    v_add_f32 v138, v138, v133
    v_cvt_pk_bf16_f32 v70, v132, v133
    v_exp_f32 v135, v15
    v_add_f32 v138, v138, v134
    ds_read_b64_tr_b16 a[254:255], v155 offset:14336
    v_mfma_f32_32x32x16_bf16 v[32:47], a[216:219], a[152:155], v[32:47]
    s_add_u32 m0, s41, 16384
    s_nop 0
    buffer_load_dwordx4 v156, s[20:23], s42 offen lds
    v_mfma_f32_32x32x16_bf16 v[48:63], a[216:219], a[184:187], v[48:63]
    v_exp_f32 v128, v16
    v_add_f32 v138, v138, v135
    v_cvt_pk_bf16_f32 v71, v134, v135
    v_exp_f32 v129, v17
    v_mfma_f32_32x32x16_bf16 v[32:47], a[220:223], a[156:159], v[32:47]
    v_exp_f32 v130, v18
    buffer_load_dwordx4 v157, s[20:23], s42 offen offset:2048 lds
    v_mfma_f32_32x32x16_bf16 v[48:63], a[220:223], a[188:191], v[48:63]
    v_add_f32 v139, v128, v129
    v_cvt_pk_bf16_f32 v72, v128, v129
    v_exp_f32 v131, v19
    v_add_f32 v139, v139, v130
    s_waitcnt lgkmcnt(0)
    v_mfma_f32_32x32x16_bf16 a[0:15], a[224:227], v[80:83], a[0:15]
    v_exp_f32 v132, v20
    v_add_f32 v139, v139, v131
    v_cvt_pk_bf16_f32 v73, v130, v131
    v_exp_f32 v133, v21
    v_mfma_f32_32x32x16_bf16 a[64:79], a[224:227], v[88:91], a[64:79]
    v_add_f32 v139, v139, v132
    v_exp_f32 v134, v22
    v_add_f32 v139, v139, v133
    v_cvt_pk_bf16_f32 v74, v132, v133
    ds_read_b128 a[192:195], v144 offset:0
    v_mfma_f32_32x32x16_bf16 a[16:31], a[228:231], v[80:83], a[16:31]
    v_exp_f32 v135, v23
    v_add_f32 v139, v139, v134
    v_exp_f32 v128, v24
    ds_read_b128 a[196:199], v145 offset:0
    v_mfma_f32_32x32x16_bf16 a[80:95], a[228:231], v[88:91], a[80:95]
    v_add_f32 v139, v139, v135
    v_cvt_pk_bf16_f32 v75, v134, v135
    v_exp_f32 v129, v25
    v_add_f32 v139, v139, v128
    ds_read_b128 a[200:203], v146 offset:0
    v_mfma_f32_32x32x16_bf16 a[32:47], a[232:235], v[80:83], a[32:47]
    v_exp_f32 v130, v26
    v_add_f32 v139, v139, v129
    v_cvt_pk_bf16_f32 v76, v128, v129
    ds_read_b128 a[204:207], v147 offset:0
    v_mfma_f32_32x32x16_bf16 a[96:111], a[232:235], v[88:91], a[96:111]
    v_exp_f32 v131, v27
    v_add_f32 v139, v139, v130
    v_exp_f32 v132, v28
    v_add_f32 v139, v139, v131
    v_mfma_f32_32x32x16_bf16 a[48:63], a[236:239], v[80:83], a[48:63]
    v_cvt_pk_bf16_f32 v77, v130, v131
    v_exp_f32 v133, v29
    v_add_f32 v139, v139, v132
    ds_read_b128 a[208:211], v148 offset:0
    v_mfma_f32_32x32x16_bf16 a[112:127], a[236:239], v[88:91], a[112:127]
    v_exp_f32 v134, v30
    v_add_f32 v139, v139, v133
    v_cvt_pk_bf16_f32 v78, v132, v133
    ds_read_b128 a[212:215], v149 offset:0
    v_mfma_f32_32x32x16_bf16 a[0:15], a[240:243], v[84:87], a[0:15]
    v_exp_f32 v135, v31
    v_add_f32 v139, v139, v134
    v_add_f32 v139, v139, v135
    s_nop 0
    ds_read_b128 a[216:219], v150 offset:0
    v_mfma_f32_32x32x16_bf16 a[64:79], a[240:243], v[92:95], a[64:79]
    v_cvt_pk_bf16_f32 v79, v134, v135
    v_max_f32 v140, v138, v139
    v_cmp_nge_f32 vcc, s44, v140
    ds_read_b128 a[220:223], v151 offset:0
    v_mfma_f32_32x32x16_bf16 a[16:31], a[244:247], v[84:87], a[16:31]
    s_add_u32 m0, s41, 57344
    s_nop 0
    buffer_load_dwordx4 v158, s[24:27], s43 offen lds
    v_mfma_f32_32x32x16_bf16 a[80:95], a[244:247], v[92:95], a[80:95]
    v_mfma_f32_32x32x16_bf16 a[32:47], a[248:251], v[84:87], a[32:47]
    buffer_load_dwordx4 v158, s[24:27], s43 offen offset:2048 lds
    v_mfma_f32_32x32x16_bf16 a[96:111], a[248:251], v[92:95], a[96:111]
    s_add_u32 s42, s42, 8192
    s_add_u32 s43, s43, 8192
    v_mfma_f32_32x32x16_bf16 a[48:63], a[252:255], v[84:87], a[48:63]
    v_mfma_f32_32x32x16_bf16 a[112:127], a[252:255], v[92:95], a[112:127]
    s_cbranch_vccnz att_L1_slow
att_L1_back:
    s_waitcnt vmcnt(4) lgkmcnt(0)
    s_barrier
    v_mfma_f32_32x32x16_bf16 v[0:15], a[192:195], a[128:131], v[96:111]
    v_add_f32 v136, v136, v138
    v_add_f32 v137, v137, v139
    v_exp_f32 v128, v32
    ds_read_b64_tr_b16 a[224:225], v152 offset:16384
    ds_read_b64_tr_b16 a[226:227], v152 offset:18432
    v_mfma_f32_32x32x16_bf16 v[16:31], a[192:195], a[160:163], v[112:127]
    v_exp_f32 v129, v33
    v_exp_f32 v130, v34
    v_add_f32 v138, v128, v129
    ds_read_b64_tr_b16 a[228:229], v153 offset:16384
    v_mfma_f32_32x32x16_bf16 v[0:15], a[196:199], a[132:135], v[0:15]
    v_cvt_pk_bf16_f32 v80, v128, v129
    v_exp_f32 v131, v35
    v_add_f32 v138, v138, v130
    ds_read_b64_tr_b16 a[230:231], v153 offset:18432
    v_mfma_f32_32x32x16_bf16 v[16:31], a[196:199], a[164:167], v[16:31]
    v_exp_f32 v132, v36
    v_add_f32 v138, v138, v131
    v_cvt_pk_bf16_f32 v81, v130, v131
    ds_read_b64_tr_b16 a[232:233], v154 offset:16384
    ds_read_b64_tr_b16 a[234:235], v154 offset:18432
    v_mfma_f32_32x32x16_bf16 v[0:15], a[200:203], a[136:139], v[0:15]
    v_exp_f32 v133, v37
    v_add_f32 v138, v138, v132
    v_exp_f32 v134, v38
    ds_read_b64_tr_b16 a[236:237], v155 offset:16384
    v_mfma_f32_32x32x16_bf16 v[16:31], a[200:203], a[168:171], v[16:31]
    v_add_f32 v138, v138, v133
    v_cvt_pk_bf16_f32 v82, v132, v133
    v_exp_f32 v135, v39
    v_add_f32 v138, v138, v134
    ds_read_b64_tr_b16 a[238:239], v155 offset:18432
    v_mfma_f32_32x32x16_bf16 v[0:15], a[204:207], a[140:143], v[0:15]
    v_exp_f32 v128, v40
    v_add_f32 v138, v138, v135
    v_cvt_pk_bf16_f32 v83, v134, v135
    ds_read_b64_tr_b16 a[240:241], v152 offset:20480
    ds_read_b64_tr_b16 a[242:243], v152 offset:22528
    v_mfma_f32_32x32x16_bf16 v[16:31], a[204:207], a[172:175], v[16:31]
    v_exp_f32 v129, v41
    v_add_f32 v138, v138, v128
    v_exp_f32 v130, v42
    ds_read_b64_tr_b16 a[244:245], v153 offset:20480
    v_mfma_f32_32x32x16_bf16 v[0:15], a[208:211], a[144:147], v[0:15]
    v_add_f32 v138, v138, v129
    v_cvt_pk_bf16_f32 v84, v128, v129
    v_exp_f32 v131, v43
    v_add_f32 v138, v138, v130
    ds_read_b64_tr_b16 a[246:247], v153 offset:22528
    v_mfma_f32_32x32x16_bf16 v[16:31], a[208:211], a[176:179], v[16:31]
    v_exp_f32 v132, v44
    v_add_f32 v138, v138, v131
    v_cvt_pk_bf16_f32 v85, v130, v131
    ds_read_b64_tr_b16 a[248:249], v154 offset:20480
    ds_read_b64_tr_b16 a[250:251], v154 offset:22528
    v_mfma_f32_32x32x16_bf16 v[0:15], a[212:215], a[148:151], v[0:15]
    v_exp_f32 v133, v45
    v_add_f32 v138, v138, v132
    v_exp_f32 v134, v46
    ds_read_b64_tr_b16 a[252:253], v155 offset:20480
    v_mfma_f32_32x32x16_bf16 v[16:31], a[212:215], a[180:183], v[16:31]
    v_add_f32 v138, v138, v133
    v_cvt_pk_bf16_f32 v86, v132, v133
    v_exp_f32 v135, v47
    v_add_f32 v138, v138, v134
    ds_read_b64_tr_b16 a[254:255], v155 offset:22528
    v_mfma_f32_32x32x16_bf16 v[0:15], a[216:219], a[152:155], v[0:15]
    s_add_u32 m0, s41, 24576
    s_nop 0
    buffer_load_dwordx4 v156, s[20:23], s42 offen lds
    v_mfma_f32_32x32x16_bf16 v[16:31], a[216:219], a[184:187], v[16:31]
    v_exp_f32 v128, v48
    v_add_f32 v138, v138, v135
    v_cvt_pk_bf16_f32 v87, v134, v135
    v_exp_f32 v129, v49
    v_mfma_f32_32x32x16_bf16 v[0:15], a[220:223], a[156:159], v[0:15]
    v_exp_f32 v130, v50
    buffer_load_dwordx4 v157, s[20:23], s42 offen offset:2048 lds
    v_mfma_f32_32x32x16_bf16 v[16:31], a[220:223], a[188:191], v[16:31]
    v_add_f32 v139, v128, v129
    v_cvt_pk_bf16_f32 v88, v128, v129
    v_exp_f32 v131, v51
    v_add_f32 v139, v139, v130
    s_waitcnt lgkmcnt(0)
    v_mfma_f32_32x32x16_bf16 a[0:15], a[224:227], v[64:67], a[0:15]
    v_exp_f32 v132, v52
    v_add_f32 v139, v139, v131
    v_cvt_pk_bf16_f32 v89, v130, v131
    v_exp_f32 v133, v53
    v_mfma_f32_32x32x16_bf16 a[64:79], a[224:227], v[72:75], a[64:79]
    v_add_f32 v139, v139, v132
    v_exp_f32 v134, v54
    v_add_f32 v139, v139, v133
    v_cvt_pk_bf16_f32 v90, v132, v133
    ds_read_b128 a[192:195], v144 offset:8192
    v_mfma_f32_32x32x16_bf16 a[16:31], a[228:231], v[64:67], a[16:31]
    v_exp_f32 v135, v55
    v_add_f32 v139, v139, v134
    v_exp_f32 v128, v56
    ds_read_b128 a[196:199], v145 offset:8192
    v_mfma_f32_32x32x16_bf16 a[80:95], a[228:231], v[72:75], a[80:95]
    v_add_f32 v139, v139, v135
    v_cvt_pk_bf16_f32 v91, v134, v135
    v_exp_f32 v129, v57
    v_add_f32 v139, v139, v128
    ds_read_b128 a[200:203], v146 offset:8192
    v_mfma_f32_32x32x16_bf16 a[32:47], a[232:235], v[64:67], a[32:47]
    v_exp_f32 v130, v58
    v_add_f32 v139, v139, v129
    v_cvt_pk_bf16_f32 v92, v128, v129
    ds_read_b128 a[204:207], v147 offset:8192
    v_mfma_f32_32x32x16_bf16 a[96:111], a[232:235], v[72:75], a[96:111]
    v_exp_f32 v131, v59
    v_add_f32 v139, v139, v130
    v_exp_f32 v132, v60
    v_add_f32 v139, v139, v131
    v_mfma_f32_32x32x16_bf16 a[48:63], a[236:239], v[64:67], a[48:63]
    v_cvt_pk_bf16_f32 v93, v130, v131
    v_exp_f32 v133, v61
    v_add_f32 v139, v139, v132
    ds_read_b128 a[208:211], v148 offset:8192
    v_mfma_f32_32x32x16_bf16 a[112:127], a[236:239], v[72:75], a[112:127]
    v_exp_f32 v134, v62
    v_add_f32 v139, v139, v133
    v_cvt_pk_bf16_f32 v94, v132, v133
    ds_read_b128 a[212:215], v149 offset:8192
    v_mfma_f32_32x32x16_bf16 a[0:15], a[240:243], v[68:71], a[0:15]
    v_exp_f32 v135, v63
    v_add_f32 v139, v139, v134
    v_add_f32 v139, v139, v135
    s_nop 0
    ds_read_b128 a[216:219], v150 offset:8192
    v_mfma_f32_32x32x16_bf16 a[64:79], a[240:243], v[76:79], a[64:79]
    v_cvt_pk_bf16_f32 v95, v134, v135
    v_max_f32 v140, v138, v139
    v_cmp_nge_f32 vcc, s44, v140
    ds_read_b128 a[220:223], v151 offset:8192
    v_mfma_f32_32x32x16_bf16 a[16:31], a[244:247], v[68:71], a[16:31]
    s_add_u32 m0, s41, 32768
    s_nop 0
    buffer_load_dwordx4 v158, s[24:27], s43 offen lds
    v_mfma_f32_32x32x16_bf16 a[80:95], a[244:247], v[76:79], a[80:95]
    v_mfma_f32_32x32x16_bf16 a[32:47], a[248:251], v[68:71], a[32:47]
    buffer_load_dwordx4 v158, s[24:27], s43 offen offset:2048 lds
    v_mfma_f32_32x32x16_bf16 a[96:111], a[248:251], v[76:79], a[96:111]
    s_add_u32 s42, s42, 8192
    s_add_u32 s43, s43, 8192
    v_mfma_f32_32x32x16_bf16 a[48:63], a[252:255], v[68:71], a[48:63]
    v_mfma_f32_32x32x16_bf16 a[112:127], a[252:255], v[76:79], a[112:127]
    s_cbranch_vccnz att_L2_slow
att_L2_back:
    s_waitcnt vmcnt(4) lgkmcnt(0)
    s_barrier
    v_mfma_f32_32x32x16_bf16 v[32:47], a[192:195], a[128:131], v[96:111]
    v_add_f32 v136, v136, v138
    v_add_f32 v137, v137, v139
    v_exp_f32 v128, v0
    ds_read_b64_tr_b16 a[224:225], v152 offset:24576
    ds_read_b64_tr_b16 a[226:227], v152 offset:26624
    v_mfma_f32_32x32x16_bf16 v[48:63], a[192:195], a[160:163], v[112:127]
    v_exp_f32 v129, v1
    v_exp_f32 v130, v2
    v_add_f32 v138, v128, v129
    ds_read_b64_tr_b16 a[228:229], v153 offset:24576
    v_mfma_f32_32x32x16_bf16 v[32:47], a[196:199], a[132:135], v[32:47]
    v_cvt_pk_bf16_f32 v64, v128, v129
    v_exp_f32 v131, v3
    v_add_f32 v138, v138, v130
    ds_read_b64_tr_b16 a[230:231], v153 offset:26624
    v_mfma_f32_32x32x16_bf16 v[48:63], a[196:199], a[164:167], v[48:63]
    v_exp_f32 v132, v4
    v_add_f32 v138, v138, v131
    v_cvt_pk_bf16_f32 v65, v130, v131
    ds_read_b64_tr_b16 a[232:233], v154 offset:24576
    ds_read_b64_tr_b16 a[234:235], v154 offset:26624
    v_mfma_f32_32x32x16_bf16 v[32:47], a[200:203], a[136:139], v[32:47]
    v_exp_f32 v133, v5
    v_add_f32 v138, v138, v132
    v_exp_f32 v134, v6
    ds_read_b64_tr_b16 a[236:237], v155 offset:24576
    v_mfma_f32_32x32x16_bf16 v[48:63], a[200:203], a[168:171], v[48:63]
    v_add_f32 v138, v138, v133
    v_cvt_pk_bf16_f32 v66, v132, v133
    v_exp_f32 v135, v7
    v_add_f32 v138, v138, v134
    ds_read_b64_tr_b16 a[238:239], v155 offset:26624
    v_mfma_f32_32x32x16_bf16 v[32:47], a[204:207], a[140:143], v[32:47]
    v_exp_f32 v128, v8
    v_add_f32 v138, v138, v135
    v_cvt_pk_bf16_f32 v67, v134, v135
    ds_read_b64_tr_b16 a[240:241], v152 offset:28672
    ds_read_b64_tr_b16 a[242:243], v152 offset:30720
    v_mfma_f32_32x32x16_bf16 v[48:63], a[204:207], a[172:175], v[48:63]
    v_exp_f32 v129, v9
    v_add_f32 v138, v138, v128
    v_exp_f32 v130, v10
    ds_read_b64_tr_b16 a[244:245], v153 offset:28672
    v_mfma_f32_32x32x16_bf16 v[32:47], a[208:211], a[144:147], v[32:47]
    v_add_f32 v138, v138, v129
    v_cvt_pk_bf16_f32 v68, v128, v129
    v_exp_f32 v131, v11
    v_add_f32 v138, v138, v130
    ds_read_b64_tr_b16 a[246:247], v153 offset:30720
    v_mfma_f32_32x32x16_bf16 v[48:63], a[208:211], a[176:179], v[48:63]
    v_exp_f32 v132, v12
    v_add_f32 v138, v138, v131
    v_cvt_pk_bf16_f32 v69, v130, v131
    ds_read_b64_tr_b16 a[248:249], v154 offset:28672
    ds_read_b64_tr_b16 a[250:251], v154 offset:30720
    v_mfma_f32_32x32x16_bf16 v[32:47], a[212:215], a[148:151], v[32:47]
    v_exp_f32 v133, v13
    v_add_f32 v138, v138, v132
    v_exp_f32 v134, v14
    ds_read_b64_tr_b16 a[252:253], v155 offset:28672
    v_mfma_f32_32x32x16_bf16 v[48:63], a[212:215], a[180:183], v[48:63]
    v_add_f32 v138, v138, v133
    v_cvt_pk_bf16_f32 v70, v132, v133
    v_exp_f32 v135, v15
    v_add_f32 v138, v138, v134
    ds_read_b64_tr_b16 a[254:255], v155 offset:30720
    v_mfma_f32_32x32x16_bf16 v[32:47], a[216:219], a[152:155], v[32:47]
    s_add_u32 m0, s41, 0
    s_nop 0
    buffer_load_dwordx4 v156, s[20:23], s42 offen lds
    v_mfma_f32_32x32x16_bf16 v[48:63], a[216:219], a[184:187], v[48:63]
    v_exp_f32 v128, v16
    v_add_f32 v138, v138, v135
    v_cvt_pk_bf16_f32 v71, v134, v135
    v_exp_f32 v129, v17
    v_mfma_f32_32x32x16_bf16 v[32:47], a[220:223], a[156:159], v[32:47]
    v_exp_f32 v130, v18
    buffer_load_dwordx4 v157, s[20:23], s42 offen offset:2048 lds
    v_mfma_f32_32x32x16_bf16 v[48:63], a[220:223], a[188:191], v[48:63]
    v_add_f32 v139, v128, v129
    v_cvt_pk_bf16_f32 v72, v128, v129
    v_exp_f32 v131, v19
    v_add_f32 v139, v139, v130
    s_waitcnt lgkmcnt(0)
    v_mfma_f32_32x32x16_bf16 a[0:15], a[224:227], v[80:83], a[0:15]
    v_exp_f32 v132, v20
    v_add_f32 v139, v139, v131
    v_cvt_pk_bf16_f32 v73, v130, v131
    v_exp_f32 v133, v21
    v_mfma_f32_32x32x16_bf16 a[64:79], a[224:227], v[88:91], a[64:79]
    v_add_f32 v139, v139, v132
    v_exp_f32 v134, v22
    v_add_f32 v139, v139, v133
    v_cvt_pk_bf16_f32 v74, v132, v133
    ds_read_b128 a[192:195], v144 offset:16384
    v_mfma_f32_32x32x16_bf16 a[16:31], a[228:231], v[80:83], a[16:31]
    v_exp_f32 v135, v23
    v_add_f32 v139, v139, v134
    v_exp_f32 v128, v24
    ds_read_b128 a[196:199], v145 offset:16384
    v_mfma_f32_32x32x16_bf16 a[80:95], a[228:231], v[88:91], a[80:95]
    v_add_f32 v139, v139, v135
    v_cvt_pk_bf16_f32 v75, v134, v135
    v_exp_f32 v129, v25
    v_add_f32 v139, v139, v128
    ds_read_b128 a[200:203], v146 offset:16384
    v_mfma_f32_32x32x16_bf16 a[32:47], a[232:235], v[80:83], a[32:47]
    v_exp_f32 v130, v26
    v_add_f32 v139, v139, v129
    v_cvt_pk_bf16_f32 v76, v128, v129
    ds_read_b128 a[204:207], v147 offset:16384
    v_mfma_f32_32x32x16_bf16 a[96:111], a[232:235], v[88:91], a[96:111]
    v_exp_f32 v131, v27
    v_add_f32 v139, v139, v130
    v_exp_f32 v132, v28
    v_add_f32 v139, v139, v131
    v_mfma_f32_32x32x16_bf16 a[48:63], a[236:239], v[80:83], a[48:63]
    v_cvt_pk_bf16_f32 v77, v130, v131
    v_exp_f32 v133, v29
    v_add_f32 v139, v139, v132
    ds_read_b128 a[208:211], v148 offset:16384
    v_mfma_f32_32x32x16_bf16 a[112:127], a[236:239], v[88:91], a[112:127]
    v_exp_f32 v134, v30
    v_add_f32 v139, v139, v133
    v_cvt_pk_bf16_f32 v78, v132, v133
    ds_read_b128 a[212:215], v149 offset:16384
    v_mfma_f32_32x32x16_bf16 a[0:15], a[240:243], v[84:87], a[0:15]
    v_exp_f32 v135, v31
    v_add_f32 v139, v139, v134
    v_add_f32 v139, v139, v135
    s_nop 0
    ds_read_b128 a[216:219], v150 offset:16384
    v_mfma_f32_32x32x16_bf16 a[64:79], a[240:243], v[92:95], a[64:79]
    v_cvt_pk_bf16_f32 v79, v134, v135
    v_max_f32 v140, v138, v139
    v_cmp_nge_f32 vcc, s44, v140
    ds_read_b128 a[220:223], v151 offset:16384
    v_mfma_f32_32x32x16_bf16 a[16:31], a[244:247], v[84:87], a[16:31]
    s_add_u32 m0, s41, 40960
    s_nop 0
    buffer_load_dwordx4 v158, s[24:27], s43 offen lds
    v_mfma_f32_32x32x16_bf16 a[80:95], a[244:247], v[92:95], a[80:95]
    v_mfma_f32_32x32x16_bf16 a[32:47], a[248:251], v[84:87], a[32:47]
    buffer_load_dwordx4 v158, s[24:27], s43 offen offset:2048 lds
    v_mfma_f32_32x32x16_bf16 a[96:111], a[248:251], v[92:95], a[96:111]
    s_add_u32 s42, s42, 8192
    s_add_u32 s43, s43, 8192
    v_mfma_f32_32x32x16_bf16 a[48:63], a[252:255], v[84:87], a[48:63]
    v_mfma_f32_32x32x16_bf16 a[112:127], a[252:255], v[92:95], a[112:127]
    s_cbranch_vccnz att_L3_slow
att_L3_back:
    s_sub_u32 s47, s47, 1
    s_cmp_lg_u32 s47, 0
    s_cbranch_scc1 att_loop
    s_load_dwordx2 s[52:53], s[0:1], 32
    s_load_dwordx2 s[56:57], s[0:1], 48
    s_load_dwordx2 s[72:73], s[0:1], 56
    s_load_dwordx2 s[76:77], s[0:1], 64
    s_waitcnt lgkmcnt(0)
    s_add_u32 s52, s52, 0
    s_addc_u32 s53, s53, 0
    s_mov_b32 s54, 4718592
    s_mov_b32 s55, 0x20000
    s_add_u32 s56, s56, 0
    s_addc_u32 s57, s57, 0
    s_mov_b32 s58, 5308416
    s_mov_b32 s59, 0x20000
    s_add_u32 s72, s72, 0
    s_addc_u32 s73, s73, 0
    s_mov_b32 s74, 5308416
    s_mov_b32 s75, 0x20000
    s_add_u32 s76, s76, 0
    s_addc_u32 s77, s77, 0
    s_mov_b32 s78, 5308416
    s_mov_b32 s79, 0x20000
    s_lshl_b32 s13, s2, 2
    s_add_u32 s13, s13, s40
    s_mul_i32 s13, s13, 5248
    v_lshlrev_b32 v163, 2, v161
    v_add_u32 v163, s13, v163
    v_add_u32 v164, 4096, v163
    s_waitcnt vmcnt(4) lgkmcnt(0)
    s_barrier
    v_mfma_f32_32x32x16_bf16 v[0:15], a[192:195], a[128:131], v[96:111]
    v_add_f32 v136, v136, v138
    v_add_f32 v137, v137, v139
    v_exp_f32 v128, v32
    ds_read_b64_tr_b16 a[224:225], v152 offset:0
    ds_read_b64_tr_b16 a[226:227], v152 offset:2048
    v_mfma_f32_32x32x16_bf16 v[16:31], a[192:195], a[160:163], v[112:127]
    v_exp_f32 v129, v33
    v_exp_f32 v130, v34
    v_add_f32 v138, v128, v129
    ds_read_b64_tr_b16 a[228:229], v153 offset:0
    v_mfma_f32_32x32x16_bf16 v[0:15], a[196:199], a[132:135], v[0:15]
    v_cvt_pk_bf16_f32 v80, v128, v129
    v_exp_f32 v131, v35
    buffer_load_dword v162, v163, s[52:55], 0 offen
    ds_read_b64_tr_b16 a[230:231], v153 offset:2048
    v_mfma_f32_32x32x16_bf16 v[16:31], a[196:199], a[164:167], v[16:31]
    v_add_f32 v138, v138, v130
    v_exp_f32 v132, v36
    v_add_f32 v138, v138, v131
    ds_read_b64_tr_b16 a[232:233], v154 offset:0
    ds_read_b64_tr_b16 a[234:235], v154 offset:2048
    v_mfma_f32_32x32x16_bf16 v[0:15], a[200:203], a[136:139], v[0:15]
    v_cvt_pk_bf16_f32 v81, v130, v131
    v_exp_f32 v133, v37
    v_add_f32 v138, v138, v132
    ds_read_b64_tr_b16 a[236:237], v155 offset:0
    v_mfma_f32_32x32x16_bf16 v[16:31], a[200:203], a[168:171], v[16:31]
    v_exp_f32 v134, v38
    v_add_f32 v138, v138, v133
    v_cvt_pk_bf16_f32 v82, v132, v133
    ds_read_b64_tr_b16 a[238:239], v155 offset:2048
    v_mfma_f32_32x32x16_bf16 v[0:15], a[204:207], a[140:143], v[0:15]
    v_exp_f32 v135, v39
    buffer_load_dword v162, v164, s[52:55], 0 offen
    ds_read_b64_tr_b16 a[240:241], v152 offset:4096
    ds_read_b64_tr_b16 a[242:243], v152 offset:6144
    v_mfma_f32_32x32x16_bf16 v[16:31], a[204:207], a[172:175], v[16:31]
    v_add_f32 v138, v138, v134
    v_exp_f32 v128, v40
    v_add_f32 v138, v138, v135
    v_cvt_pk_bf16_f32 v83, v134, v135
    ds_read_b64_tr_b16 a[244:245], v153 offset:4096
    v_mfma_f32_32x32x16_bf16 v[0:15], a[208:211], a[144:147], v[0:15]
    v_exp_f32 v129, v41
    v_add_f32 v138, v138, v128
    v_exp_f32 v130, v42
    ds_read_b64_tr_b16 a[246:247], v153 offset:6144
    v_mfma_f32_32x32x16_bf16 v[16:31], a[208:211], a[176:179], v[16:31]
    v_add_f32 v138, v138, v129
    v_cvt_pk_bf16_f32 v84, v128, v129
    v_exp_f32 v131, v43
    ds_read_b64_tr_b16 a[248:249], v154 offset:4096
    ds_read_b64_tr_b16 a[250:251], v154 offset:6144
    v_mfma_f32_32x32x16_bf16 v[0:15], a[212:215], a[148:151], v[0:15]
    v_add_f32 v138, v138, v130
    v_exp_f32 v132, v44
    v_add_f32 v138, v138, v131
    v_cvt_pk_bf16_f32 v85, v130, v131
    ds_read_b64_tr_b16 a[252:253], v155 offset:4096
    v_mfma_f32_32x32x16_bf16 v[16:31], a[212:215], a[180:183], v[16:31]
    v_exp_f32 v133, v45
    v_add_f32 v138, v138, v132
    v_exp_f32 v134, v46
    ds_read_b64_tr_b16 a[254:255], v155 offset:6144
    v_mfma_f32_32x32x16_bf16 v[0:15], a[216:219], a[152:155], v[0:15]
    v_add_f32 v138, v138, v133
    s_add_u32 m0, s41, 8192
    s_nop 0
    buffer_load_dwordx4 v156, s[20:23], s42 offen lds
    v_mfma_f32_32x32x16_bf16 v[16:31], a[216:219], a[184:187], v[16:31]
    v_cvt_pk_bf16_f32 v86, v132, v133
    v_exp_f32 v135, v47
    v_add_f32 v138, v138, v134
    v_exp_f32 v128, v48
    v_mfma_f32_32x32x16_bf16 v[0:15], a[220:223], a[156:159], v[0:15]
    v_add_f32 v138, v138, v135
    v_cvt_pk_bf16_f32 v87, v134, v135
    buffer_load_dwordx4 v157, s[20:23], s42 offen offset:2048 lds
    v_mfma_f32_32x32x16_bf16 v[16:31], a[220:223], a[188:191], v[16:31]
    v_exp_f32 v129, v49
    v_exp_f32 v130, v50
    v_add_f32 v139, v128, v129
    v_cvt_pk_bf16_f32 v88, v128, v129
    s_waitcnt lgkmcnt(0)
    v_mfma_f32_32x32x16_bf16 a[0:15], a[224:227], v[64:67], a[0:15]
    v_exp_f32 v131, v51
    v_add_f32 v139, v139, v130
    v_exp_f32 v132, v52
    v_add_f32 v139, v139, v131
    v_mfma_f32_32x32x16_bf16 a[64:79], a[224:227], v[72:75], a[64:79]
    v_cvt_pk_bf16_f32 v89, v130, v131
    v_exp_f32 v133, v53
    v_add_f32 v139, v139, v132
    ds_read_b128 a[192:195], v144 offset:24576
    v_mfma_f32_32x32x16_bf16 a[16:31], a[228:231], v[64:67], a[16:31]
    v_exp_f32 v134, v54
    v_add_f32 v139, v139, v133
    v_cvt_pk_bf16_f32 v90, v132, v133
    ds_read_b128 a[196:199], v145 offset:24576
    v_mfma_f32_32x32x16_bf16 a[80:95], a[228:231], v[72:75], a[80:95]
    v_exp_f32 v135, v55
    v_add_f32 v139, v139, v134
    v_exp_f32 v128, v56
    ds_read_b128 a[200:203], v146 offset:24576
    v_mfma_f32_32x32x16_bf16 a[32:47], a[232:235], v[64:67], a[32:47]
    v_add_f32 v139, v139, v135
    v_cvt_pk_bf16_f32 v91, v134, v135
    v_exp_f32 v129, v57
    v_add_f32 v139, v139, v128
    ds_read_b128 a[204:207], v147 offset:24576
    v_mfma_f32_32x32x16_bf16 a[96:111], a[232:235], v[72:75], a[96:111]
    v_exp_f32 v130, v58
    v_add_f32 v139, v139, v129
    v_cvt_pk_bf16_f32 v92, v128, v129
    v_exp_f32 v131, v59
    v_mfma_f32_32x32x16_bf16 a[48:63], a[236:239], v[64:67], a[48:63]
    v_add_f32 v139, v139, v130
    v_exp_f32 v132, v60
    v_add_f32 v139, v139, v131
    v_cvt_pk_bf16_f32 v93, v130, v131
    ds_read_b128 a[208:211], v148 offset:24576
    v_mfma_f32_32x32x16_bf16 a[112:127], a[236:239], v[72:75], a[112:127]
    v_exp_f32 v133, v61
    v_add_f32 v139, v139, v132
    v_exp_f32 v134, v62
    ds_read_b128 a[212:215], v149 offset:24576
    v_mfma_f32_32x32x16_bf16 a[0:15], a[240:243], v[68:71], a[0:15]
    v_add_f32 v139, v139, v133
    v_cvt_pk_bf16_f32 v94, v132, v133
    v_exp_f32 v135, v63
    v_add_f32 v139, v139, v134
    ds_read_b128 a[216:219], v150 offset:24576
    v_mfma_f32_32x32x16_bf16 a[64:79], a[240:243], v[76:79], a[64:79]
    v_add_f32 v139, v139, v135
    v_cvt_pk_bf16_f32 v95, v134, v135
    v_max_f32 v140, v138, v139
    v_cmp_nge_f32 vcc, s44, v140
    s_nop 0
    ds_read_b128 a[220:223], v151 offset:24576
    v_mfma_f32_32x32x16_bf16 a[16:31], a[244:247], v[68:71], a[16:31]
    s_add_u32 m0, s41, 49152
    s_nop 0
    buffer_load_dwordx4 v158, s[24:27], s43 offen lds
    v_mfma_f32_32x32x16_bf16 a[80:95], a[244:247], v[76:79], a[80:95]
    v_mfma_f32_32x32x16_bf16 a[32:47], a[248:251], v[68:71], a[32:47]
    buffer_load_dwordx4 v158, s[24:27], s43 offen offset:2048 lds
    v_mfma_f32_32x32x16_bf16 a[96:111], a[248:251], v[76:79], a[96:111]
    s_add_u32 s42, s42, 8192
    s_add_u32 s43, s43, 8192
    v_mfma_f32_32x32x16_bf16 a[48:63], a[252:255], v[68:71], a[48:63]
    v_mfma_f32_32x32x16_bf16 a[112:127], a[252:255], v[76:79], a[112:127]
    s_cbranch_vccnz att_T56_0_slow
att_T56_0_back:
    s_waitcnt vmcnt(6) lgkmcnt(0)
    s_barrier
    v_mfma_f32_32x32x16_bf16 v[32:47], a[192:195], a[128:131], v[96:111]
    v_add_f32 v136, v136, v138
    v_add_f32 v137, v137, v139
    v_exp_f32 v128, v0
    ds_read_b64_tr_b16 a[224:225], v152 offset:8192
    ds_read_b64_tr_b16 a[226:227], v152 offset:10240
    v_mfma_f32_32x32x16_bf16 v[48:63], a[192:195], a[160:163], v[112:127]
    v_exp_f32 v129, v1
    v_exp_f32 v130, v2
    v_add_f32 v138, v128, v129
    ds_read_b64_tr_b16 a[228:229], v153 offset:8192
    v_mfma_f32_32x32x16_bf16 v[32:47], a[196:199], a[132:135], v[32:47]
    v_cvt_pk_bf16_f32 v64, v128, v129
    v_exp_f32 v131, v3
    buffer_load_dword v162, v163, s[56:59], 0 offen
    ds_read_b64_tr_b16 a[230:231], v153 offset:10240
    v_mfma_f32_32x32x16_bf16 v[48:63], a[196:199], a[164:167], v[48:63]
    v_add_f32 v138, v138, v130
    v_exp_f32 v132, v4
    v_add_f32 v138, v138, v131
    ds_read_b64_tr_b16 a[232:233], v154 offset:8192
    ds_read_b64_tr_b16 a[234:235], v154 offset:10240
    v_mfma_f32_32x32x16_bf16 v[32:47], a[200:203], a[136:139], v[32:47]
    v_cvt_pk_bf16_f32 v65, v130, v131
    v_exp_f32 v133, v5
    v_add_f32 v138, v138, v132
    ds_read_b64_tr_b16 a[236:237], v155 offset:8192
    v_mfma_f32_32x32x16_bf16 v[48:63], a[200:203], a[168:171], v[48:63]
    v_exp_f32 v134, v6
    v_add_f32 v138, v138, v133
    v_cvt_pk_bf16_f32 v66, v132, v133
    ds_read_b64_tr_b16 a[238:239], v155 offset:10240
    v_mfma_f32_32x32x16_bf16 v[32:47], a[204:207], a[140:143], v[32:47]
    v_exp_f32 v135, v7
    buffer_load_dword v162, v164, s[56:59], 0 offen
    ds_read_b64_tr_b16 a[240:241], v152 offset:12288
    ds_read_b64_tr_b16 a[242:243], v152 offset:14336
    v_mfma_f32_32x32x16_bf16 v[48:63], a[204:207], a[172:175], v[48:63]
    v_add_f32 v138, v138, v134
    v_exp_f32 v128, v8
    v_add_f32 v138, v138, v135
    v_cvt_pk_bf16_f32 v67, v134, v135
    ds_read_b64_tr_b16 a[244:245], v153 offset:12288
    v_mfma_f32_32x32x16_bf16 v[32:47], a[208:211], a[144:147], v[32:47]
    v_exp_f32 v129, v9
    v_add_f32 v138, v138, v128
    v_exp_f32 v130, v10
    ds_read_b64_tr_b16 a[246:247], v153 offset:14336
    v_mfma_f32_32x32x16_bf16 v[48:63], a[208:211], a[176:179], v[48:63]
    v_add_f32 v138, v138, v129
    v_cvt_pk_bf16_f32 v68, v128, v129
    v_exp_f32 v131, v11
    ds_read_b64_tr_b16 a[248:249], v154 offset:12288
    ds_read_b64_tr_b16 a[250:251], v154 offset:14336
    v_mfma_f32_32x32x16_bf16 v[32:47], a[212:215], a[148:151], v[32:47]
    v_add_f32 v138, v138, v130
    v_exp_f32 v132, v12
    v_add_f32 v138, v138, v131
    v_cvt_pk_bf16_f32 v69, v130, v131
    ds_read_b64_tr_b16 a[252:253], v155 offset:12288
    v_mfma_f32_32x32x16_bf16 v[48:63], a[212:215], a[180:183], v[48:63]
    v_exp_f32 v133, v13
    v_add_f32 v138, v138, v132
    v_exp_f32 v134, v14
    ds_read_b64_tr_b16 a[254:255], v155 offset:14336
    v_mfma_f32_32x32x16_bf16 v[32:47], a[216:219], a[152:155], v[32:47]
    v_add_f32 v138, v138, v133
    s_add_u32 m0, s41, 16384
    s_nop 0
    buffer_load_dwordx4 v156, s[20:23], s42 offen lds
    v_mfma_f32_32x32x16_bf16 v[48:63], a[216:219], a[184:187], v[48:63]
    v_cvt_pk_bf16_f32 v70, v132, v133
    v_exp_f32 v135, v15
    v_add_f32 v138, v138, v134
    v_exp_f32 v128, v16
    v_mfma_f32_32x32x16_bf16 v[32:47], a[220:223], a[156:159], v[32:47]
    v_add_f32 v138, v138, v135
    v_cvt_pk_bf16_f32 v71, v134, v135
    buffer_load_dwordx4 v157, s[20:23], s42 offen offset:2048 lds
    v_mfma_f32_32x32x16_bf16 v[48:63], a[220:223], a[188:191], v[48:63]
    v_exp_f32 v129, v17
    v_exp_f32 v130, v18
    v_add_f32 v139, v128, v129
    v_cvt_pk_bf16_f32 v72, v128, v129
    s_waitcnt lgkmcnt(0)
    v_mfma_f32_32x32x16_bf16 a[0:15], a[224:227], v[80:83], a[0:15]
    v_exp_f32 v131, v19
    v_add_f32 v139, v139, v130
    v_exp_f32 v132, v20
    v_add_f32 v139, v139, v131
    v_mfma_f32_32x32x16_bf16 a[64:79], a[224:227], v[88:91], a[64:79]
    v_cvt_pk_bf16_f32 v73, v130, v131
    v_exp_f32 v133, v21
    v_add_f32 v139, v139, v132
    ds_read_b128 a[192:195], v144 offset:0
    v_mfma_f32_32x32x16_bf16 a[16:31], a[228:231], v[80:83], a[16:31]
    v_exp_f32 v134, v22
    v_add_f32 v139, v139, v133
    v_cvt_pk_bf16_f32 v74, v132, v133
    ds_read_b128 a[196:199], v145 offset:0
    v_mfma_f32_32x32x16_bf16 a[80:95], a[228:231], v[88:91], a[80:95]
    v_exp_f32 v135, v23
    v_add_f32 v139, v139, v134
    v_exp_f32 v128, v24
    ds_read_b128 a[200:203], v146 offset:0
    v_mfma_f32_32x32x16_bf16 a[32:47], a[232:235], v[80:83], a[32:47]
    v_add_f32 v139, v139, v135
    v_cvt_pk_bf16_f32 v75, v134, v135
    v_exp_f32 v129, v25
    v_add_f32 v139, v139, v128
    ds_read_b128 a[204:207], v147 offset:0
    v_mfma_f32_32x32x16_bf16 a[96:111], a[232:235], v[88:91], a[96:111]
    v_exp_f32 v130, v26
    v_add_f32 v139, v139, v129
    v_cvt_pk_bf16_f32 v76, v128, v129
    v_exp_f32 v131, v27
    v_mfma_f32_32x32x16_bf16 a[48:63], a[236:239], v[80:83], a[48:63]
    v_add_f32 v139, v139, v130
    v_exp_f32 v132, v28
    v_add_f32 v139, v139, v131
    v_cvt_pk_bf16_f32 v77, v130, v131
    ds_read_b128 a[208:211], v148 offset:0
    v_mfma_f32_32x32x16_bf16 a[112:127], a[236:239], v[88:91], a[112:127]
    v_exp_f32 v133, v29
    v_add_f32 v139, v139, v132
    v_exp_f32 v134, v30
    ds_read_b128 a[212:215], v149 offset:0
    v_mfma_f32_32x32x16_bf16 a[0:15], a[240:243], v[84:87], a[0:15]
    v_add_f32 v139, v139, v133
    v_cvt_pk_bf16_f32 v78, v132, v133
    v_exp_f32 v135, v31
    v_add_f32 v139, v139, v134
    ds_read_b128 a[216:219], v150 offset:0
    v_mfma_f32_32x32x16_bf16 a[64:79], a[240:243], v[92:95], a[64:79]
    v_add_f32 v139, v139, v135
    v_cvt_pk_bf16_f32 v79, v134, v135
    v_max_f32 v140, v138, v139
    v_cmp_nge_f32 vcc, s44, v140
    s_nop 0
    ds_read_b128 a[220:223], v151 offset:0
    v_mfma_f32_32x32x16_bf16 a[16:31], a[244:247], v[84:87], a[16:31]
    s_add_u32 m0, s41, 57344
    s_nop 0
    buffer_load_dwordx4 v158, s[24:27], s43 offen lds
    v_mfma_f32_32x32x16_bf16 a[80:95], a[244:247], v[92:95], a[80:95]
    v_mfma_f32_32x32x16_bf16 a[32:47], a[248:251], v[84:87], a[32:47]
    buffer_load_dwordx4 v158, s[24:27], s43 offen offset:2048 lds
    v_mfma_f32_32x32x16_bf16 a[96:111], a[248:251], v[92:95], a[96:111]
    s_add_u32 s42, s42, 8192
    s_add_u32 s43, s43, 8192
    v_mfma_f32_32x32x16_bf16 a[48:63], a[252:255], v[84:87], a[48:63]
    v_mfma_f32_32x32x16_bf16 a[112:127], a[252:255], v[92:95], a[112:127]
    s_cbranch_vccnz att_T57_1_slow
att_T57_1_back:
    s_waitcnt vmcnt(6) lgkmcnt(0)
    s_barrier
    v_mfma_f32_32x32x16_bf16 v[0:15], a[192:195], a[128:131], v[96:111]
    v_add_f32 v136, v136, v138
    v_add_f32 v137, v137, v139
    v_exp_f32 v128, v32
    ds_read_b64_tr_b16 a[224:225], v152 offset:16384
    ds_read_b64_tr_b16 a[226:227], v152 offset:18432
    v_mfma_f32_32x32x16_bf16 v[16:31], a[192:195], a[160:163], v[112:127]
    v_exp_f32 v129, v33
    v_exp_f32 v130, v34
    v_add_f32 v138, v128, v129
    ds_read_b64_tr_b16 a[228:229], v153 offset:16384
    v_mfma_f32_32x32x16_bf16 v[0:15], a[196:199], a[132:135], v[0:15]
    v_cvt_pk_bf16_f32 v80, v128, v129
    v_exp_f32 v131, v35
    buffer_load_dword v162, v163, s[72:75], 0 offen
    ds_read_b64_tr_b16 a[230:231], v153 offset:18432
    v_mfma_f32_32x32x16_bf16 v[16:31], a[196:199], a[164:167], v[16:31]
    v_add_f32 v138, v138, v130
    v_exp_f32 v132, v36
    v_add_f32 v138, v138, v131
    ds_read_b64_tr_b16 a[232:233], v154 offset:16384
    ds_read_b64_tr_b16 a[234:235], v154 offset:18432
    v_mfma_f32_32x32x16_bf16 v[0:15], a[200:203], a[136:139], v[0:15]
    v_cvt_pk_bf16_f32 v81, v130, v131
    v_exp_f32 v133, v37
    v_add_f32 v138, v138, v132
    ds_read_b64_tr_b16 a[236:237], v155 offset:16384
    v_mfma_f32_32x32x16_bf16 v[16:31], a[200:203], a[168:171], v[16:31]
    v_exp_f32 v134, v38
    v_add_f32 v138, v138, v133
    v_cvt_pk_bf16_f32 v82, v132, v133
    ds_read_b64_tr_b16 a[238:239], v155 offset:18432
    v_mfma_f32_32x32x16_bf16 v[0:15], a[204:207], a[140:143], v[0:15]
    v_exp_f32 v135, v39
    buffer_load_dword v162, v164, s[72:75], 0 offen
    ds_read_b64_tr_b16 a[240:241], v152 offset:20480
    ds_read_b64_tr_b16 a[242:243], v152 offset:22528
    v_mfma_f32_32x32x16_bf16 v[16:31], a[204:207], a[172:175], v[16:31]
    v_add_f32 v138, v138, v134
    v_exp_f32 v128, v40
    v_add_f32 v138, v138, v135
    v_cvt_pk_bf16_f32 v83, v134, v135
    ds_read_b64_tr_b16 a[244:245], v153 offset:20480
    v_mfma_f32_32x32x16_bf16 v[0:15], a[208:211], a[144:147], v[0:15]
    v_exp_f32 v129, v41
    v_add_f32 v138, v138, v128
    v_exp_f32 v130, v42
    ds_read_b64_tr_b16 a[246:247], v153 offset:22528
    v_mfma_f32_32x32x16_bf16 v[16:31], a[208:211], a[176:179], v[16:31]
    v_add_f32 v138, v138, v129
    v_cvt_pk_bf16_f32 v84, v128, v129
    v_exp_f32 v131, v43
    ds_read_b64_tr_b16 a[248:249], v154 offset:20480
    ds_read_b64_tr_b16 a[250:251], v154 offset:22528
    v_mfma_f32_32x32x16_bf16 v[0:15], a[212:215], a[148:151], v[0:15]
    v_add_f32 v138, v138, v130
    v_exp_f32 v132, v44
    v_add_f32 v138, v138, v131
    v_cvt_pk_bf16_f32 v85, v130, v131
    ds_read_b64_tr_b16 a[252:253], v155 offset:20480
    v_mfma_f32_32x32x16_bf16 v[16:31], a[212:215], a[180:183], v[16:31]
    v_exp_f32 v133, v45
    v_add_f32 v138, v138, v132
    v_exp_f32 v134, v46
    ds_read_b64_tr_b16 a[254:255], v155 offset:22528
    v_mfma_f32_32x32x16_bf16 v[0:15], a[216:219], a[152:155], v[0:15]
    v_add_f32 v138, v138, v133
    s_add_u32 m0, s41, 24576
    s_nop 0
    buffer_load_dwordx4 v156, s[20:23], s42 offen lds
    v_mfma_f32_32x32x16_bf16 v[16:31], a[216:219], a[184:187], v[16:31]
    v_cvt_pk_bf16_f32 v86, v132, v133
    v_exp_f32 v135, v47
    v_add_f32 v138, v138, v134
    v_exp_f32 v128, v48
    v_mfma_f32_32x32x16_bf16 v[0:15], a[220:223], a[156:159], v[0:15]
    v_add_f32 v138, v138, v135
    v_cvt_pk_bf16_f32 v87, v134, v135
    buffer_load_dwordx4 v157, s[20:23], s42 offen offset:2048 lds
    v_mfma_f32_32x32x16_bf16 v[16:31], a[220:223], a[188:191], v[16:31]
    v_exp_f32 v129, v49
    v_exp_f32 v130, v50
    v_add_f32 v139, v128, v129
    v_cvt_pk_bf16_f32 v88, v128, v129
    s_waitcnt lgkmcnt(0)
    v_mfma_f32_32x32x16_bf16 a[0:15], a[224:227], v[64:67], a[0:15]
    v_exp_f32 v131, v51
    v_add_f32 v139, v139, v130
    v_exp_f32 v132, v52
    v_add_f32 v139, v139, v131
    v_mfma_f32_32x32x16_bf16 a[64:79], a[224:227], v[72:75], a[64:79]
    v_cvt_pk_bf16_f32 v89, v130, v131
    v_exp_f32 v133, v53
    v_add_f32 v139, v139, v132
    ds_read_b128 a[192:195], v144 offset:8192
    v_mfma_f32_32x32x16_bf16 a[16:31], a[228:231], v[64:67], a[16:31]
    v_exp_f32 v134, v54
    v_add_f32 v139, v139, v133
    v_cvt_pk_bf16_f32 v90, v132, v133
    ds_read_b128 a[196:199], v145 offset:8192
    v_mfma_f32_32x32x16_bf16 a[80:95], a[228:231], v[72:75], a[80:95]
    v_exp_f32 v135, v55
    v_add_f32 v139, v139, v134
    v_exp_f32 v128, v56
    ds_read_b128 a[200:203], v146 offset:8192
    v_mfma_f32_32x32x16_bf16 a[32:47], a[232:235], v[64:67], a[32:47]
    v_add_f32 v139, v139, v135
    v_cvt_pk_bf16_f32 v91, v134, v135
    v_exp_f32 v129, v57
    v_add_f32 v139, v139, v128
    ds_read_b128 a[204:207], v147 offset:8192
    v_mfma_f32_32x32x16_bf16 a[96:111], a[232:235], v[72:75], a[96:111]
    v_exp_f32 v130, v58
    v_add_f32 v139, v139, v129
    v_cvt_pk_bf16_f32 v92, v128, v129
    v_exp_f32 v131, v59
    v_mfma_f32_32x32x16_bf16 a[48:63], a[236:239], v[64:67], a[48:63]
    v_add_f32 v139, v139, v130
    v_exp_f32 v132, v60
    v_add_f32 v139, v139, v131
    v_cvt_pk_bf16_f32 v93, v130, v131
    ds_read_b128 a[208:211], v148 offset:8192
    v_mfma_f32_32x32x16_bf16 a[112:127], a[236:239], v[72:75], a[112:127]
    v_exp_f32 v133, v61
    v_add_f32 v139, v139, v132
    v_exp_f32 v134, v62
    ds_read_b128 a[212:215], v149 offset:8192
    v_mfma_f32_32x32x16_bf16 a[0:15], a[240:243], v[68:71], a[0:15]
    v_add_f32 v139, v139, v133
    v_cvt_pk_bf16_f32 v94, v132, v133
    v_exp_f32 v135, v63
    v_add_f32 v139, v139, v134
    ds_read_b128 a[216:219], v150 offset:8192
    v_mfma_f32_32x32x16_bf16 a[64:79], a[240:243], v[76:79], a[64:79]
    v_add_f32 v139, v139, v135
    v_cvt_pk_bf16_f32 v95, v134, v135
    v_max_f32 v140, v138, v139
    v_cmp_nge_f32 vcc, s44, v140
    s_nop 0
    ds_read_b128 a[220:223], v151 offset:8192
    v_mfma_f32_32x32x16_bf16 a[16:31], a[244:247], v[68:71], a[16:31]
    s_add_u32 m0, s41, 32768
    s_nop 0
    buffer_load_dwordx4 v158, s[24:27], s43 offen lds
    v_mfma_f32_32x32x16_bf16 a[80:95], a[244:247], v[76:79], a[80:95]
    v_mfma_f32_32x32x16_bf16 a[32:47], a[248:251], v[68:71], a[32:47]
    buffer_load_dwordx4 v158, s[24:27], s43 offen offset:2048 lds
    v_mfma_f32_32x32x16_bf16 a[96:111], a[248:251], v[76:79], a[96:111]
    s_add_u32 s42, s42, 8192
    s_add_u32 s43, s43, 8192
    v_mfma_f32_32x32x16_bf16 a[48:63], a[252:255], v[68:71], a[48:63]
    v_mfma_f32_32x32x16_bf16 a[112:127], a[252:255], v[76:79], a[112:127]
    s_cbranch_vccnz att_T58_2_slow
att_T58_2_back:
    s_waitcnt vmcnt(6) lgkmcnt(0)
    s_barrier
    v_mfma_f32_32x32x16_bf16 v[32:47], a[192:195], a[128:131], v[96:111]
    v_add_f32 v136, v136, v138
    v_add_f32 v137, v137, v139
    v_exp_f32 v128, v0
    ds_read_b64_tr_b16 a[224:225], v152 offset:24576
    ds_read_b64_tr_b16 a[226:227], v152 offset:26624
    v_mfma_f32_32x32x16_bf16 v[48:63], a[192:195], a[160:163], v[112:127]
    v_exp_f32 v129, v1
    v_exp_f32 v130, v2
    v_add_f32 v138, v128, v129
    ds_read_b64_tr_b16 a[228:229], v153 offset:24576
    v_mfma_f32_32x32x16_bf16 v[32:47], a[196:199], a[132:135], v[32:47]
    v_cvt_pk_bf16_f32 v64, v128, v129
    v_exp_f32 v131, v3
    buffer_load_dword v162, v163, s[76:79], 0 offen
    ds_read_b64_tr_b16 a[230:231], v153 offset:26624
    v_mfma_f32_32x32x16_bf16 v[48:63], a[196:199], a[164:167], v[48:63]
    v_add_f32 v138, v138, v130
    v_exp_f32 v132, v4
    v_add_f32 v138, v138, v131
    ds_read_b64_tr_b16 a[232:233], v154 offset:24576
    ds_read_b64_tr_b16 a[234:235], v154 offset:26624
    v_mfma_f32_32x32x16_bf16 v[32:47], a[200:203], a[136:139], v[32:47]
    v_cvt_pk_bf16_f32 v65, v130, v131
    v_exp_f32 v133, v5
    v_add_f32 v138, v138, v132
    ds_read_b64_tr_b16 a[236:237], v155 offset:24576
    v_mfma_f32_32x32x16_bf16 v[48:63], a[200:203], a[168:171], v[48:63]
    v_exp_f32 v134, v6
    v_add_f32 v138, v138, v133
    v_cvt_pk_bf16_f32 v66, v132, v133
    ds_read_b64_tr_b16 a[238:239], v155 offset:26624
    v_mfma_f32_32x32x16_bf16 v[32:47], a[204:207], a[140:143], v[32:47]
    v_exp_f32 v135, v7
    buffer_load_dword v162, v164, s[76:79], 0 offen
    ds_read_b64_tr_b16 a[240:241], v152 offset:28672
    ds_read_b64_tr_b16 a[242:243], v152 offset:30720
    v_mfma_f32_32x32x16_bf16 v[48:63], a[204:207], a[172:175], v[48:63]
    v_add_f32 v138, v138, v134
    v_exp_f32 v128, v8
    v_add_f32 v138, v138, v135
    v_cvt_pk_bf16_f32 v67, v134, v135
    ds_read_b64_tr_b16 a[244:245], v153 offset:28672
    v_mfma_f32_32x32x16_bf16 v[32:47], a[208:211], a[144:147], v[32:47]
    v_exp_f32 v129, v9
    v_add_f32 v138, v138, v128
    v_exp_f32 v130, v10
    ds_read_b64_tr_b16 a[246:247], v153 offset:30720
    v_mfma_f32_32x32x16_bf16 v[48:63], a[208:211], a[176:179], v[48:63]
    v_add_f32 v138, v138, v129
    v_cvt_pk_bf16_f32 v68, v128, v129
    v_exp_f32 v131, v11
    ds_read_b64_tr_b16 a[248:249], v154 offset:28672
    ds_read_b64_tr_b16 a[250:251], v154 offset:30720
    v_mfma_f32_32x32x16_bf16 v[32:47], a[212:215], a[148:151], v[32:47]
    v_add_f32 v138, v138, v130
    v_exp_f32 v132, v12
    v_add_f32 v138, v138, v131
    v_cvt_pk_bf16_f32 v69, v130, v131
    ds_read_b64_tr_b16 a[252:253], v155 offset:28672
    v_mfma_f32_32x32x16_bf16 v[48:63], a[212:215], a[180:183], v[48:63]
    v_exp_f32 v133, v13
    v_add_f32 v138, v138, v132
    v_exp_f32 v134, v14
    ds_read_b64_tr_b16 a[254:255], v155 offset:30720
    v_mfma_f32_32x32x16_bf16 v[32:47], a[216:219], a[152:155], v[32:47]
    v_add_f32 v138, v138, v133
    s_add_u32 m0, s41, 40960
    s_nop 0
    buffer_load_dwordx4 v158, s[24:27], s43 offen lds
    v_mfma_f32_32x32x16_bf16 v[48:63], a[216:219], a[184:187], v[48:63]
    v_cvt_pk_bf16_f32 v70, v132, v133
    v_exp_f32 v135, v15
    v_add_f32 v138, v138, v134
    v_exp_f32 v128, v16
    v_mfma_f32_32x32x16_bf16 v[32:47], a[220:223], a[156:159], v[32:47]
    v_add_f32 v138, v138, v135
    v_cvt_pk_bf16_f32 v71, v134, v135
    buffer_load_dwordx4 v158, s[24:27], s43 offen offset:2048 lds
    v_mfma_f32_32x32x16_bf16 v[48:63], a[220:223], a[188:191], v[48:63]
    v_exp_f32 v129, v17
    v_exp_f32 v130, v18
    v_add_f32 v139, v128, v129
    s_add_u32 s42, s42, 8192
    s_add_u32 s43, s43, 8192
    s_waitcnt lgkmcnt(0)
    v_mfma_f32_32x32x16_bf16 a[0:15], a[224:227], v[80:83], a[0:15]
    v_cvt_pk_bf16_f32 v72, v128, v129
    v_exp_f32 v131, v19
    v_add_f32 v139, v139, v130
    v_exp_f32 v132, v20
    v_mfma_f32_32x32x16_bf16 a[64:79], a[224:227], v[88:91], a[64:79]
    v_add_f32 v139, v139, v131
    v_cvt_pk_bf16_f32 v73, v130, v131
    v_exp_f32 v133, v21
    v_add_f32 v139, v139, v132
    ds_read_b128 a[192:195], v144 offset:16384
    v_mfma_f32_32x32x16_bf16 a[16:31], a[228:231], v[80:83], a[16:31]
    v_exp_f32 v134, v22
    v_add_f32 v139, v139, v133
    v_cvt_pk_bf16_f32 v74, v132, v133
    ds_read_b128 a[196:199], v145 offset:16384
    v_mfma_f32_32x32x16_bf16 a[80:95], a[228:231], v[88:91], a[80:95]
    v_exp_f32 v135, v23
    v_add_f32 v139, v139, v134
    v_exp_f32 v128, v24
    ds_read_b128 a[200:203], v146 offset:16384
    v_mfma_f32_32x32x16_bf16 a[32:47], a[232:235], v[80:83], a[32:47]
    v_add_f32 v139, v139, v135
    v_cvt_pk_bf16_f32 v75, v134, v135
    v_exp_f32 v129, v25
    v_add_f32 v139, v139, v128
    ds_read_b128 a[204:207], v147 offset:16384
    v_mfma_f32_32x32x16_bf16 a[96:111], a[232:235], v[88:91], a[96:111]
    v_exp_f32 v130, v26
    v_add_f32 v139, v139, v129
    v_cvt_pk_bf16_f32 v76, v128, v129
    v_exp_f32 v131, v27
    v_mfma_f32_32x32x16_bf16 a[48:63], a[236:239], v[80:83], a[48:63]
    v_add_f32 v139, v139, v130
    v_exp_f32 v132, v28
    v_add_f32 v139, v139, v131
    v_cvt_pk_bf16_f32 v77, v130, v131
    ds_read_b128 a[208:211], v148 offset:16384
    v_mfma_f32_32x32x16_bf16 a[112:127], a[236:239], v[88:91], a[112:127]
    v_exp_f32 v133, v29
    v_add_f32 v139, v139, v132
    v_exp_f32 v134, v30
    ds_read_b128 a[212:215], v149 offset:16384
    v_mfma_f32_32x32x16_bf16 a[0:15], a[240:243], v[84:87], a[0:15]
    v_add_f32 v139, v139, v133
    v_cvt_pk_bf16_f32 v78, v132, v133
    v_exp_f32 v135, v31
    v_add_f32 v139, v139, v134
    ds_read_b128 a[216:219], v150 offset:16384
    v_mfma_f32_32x32x16_bf16 a[64:79], a[240:243], v[92:95], a[64:79]
    v_add_f32 v139, v139, v135
    v_cvt_pk_bf16_f32 v79, v134, v135
    v_max_f32 v140, v138, v139
    v_cmp_nge_f32 vcc, s44, v140
    s_nop 0
    ds_read_b128 a[220:223], v151 offset:16384
    v_mfma_f32_32x32x16_bf16 a[16:31], a[244:247], v[84:87], a[16:31]
    v_mfma_f32_32x32x16_bf16 a[80:95], a[244:247], v[92:95], a[80:95]
    v_mfma_f32_32x32x16_bf16 a[32:47], a[248:251], v[84:87], a[32:47]
    v_mfma_f32_32x32x16_bf16 a[96:111], a[248:251], v[92:95], a[96:111]
    v_mfma_f32_32x32x16_bf16 a[48:63], a[252:255], v[84:87], a[48:63]
    v_mfma_f32_32x32x16_bf16 a[112:127], a[252:255], v[92:95], a[112:127]
    s_cbranch_vccnz att_T59_3_slow
att_T59_3_back:
    s_waitcnt vmcnt(4) lgkmcnt(0)
    s_barrier
    v_mfma_f32_32x32x16_bf16 v[0:15], a[192:195], a[128:131], v[96:111]
    v_add_f32 v136, v136, v138
    v_add_f32 v137, v137, v139
    v_exp_f32 v128, v32
    ds_read_b64_tr_b16 a[224:225], v152 offset:0
    ds_read_b64_tr_b16 a[226:227], v152 offset:2048
    v_mfma_f32_32x32x16_bf16 v[16:31], a[192:195], a[160:163], v[112:127]
    v_exp_f32 v129, v33
    v_exp_f32 v130, v34
    v_add_f32 v138, v128, v129
    ds_read_b64_tr_b16 a[228:229], v153 offset:0
    v_mfma_f32_32x32x16_bf16 v[0:15], a[196:199], a[132:135], v[0:15]
    v_cvt_pk_bf16_f32 v80, v128, v129
    v_exp_f32 v131, v35
    v_add_f32 v138, v138, v130
    ds_read_b64_tr_b16 a[230:231], v153 offset:2048
    v_mfma_f32_32x32x16_bf16 v[16:31], a[196:199], a[164:167], v[16:31]
    v_exp_f32 v132, v36
    v_add_f32 v138, v138, v131
    v_cvt_pk_bf16_f32 v81, v130, v131
    ds_read_b64_tr_b16 a[232:233], v154 offset:0
    ds_read_b64_tr_b16 a[234:235], v154 offset:2048
    v_mfma_f32_32x32x16_bf16 v[0:15], a[200:203], a[136:139], v[0:15]
    v_exp_f32 v133, v37
    v_add_f32 v138, v138, v132
    v_exp_f32 v134, v38
    ds_read_b64_tr_b16 a[236:237], v155 offset:0
    v_mfma_f32_32x32x16_bf16 v[16:31], a[200:203], a[168:171], v[16:31]
    v_add_f32 v138, v138, v133
    v_cvt_pk_bf16_f32 v82, v132, v133
    v_exp_f32 v135, v39
    v_add_f32 v138, v138, v134
    ds_read_b64_tr_b16 a[238:239], v155 offset:2048
    v_mfma_f32_32x32x16_bf16 v[0:15], a[204:207], a[140:143], v[0:15]
    v_exp_f32 v128, v40
    v_add_f32 v138, v138, v135
    v_cvt_pk_bf16_f32 v83, v134, v135
    ds_read_b64_tr_b16 a[240:241], v152 offset:4096
    ds_read_b64_tr_b16 a[242:243], v152 offset:6144
    v_mfma_f32_32x32x16_bf16 v[16:31], a[204:207], a[172:175], v[16:31]
    v_exp_f32 v129, v41
    v_add_f32 v138, v138, v128
    v_exp_f32 v130, v42
    ds_read_b64_tr_b16 a[244:245], v153 offset:4096
    v_mfma_f32_32x32x16_bf16 v[0:15], a[208:211], a[144:147], v[0:15]
    v_add_f32 v138, v138, v129
    v_cvt_pk_bf16_f32 v84, v128, v129
    v_exp_f32 v131, v43
    v_add_f32 v138, v138, v130
    ds_read_b64_tr_b16 a[246:247], v153 offset:6144
    v_mfma_f32_32x32x16_bf16 v[16:31], a[208:211], a[176:179], v[16:31]
    v_exp_f32 v132, v44
    v_add_f32 v138, v138, v131
    v_cvt_pk_bf16_f32 v85, v130, v131
    ds_read_b64_tr_b16 a[248:249], v154 offset:4096
    ds_read_b64_tr_b16 a[250:251], v154 offset:6144
    v_mfma_f32_32x32x16_bf16 v[0:15], a[212:215], a[148:151], v[0:15]
    v_exp_f32 v133, v45
    v_add_f32 v138, v138, v132
    v_exp_f32 v134, v46
    ds_read_b64_tr_b16 a[252:253], v155 offset:4096
    v_mfma_f32_32x32x16_bf16 v[16:31], a[212:215], a[180:183], v[16:31]
    v_add_f32 v138, v138, v133
    v_cvt_pk_bf16_f32 v86, v132, v133
    v_exp_f32 v135, v47
    v_add_f32 v138, v138, v134
    ds_read_b64_tr_b16 a[254:255], v155 offset:6144
    v_mfma_f32_32x32x16_bf16 v[0:15], a[216:219], a[152:155], v[0:15]
    s_add_u32 m0, s41, 49152
    s_nop 0
    buffer_load_dwordx4 v158, s[24:27], s43 offen lds
    v_mfma_f32_32x32x16_bf16 v[16:31], a[216:219], a[184:187], v[16:31]
    v_exp_f32 v128, v48
    v_add_f32 v138, v138, v135
    v_cvt_pk_bf16_f32 v87, v134, v135
    v_exp_f32 v129, v49
    v_mfma_f32_32x32x16_bf16 v[0:15], a[220:223], a[156:159], v[0:15]
    v_exp_f32 v130, v50
    buffer_load_dwordx4 v158, s[24:27], s43 offen offset:2048 lds
    v_mfma_f32_32x32x16_bf16 v[16:31], a[220:223], a[188:191], v[16:31]
    v_add_f32 v139, v128, v129
    v_cvt_pk_bf16_f32 v88, v128, v129
    v_exp_f32 v131, v51
    v_add_f32 v139, v139, v130
    s_add_u32 s42, s42, 8192
    s_add_u32 s43, s43, 8192
    s_waitcnt lgkmcnt(0)
    v_mfma_f32_32x32x16_bf16 a[0:15], a[224:227], v[64:67], a[0:15]
    v_exp_f32 v132, v52
    v_add_f32 v139, v139, v131
    v_cvt_pk_bf16_f32 v89, v130, v131
    v_exp_f32 v133, v53
    v_mfma_f32_32x32x16_bf16 a[64:79], a[224:227], v[72:75], a[64:79]
    v_add_f32 v139, v139, v132
    v_exp_f32 v134, v54
    v_add_f32 v139, v139, v133
    v_cvt_pk_bf16_f32 v90, v132, v133
    ds_read_b128 a[192:195], v144 offset:24576
    v_mfma_f32_32x32x16_bf16 a[16:31], a[228:231], v[64:67], a[16:31]
    v_exp_f32 v135, v55
    v_add_f32 v139, v139, v134
    v_exp_f32 v128, v56
    ds_read_b128 a[196:199], v145 offset:24576
    v_mfma_f32_32x32x16_bf16 a[80:95], a[228:231], v[72:75], a[80:95]
    v_add_f32 v139, v139, v135
    v_cvt_pk_bf16_f32 v91, v134, v135
    v_exp_f32 v129, v57
    v_add_f32 v139, v139, v128
    ds_read_b128 a[200:203], v146 offset:24576
    v_mfma_f32_32x32x16_bf16 a[32:47], a[232:235], v[64:67], a[32:47]
    v_exp_f32 v130, v58
    v_add_f32 v139, v139, v129
    v_cvt_pk_bf16_f32 v92, v128, v129
    ds_read_b128 a[204:207], v147 offset:24576
    v_mfma_f32_32x32x16_bf16 a[96:111], a[232:235], v[72:75], a[96:111]
    v_exp_f32 v131, v59
    v_add_f32 v139, v139, v130
    v_exp_f32 v132, v60
    v_add_f32 v139, v139, v131
    v_mfma_f32_32x32x16_bf16 a[48:63], a[236:239], v[64:67], a[48:63]
    v_cvt_pk_bf16_f32 v93, v130, v131
    v_exp_f32 v133, v61
    v_add_f32 v139, v139, v132
    ds_read_b128 a[208:211], v148 offset:24576
    v_mfma_f32_32x32x16_bf16 a[112:127], a[236:239], v[72:75], a[112:127]
    v_exp_f32 v134, v62
    v_add_f32 v139, v139, v133
    v_cvt_pk_bf16_f32 v94, v132, v133
    ds_read_b128 a[212:215], v149 offset:24576
    v_mfma_f32_32x32x16_bf16 a[0:15], a[240:243], v[68:71], a[0:15]
    v_exp_f32 v135, v63
    v_add_f32 v139, v139, v134
    v_add_f32 v139, v139, v135
    s_nop 0
    ds_read_b128 a[216:219], v150 offset:24576
    v_mfma_f32_32x32x16_bf16 a[64:79], a[240:243], v[76:79], a[64:79]
    v_cvt_pk_bf16_f32 v95, v134, v135
    v_max_f32 v140, v138, v139
    v_cmp_nge_f32 vcc, s44, v140
    ds_read_b128 a[220:223], v151 offset:24576
    v_mfma_f32_32x32x16_bf16 a[16:31], a[244:247], v[68:71], a[16:31]
    v_mfma_f32_32x32x16_bf16 a[80:95], a[244:247], v[76:79], a[80:95]
    v_mfma_f32_32x32x16_bf16 a[32:47], a[248:251], v[68:71], a[32:47]
    v_mfma_f32_32x32x16_bf16 a[96:111], a[248:251], v[76:79], a[96:111]
    v_mfma_f32_32x32x16_bf16 a[48:63], a[252:255], v[68:71], a[48:63]
    v_mfma_f32_32x32x16_bf16 a[112:127], a[252:255], v[76:79], a[112:127]
    s_cbranch_vccnz att_T60_0_slow
att_T60_0_back:
    s_waitcnt vmcnt(2) lgkmcnt(0)
    s_barrier
    v_mfma_f32_32x32x16_bf16 v[32:47], a[192:195], a[128:131], v[96:111]
    v_add_f32 v136, v136, v138
    v_add_f32 v137, v137, v139
    v_exp_f32 v128, v0
    ds_read_b64_tr_b16 a[224:225], v152 offset:8192
    ds_read_b64_tr_b16 a[226:227], v152 offset:10240
    v_mfma_f32_32x32x16_bf16 v[48:63], a[192:195], a[160:163], v[112:127]
    v_exp_f32 v129, v1
    v_exp_f32 v130, v2
    v_add_f32 v138, v128, v129
    ds_read_b64_tr_b16 a[228:229], v153 offset:8192
    v_mfma_f32_32x32x16_bf16 v[32:47], a[196:199], a[132:135], v[32:47]
    v_cvt_pk_bf16_f32 v64, v128, v129
    v_exp_f32 v131, v3
    v_add_f32 v138, v138, v130
    ds_read_b64_tr_b16 a[230:231], v153 offset:10240
    v_mfma_f32_32x32x16_bf16 v[48:63], a[196:199], a[164:167], v[48:63]
    v_exp_f32 v132, v4
    v_add_f32 v138, v138, v131
    v_cvt_pk_bf16_f32 v65, v130, v131
    ds_read_b64_tr_b16 a[232:233], v154 offset:8192
    ds_read_b64_tr_b16 a[234:235], v154 offset:10240
    v_mfma_f32_32x32x16_bf16 v[32:47], a[200:203], a[136:139], v[32:47]
    v_exp_f32 v133, v5
    v_add_f32 v138, v138, v132
    v_exp_f32 v134, v6
    ds_read_b64_tr_b16 a[236:237], v155 offset:8192
    v_mfma_f32_32x32x16_bf16 v[48:63], a[200:203], a[168:171], v[48:63]
    v_add_f32 v138, v138, v133
    v_cvt_pk_bf16_f32 v66, v132, v133
    v_exp_f32 v135, v7
    v_add_f32 v138, v138, v134
    ds_read_b64_tr_b16 a[238:239], v155 offset:10240
    v_mfma_f32_32x32x16_bf16 v[32:47], a[204:207], a[140:143], v[32:47]
    v_exp_f32 v128, v8
    v_add_f32 v138, v138, v135
    v_cvt_pk_bf16_f32 v67, v134, v135
    ds_read_b64_tr_b16 a[240:241], v152 offset:12288
    ds_read_b64_tr_b16 a[242:243], v152 offset:14336
    v_mfma_f32_32x32x16_bf16 v[48:63], a[204:207], a[172:175], v[48:63]
    v_exp_f32 v129, v9
    v_add_f32 v138, v138, v128
    v_exp_f32 v130, v10
    ds_read_b64_tr_b16 a[244:245], v153 offset:12288
    v_mfma_f32_32x32x16_bf16 v[32:47], a[208:211], a[144:147], v[32:47]
    v_add_f32 v138, v138, v129
    v_cvt_pk_bf16_f32 v68, v128, v129
    v_exp_f32 v131, v11
    v_add_f32 v138, v138, v130
    ds_read_b64_tr_b16 a[246:247], v153 offset:14336
    v_mfma_f32_32x32x16_bf16 v[48:63], a[208:211], a[176:179], v[48:63]
    v_exp_f32 v132, v12
    v_add_f32 v138, v138, v131
    v_cvt_pk_bf16_f32 v69, v130, v131
    ds_read_b64_tr_b16 a[248:249], v154 offset:12288
    ds_read_b64_tr_b16 a[250:251], v154 offset:14336
    v_mfma_f32_32x32x16_bf16 v[32:47], a[212:215], a[148:151], v[32:47]
    v_exp_f32 v133, v13
    v_add_f32 v138, v138, v132
    v_exp_f32 v134, v14
    ds_read_b64_tr_b16 a[252:253], v155 offset:12288
    v_mfma_f32_32x32x16_bf16 v[48:63], a[212:215], a[180:183], v[48:63]
    v_add_f32 v138, v138, v133
    v_cvt_pk_bf16_f32 v70, v132, v133
    v_exp_f32 v135, v15
    v_add_f32 v138, v138, v134
    ds_read_b64_tr_b16 a[254:255], v155 offset:14336
    v_mfma_f32_32x32x16_bf16 v[32:47], a[216:219], a[152:155], v[32:47]
    s_add_u32 m0, s41, 57344
    s_nop 0
    buffer_load_dwordx4 v158, s[24:27], s43 offen lds
    v_mfma_f32_32x32x16_bf16 v[48:63], a[216:219], a[184:187], v[48:63]
    v_exp_f32 v128, v16
    v_add_f32 v138, v138, v135
    v_cvt_pk_bf16_f32 v71, v134, v135
    v_exp_f32 v129, v17
    v_mfma_f32_32x32x16_bf16 v[32:47], a[220:223], a[156:159], v[32:47]
    v_exp_f32 v130, v18
    buffer_load_dwordx4 v158, s[24:27], s43 offen offset:2048 lds
    v_mfma_f32_32x32x16_bf16 v[48:63], a[220:223], a[188:191], v[48:63]
    v_add_f32 v139, v128, v129
    v_cvt_pk_bf16_f32 v72, v128, v129
    v_exp_f32 v131, v19
    v_add_f32 v139, v139, v130
    s_add_u32 s42, s42, 8192
    s_add_u32 s43, s43, 8192
    s_waitcnt lgkmcnt(0)
    v_mfma_f32_32x32x16_bf16 a[0:15], a[224:227], v[80:83], a[0:15]
    v_exp_f32 v132, v20
    v_add_f32 v139, v139, v131
    v_cvt_pk_bf16_f32 v73, v130, v131
    v_exp_f32 v133, v21
    v_mfma_f32_32x32x16_bf16 a[64:79], a[224:227], v[88:91], a[64:79]
    v_add_f32 v139, v139, v132
    v_exp_f32 v134, v22
    v_add_f32 v139, v139, v133
    v_cvt_pk_bf16_f32 v74, v132, v133
    v_mfma_f32_32x32x16_bf16 a[16:31], a[228:231], v[80:83], a[16:31]
    v_exp_f32 v135, v23
    v_add_f32 v139, v139, v134
    v_exp_f32 v128, v24
    v_add_f32 v139, v139, v135
    v_mfma_f32_32x32x16_bf16 a[80:95], a[228:231], v[88:91], a[80:95]
    v_cvt_pk_bf16_f32 v75, v134, v135
    v_exp_f32 v129, v25
    v_add_f32 v139, v139, v128
    v_exp_f32 v130, v26
    v_mfma_f32_32x32x16_bf16 a[32:47], a[232:235], v[80:83], a[32:47]
    v_add_f32 v139, v139, v129
    v_cvt_pk_bf16_f32 v76, v128, v129
    v_exp_f32 v131, v27
    v_add_f32 v139, v139, v130
    v_mfma_f32_32x32x16_bf16 a[96:111], a[232:235], v[88:91], a[96:111]
    v_exp_f32 v132, v28
    v_add_f32 v139, v139, v131
    v_cvt_pk_bf16_f32 v77, v130, v131
    v_exp_f32 v133, v29
    v_mfma_f32_32x32x16_bf16 a[48:63], a[236:239], v[80:83], a[48:63]
    v_add_f32 v139, v139, v132
    v_exp_f32 v134, v30
    v_add_f32 v139, v139, v133
    v_cvt_pk_bf16_f32 v78, v132, v133
    v_mfma_f32_32x32x16_bf16 a[112:127], a[236:239], v[88:91], a[112:127]
    v_exp_f32 v135, v31
    v_add_f32 v139, v139, v134
    v_add_f32 v139, v139, v135
    v_cvt_pk_bf16_f32 v79, v134, v135
    s_nop 0
    v_mfma_f32_32x32x16_bf16 a[0:15], a[240:243], v[84:87], a[0:15]
    v_max_f32 v140, v138, v139
    v_cmp_nge_f32 vcc, s44, v140
    v_mfma_f32_32x32x16_bf16 a[64:79], a[240:243], v[92:95], a[64:79]
    v_mfma_f32_32x32x16_bf16 a[16:31], a[244:247], v[84:87], a[16:31]
    v_mfma_f32_32x32x16_bf16 a[80:95], a[244:247], v[92:95], a[80:95]
    v_mfma_f32_32x32x16_bf16 a[32:47], a[248:251], v[84:87], a[32:47]
    v_mfma_f32_32x32x16_bf16 a[96:111], a[248:251], v[92:95], a[96:111]
    v_mfma_f32_32x32x16_bf16 a[48:63], a[252:255], v[84:87], a[48:63]
    v_mfma_f32_32x32x16_bf16 a[112:127], a[252:255], v[92:95], a[112:127]
    s_cbranch_vccnz att_T61_1_slow
att_T61_1_back:
    s_waitcnt vmcnt(2) lgkmcnt(0)
    s_barrier
    ds_read_b64_tr_b16 a[224:225], v152 offset:16384
    ds_read_b64_tr_b16 a[226:227], v152 offset:18432
    ds_read_b64_tr_b16 a[228:229], v153 offset:16384
    ds_read_b64_tr_b16 a[230:231], v153 offset:18432
    ds_read_b64_tr_b16 a[232:233], v154 offset:16384
    ds_read_b64_tr_b16 a[234:235], v154 offset:18432
    ds_read_b64_tr_b16 a[236:237], v155 offset:16384
    ds_read_b64_tr_b16 a[238:239], v155 offset:18432
    ds_read_b64_tr_b16 a[240:241], v152 offset:20480
    ds_read_b64_tr_b16 a[242:243], v152 offset:22528
    ds_read_b64_tr_b16 a[244:245], v153 offset:20480
    ds_read_b64_tr_b16 a[246:247], v153 offset:22528
    ds_read_b64_tr_b16 a[248:249], v154 offset:20480
    ds_read_b64_tr_b16 a[250:251], v154 offset:22528
    ds_read_b64_tr_b16 a[252:253], v155 offset:20480
    ds_read_b64_tr_b16 a[254:255], v155 offset:22528
    s_waitcnt lgkmcnt(0)
    v_mfma_f32_32x32x16_bf16 a[0:15], a[224:227], v[64:67], a[0:15]
    v_add_f32 v136, v136, v138
    v_add_f32 v137, v137, v139
    v_exp_f32 v128, v32
    v_exp_f32 v129, v33
    v_exp_f32 v130, v34
    v_add_f32 v138, v128, v129
    v_cvt_pk_bf16_f32 v80, v128, v129
    v_exp_f32 v131, v35
    v_add_f32 v138, v138, v130
    v_exp_f32 v132, v36
    v_mfma_f32_32x32x16_bf16 a[64:79], a[224:227], v[72:75], a[64:79]
    v_add_f32 v138, v138, v131
    v_cvt_pk_bf16_f32 v81, v130, v131
    v_exp_f32 v133, v37
    v_add_f32 v138, v138, v132
    v_exp_f32 v134, v38
    v_add_f32 v138, v138, v133
    v_cvt_pk_bf16_f32 v82, v132, v133
    v_exp_f32 v135, v39
    v_add_f32 v138, v138, v134
    v_exp_f32 v128, v40
    v_add_f32 v138, v138, v135
    v_mfma_f32_32x32x16_bf16 a[16:31], a[228:231], v[64:67], a[16:31]
    v_cvt_pk_bf16_f32 v83, v134, v135
    v_exp_f32 v129, v41
    v_add_f32 v138, v138, v128
    v_exp_f32 v130, v42
    v_add_f32 v138, v138, v129
    v_cvt_pk_bf16_f32 v84, v128, v129
    v_exp_f32 v131, v43
    v_add_f32 v138, v138, v130
    v_exp_f32 v132, v44
    v_add_f32 v138, v138, v131
    v_cvt_pk_bf16_f32 v85, v130, v131
    v_mfma_f32_32x32x16_bf16 a[80:95], a[228:231], v[72:75], a[80:95]
    v_exp_f32 v133, v45
    v_add_f32 v138, v138, v132
    v_exp_f32 v134, v46
    v_add_f32 v138, v138, v133
    v_cvt_pk_bf16_f32 v86, v132, v133
    v_exp_f32 v135, v47
    v_add_f32 v138, v138, v134
    v_exp_f32 v128, v48
    v_add_f32 v138, v138, v135
    v_cvt_pk_bf16_f32 v87, v134, v135
    v_mfma_f32_32x32x16_bf16 a[32:47], a[232:235], v[64:67], a[32:47]
    v_exp_f32 v129, v49
    v_exp_f32 v130, v50
    v_add_f32 v139, v128, v129
    v_cvt_pk_bf16_f32 v88, v128, v129
    v_exp_f32 v131, v51
    v_add_f32 v139, v139, v130
    v_exp_f32 v132, v52
    v_add_f32 v139, v139, v131
    v_cvt_pk_bf16_f32 v89, v130, v131
    v_exp_f32 v133, v53
    v_mfma_f32_32x32x16_bf16 a[96:111], a[232:235], v[72:75], a[96:111]
    v_add_f32 v139, v139, v132
    v_exp_f32 v134, v54
    v_add_f32 v139, v139, v133
    v_cvt_pk_bf16_f32 v90, v132, v133
    v_exp_f32 v135, v55
    v_add_f32 v139, v139, v134
    v_exp_f32 v128, v56
    v_add_f32 v139, v139, v135
    v_cvt_pk_bf16_f32 v91, v134, v135
    v_exp_f32 v129, v57
    v_add_f32 v139, v139, v128
    v_mfma_f32_32x32x16_bf16 a[48:63], a[236:239], v[64:67], a[48:63]
    v_exp_f32 v130, v58
    v_add_f32 v139, v139, v129
    v_cvt_pk_bf16_f32 v92, v128, v129
    v_exp_f32 v131, v59
    v_add_f32 v139, v139, v130
    v_exp_f32 v132, v60
    v_add_f32 v139, v139, v131
    v_cvt_pk_bf16_f32 v93, v130, v131
    v_exp_f32 v133, v61
    v_add_f32 v139, v139, v132
    v_mfma_f32_32x32x16_bf16 a[112:127], a[236:239], v[72:75], a[112:127]
    v_exp_f32 v134, v62
    v_add_f32 v139, v139, v133
    v_cvt_pk_bf16_f32 v94, v132, v133
    v_exp_f32 v135, v63
    v_add_f32 v139, v139, v134
    v_add_f32 v139, v139, v135
    v_cvt_pk_bf16_f32 v95, v134, v135
    v_max_f32 v140, v138, v139
    v_cmp_nge_f32 vcc, s44, v140
    s_nop 0
    v_mfma_f32_32x32x16_bf16 a[0:15], a[240:243], v[68:71], a[0:15]
    v_mfma_f32_32x32x16_bf16 a[64:79], a[240:243], v[76:79], a[64:79]
    v_mfma_f32_32x32x16_bf16 a[16:31], a[244:247], v[68:71], a[16:31]
    v_mfma_f32_32x32x16_bf16 a[80:95], a[244:247], v[76:79], a[80:95]
    v_mfma_f32_32x32x16_bf16 a[32:47], a[248:251], v[68:71], a[32:47]
    v_mfma_f32_32x32x16_bf16 a[96:111], a[248:251], v[76:79], a[96:111]
    v_mfma_f32_32x32x16_bf16 a[48:63], a[252:255], v[68:71], a[48:63]
    v_mfma_f32_32x32x16_bf16 a[112:127], a[252:255], v[76:79], a[112:127]
    s_cbranch_vccnz att_T62_2_slow
att_T62_2_back:
    s_waitcnt vmcnt(0) lgkmcnt(0)
    s_barrier
    ds_read_b64_tr_b16 a[224:225], v152 offset:24576
    ds_read_b64_tr_b16 a[226:227], v152 offset:26624
    ds_read_b64_tr_b16 a[228:229], v153 offset:24576
    ds_read_b64_tr_b16 a[230:231], v153 offset:26624
    ds_read_b64_tr_b16 a[232:233], v154 offset:24576
    ds_read_b64_tr_b16 a[234:235], v154 offset:26624
    ds_read_b64_tr_b16 a[236:237], v155 offset:24576
    ds_read_b64_tr_b16 a[238:239], v155 offset:26624
    ds_read_b64_tr_b16 a[240:241], v152 offset:28672
    ds_read_b64_tr_b16 a[242:243], v152 offset:30720
    ds_read_b64_tr_b16 a[244:245], v153 offset:28672
    ds_read_b64_tr_b16 a[246:247], v153 offset:30720
    ds_read_b64_tr_b16 a[248:249], v154 offset:28672
    ds_read_b64_tr_b16 a[250:251], v154 offset:30720
    ds_read_b64_tr_b16 a[252:253], v155 offset:28672
    ds_read_b64_tr_b16 a[254:255], v155 offset:30720
    s_waitcnt lgkmcnt(0)
    v_mfma_f32_32x32x16_bf16 a[0:15], a[224:227], v[80:83], a[0:15]
    v_add_f32 v136, v136, v138
    v_add_f32 v137, v137, v139
    v_mfma_f32_32x32x16_bf16 a[64:79], a[224:227], v[88:91], a[64:79]
    v_mfma_f32_32x32x16_bf16 a[16:31], a[228:231], v[80:83], a[16:31]
    v_mfma_f32_32x32x16_bf16 a[80:95], a[228:231], v[88:91], a[80:95]
    v_mfma_f32_32x32x16_bf16 a[32:47], a[232:235], v[80:83], a[32:47]
    v_mfma_f32_32x32x16_bf16 a[96:111], a[232:235], v[88:91], a[96:111]
    v_mfma_f32_32x32x16_bf16 a[48:63], a[236:239], v[80:83], a[48:63]
    v_mfma_f32_32x32x16_bf16 a[112:127], a[236:239], v[88:91], a[112:127]
    v_mfma_f32_32x32x16_bf16 a[0:15], a[240:243], v[84:87], a[0:15]
    v_mfma_f32_32x32x16_bf16 a[64:79], a[240:243], v[92:95], a[64:79]
    v_mfma_f32_32x32x16_bf16 a[16:31], a[244:247], v[84:87], a[16:31]
    v_mfma_f32_32x32x16_bf16 a[80:95], a[244:247], v[92:95], a[80:95]
    v_mfma_f32_32x32x16_bf16 a[32:47], a[248:251], v[84:87], a[32:47]
    v_mfma_f32_32x32x16_bf16 a[96:111], a[248:251], v[92:95], a[96:111]
    v_mfma_f32_32x32x16_bf16 a[48:63], a[252:255], v[84:87], a[48:63]
    v_mfma_f32_32x32x16_bf16 a[112:127], a[252:255], v[92:95], a[112:127]
    s_nop 15
    s_lshl_b32 s19, s14, 8
    s_lshl_b32 s13, s12, 4
    s_add_u32 s19, s19, s13
    s_lshl_b32 s19, s19, 10
    v_mov_b32 v0, v136
    v_mov_b32 v1, v136
    s_nop 1
    v_permlane32_swap_b32 v0, v1
    s_nop 1
    v_add_f32 v0, v0, v1
    v_rcp_f32 v0, v0
    s_nop 0
    v_mov_b32 v1, v0
    v_accvgpr_read_b32 v16, a0
    v_accvgpr_read_b32 v17, a1
    v_accvgpr_read_b32 v18, a2
    v_accvgpr_read_b32 v19, a3
    v_accvgpr_read_b32 v20, a4
    v_accvgpr_read_b32 v21, a5
    v_accvgpr_read_b32 v22, a6
    v_accvgpr_read_b32 v23, a7
    v_pk_mul_f32 v[16:17], v[16:17], v[0:1]
    v_pk_mul_f32 v[18:19], v[18:19], v[0:1]
    v_pk_mul_f32 v[20:21], v[20:21], v[0:1]
    v_pk_mul_f32 v[22:23], v[22:23], v[0:1]
    v_cvt_pk_bf16_f32 v24, v16, v17
    v_cvt_pk_bf16_f32 v25, v18, v19
    v_cvt_pk_bf16_f32 v26, v20, v21
    v_cvt_pk_bf16_f32 v27, v22, v23
    s_add_u32 s13, s19, 0
    buffer_store_dwordx4 v[24:27], v161, s[36:39], s13 offen sc1
    v_accvgpr_read_b32 v32, a8
    v_accvgpr_read_b32 v33, a9
    v_accvgpr_read_b32 v34, a10
    v_accvgpr_read_b32 v35, a11
    v_accvgpr_read_b32 v36, a12
    v_accvgpr_read_b32 v37, a13
    v_accvgpr_read_b32 v38, a14
    v_accvgpr_read_b32 v39, a15
    v_pk_mul_f32 v[32:33], v[32:33], v[0:1]
    v_pk_mul_f32 v[34:35], v[34:35], v[0:1]
    v_pk_mul_f32 v[36:37], v[36:37], v[0:1]
    v_pk_mul_f32 v[38:39], v[38:39], v[0:1]
    v_cvt_pk_bf16_f32 v40, v32, v33
    v_cvt_pk_bf16_f32 v41, v34, v35
    v_cvt_pk_bf16_f32 v42, v36, v37
    v_cvt_pk_bf16_f32 v43, v38, v39
    s_add_u32 s13, s19, 1024
    buffer_store_dwordx4 v[40:43], v161, s[36:39], s13 offen sc1
    v_accvgpr_read_b32 v48, a16
    v_accvgpr_read_b32 v49, a17
    v_accvgpr_read_b32 v50, a18
    v_accvgpr_read_b32 v51, a19
    v_accvgpr_read_b32 v52, a20
    v_accvgpr_read_b32 v53, a21
    v_accvgpr_read_b32 v54, a22
    v_accvgpr_read_b32 v55, a23
    v_pk_mul_f32 v[48:49], v[48:49], v[0:1]
    v_pk_mul_f32 v[50:51], v[50:51], v[0:1]
    v_pk_mul_f32 v[52:53], v[52:53], v[0:1]
    v_pk_mul_f32 v[54:55], v[54:55], v[0:1]
    v_cvt_pk_bf16_f32 v56, v48, v49
    v_cvt_pk_bf16_f32 v57, v50, v51
    v_cvt_pk_bf16_f32 v58, v52, v53
    v_cvt_pk_bf16_f32 v59, v54, v55
    s_add_u32 s13, s19, 2048
    buffer_store_dwordx4 v[56:59], v161, s[36:39], s13 offen sc1
    v_accvgpr_read_b32 v64, a24
    v_accvgpr_read_b32 v65, a25
    v_accvgpr_read_b32 v66, a26
    v_accvgpr_read_b32 v67, a27
    v_accvgpr_read_b32 v68, a28
    v_accvgpr_read_b32 v69, a29
    v_accvgpr_read_b32 v70, a30
    v_accvgpr_read_b32 v71, a31
    v_pk_mul_f32 v[64:65], v[64:65], v[0:1]
    v_pk_mul_f32 v[66:67], v[66:67], v[0:1]
    v_pk_mul_f32 v[68:69], v[68:69], v[0:1]
    v_pk_mul_f32 v[70:71], v[70:71], v[0:1]
    v_cvt_pk_bf16_f32 v72, v64, v65
    v_cvt_pk_bf16_f32 v73, v66, v67
    v_cvt_pk_bf16_f32 v74, v68, v69
    v_cvt_pk_bf16_f32 v75, v70, v71
    s_add_u32 s13, s19, 3072
    buffer_store_dwordx4 v[72:75], v161, s[36:39], s13 offen sc1
    v_accvgpr_read_b32 v16, a32
    v_accvgpr_read_b32 v17, a33
    v_accvgpr_read_b32 v18, a34
    v_accvgpr_read_b32 v19, a35
    v_accvgpr_read_b32 v20, a36
    v_accvgpr_read_b32 v21, a37
    v_accvgpr_read_b32 v22, a38
    v_accvgpr_read_b32 v23, a39
    v_pk_mul_f32 v[16:17], v[16:17], v[0:1]
    v_pk_mul_f32 v[18:19], v[18:19], v[0:1]
    v_pk_mul_f32 v[20:21], v[20:21], v[0:1]
    v_pk_mul_f32 v[22:23], v[22:23], v[0:1]
    v_cvt_pk_bf16_f32 v24, v16, v17
    v_cvt_pk_bf16_f32 v25, v18, v19
    v_cvt_pk_bf16_f32 v26, v20, v21
    v_cvt_pk_bf16_f32 v27, v22, v23
    s_add_u32 s13, s19, 4096
    buffer_store_dwordx4 v[24:27], v161, s[36:39], s13 offen sc1
    v_accvgpr_read_b32 v32, a40
    v_accvgpr_read_b32 v33, a41
    v_accvgpr_read_b32 v34, a42
    v_accvgpr_read_b32 v35, a43
    v_accvgpr_read_b32 v36, a44
    v_accvgpr_read_b32 v37, a45
    v_accvgpr_read_b32 v38, a46
    v_accvgpr_read_b32 v39, a47
    v_pk_mul_f32 v[32:33], v[32:33], v[0:1]
    v_pk_mul_f32 v[34:35], v[34:35], v[0:1]
    v_pk_mul_f32 v[36:37], v[36:37], v[0:1]
    v_pk_mul_f32 v[38:39], v[38:39], v[0:1]
    v_cvt_pk_bf16_f32 v40, v32, v33
    v_cvt_pk_bf16_f32 v41, v34, v35
    v_cvt_pk_bf16_f32 v42, v36, v37
    v_cvt_pk_bf16_f32 v43, v38, v39
    s_add_u32 s13, s19, 5120
    buffer_store_dwordx4 v[40:43], v161, s[36:39], s13 offen sc1
    v_accvgpr_read_b32 v48, a48
    v_accvgpr_read_b32 v49, a49
    v_accvgpr_read_b32 v50, a50
    v_accvgpr_read_b32 v51, a51
    v_accvgpr_read_b32 v52, a52
    v_accvgpr_read_b32 v53, a53
    v_accvgpr_read_b32 v54, a54
    v_accvgpr_read_b32 v55, a55
    v_pk_mul_f32 v[48:49], v[48:49], v[0:1]
    v_pk_mul_f32 v[50:51], v[50:51], v[0:1]
    v_pk_mul_f32 v[52:53], v[52:53], v[0:1]
    v_pk_mul_f32 v[54:55], v[54:55], v[0:1]
    v_cvt_pk_bf16_f32 v56, v48, v49
    v_cvt_pk_bf16_f32 v57, v50, v51
    v_cvt_pk_bf16_f32 v58, v52, v53
    v_cvt_pk_bf16_f32 v59, v54, v55
    s_add_u32 s13, s19, 6144
    buffer_store_dwordx4 v[56:59], v161, s[36:39], s13 offen sc1
    v_accvgpr_read_b32 v64, a56
    v_accvgpr_read_b32 v65, a57
    v_accvgpr_read_b32 v66, a58
    v_accvgpr_read_b32 v67, a59
    v_accvgpr_read_b32 v68, a60
    v_accvgpr_read_b32 v69, a61
    v_accvgpr_read_b32 v70, a62
    v_accvgpr_read_b32 v71, a63
    v_pk_mul_f32 v[64:65], v[64:65], v[0:1]
    v_pk_mul_f32 v[66:67], v[66:67], v[0:1]
    v_pk_mul_f32 v[68:69], v[68:69], v[0:1]
    v_pk_mul_f32 v[70:71], v[70:71], v[0:1]
    v_cvt_pk_bf16_f32 v72, v64, v65
    v_cvt_pk_bf16_f32 v73, v66, v67
    v_cvt_pk_bf16_f32 v74, v68, v69
    v_cvt_pk_bf16_f32 v75, v70, v71
    s_add_u32 s13, s19, 7168
    buffer_store_dwordx4 v[72:75], v161, s[36:39], s13 offen sc1
    v_mov_b32 v0, v137
    v_mov_b32 v1, v137
    s_nop 1
    v_permlane32_swap_b32 v0, v1
    s_nop 1
    v_add_f32 v0, v0, v1
    v_rcp_f32 v0, v0
    s_nop 0
    v_mov_b32 v1, v0
    v_accvgpr_read_b32 v16, a64
    v_accvgpr_read_b32 v17, a65
    v_accvgpr_read_b32 v18, a66
    v_accvgpr_read_b32 v19, a67
    v_accvgpr_read_b32 v20, a68
    v_accvgpr_read_b32 v21, a69
    v_accvgpr_read_b32 v22, a70
    v_accvgpr_read_b32 v23, a71
    v_pk_mul_f32 v[16:17], v[16:17], v[0:1]
    v_pk_mul_f32 v[18:19], v[18:19], v[0:1]
    v_pk_mul_f32 v[20:21], v[20:21], v[0:1]
    v_pk_mul_f32 v[22:23], v[22:23], v[0:1]
    v_cvt_pk_bf16_f32 v24, v16, v17
    v_cvt_pk_bf16_f32 v25, v18, v19
    v_cvt_pk_bf16_f32 v26, v20, v21
    v_cvt_pk_bf16_f32 v27, v22, v23
    s_add_u32 s13, s19, 8192
    buffer_store_dwordx4 v[24:27], v161, s[36:39], s13 offen sc1
    v_accvgpr_read_b32 v32, a72
    v_accvgpr_read_b32 v33, a73
    v_accvgpr_read_b32 v34, a74
    v_accvgpr_read_b32 v35, a75
    v_accvgpr_read_b32 v36, a76
    v_accvgpr_read_b32 v37, a77
    v_accvgpr_read_b32 v38, a78
    v_accvgpr_read_b32 v39, a79
    v_pk_mul_f32 v[32:33], v[32:33], v[0:1]
    v_pk_mul_f32 v[34:35], v[34:35], v[0:1]
    v_pk_mul_f32 v[36:37], v[36:37], v[0:1]
    v_pk_mul_f32 v[38:39], v[38:39], v[0:1]
    v_cvt_pk_bf16_f32 v40, v32, v33
    v_cvt_pk_bf16_f32 v41, v34, v35
    v_cvt_pk_bf16_f32 v42, v36, v37
    v_cvt_pk_bf16_f32 v43, v38, v39
    s_add_u32 s13, s19, 9216
    buffer_store_dwordx4 v[40:43], v161, s[36:39], s13 offen sc1
    v_accvgpr_read_b32 v48, a80
    v_accvgpr_read_b32 v49, a81
    v_accvgpr_read_b32 v50, a82
    v_accvgpr_read_b32 v51, a83
    v_accvgpr_read_b32 v52, a84
    v_accvgpr_read_b32 v53, a85
    v_accvgpr_read_b32 v54, a86
    v_accvgpr_read_b32 v55, a87
    v_pk_mul_f32 v[48:49], v[48:49], v[0:1]
    v_pk_mul_f32 v[50:51], v[50:51], v[0:1]
    v_pk_mul_f32 v[52:53], v[52:53], v[0:1]
    v_pk_mul_f32 v[54:55], v[54:55], v[0:1]
    v_cvt_pk_bf16_f32 v56, v48, v49
    v_cvt_pk_bf16_f32 v57, v50, v51
    v_cvt_pk_bf16_f32 v58, v52, v53
    v_cvt_pk_bf16_f32 v59, v54, v55
    s_add_u32 s13, s19, 10240
    buffer_store_dwordx4 v[56:59], v161, s[36:39], s13 offen sc1
    v_accvgpr_read_b32 v64, a88
    v_accvgpr_read_b32 v65, a89
    v_accvgpr_read_b32 v66, a90
    v_accvgpr_read_b32 v67, a91
    v_accvgpr_read_b32 v68, a92
    v_accvgpr_read_b32 v69, a93
    v_accvgpr_read_b32 v70, a94
    v_accvgpr_read_b32 v71, a95
    v_pk_mul_f32 v[64:65], v[64:65], v[0:1]
    v_pk_mul_f32 v[66:67], v[66:67], v[0:1]
    v_pk_mul_f32 v[68:69], v[68:69], v[0:1]
    v_pk_mul_f32 v[70:71], v[70:71], v[0:1]
    v_cvt_pk_bf16_f32 v72, v64, v65
    v_cvt_pk_bf16_f32 v73, v66, v67
    v_cvt_pk_bf16_f32 v74, v68, v69
    v_cvt_pk_bf16_f32 v75, v70, v71
    s_add_u32 s13, s19, 11264
    buffer_store_dwordx4 v[72:75], v161, s[36:39], s13 offen sc1
    v_accvgpr_read_b32 v16, a96
    v_accvgpr_read_b32 v17, a97
    v_accvgpr_read_b32 v18, a98
    v_accvgpr_read_b32 v19, a99
    v_accvgpr_read_b32 v20, a100
    v_accvgpr_read_b32 v21, a101
    v_accvgpr_read_b32 v22, a102
    v_accvgpr_read_b32 v23, a103
    v_pk_mul_f32 v[16:17], v[16:17], v[0:1]
    v_pk_mul_f32 v[18:19], v[18:19], v[0:1]
    v_pk_mul_f32 v[20:21], v[20:21], v[0:1]
    v_pk_mul_f32 v[22:23], v[22:23], v[0:1]
    v_cvt_pk_bf16_f32 v24, v16, v17
    v_cvt_pk_bf16_f32 v25, v18, v19
    v_cvt_pk_bf16_f32 v26, v20, v21
    v_cvt_pk_bf16_f32 v27, v22, v23
    s_add_u32 s13, s19, 12288
    buffer_store_dwordx4 v[24:27], v161, s[36:39], s13 offen sc1
    v_accvgpr_read_b32 v32, a104
    v_accvgpr_read_b32 v33, a105
    v_accvgpr_read_b32 v34, a106
    v_accvgpr_read_b32 v35, a107
    v_accvgpr_read_b32 v36, a108
    v_accvgpr_read_b32 v37, a109
    v_accvgpr_read_b32 v38, a110
    v_accvgpr_read_b32 v39, a111
    v_pk_mul_f32 v[32:33], v[32:33], v[0:1]
    v_pk_mul_f32 v[34:35], v[34:35], v[0:1]
    v_pk_mul_f32 v[36:37], v[36:37], v[0:1]
    v_pk_mul_f32 v[38:39], v[38:39], v[0:1]
    v_cvt_pk_bf16_f32 v40, v32, v33
    v_cvt_pk_bf16_f32 v41, v34, v35
    v_cvt_pk_bf16_f32 v42, v36, v37
    v_cvt_pk_bf16_f32 v43, v38, v39
    s_add_u32 s13, s19, 13312
    buffer_store_dwordx4 v[40:43], v161, s[36:39], s13 offen sc1
    v_accvgpr_read_b32 v48, a112
    v_accvgpr_read_b32 v49, a113
    v_accvgpr_read_b32 v50, a114
    v_accvgpr_read_b32 v51, a115
    v_accvgpr_read_b32 v52, a116
    v_accvgpr_read_b32 v53, a117
    v_accvgpr_read_b32 v54, a118
    v_accvgpr_read_b32 v55, a119
    v_pk_mul_f32 v[48:49], v[48:49], v[0:1]
    v_pk_mul_f32 v[50:51], v[50:51], v[0:1]
    v_pk_mul_f32 v[52:53], v[52:53], v[0:1]
    v_pk_mul_f32 v[54:55], v[54:55], v[0:1]
    v_cvt_pk_bf16_f32 v56, v48, v49
    v_cvt_pk_bf16_f32 v57, v50, v51
    v_cvt_pk_bf16_f32 v58, v52, v53
    v_cvt_pk_bf16_f32 v59, v54, v55
    s_add_u32 s13, s19, 14336
    buffer_store_dwordx4 v[56:59], v161, s[36:39], s13 offen sc1
    v_accvgpr_read_b32 v64, a120
    v_accvgpr_read_b32 v65, a121
    v_accvgpr_read_b32 v66, a122
    v_accvgpr_read_b32 v67, a123
    v_accvgpr_read_b32 v68, a124
    v_accvgpr_read_b32 v69, a125
    v_accvgpr_read_b32 v70, a126
    v_accvgpr_read_b32 v71, a127
    v_pk_mul_f32 v[64:65], v[64:65], v[0:1]
    v_pk_mul_f32 v[66:67], v[66:67], v[0:1]
    v_pk_mul_f32 v[68:69], v[68:69], v[0:1]
    v_pk_mul_f32 v[70:71], v[70:71], v[0:1]
    v_cvt_pk_bf16_f32 v72, v64, v65
    v_cvt_pk_bf16_f32 v73, v66, v67
    v_cvt_pk_bf16_f32 v74, v68, v69
    v_cvt_pk_bf16_f32 v75, v70, v71
    s_add_u32 s13, s19, 15360
    buffer_store_dwordx4 v[72:75], v161, s[36:39], s13 offen sc1
    s_waitcnt vmcnt(0)
k2_attn_kernel_end:
    s_endpgm
att_L0_slow:
    s_call_b64 s[48:49], att_sub1
    s_branch att_L0_back
att_L1_slow:
    s_call_b64 s[48:49], att_sub0
    s_branch att_L1_back
att_L2_slow:
    s_call_b64 s[48:49], att_sub1
    s_branch att_L2_back
att_L3_slow:
    s_call_b64 s[48:49], att_sub0
    s_branch att_L3_back
att_T56_0_slow:
    s_call_b64 s[48:49], att_sub1
    s_branch att_T56_0_back
att_T57_1_slow:
    s_call_b64 s[48:49], att_sub0
    s_branch att_T57_1_back
att_T58_2_slow:
    s_call_b64 s[48:49], att_sub1
    s_branch att_T58_2_back
att_T59_3_slow:
    s_call_b64 s[48:49], att_sub0
    s_branch att_T59_3_back
att_T60_0_slow:
    s_call_b64 s[48:49], att_sub1
    s_branch att_T60_0_back
att_T61_1_slow:
    s_call_b64 s[48:49], att_sub0
    s_branch att_T61_1_back
att_T62_2_slow:
    s_call_b64 s[48:49], att_sub1
    s_branch att_T62_2_back
att_sub0:
    s_nop 15
    s_nop 7
    v_max3_f32 v140, v0, v1, v2
    v_max3_f32 v140, v140, v3, v4
    v_max3_f32 v140, v140, v5, v6
    v_max3_f32 v140, v140, v7, v8
    v_max3_f32 v140, v140, v9, v10
    v_max3_f32 v140, v140, v11, v12
    v_max3_f32 v140, v140, v13, v14
    v_max_f32 v140, v140, v15
    v_mov_b32 v141, v140
    s_nop 1
    v_permlane32_swap_b32 v140, v141
    s_nop 1
    v_max_f32 v140, v140, v141
    v_max_f32 v140, 0, v140
    v_sub_f32 v0, v0, v140
    v_sub_f32 v32, v32, v140
    v_sub_f32 v96, v96, v140
    v_sub_f32 v1, v1, v140
    v_sub_f32 v33, v33, v140
    v_sub_f32 v97, v97, v140
    v_sub_f32 v2, v2, v140
    v_sub_f32 v34, v34, v140
    v_sub_f32 v98, v98, v140
    v_sub_f32 v3, v3, v140
    v_sub_f32 v35, v35, v140
    v_sub_f32 v99, v99, v140
    v_sub_f32 v4, v4, v140
    v_sub_f32 v36, v36, v140
    v_sub_f32 v100, v100, v140
    v_sub_f32 v5, v5, v140
    v_sub_f32 v37, v37, v140
    v_sub_f32 v101, v101, v140
    v_sub_f32 v6, v6, v140
    v_sub_f32 v38, v38, v140
    v_sub_f32 v102, v102, v140
    v_sub_f32 v7, v7, v140
    v_sub_f32 v39, v39, v140
    v_sub_f32 v103, v103, v140
    v_sub_f32 v8, v8, v140
    v_sub_f32 v40, v40, v140
    v_sub_f32 v104, v104, v140
    v_sub_f32 v9, v9, v140
    v_sub_f32 v41, v41, v140
    v_sub_f32 v105, v105, v140
    v_sub_f32 v10, v10, v140
    v_sub_f32 v42, v42, v140
    v_sub_f32 v106, v106, v140
    v_sub_f32 v11, v11, v140
    v_sub_f32 v43, v43, v140
    v_sub_f32 v107, v107, v140
    v_sub_f32 v12, v12, v140
    v_sub_f32 v44, v44, v140
    v_sub_f32 v108, v108, v140
    v_sub_f32 v13, v13, v140
    v_sub_f32 v45, v45, v140
    v_sub_f32 v109, v109, v140
    v_sub_f32 v14, v14, v140
    v_sub_f32 v46, v46, v140
    v_sub_f32 v110, v110, v140
    v_sub_f32 v15, v15, v140
    v_sub_f32 v47, v47, v140
    v_sub_f32 v111, v111, v140
    v_sub_f32 v141, 0, v140
    v_exp_f32 v141, v141
    s_nop 0
    v_mul_f32 v136, v136, v141
    v_accvgpr_read_b32 v128, a0
    v_accvgpr_read_b32 v129, a1
    v_accvgpr_read_b32 v130, a2
    v_accvgpr_read_b32 v131, a3
    v_mul_f32 v128, v128, v141
    v_mul_f32 v129, v129, v141
    v_mul_f32 v130, v130, v141
    v_mul_f32 v131, v131, v141
    v_accvgpr_write_b32 a0, v128
    v_accvgpr_write_b32 a1, v129
    v_accvgpr_write_b32 a2, v130
    v_accvgpr_write_b32 a3, v131
    v_accvgpr_read_b32 v128, a4
    v_accvgpr_read_b32 v129, a5
    v_accvgpr_read_b32 v130, a6
    v_accvgpr_read_b32 v131, a7
    v_mul_f32 v128, v128, v141
    v_mul_f32 v129, v129, v141
    v_mul_f32 v130, v130, v141
    v_mul_f32 v131, v131, v141
    v_accvgpr_write_b32 a4, v128
    v_accvgpr_write_b32 a5, v129
    v_accvgpr_write_b32 a6, v130
    v_accvgpr_write_b32 a7, v131
    v_accvgpr_read_b32 v128, a8
    v_accvgpr_read_b32 v129, a9
    v_accvgpr_read_b32 v130, a10
    v_accvgpr_read_b32 v131, a11
    v_mul_f32 v128, v128, v141
    v_mul_f32 v129, v129, v141
    v_mul_f32 v130, v130, v141
    v_mul_f32 v131, v131, v141
    v_accvgpr_write_b32 a8, v128
    v_accvgpr_write_b32 a9, v129
    v_accvgpr_write_b32 a10, v130
    v_accvgpr_write_b32 a11, v131
    v_accvgpr_read_b32 v128, a12
    v_accvgpr_read_b32 v129, a13
    v_accvgpr_read_b32 v130, a14
    v_accvgpr_read_b32 v131, a15
    v_mul_f32 v128, v128, v141
    v_mul_f32 v129, v129, v141
    v_mul_f32 v130, v130, v141
    v_mul_f32 v131, v131, v141
    v_accvgpr_write_b32 a12, v128
    v_accvgpr_write_b32 a13, v129
    v_accvgpr_write_b32 a14, v130
    v_accvgpr_write_b32 a15, v131
    v_accvgpr_read_b32 v128, a16
    v_accvgpr_read_b32 v129, a17
    v_accvgpr_read_b32 v130, a18
    v_accvgpr_read_b32 v131, a19
    v_mul_f32 v128, v128, v141
    v_mul_f32 v129, v129, v141
    v_mul_f32 v130, v130, v141
    v_mul_f32 v131, v131, v141
    v_accvgpr_write_b32 a16, v128
    v_accvgpr_write_b32 a17, v129
    v_accvgpr_write_b32 a18, v130
    v_accvgpr_write_b32 a19, v131
    v_accvgpr_read_b32 v128, a20
    v_accvgpr_read_b32 v129, a21
    v_accvgpr_read_b32 v130, a22
    v_accvgpr_read_b32 v131, a23
    v_mul_f32 v128, v128, v141
    v_mul_f32 v129, v129, v141
    v_mul_f32 v130, v130, v141
    v_mul_f32 v131, v131, v141
    v_accvgpr_write_b32 a20, v128
    v_accvgpr_write_b32 a21, v129
    v_accvgpr_write_b32 a22, v130
    v_accvgpr_write_b32 a23, v131
    v_accvgpr_read_b32 v128, a24
    v_accvgpr_read_b32 v129, a25
    v_accvgpr_read_b32 v130, a26
    v_accvgpr_read_b32 v131, a27
    v_mul_f32 v128, v128, v141
    v_mul_f32 v129, v129, v141
    v_mul_f32 v130, v130, v141
    v_mul_f32 v131, v131, v141
    v_accvgpr_write_b32 a24, v128
    v_accvgpr_write_b32 a25, v129
    v_accvgpr_write_b32 a26, v130
    v_accvgpr_write_b32 a27, v131
    v_accvgpr_read_b32 v128, a28
    v_accvgpr_read_b32 v129, a29
    v_accvgpr_read_b32 v130, a30
    v_accvgpr_read_b32 v131, a31
    v_mul_f32 v128, v128, v141
    v_mul_f32 v129, v129, v141
    v_mul_f32 v130, v130, v141
    v_mul_f32 v131, v131, v141
    v_accvgpr_write_b32 a28, v128
    v_accvgpr_write_b32 a29, v129
    v_accvgpr_write_b32 a30, v130
    v_accvgpr_write_b32 a31, v131
    v_accvgpr_read_b32 v128, a32
    v_accvgpr_read_b32 v129, a33
    v_accvgpr_read_b32 v130, a34
    v_accvgpr_read_b32 v131, a35
    v_mul_f32 v128, v128, v141
    v_mul_f32 v129, v129, v141
    v_mul_f32 v130, v130, v141
    v_mul_f32 v131, v131, v141
    v_accvgpr_write_b32 a32, v128
    v_accvgpr_write_b32 a33, v129
    v_accvgpr_write_b32 a34, v130
    v_accvgpr_write_b32 a35, v131
    v_accvgpr_read_b32 v128, a36
    v_accvgpr_read_b32 v129, a37
    v_accvgpr_read_b32 v130, a38
    v_accvgpr_read_b32 v131, a39
    v_mul_f32 v128, v128, v141
    v_mul_f32 v129, v129, v141
    v_mul_f32 v130, v130, v141
    v_mul_f32 v131, v131, v141
    v_accvgpr_write_b32 a36, v128
    v_accvgpr_write_b32 a37, v129
    v_accvgpr_write_b32 a38, v130
    v_accvgpr_write_b32 a39, v131
    v_accvgpr_read_b32 v128, a40
    v_accvgpr_read_b32 v129, a41
    v_accvgpr_read_b32 v130, a42
    v_accvgpr_read_b32 v131, a43
    v_mul_f32 v128, v128, v141
    v_mul_f32 v129, v129, v141
    v_mul_f32 v130, v130, v141
    v_mul_f32 v131, v131, v141
    v_accvgpr_write_b32 a40, v128
    v_accvgpr_write_b32 a41, v129
    v_accvgpr_write_b32 a42, v130
    v_accvgpr_write_b32 a43, v131
    v_accvgpr_read_b32 v128, a44
    v_accvgpr_read_b32 v129, a45
    v_accvgpr_read_b32 v130, a46
    v_accvgpr_read_b32 v131, a47
    v_mul_f32 v128, v128, v141
    v_mul_f32 v129, v129, v141
    v_mul_f32 v130, v130, v141
    v_mul_f32 v131, v131, v141
    v_accvgpr_write_b32 a44, v128
    v_accvgpr_write_b32 a45, v129
    v_accvgpr_write_b32 a46, v130
    v_accvgpr_write_b32 a47, v131
    v_accvgpr_read_b32 v128, a48
    v_accvgpr_read_b32 v129, a49
    v_accvgpr_read_b32 v130, a50
    v_accvgpr_read_b32 v131, a51
    v_mul_f32 v128, v128, v141
    v_mul_f32 v129, v129, v141
    v_mul_f32 v130, v130, v141
    v_mul_f32 v131, v131, v141
    v_accvgpr_write_b32 a48, v128
    v_accvgpr_write_b32 a49, v129
    v_accvgpr_write_b32 a50, v130
    v_accvgpr_write_b32 a51, v131
    v_accvgpr_read_b32 v128, a52
    v_accvgpr_read_b32 v129, a53
    v_accvgpr_read_b32 v130, a54
    v_accvgpr_read_b32 v131, a55
    v_mul_f32 v128, v128, v141
    v_mul_f32 v129, v129, v141
    v_mul_f32 v130, v130, v141
    v_mul_f32 v131, v131, v141
    v_accvgpr_write_b32 a52, v128
    v_accvgpr_write_b32 a53, v129
    v_accvgpr_write_b32 a54, v130
    v_accvgpr_write_b32 a55, v131
    v_accvgpr_read_b32 v128, a56
    v_accvgpr_read_b32 v129, a57
    v_accvgpr_read_b32 v130, a58
    v_accvgpr_read_b32 v131, a59
    v_mul_f32 v128, v128, v141
    v_mul_f32 v129, v129, v141
    v_mul_f32 v130, v130, v141
    v_mul_f32 v131, v131, v141
    v_accvgpr_write_b32 a56, v128
    v_accvgpr_write_b32 a57, v129
    v_accvgpr_write_b32 a58, v130
    v_accvgpr_write_b32 a59, v131
    v_accvgpr_read_b32 v128, a60
    v_accvgpr_read_b32 v129, a61
    v_accvgpr_read_b32 v130, a62
    v_accvgpr_read_b32 v131, a63
    v_mul_f32 v128, v128, v141
    v_mul_f32 v129, v129, v141
    v_mul_f32 v130, v130, v141
    v_mul_f32 v131, v131, v141
    v_accvgpr_write_b32 a60, v128
    v_accvgpr_write_b32 a61, v129
    v_accvgpr_write_b32 a62, v130
    v_accvgpr_write_b32 a63, v131
    v_max3_f32 v140, v16, v17, v18
    v_max3_f32 v140, v140, v19, v20
    v_max3_f32 v140, v140, v21, v22
    v_max3_f32 v140, v140, v23, v24
    v_max3_f32 v140, v140, v25, v26
    v_max3_f32 v140, v140, v27, v28
    v_max3_f32 v140, v140, v29, v30
    v_max_f32 v140, v140, v31
    v_mov_b32 v141, v140
    s_nop 1
    v_permlane32_swap_b32 v140, v141
    s_nop 1
    v_max_f32 v140, v140, v141
    v_max_f32 v140, 0, v140
    v_sub_f32 v16, v16, v140
    v_sub_f32 v48, v48, v140
    v_sub_f32 v112, v112, v140
    v_sub_f32 v17, v17, v140
    v_sub_f32 v49, v49, v140
    v_sub_f32 v113, v113, v140
    v_sub_f32 v18, v18, v140
    v_sub_f32 v50, v50, v140
    v_sub_f32 v114, v114, v140
    v_sub_f32 v19, v19, v140
    v_sub_f32 v51, v51, v140
    v_sub_f32 v115, v115, v140
    v_sub_f32 v20, v20, v140
    v_sub_f32 v52, v52, v140
    v_sub_f32 v116, v116, v140
    v_sub_f32 v21, v21, v140
    v_sub_f32 v53, v53, v140
    v_sub_f32 v117, v117, v140
    v_sub_f32 v22, v22, v140
    v_sub_f32 v54, v54, v140
    v_sub_f32 v118, v118, v140
    v_sub_f32 v23, v23, v140
    v_sub_f32 v55, v55, v140
    v_sub_f32 v119, v119, v140
    v_sub_f32 v24, v24, v140
    v_sub_f32 v56, v56, v140
    v_sub_f32 v120, v120, v140
    v_sub_f32 v25, v25, v140
    v_sub_f32 v57, v57, v140
    v_sub_f32 v121, v121, v140
    v_sub_f32 v26, v26, v140
    v_sub_f32 v58, v58, v140
    v_sub_f32 v122, v122, v140
    v_sub_f32 v27, v27, v140
    v_sub_f32 v59, v59, v140
    v_sub_f32 v123, v123, v140
    v_sub_f32 v28, v28, v140
    v_sub_f32 v60, v60, v140
    v_sub_f32 v124, v124, v140
    v_sub_f32 v29, v29, v140
    v_sub_f32 v61, v61, v140
    v_sub_f32 v125, v125, v140
    v_sub_f32 v30, v30, v140
    v_sub_f32 v62, v62, v140
    v_sub_f32 v126, v126, v140
    v_sub_f32 v31, v31, v140
    v_sub_f32 v63, v63, v140
    v_sub_f32 v127, v127, v140
    v_sub_f32 v141, 0, v140
    v_exp_f32 v141, v141
    s_nop 0
    v_mul_f32 v137, v137, v141
    v_accvgpr_read_b32 v128, a64
    v_accvgpr_read_b32 v129, a65
    v_accvgpr_read_b32 v130, a66
    v_accvgpr_read_b32 v131, a67
    v_mul_f32 v128, v128, v141
    v_mul_f32 v129, v129, v141
    v_mul_f32 v130, v130, v141
    v_mul_f32 v131, v131, v141
    v_accvgpr_write_b32 a64, v128
    v_accvgpr_write_b32 a65, v129
    v_accvgpr_write_b32 a66, v130
    v_accvgpr_write_b32 a67, v131
    v_accvgpr_read_b32 v128, a68
    v_accvgpr_read_b32 v129, a69
    v_accvgpr_read_b32 v130, a70
    v_accvgpr_read_b32 v131, a71
    v_mul_f32 v128, v128, v141
    v_mul_f32 v129, v129, v141
    v_mul_f32 v130, v130, v141
    v_mul_f32 v131, v131, v141
    v_accvgpr_write_b32 a68, v128
    v_accvgpr_write_b32 a69, v129
    v_accvgpr_write_b32 a70, v130
    v_accvgpr_write_b32 a71, v131
    v_accvgpr_read_b32 v128, a72
    v_accvgpr_read_b32 v129, a73
    v_accvgpr_read_b32 v130, a74
    v_accvgpr_read_b32 v131, a75
    v_mul_f32 v128, v128, v141
    v_mul_f32 v129, v129, v141
    v_mul_f32 v130, v130, v141
    v_mul_f32 v131, v131, v141
    v_accvgpr_write_b32 a72, v128
    v_accvgpr_write_b32 a73, v129
    v_accvgpr_write_b32 a74, v130
    v_accvgpr_write_b32 a75, v131
    v_accvgpr_read_b32 v128, a76
    v_accvgpr_read_b32 v129, a77
    v_accvgpr_read_b32 v130, a78
    v_accvgpr_read_b32 v131, a79
    v_mul_f32 v128, v128, v141
    v_mul_f32 v129, v129, v141
    v_mul_f32 v130, v130, v141
    v_mul_f32 v131, v131, v141
    v_accvgpr_write_b32 a76, v128
    v_accvgpr_write_b32 a77, v129
    v_accvgpr_write_b32 a78, v130
    v_accvgpr_write_b32 a79, v131
    v_accvgpr_read_b32 v128, a80
    v_accvgpr_read_b32 v129, a81
    v_accvgpr_read_b32 v130, a82
    v_accvgpr_read_b32 v131, a83
    v_mul_f32 v128, v128, v141
    v_mul_f32 v129, v129, v141
    v_mul_f32 v130, v130, v141
    v_mul_f32 v131, v131, v141
    v_accvgpr_write_b32 a80, v128
    v_accvgpr_write_b32 a81, v129
    v_accvgpr_write_b32 a82, v130
    v_accvgpr_write_b32 a83, v131
    v_accvgpr_read_b32 v128, a84
    v_accvgpr_read_b32 v129, a85
    v_accvgpr_read_b32 v130, a86
    v_accvgpr_read_b32 v131, a87
    v_mul_f32 v128, v128, v141
    v_mul_f32 v129, v129, v141
    v_mul_f32 v130, v130, v141
    v_mul_f32 v131, v131, v141
    v_accvgpr_write_b32 a84, v128
    v_accvgpr_write_b32 a85, v129
    v_accvgpr_write_b32 a86, v130
    v_accvgpr_write_b32 a87, v131
    v_accvgpr_read_b32 v128, a88
    v_accvgpr_read_b32 v129, a89
    v_accvgpr_read_b32 v130, a90
    v_accvgpr_read_b32 v131, a91
    v_mul_f32 v128, v128, v141
    v_mul_f32 v129, v129, v141
    v_mul_f32 v130, v130, v141
    v_mul_f32 v131, v131, v141
    v_accvgpr_write_b32 a88, v128
    v_accvgpr_write_b32 a89, v129
    v_accvgpr_write_b32 a90, v130
    v_accvgpr_write_b32 a91, v131
    v_accvgpr_read_b32 v128, a92
    v_accvgpr_read_b32 v129, a93
    v_accvgpr_read_b32 v130, a94
    v_accvgpr_read_b32 v131, a95
    v_mul_f32 v128, v128, v141
    v_mul_f32 v129, v129, v141
    v_mul_f32 v130, v130, v141
    v_mul_f32 v131, v131, v141
    v_accvgpr_write_b32 a92, v128
    v_accvgpr_write_b32 a93, v129
    v_accvgpr_write_b32 a94, v130
    v_accvgpr_write_b32 a95, v131
    v_accvgpr_read_b32 v128, a96
    v_accvgpr_read_b32 v129, a97
    v_accvgpr_read_b32 v130, a98
    v_accvgpr_read_b32 v131, a99
    v_mul_f32 v128, v128, v141
    v_mul_f32 v129, v129, v141
    v_mul_f32 v130, v130, v141
    v_mul_f32 v131, v131, v141
    v_accvgpr_write_b32 a96, v128
    v_accvgpr_write_b32 a97, v129
    v_accvgpr_write_b32 a98, v130
    v_accvgpr_write_b32 a99, v131
    v_accvgpr_read_b32 v128, a100
    v_accvgpr_read_b32 v129, a101
    v_accvgpr_read_b32 v130, a102
    v_accvgpr_read_b32 v131, a103
    v_mul_f32 v128, v128, v141
    v_mul_f32 v129, v129, v141
    v_mul_f32 v130, v130, v141
    v_mul_f32 v131, v131, v141
    v_accvgpr_write_b32 a100, v128
    v_accvgpr_write_b32 a101, v129
    v_accvgpr_write_b32 a102, v130
    v_accvgpr_write_b32 a103, v131
    v_accvgpr_read_b32 v128, a104
    v_accvgpr_read_b32 v129, a105
    v_accvgpr_read_b32 v130, a106
    v_accvgpr_read_b32 v131, a107
    v_mul_f32 v128, v128, v141
    v_mul_f32 v129, v129, v141
    v_mul_f32 v130, v130, v141
    v_mul_f32 v131, v131, v141
    v_accvgpr_write_b32 a104, v128
    v_accvgpr_write_b32 a105, v129
    v_accvgpr_write_b32 a106, v130
    v_accvgpr_write_b32 a107, v131
    v_accvgpr_read_b32 v128, a108
    v_accvgpr_read_b32 v129, a109
    v_accvgpr_read_b32 v130, a110
    v_accvgpr_read_b32 v131, a111
    v_mul_f32 v128, v128, v141
    v_mul_f32 v129, v129, v141
    v_mul_f32 v130, v130, v141
    v_mul_f32 v131, v131, v141
    v_accvgpr_write_b32 a108, v128
    v_accvgpr_write_b32 a109, v129
    v_accvgpr_write_b32 a110, v130
    v_accvgpr_write_b32 a111, v131
    v_accvgpr_read_b32 v128, a112
    v_accvgpr_read_b32 v129, a113
    v_accvgpr_read_b32 v130, a114
    v_accvgpr_read_b32 v131, a115
    v_mul_f32 v128, v128, v141
    v_mul_f32 v129, v129, v141
    v_mul_f32 v130, v130, v141
    v_mul_f32 v131, v131, v141
    v_accvgpr_write_b32 a112, v128
    v_accvgpr_write_b32 a113, v129
    v_accvgpr_write_b32 a114, v130
    v_accvgpr_write_b32 a115, v131
    v_accvgpr_read_b32 v128, a116
    v_accvgpr_read_b32 v129, a117
    v_accvgpr_read_b32 v130, a118
    v_accvgpr_read_b32 v131, a119
    v_mul_f32 v128, v128, v141
    v_mul_f32 v129, v129, v141
    v_mul_f32 v130, v130, v141
    v_mul_f32 v131, v131, v141
    v_accvgpr_write_b32 a116, v128
    v_accvgpr_write_b32 a117, v129
    v_accvgpr_write_b32 a118, v130
    v_accvgpr_write_b32 a119, v131
    v_accvgpr_read_b32 v128, a120
    v_accvgpr_read_b32 v129, a121
    v_accvgpr_read_b32 v130, a122
    v_accvgpr_read_b32 v131, a123
    v_mul_f32 v128, v128, v141
    v_mul_f32 v129, v129, v141
    v_mul_f32 v130, v130, v141
    v_mul_f32 v131, v131, v141
    v_accvgpr_write_b32 a120, v128
    v_accvgpr_write_b32 a121, v129
    v_accvgpr_write_b32 a122, v130
    v_accvgpr_write_b32 a123, v131
    v_accvgpr_read_b32 v128, a124
    v_accvgpr_read_b32 v129, a125
    v_accvgpr_read_b32 v130, a126
    v_accvgpr_read_b32 v131, a127
    v_mul_f32 v128, v128, v141
    v_mul_f32 v129, v129, v141
    v_mul_f32 v130, v130, v141
    v_mul_f32 v131, v131, v141
    v_accvgpr_write_b32 a124, v128
    v_accvgpr_write_b32 a125, v129
    v_accvgpr_write_b32 a126, v130
    v_accvgpr_write_b32 a127, v131
    v_exp_f32 v128, v0
    s_nop 0
    v_exp_f32 v129, v1
    s_nop 0
    v_exp_f32 v130, v2
    v_add_f32 v138, v128, v129
    v_cvt_pk_bf16_f32 v64, v128, v129
    s_nop 0
    v_exp_f32 v131, v3
    v_add_f32 v138, v138, v130
    s_nop 0
    v_exp_f32 v132, v4
    v_add_f32 v138, v138, v131
    v_cvt_pk_bf16_f32 v65, v130, v131
    s_nop 0
    v_exp_f32 v133, v5
    v_add_f32 v138, v138, v132
    s_nop 0
    v_exp_f32 v134, v6
    v_add_f32 v138, v138, v133
    v_cvt_pk_bf16_f32 v66, v132, v133
    s_nop 0
    v_exp_f32 v135, v7
    v_add_f32 v138, v138, v134
    s_nop 0
    v_exp_f32 v128, v8
    v_add_f32 v138, v138, v135
    v_cvt_pk_bf16_f32 v67, v134, v135
    s_nop 0
    v_exp_f32 v129, v9
    v_add_f32 v138, v138, v128
    s_nop 0
    v_exp_f32 v130, v10
    v_add_f32 v138, v138, v129
    v_cvt_pk_bf16_f32 v68, v128, v129
    s_nop 0
    v_exp_f32 v131, v11
    v_add_f32 v138, v138, v130
    s_nop 0
    v_exp_f32 v132, v12
    v_add_f32 v138, v138, v131
    v_cvt_pk_bf16_f32 v69, v130, v131
    s_nop 0
    v_exp_f32 v133, v13
    v_add_f32 v138, v138, v132
    s_nop 0
    v_exp_f32 v134, v14
    v_add_f32 v138, v138, v133
    v_cvt_pk_bf16_f32 v70, v132, v133
    s_nop 0
    v_exp_f32 v135, v15
    v_add_f32 v138, v138, v134
    s_nop 0
    v_exp_f32 v128, v16
    v_add_f32 v138, v138, v135
    v_cvt_pk_bf16_f32 v71, v134, v135
    s_nop 0
    v_exp_f32 v129, v17
    s_nop 0
    v_exp_f32 v130, v18
    v_add_f32 v139, v128, v129
    v_cvt_pk_bf16_f32 v72, v128, v129
    s_nop 0
    v_exp_f32 v131, v19
    v_add_f32 v139, v139, v130
    s_nop 0
    v_exp_f32 v132, v20
    v_add_f32 v139, v139, v131
    v_cvt_pk_bf16_f32 v73, v130, v131
    s_nop 0
    v_exp_f32 v133, v21
    v_add_f32 v139, v139, v132
    s_nop 0
    v_exp_f32 v134, v22
    v_add_f32 v139, v139, v133
    v_cvt_pk_bf16_f32 v74, v132, v133
    s_nop 0
    v_exp_f32 v135, v23
    v_add_f32 v139, v139, v134
    s_nop 0
    v_exp_f32 v128, v24
    v_add_f32 v139, v139, v135
    v_cvt_pk_bf16_f32 v75, v134, v135
    s_nop 0
    v_exp_f32 v129, v25
    v_add_f32 v139, v139, v128
    s_nop 0
    v_exp_f32 v130, v26
    v_add_f32 v139, v139, v129
    v_cvt_pk_bf16_f32 v76, v128, v129
    s_nop 0
    v_exp_f32 v131, v27
    v_add_f32 v139, v139, v130
    s_nop 0
    v_exp_f32 v132, v28
    v_add_f32 v139, v139, v131
    v_cvt_pk_bf16_f32 v77, v130, v131
    s_nop 0
    v_exp_f32 v133, v29
    v_add_f32 v139, v139, v132
    s_nop 0
    v_exp_f32 v134, v30
    v_add_f32 v139, v139, v133
    v_cvt_pk_bf16_f32 v78, v132, v133
    s_nop 0
    v_exp_f32 v135, v31
    v_add_f32 v139, v139, v134
    s_nop 0
    v_add_f32 v139, v139, v135
    v_cvt_pk_bf16_f32 v79, v134, v135
    s_nop 0
    s_nop 1
    s_setpc_b64 s[48:49]
att_sub1:
    s_nop 15
    s_nop 7
    v_max3_f32 v140, v32, v33, v34
    v_max3_f32 v140, v140, v35, v36
    v_max3_f32 v140, v140, v37, v38
    v_max3_f32 v140, v140, v39, v40
    v_max3_f32 v140, v140, v41, v42
    v_max3_f32 v140, v140, v43, v44
    v_max3_f32 v140, v140, v45, v46
    v_max_f32 v140, v140, v47
    v_mov_b32 v141, v140
    s_nop 1
    v_permlane32_swap_b32 v140, v141
    s_nop 1
    v_max_f32 v140, v140, v141
    v_max_f32 v140, 0, v140
    v_sub_f32 v32, v32, v140
    v_sub_f32 v0, v0, v140
    v_sub_f32 v96, v96, v140
    v_sub_f32 v33, v33, v140
    v_sub_f32 v1, v1, v140
    v_sub_f32 v97, v97, v140
    v_sub_f32 v34, v34, v140
    v_sub_f32 v2, v2, v140
    v_sub_f32 v98, v98, v140
    v_sub_f32 v35, v35, v140
    v_sub_f32 v3, v3, v140
    v_sub_f32 v99, v99, v140
    v_sub_f32 v36, v36, v140
    v_sub_f32 v4, v4, v140
    v_sub_f32 v100, v100, v140
    v_sub_f32 v37, v37, v140
    v_sub_f32 v5, v5, v140
    v_sub_f32 v101, v101, v140
    v_sub_f32 v38, v38, v140
    v_sub_f32 v6, v6, v140
    v_sub_f32 v102, v102, v140
    v_sub_f32 v39, v39, v140
    v_sub_f32 v7, v7, v140
    v_sub_f32 v103, v103, v140
    v_sub_f32 v40, v40, v140
    v_sub_f32 v8, v8, v140
    v_sub_f32 v104, v104, v140
    v_sub_f32 v41, v41, v140
    v_sub_f32 v9, v9, v140
    v_sub_f32 v105, v105, v140
    v_sub_f32 v42, v42, v140
    v_sub_f32 v10, v10, v140
    v_sub_f32 v106, v106, v140
    v_sub_f32 v43, v43, v140
    v_sub_f32 v11, v11, v140
    v_sub_f32 v107, v107, v140
    v_sub_f32 v44, v44, v140
    v_sub_f32 v12, v12, v140
    v_sub_f32 v108, v108, v140
    v_sub_f32 v45, v45, v140
    v_sub_f32 v13, v13, v140
    v_sub_f32 v109, v109, v140
    v_sub_f32 v46, v46, v140
    v_sub_f32 v14, v14, v140
    v_sub_f32 v110, v110, v140
    v_sub_f32 v47, v47, v140
    v_sub_f32 v15, v15, v140
    v_sub_f32 v111, v111, v140
    v_sub_f32 v141, 0, v140
    v_exp_f32 v141, v141
    s_nop 0
    v_mul_f32 v136, v136, v141
    v_accvgpr_read_b32 v128, a0
    v_accvgpr_read_b32 v129, a1
    v_accvgpr_read_b32 v130, a2
    v_accvgpr_read_b32 v131, a3
    v_mul_f32 v128, v128, v141
    v_mul_f32 v129, v129, v141
    v_mul_f32 v130, v130, v141
    v_mul_f32 v131, v131, v141
    v_accvgpr_write_b32 a0, v128
    v_accvgpr_write_b32 a1, v129
    v_accvgpr_write_b32 a2, v130
    v_accvgpr_write_b32 a3, v131
    v_accvgpr_read_b32 v128, a4
    v_accvgpr_read_b32 v129, a5
    v_accvgpr_read_b32 v130, a6
    v_accvgpr_read_b32 v131, a7
    v_mul_f32 v128, v128, v141
    v_mul_f32 v129, v129, v141
    v_mul_f32 v130, v130, v141
    v_mul_f32 v131, v131, v141
    v_accvgpr_write_b32 a4, v128
    v_accvgpr_write_b32 a5, v129
    v_accvgpr_write_b32 a6, v130
    v_accvgpr_write_b32 a7, v131
    v_accvgpr_read_b32 v128, a8
    v_accvgpr_read_b32 v129, a9
    v_accvgpr_read_b32 v130, a10
    v_accvgpr_read_b32 v131, a11
    v_mul_f32 v128, v128, v141
    v_mul_f32 v129, v129, v141
    v_mul_f32 v130, v130, v141
    v_mul_f32 v131, v131, v141
    v_accvgpr_write_b32 a8, v128
    v_accvgpr_write_b32 a9, v129
    v_accvgpr_write_b32 a10, v130
    v_accvgpr_write_b32 a11, v131
    v_accvgpr_read_b32 v128, a12
    v_accvgpr_read_b32 v129, a13
    v_accvgpr_read_b32 v130, a14
    v_accvgpr_read_b32 v131, a15
    v_mul_f32 v128, v128, v141
    v_mul_f32 v129, v129, v141
    v_mul_f32 v130, v130, v141
    v_mul_f32 v131, v131, v141
    v_accvgpr_write_b32 a12, v128
    v_accvgpr_write_b32 a13, v129
    v_accvgpr_write_b32 a14, v130
    v_accvgpr_write_b32 a15, v131
    v_accvgpr_read_b32 v128, a16
    v_accvgpr_read_b32 v129, a17
    v_accvgpr_read_b32 v130, a18
    v_accvgpr_read_b32 v131, a19
    v_mul_f32 v128, v128, v141
    v_mul_f32 v129, v129, v141
    v_mul_f32 v130, v130, v141
    v_mul_f32 v131, v131, v141
    v_accvgpr_write_b32 a16, v128
    v_accvgpr_write_b32 a17, v129
    v_accvgpr_write_b32 a18, v130
    v_accvgpr_write_b32 a19, v131
    v_accvgpr_read_b32 v128, a20
    v_accvgpr_read_b32 v129, a21
    v_accvgpr_read_b32 v130, a22
    v_accvgpr_read_b32 v131, a23
    v_mul_f32 v128, v128, v141
    v_mul_f32 v129, v129, v141
    v_mul_f32 v130, v130, v141
    v_mul_f32 v131, v131, v141
    v_accvgpr_write_b32 a20, v128
    v_accvgpr_write_b32 a21, v129
    v_accvgpr_write_b32 a22, v130
    v_accvgpr_write_b32 a23, v131
    v_accvgpr_read_b32 v128, a24
    v_accvgpr_read_b32 v129, a25
    v_accvgpr_read_b32 v130, a26
    v_accvgpr_read_b32 v131, a27
    v_mul_f32 v128, v128, v141
    v_mul_f32 v129, v129, v141
    v_mul_f32 v130, v130, v141
    v_mul_f32 v131, v131, v141
    v_accvgpr_write_b32 a24, v128
    v_accvgpr_write_b32 a25, v129
    v_accvgpr_write_b32 a26, v130
    v_accvgpr_write_b32 a27, v131
    v_accvgpr_read_b32 v128, a28
    v_accvgpr_read_b32 v129, a29
    v_accvgpr_read_b32 v130, a30
    v_accvgpr_read_b32 v131, a31
    v_mul_f32 v128, v128, v141
    v_mul_f32 v129, v129, v141
    v_mul_f32 v130, v130, v141
    v_mul_f32 v131, v131, v141
    v_accvgpr_write_b32 a28, v128
    v_accvgpr_write_b32 a29, v129
    v_accvgpr_write_b32 a30, v130
    v_accvgpr_write_b32 a31, v131
    v_accvgpr_read_b32 v128, a32
    v_accvgpr_read_b32 v129, a33
    v_accvgpr_read_b32 v130, a34
    v_accvgpr_read_b32 v131, a35
    v_mul_f32 v128, v128, v141
    v_mul_f32 v129, v129, v141
    v_mul_f32 v130, v130, v141
    v_mul_f32 v131, v131, v141
    v_accvgpr_write_b32 a32, v128
    v_accvgpr_write_b32 a33, v129
    v_accvgpr_write_b32 a34, v130
    v_accvgpr_write_b32 a35, v131
    v_accvgpr_read_b32 v128, a36
    v_accvgpr_read_b32 v129, a37
    v_accvgpr_read_b32 v130, a38
    v_accvgpr_read_b32 v131, a39
    v_mul_f32 v128, v128, v141
    v_mul_f32 v129, v129, v141
    v_mul_f32 v130, v130, v141
    v_mul_f32 v131, v131, v141
    v_accvgpr_write_b32 a36, v128
    v_accvgpr_write_b32 a37, v129
    v_accvgpr_write_b32 a38, v130
    v_accvgpr_write_b32 a39, v131
    v_accvgpr_read_b32 v128, a40
    v_accvgpr_read_b32 v129, a41
    v_accvgpr_read_b32 v130, a42
    v_accvgpr_read_b32 v131, a43
    v_mul_f32 v128, v128, v141
    v_mul_f32 v129, v129, v141
    v_mul_f32 v130, v130, v141
    v_mul_f32 v131, v131, v141
    v_accvgpr_write_b32 a40, v128
    v_accvgpr_write_b32 a41, v129
    v_accvgpr_write_b32 a42, v130
    v_accvgpr_write_b32 a43, v131
    v_accvgpr_read_b32 v128, a44
    v_accvgpr_read_b32 v129, a45
    v_accvgpr_read_b32 v130, a46
    v_accvgpr_read_b32 v131, a47
    v_mul_f32 v128, v128, v141
    v_mul_f32 v129, v129, v141
    v_mul_f32 v130, v130, v141
    v_mul_f32 v131, v131, v141
    v_accvgpr_write_b32 a44, v128
    v_accvgpr_write_b32 a45, v129
    v_accvgpr_write_b32 a46, v130
    v_accvgpr_write_b32 a47, v131
    v_accvgpr_read_b32 v128, a48
    v_accvgpr_read_b32 v129, a49
    v_accvgpr_read_b32 v130, a50
    v_accvgpr_read_b32 v131, a51
    v_mul_f32 v128, v128, v141
    v_mul_f32 v129, v129, v141
    v_mul_f32 v130, v130, v141
    v_mul_f32 v131, v131, v141
    v_accvgpr_write_b32 a48, v128
    v_accvgpr_write_b32 a49, v129
    v_accvgpr_write_b32 a50, v130
    v_accvgpr_write_b32 a51, v131
    v_accvgpr_read_b32 v128, a52
    v_accvgpr_read_b32 v129, a53
    v_accvgpr_read_b32 v130, a54
    v_accvgpr_read_b32 v131, a55
    v_mul_f32 v128, v128, v141
    v_mul_f32 v129, v129, v141
    v_mul_f32 v130, v130, v141
    v_mul_f32 v131, v131, v141
    v_accvgpr_write_b32 a52, v128
    v_accvgpr_write_b32 a53, v129
    v_accvgpr_write_b32 a54, v130
    v_accvgpr_write_b32 a55, v131
    v_accvgpr_read_b32 v128, a56
    v_accvgpr_read_b32 v129, a57
    v_accvgpr_read_b32 v130, a58
    v_accvgpr_read_b32 v131, a59
    v_mul_f32 v128, v128, v141
    v_mul_f32 v129, v129, v141
    v_mul_f32 v130, v130, v141
    v_mul_f32 v131, v131, v141
    v_accvgpr_write_b32 a56, v128
    v_accvgpr_write_b32 a57, v129
    v_accvgpr_write_b32 a58, v130
    v_accvgpr_write_b32 a59, v131
    v_accvgpr_read_b32 v128, a60
    v_accvgpr_read_b32 v129, a61
    v_accvgpr_read_b32 v130, a62
    v_accvgpr_read_b32 v131, a63
    v_mul_f32 v128, v128, v141
    v_mul_f32 v129, v129, v141
    v_mul_f32 v130, v130, v141
    v_mul_f32 v131, v131, v141
    v_accvgpr_write_b32 a60, v128
    v_accvgpr_write_b32 a61, v129
    v_accvgpr_write_b32 a62, v130
    v_accvgpr_write_b32 a63, v131
    v_max3_f32 v140, v48, v49, v50
    v_max3_f32 v140, v140, v51, v52
    v_max3_f32 v140, v140, v53, v54
    v_max3_f32 v140, v140, v55, v56
    v_max3_f32 v140, v140, v57, v58
    v_max3_f32 v140, v140, v59, v60
    v_max3_f32 v140, v140, v61, v62
    v_max_f32 v140, v140, v63
    v_mov_b32 v141, v140
    s_nop 1
    v_permlane32_swap_b32 v140, v141
    s_nop 1
    v_max_f32 v140, v140, v141
    v_max_f32 v140, 0, v140
    v_sub_f32 v48, v48, v140
    v_sub_f32 v16, v16, v140
    v_sub_f32 v112, v112, v140
    v_sub_f32 v49, v49, v140
    v_sub_f32 v17, v17, v140
    v_sub_f32 v113, v113, v140
    v_sub_f32 v50, v50, v140
    v_sub_f32 v18, v18, v140
    v_sub_f32 v114, v114, v140
    v_sub_f32 v51, v51, v140
    v_sub_f32 v19, v19, v140
    v_sub_f32 v115, v115, v140
    v_sub_f32 v52, v52, v140
    v_sub_f32 v20, v20, v140
    v_sub_f32 v116, v116, v140
    v_sub_f32 v53, v53, v140
    v_sub_f32 v21, v21, v140
    v_sub_f32 v117, v117, v140
    v_sub_f32 v54, v54, v140
    v_sub_f32 v22, v22, v140
    v_sub_f32 v118, v118, v140
    v_sub_f32 v55, v55, v140
    v_sub_f32 v23, v23, v140
    v_sub_f32 v119, v119, v140
    v_sub_f32 v56, v56, v140
    v_sub_f32 v24, v24, v140
    v_sub_f32 v120, v120, v140
    v_sub_f32 v57, v57, v140
    v_sub_f32 v25, v25, v140
    v_sub_f32 v121, v121, v140
    v_sub_f32 v58, v58, v140
    v_sub_f32 v26, v26, v140
    v_sub_f32 v122, v122, v140
    v_sub_f32 v59, v59, v140
    v_sub_f32 v27, v27, v140
    v_sub_f32 v123, v123, v140
    v_sub_f32 v60, v60, v140
    v_sub_f32 v28, v28, v140
    v_sub_f32 v124, v124, v140
    v_sub_f32 v61, v61, v140
    v_sub_f32 v29, v29, v140
    v_sub_f32 v125, v125, v140
    v_sub_f32 v62, v62, v140
    v_sub_f32 v30, v30, v140
    v_sub_f32 v126, v126, v140
    v_sub_f32 v63, v63, v140
    v_sub_f32 v31, v31, v140
    v_sub_f32 v127, v127, v140
    v_sub_f32 v141, 0, v140
    v_exp_f32 v141, v141
    s_nop 0
    v_mul_f32 v137, v137, v141
    v_accvgpr_read_b32 v128, a64
    v_accvgpr_read_b32 v129, a65
    v_accvgpr_read_b32 v130, a66
    v_accvgpr_read_b32 v131, a67
    v_mul_f32 v128, v128, v141
    v_mul_f32 v129, v129, v141
    v_mul_f32 v130, v130, v141
    v_mul_f32 v131, v131, v141
    v_accvgpr_write_b32 a64, v128
    v_accvgpr_write_b32 a65, v129
    v_accvgpr_write_b32 a66, v130
    v_accvgpr_write_b32 a67, v131
    v_accvgpr_read_b32 v128, a68
    v_accvgpr_read_b32 v129, a69
    v_accvgpr_read_b32 v130, a70
    v_accvgpr_read_b32 v131, a71
    v_mul_f32 v128, v128, v141
    v_mul_f32 v129, v129, v141
    v_mul_f32 v130, v130, v141
    v_mul_f32 v131, v131, v141
    v_accvgpr_write_b32 a68, v128
    v_accvgpr_write_b32 a69, v129
    v_accvgpr_write_b32 a70, v130
    v_accvgpr_write_b32 a71, v131
    v_accvgpr_read_b32 v128, a72
    v_accvgpr_read_b32 v129, a73
    v_accvgpr_read_b32 v130, a74
    v_accvgpr_read_b32 v131, a75
    v_mul_f32 v128, v128, v141
    v_mul_f32 v129, v129, v141
    v_mul_f32 v130, v130, v141
    v_mul_f32 v131, v131, v141
    v_accvgpr_write_b32 a72, v128
    v_accvgpr_write_b32 a73, v129
    v_accvgpr_write_b32 a74, v130
    v_accvgpr_write_b32 a75, v131
    v_accvgpr_read_b32 v128, a76
    v_accvgpr_read_b32 v129, a77
    v_accvgpr_read_b32 v130, a78
    v_accvgpr_read_b32 v131, a79
    v_mul_f32 v128, v128, v141
    v_mul_f32 v129, v129, v141
    v_mul_f32 v130, v130, v141
    v_mul_f32 v131, v131, v141
    v_accvgpr_write_b32 a76, v128
    v_accvgpr_write_b32 a77, v129
    v_accvgpr_write_b32 a78, v130
    v_accvgpr_write_b32 a79, v131
    v_accvgpr_read_b32 v128, a80
    v_accvgpr_read_b32 v129, a81
    v_accvgpr_read_b32 v130, a82
    v_accvgpr_read_b32 v131, a83
    v_mul_f32 v128, v128, v141
    v_mul_f32 v129, v129, v141
    v_mul_f32 v130, v130, v141
    v_mul_f32 v131, v131, v141
    v_accvgpr_write_b32 a80, v128
    v_accvgpr_write_b32 a81, v129
    v_accvgpr_write_b32 a82, v130
    v_accvgpr_write_b32 a83, v131
    v_accvgpr_read_b32 v128, a84
    v_accvgpr_read_b32 v129, a85
    v_accvgpr_read_b32 v130, a86
    v_accvgpr_read_b32 v131, a87
    v_mul_f32 v128, v128, v141
    v_mul_f32 v129, v129, v141
    v_mul_f32 v130, v130, v141
    v_mul_f32 v131, v131, v141
    v_accvgpr_write_b32 a84, v128
    v_accvgpr_write_b32 a85, v129
    v_accvgpr_write_b32 a86, v130
    v_accvgpr_write_b32 a87, v131
    v_accvgpr_read_b32 v128, a88
    v_accvgpr_read_b32 v129, a89
    v_accvgpr_read_b32 v130, a90
    v_accvgpr_read_b32 v131, a91
    v_mul_f32 v128, v128, v141
    v_mul_f32 v129, v129, v141
    v_mul_f32 v130, v130, v141
    v_mul_f32 v131, v131, v141
    v_accvgpr_write_b32 a88, v128
    v_accvgpr_write_b32 a89, v129
    v_accvgpr_write_b32 a90, v130
    v_accvgpr_write_b32 a91, v131
    v_accvgpr_read_b32 v128, a92
    v_accvgpr_read_b32 v129, a93
    v_accvgpr_read_b32 v130, a94
    v_accvgpr_read_b32 v131, a95
    v_mul_f32 v128, v128, v141
    v_mul_f32 v129, v129, v141
    v_mul_f32 v130, v130, v141
    v_mul_f32 v131, v131, v141
    v_accvgpr_write_b32 a92, v128
    v_accvgpr_write_b32 a93, v129
    v_accvgpr_write_b32 a94, v130
    v_accvgpr_write_b32 a95, v131
    v_accvgpr_read_b32 v128, a96
    v_accvgpr_read_b32 v129, a97
    v_accvgpr_read_b32 v130, a98
    v_accvgpr_read_b32 v131, a99
    v_mul_f32 v128, v128, v141
    v_mul_f32 v129, v129, v141
    v_mul_f32 v130, v130, v141
    v_mul_f32 v131, v131, v141
    v_accvgpr_write_b32 a96, v128
    v_accvgpr_write_b32 a97, v129
    v_accvgpr_write_b32 a98, v130
    v_accvgpr_write_b32 a99, v131
    v_accvgpr_read_b32 v128, a100
    v_accvgpr_read_b32 v129, a101
    v_accvgpr_read_b32 v130, a102
    v_accvgpr_read_b32 v131, a103
    v_mul_f32 v128, v128, v141
    v_mul_f32 v129, v129, v141
    v_mul_f32 v130, v130, v141
    v_mul_f32 v131, v131, v141
    v_accvgpr_write_b32 a100, v128
    v_accvgpr_write_b32 a101, v129
    v_accvgpr_write_b32 a102, v130
    v_accvgpr_write_b32 a103, v131
    v_accvgpr_read_b32 v128, a104
    v_accvgpr_read_b32 v129, a105
    v_accvgpr_read_b32 v130, a106
    v_accvgpr_read_b32 v131, a107
    v_mul_f32 v128, v128, v141
    v_mul_f32 v129, v129, v141
    v_mul_f32 v130, v130, v141
    v_mul_f32 v131, v131, v141
    v_accvgpr_write_b32 a104, v128
    v_accvgpr_write_b32 a105, v129
    v_accvgpr_write_b32 a106, v130
    v_accvgpr_write_b32 a107, v131
    v_accvgpr_read_b32 v128, a108
    v_accvgpr_read_b32 v129, a109
    v_accvgpr_read_b32 v130, a110
    v_accvgpr_read_b32 v131, a111
    v_mul_f32 v128, v128, v141
    v_mul_f32 v129, v129, v141
    v_mul_f32 v130, v130, v141
    v_mul_f32 v131, v131, v141
    v_accvgpr_write_b32 a108, v128
    v_accvgpr_write_b32 a109, v129
    v_accvgpr_write_b32 a110, v130
    v_accvgpr_write_b32 a111, v131
    v_accvgpr_read_b32 v128, a112
    v_accvgpr_read_b32 v129, a113
    v_accvgpr_read_b32 v130, a114
    v_accvgpr_read_b32 v131, a115
    v_mul_f32 v128, v128, v141
    v_mul_f32 v129, v129, v141
    v_mul_f32 v130, v130, v141
    v_mul_f32 v131, v131, v141
    v_accvgpr_write_b32 a112, v128
    v_accvgpr_write_b32 a113, v129
    v_accvgpr_write_b32 a114, v130
    v_accvgpr_write_b32 a115, v131
    v_accvgpr_read_b32 v128, a116
    v_accvgpr_read_b32 v129, a117
    v_accvgpr_read_b32 v130, a118
    v_accvgpr_read_b32 v131, a119
    v_mul_f32 v128, v128, v141
    v_mul_f32 v129, v129, v141
    v_mul_f32 v130, v130, v141
    v_mul_f32 v131, v131, v141
    v_accvgpr_write_b32 a116, v128
    v_accvgpr_write_b32 a117, v129
    v_accvgpr_write_b32 a118, v130
    v_accvgpr_write_b32 a119, v131
    v_accvgpr_read_b32 v128, a120
    v_accvgpr_read_b32 v129, a121
    v_accvgpr_read_b32 v130, a122
    v_accvgpr_read_b32 v131, a123
    v_mul_f32 v128, v128, v141
    v_mul_f32 v129, v129, v141
    v_mul_f32 v130, v130, v141
    v_mul_f32 v131, v131, v141
    v_accvgpr_write_b32 a120, v128
    v_accvgpr_write_b32 a121, v129
    v_accvgpr_write_b32 a122, v130
    v_accvgpr_write_b32 a123, v131
    v_accvgpr_read_b32 v128, a124
    v_accvgpr_read_b32 v129, a125
    v_accvgpr_read_b32 v130, a126
    v_accvgpr_read_b32 v131, a127
    v_mul_f32 v128, v128, v141
    v_mul_f32 v129, v129, v141
    v_mul_f32 v130, v130, v141
    v_mul_f32 v131, v131, v141
    v_accvgpr_write_b32 a124, v128
    v_accvgpr_write_b32 a125, v129
    v_accvgpr_write_b32 a126, v130
    v_accvgpr_write_b32 a127, v131
    v_exp_f32 v128, v32
    s_nop 0
    v_exp_f32 v129, v33
    s_nop 0
    v_exp_f32 v130, v34
    v_add_f32 v138, v128, v129
    v_cvt_pk_bf16_f32 v80, v128, v129
    s_nop 0
    v_exp_f32 v131, v35
    v_add_f32 v138, v138, v130
    s_nop 0
    v_exp_f32 v132, v36
    v_add_f32 v138, v138, v131
    v_cvt_pk_bf16_f32 v81, v130, v131
    s_nop 0
    v_exp_f32 v133, v37
    v_add_f32 v138, v138, v132
    s_nop 0
    v_exp_f32 v134, v38
    v_add_f32 v138, v138, v133
    v_cvt_pk_bf16_f32 v82, v132, v133
    s_nop 0
    v_exp_f32 v135, v39
    v_add_f32 v138, v138, v134
    s_nop 0
    v_exp_f32 v128, v40
    v_add_f32 v138, v138, v135
    v_cvt_pk_bf16_f32 v83, v134, v135
    s_nop 0
    v_exp_f32 v129, v41
    v_add_f32 v138, v138, v128
    s_nop 0
    v_exp_f32 v130, v42
    v_add_f32 v138, v138, v129
    v_cvt_pk_bf16_f32 v84, v128, v129
    s_nop 0
    v_exp_f32 v131, v43
    v_add_f32 v138, v138, v130
    s_nop 0
    v_exp_f32 v132, v44
    v_add_f32 v138, v138, v131
    v_cvt_pk_bf16_f32 v85, v130, v131
    s_nop 0
    v_exp_f32 v133, v45
    v_add_f32 v138, v138, v132
    s_nop 0
    v_exp_f32 v134, v46
    v_add_f32 v138, v138, v133
    v_cvt_pk_bf16_f32 v86, v132, v133
    s_nop 0
    v_exp_f32 v135, v47
    v_add_f32 v138, v138, v134
    s_nop 0
    v_exp_f32 v128, v48
    v_add_f32 v138, v138, v135
    v_cvt_pk_bf16_f32 v87, v134, v135
    s_nop 0
    v_exp_f32 v129, v49
    s_nop 0
    v_exp_f32 v130, v50
    v_add_f32 v139, v128, v129
    v_cvt_pk_bf16_f32 v88, v128, v129
    s_nop 0
    v_exp_f32 v131, v51
    v_add_f32 v139, v139, v130
    s_nop 0
    v_exp_f32 v132, v52
    v_add_f32 v139, v139, v131
    v_cvt_pk_bf16_f32 v89, v130, v131
    s_nop 0
    v_exp_f32 v133, v53
    v_add_f32 v139, v139, v132
    s_nop 0
    v_exp_f32 v134, v54
    v_add_f32 v139, v139, v133
    v_cvt_pk_bf16_f32 v90, v132, v133
    s_nop 0
    v_exp_f32 v135, v55
    v_add_f32 v139, v139, v134
    s_nop 0
    v_exp_f32 v128, v56
    v_add_f32 v139, v139, v135
    v_cvt_pk_bf16_f32 v91, v134, v135
    s_nop 0
    v_exp_f32 v129, v57
    v_add_f32 v139, v139, v128
    s_nop 0
    v_exp_f32 v130, v58
    v_add_f32 v139, v139, v129
    v_cvt_pk_bf16_f32 v92, v128, v129
    s_nop 0
    v_exp_f32 v131, v59
    v_add_f32 v139, v139, v130
    s_nop 0
    v_exp_f32 v132, v60
    v_add_f32 v139, v139, v131
    v_cvt_pk_bf16_f32 v93, v130, v131
    s_nop 0
    v_exp_f32 v133, v61
    v_add_f32 v139, v139, v132
    s_nop 0
    v_exp_f32 v134, v62
    v_add_f32 v139, v139, v133
    v_cvt_pk_bf16_f32 v94, v132, v133
    s_nop 0
    v_exp_f32 v135, v63
    v_add_f32 v139, v139, v134
    s_nop 0
    v_add_f32 v139, v139, v135
    v_cvt_pk_bf16_f32 v95, v134, v135
    s_nop 0
    s_nop 1
    s_setpc_b64 s[48:49]
.section .rodata,"a"
.p2align 6
.amdhsa_kernel k2_attn_kernel
  .amdhsa_next_free_vgpr 512
  .amdhsa_next_free_sgpr 96
  .amdhsa_accum_offset 256
  .amdhsa_group_segment_fixed_size 0
  .amdhsa_kernarg_size 112
  .amdhsa_user_sgpr_count 2
  .amdhsa_user_sgpr_kernarg_segment_ptr 1
  .amdhsa_system_sgpr_workgroup_id_x 1
.end_amdhsa_kernel
.text
.globl k3_oproj_kernel
.p2align 8
.type k3_oproj_kernel,@function
k3_oproj_kernel:
    s_cmp_ge_u32 s2, 240
    s_cbranch_scc1 k3_oproj_kernel_end
    s_load_dwordx2 s[4:5], s[0:1], 32
    s_load_dwordx2 s[6:7], s[0:1], 104
    v_and_b32 v1, 63, v0
    v_lshrrev_b32 v6, 6, v0
    s_nop 0
    v_readfirstlane_b32 s40, v6
    v_lshrrev_b32 v2, 5, v1
    v_bfe_u32 v3, v1, 2, 2
    v_bfe_u32 v4, v1, 4, 1
    v_and_b32 v5, 1, v1
    v_lshlrev_b32 v5, 4, v5
    v_bfe_u32 v6, v1, 1, 1
    v_lshl_add_u32 v5, v6, 3, v5
    s_and_b32 s10, s2, 7
    s_lshr_b32 s11, s2, 3
    s_mul_hi_u32 s12, s11, 0x55555556
    s_mul_i32 s13, s12, 3
    s_sub_u32 s11, s11, s13
    s_mul_i32 s10, s10, 10
    s_add_u32 s10, s10, s12
    s_lshr_b32 s12, s10, 4
    s_and_b32 s10, s10, 15
    s_and_b32 s16, s40, 3
    s_lshr_b32 s18, s40, 2
    s_lshl_b32 s14, s10, 2
    s_add_u32 s14, s14, s16
    s_mul_i32 s15, s11, 384
    s_mul_i32 s17, s18, 192
    s_add_u32 s15, s15, s17
    s_mul_i32 s17, s16, 3
    s_add_u32 s17, s17, 0
    s_lshl_b32 s19, s17, 6
    v_add_u32 v7, s19, v1
    v_mul_u32_u24 v8, 43691, v7
    v_lshrrev_b32 v8, 19, v8
    v_mul_u32_u24 v9, 12, v8
    v_sub_u32 v9, v7, v9
    v_mul_u32_u24 v8, 1152, v8
    v_lshl_add_u32 v8, v9, 4, v8
    v_add_u32 v10, s15, v8
    s_lshl_b32 s17, s17, 10
    s_mul_i32 s19, s18, 12288
    s_add_u32 s44, s17, s19
    s_mul_i32 s17, s16, 3
    s_add_u32 s17, s17, 1
    s_lshl_b32 s19, s17, 6
    v_add_u32 v7, s19, v1
    v_mul_u32_u24 v8, 43691, v7
    v_lshrrev_b32 v8, 19, v8
    v_mul_u32_u24 v9, 12, v8
    v_sub_u32 v9, v7, v9
    v_mul_u32_u24 v8, 1152, v8
    v_lshl_add_u32 v8, v9, 4, v8
    v_add_u32 v11, s15, v8
    s_lshl_b32 s17, s17, 10
    s_mul_i32 s19, s18, 12288
    s_add_u32 s45, s17, s19
    s_mul_i32 s17, s16, 3
    s_add_u32 s17, s17, 2
    s_lshl_b32 s19, s17, 6
    v_add_u32 v7, s19, v1
    v_mul_u32_u24 v8, 43691, v7
    v_lshrrev_b32 v8, 19, v8
    v_mul_u32_u24 v9, 12, v8
    v_sub_u32 v9, v7, v9
    v_mul_u32_u24 v8, 1152, v8
    v_lshl_add_u32 v8, v9, 4, v8
    v_add_u32 v12, s15, v8
    s_lshl_b32 s17, s17, 10
    s_mul_i32 s19, s18, 12288
    s_add_u32 s46, s17, s19
    s_lshr_b32 s17, s40, 1
    s_lshl_b32 s19, s10, 2
    s_add_u32 s17, s17, s19
    s_mul_i32 s17, s17, 262144
    s_and_b32 s19, s40, 1
    s_lshl_b32 s19, s19, 11
    s_add_u32 s17, s17, s19
    v_lshlrev_b32 v13, 4, v1
    v_add_u32 v13, s17, v13
    s_lshl_b32 s47, s40, 11
    s_add_u32 s47, s47, 24576
    v_lshl_add_u32 v7, v2, 3, v3
    v_mul_u32_u24 v7, 192, v7
    v_lshl_add_u32 v7, v4, 5, v7
    v_add_u32 v7, v7, v5
    s_mul_i32 s19, s18, 12288
    v_add_u32 v14, s19, v7
    v_add_u32 v15, 81920, v14
    s_lshl_b32 s19, s16, 12
    s_add_u32 s19, s19, 24576
    v_lshlrev_b32 v7, 4, v1
    v_add_u32 v8, s19, v7
    v_add_u32 v9, 81920, v8
    s_mul_i32 s48, s12, 53248
    s_mul_i32 s49, s12, 958464
    s_waitcnt lgkmcnt(0)
    s_add_u32 s20, s4, 0
    s_addc_u32 s21, s5, 0
    s_mov_b32 s22, 4718592
    s_mov_b32 s23, 0x20000
    s_add_u32 s24, s6, 16777216
    s_addc_u32 s25, s7, 0
    s_mov_b32 s26, 16777216
    s_mov_b32 s27, 0x20000
    s_add_u32 s28, s6, 67108864
    s_addc_u32 s29, s7, 0
    s_mov_b32 s30, 11796480
    s_mov_b32 s31, 0x20000
    s_add_u32 m0, s47, 0
    s_add_u32 s34, s48, 0
    buffer_load_dwordx4 v13, s[24:27], s34 offen lds
    buffer_load_dwordx4 v13, s[24:27], s34 offen offset:1024 lds
    s_add_u32 m0, s44, 0
    s_add_u32 s33, s49, 0
    buffer_load_dwordx4 v10, s[20:23], s33 offen lds
    s_add_u32 m0, s45, 0
    s_nop 0
    buffer_load_dwordx4 v11, s[20:23], s33 offen lds
    s_add_u32 m0, s46, 0
    s_nop 0
    buffer_load_dwordx4 v12, s[20:23], s33 offen lds
    s_add_u32 m0, s47, 40960
    s_add_u32 s34, s48, 4096
    buffer_load_dwordx4 v13, s[24:27], s34 offen lds
    buffer_load_dwordx4 v13, s[24:27], s34 offen offset:1024 lds
    s_add_u32 m0, s44, 40960
    s_add_u32 s33, s49, 73728
    buffer_load_dwordx4 v10, s[20:23], s33 offen lds
    s_add_u32 m0, s45, 40960
    s_nop 0
    buffer_load_dwordx4 v11, s[20:23], s33 offen lds
    s_add_u32 m0, s46, 40960
    s_nop 0
    buffer_load_dwordx4 v12, s[20:23], s33 offen lds
    s_waitcnt vmcnt(5)
    s_barrier
    ds_read_b128 v[64:67], v8 offset:0
    ds_read_b64_tr_b16 v[80:81], v14 offset:0
    ds_read_b64_tr_b16 v[82:83], v14 offset:768
    ds_read_b64_tr_b16 v[84:85], v14 offset:64
    ds_read_b64_tr_b16 v[86:87], v14 offset:832
    ds_read_b64_tr_b16 v[88:89], v14 offset:128
    ds_read_b64_tr_b16 v[90:91], v14 offset:896
    ds_read_b128 v[68:71], v8 offset:1024
    ds_read_b64_tr_b16 v[92:93], v14 offset:3072
    ds_read_b64_tr_b16 v[94:95], v14 offset:3840
    ds_read_b64_tr_b16 v[96:97], v14 offset:3136
    ds_read_b64_tr_b16 v[98:99], v14 offset:3904
    ds_read_b64_tr_b16 v[100:101], v14 offset:3200
    ds_read_b64_tr_b16 v[102:103], v14 offset:3968
    s_add_u32 m0, s47, 81920
    s_add_u32 s34, s48, 8192
    buffer_load_dwordx4 v13, s[24:27], s34 offen lds
    s_waitcnt lgkmcnt(11)
    v_mfma_f32_32x32x16_bf16 v[16:31], v[80:83], v[64:67], 0
    ds_read_b128 v[72:75], v8 offset:2048
    ds_read_b64_tr_b16 v[104:105], v14 offset:6144
    ds_read_b64_tr_b16 v[106:107], v14 offset:6912
    buffer_load_dwordx4 v13, s[24:27], s34 offen offset:1024 lds
    s_waitcnt lgkmcnt(12)
    v_mfma_f32_32x32x16_bf16 v[32:47], v[84:87], v[64:67], 0
    ds_read_b64_tr_b16 v[108:109], v14 offset:6208
    ds_read_b64_tr_b16 v[110:111], v14 offset:6976
    s_add_u32 m0, s44, 81920
    s_add_u32 s33, s49, 147456
    buffer_load_dwordx4 v10, s[20:23], s33 offen lds
    s_waitcnt lgkmcnt(12)
    v_mfma_f32_32x32x16_bf16 v[48:63], v[88:91], v[64:67], 0
    ds_read_b64_tr_b16 v[80:81], v14 offset:6272
    ds_read_b64_tr_b16 v[82:83], v14 offset:7040
    s_add_u32 m0, s45, 81920
    s_nop 0
    buffer_load_dwordx4 v11, s[20:23], s33 offen lds
    s_waitcnt lgkmcnt(11)
    v_mfma_f32_32x32x16_bf16 v[16:31], v[92:95], v[68:71], v[16:31]
    ds_read_b128 v[76:79], v8 offset:3072
    ds_read_b64_tr_b16 v[84:85], v14 offset:9216
    ds_read_b64_tr_b16 v[86:87], v14 offset:9984
    s_add_u32 m0, s46, 81920
    s_nop 0
    buffer_load_dwordx4 v12, s[20:23], s33 offen lds
    s_waitcnt lgkmcnt(12)
    v_mfma_f32_32x32x16_bf16 v[32:47], v[96:99], v[68:71], v[32:47]
    ds_read_b64_tr_b16 v[88:89], v14 offset:9280
    ds_read_b64_tr_b16 v[90:91], v14 offset:10048
    s_waitcnt lgkmcnt(12)
    v_mfma_f32_32x32x16_bf16 v[48:63], v[100:103], v[68:71], v[48:63]
    ds_read_b64_tr_b16 v[92:93], v14 offset:9344
    ds_read_b64_tr_b16 v[94:95], v14 offset:10112
    s_waitcnt lgkmcnt(11)
    v_mfma_f32_32x32x16_bf16 v[16:31], v[104:107], v[72:75], v[16:31]
    s_waitcnt vmcnt(5)
    s_barrier
    ds_read_b128 v[64:67], v8 offset:40960
    ds_read_b64_tr_b16 v[96:97], v14 offset:40960
    ds_read_b64_tr_b16 v[98:99], v14 offset:41728
    s_waitcnt lgkmcnt(12)
    v_mfma_f32_32x32x16_bf16 v[32:47], v[108:111], v[72:75], v[32:47]
    ds_read_b64_tr_b16 v[100:101], v14 offset:41024
    ds_read_b64_tr_b16 v[102:103], v14 offset:41792
    s_waitcnt lgkmcnt(12)
    v_mfma_f32_32x32x16_bf16 v[48:63], v[80:83], v[72:75], v[48:63]
    ds_read_b64_tr_b16 v[104:105], v14 offset:41088
    ds_read_b64_tr_b16 v[106:107], v14 offset:41856
    s_waitcnt lgkmcnt(11)
    v_mfma_f32_32x32x16_bf16 v[16:31], v[84:87], v[76:79], v[16:31]
    ds_read_b128 v[68:71], v8 offset:41984
    ds_read_b64_tr_b16 v[108:109], v14 offset:44032
    ds_read_b64_tr_b16 v[110:111], v14 offset:44800
    s_waitcnt lgkmcnt(12)
    v_mfma_f32_32x32x16_bf16 v[32:47], v[88:91], v[76:79], v[32:47]
    ds_read_b64_tr_b16 v[80:81], v14 offset:44096
    ds_read_b64_tr_b16 v[82:83], v14 offset:44864
    s_add_u32 m0, s47, 122880
    s_add_u32 s34, s48, 12288
    buffer_load_dwordx4 v13, s[24:27], s34 offen lds
    s_waitcnt lgkmcnt(12)
    v_mfma_f32_32x32x16_bf16 v[48:63], v[92:95], v[76:79], v[48:63]
    ds_read_b64_tr_b16 v[84:85], v14 offset:44160
    ds_read_b64_tr_b16 v[86:87], v14 offset:44928
    buffer_load_dwordx4 v13, s[24:27], s34 offen offset:1024 lds
    s_waitcnt lgkmcnt(11)
    v_mfma_f32_32x32x16_bf16 v[16:31], v[96:99], v[64:67], v[16:31]
    ds_read_b128 v[72:75], v8 offset:43008
    ds_read_b64_tr_b16 v[88:89], v14 offset:47104
    ds_read_b64_tr_b16 v[90:91], v14 offset:47872
    s_add_u32 m0, s44, 122880
    s_add_u32 s33, s49, 221184
    buffer_load_dwordx4 v10, s[20:23], s33 offen lds
    s_waitcnt lgkmcnt(12)
    v_mfma_f32_32x32x16_bf16 v[32:47], v[100:103], v[64:67], v[32:47]
    ds_read_b64_tr_b16 v[92:93], v14 offset:47168
    ds_read_b64_tr_b16 v[94:95], v14 offset:47936
    s_add_u32 m0, s45, 122880
    s_nop 0
    buffer_load_dwordx4 v11, s[20:23], s33 offen lds
    s_waitcnt lgkmcnt(12)
    v_mfma_f32_32x32x16_bf16 v[48:63], v[104:107], v[64:67], v[48:63]
    ds_read_b64_tr_b16 v[96:97], v14 offset:47232
    ds_read_b64_tr_b16 v[98:99], v14 offset:48000
    s_add_u32 m0, s46, 122880
    s_nop 0
    buffer_load_dwordx4 v12, s[20:23], s33 offen lds
    s_waitcnt lgkmcnt(11)
    v_mfma_f32_32x32x16_bf16 v[16:31], v[108:111], v[68:71], v[16:31]
    ds_read_b128 v[76:79], v8 offset:44032
    ds_read_b64_tr_b16 v[100:101], v14 offset:50176
    ds_read_b64_tr_b16 v[102:103], v14 offset:50944
    s_waitcnt lgkmcnt(12)
    v_mfma_f32_32x32x16_bf16 v[32:47], v[80:83], v[68:71], v[32:47]
    ds_read_b64_tr_b16 v[104:105], v14 offset:50240
    ds_read_b64_tr_b16 v[106:107], v14 offset:51008
    s_waitcnt lgkmcnt(12)
    v_mfma_f32_32x32x16_bf16 v[48:63], v[84:87], v[68:71], v[48:63]
    ds_read_b64_tr_b16 v[108:109], v14 offset:50304
    ds_read_b64_tr_b16 v[110:111], v14 offset:51072
    s_waitcnt lgkmcnt(11)
    v_mfma_f32_32x32x16_bf16 v[16:31], v[88:91], v[72:75], v[16:31]
    s_waitcnt vmcnt(5)
    s_barrier
    ds_read_b128 v[64:67], v9 offset:0
    ds_read_b64_tr_b16 v[80:81], v15 offset:0
    ds_read_b64_tr_b16 v[82:83], v15 offset:768
    s_waitcnt lgkmcnt(12)
    v_mfma_f32_32x32x16_bf16 v[32:47], v[92:95], v[72:75], v[32:47]
    ds_read_b64_tr_b16 v[84:85], v15 offset:64
    ds_read_b64_tr_b16 v[86:87], v15 offset:832
    s_waitcnt lgkmcnt(12)
    v_mfma_f32_32x32x16_bf16 v[48:63], v[96:99], v[72:75], v[48:63]
    ds_read_b64_tr_b16 v[88:89], v15 offset:128
    ds_read_b64_tr_b16 v[90:91], v15 offset:896
    s_waitcnt lgkmcnt(11)
    v_mfma_f32_32x32x16_bf16 v[16:31], v[100:103], v[76:79], v[16:31]
    ds_read_b128 v[68:71], v9 offset:1024
    ds_read_b64_tr_b16 v[92:93], v15 offset:3072
    ds_read_b64_tr_b16 v[94:95], v15 offset:3840
    s_add_u32 m0, s47, 0
    s_add_u32 s34, s48, 16384
    buffer_load_dwordx4 v13, s[24:27], s34 offen lds
    s_waitcnt lgkmcnt(12)
    v_mfma_f32_32x32x16_bf16 v[32:47], v[104:107], v[76:79], v[32:47]
    ds_read_b64_tr_b16 v[96:97], v15 offset:3136
    ds_read_b64_tr_b16 v[98:99], v15 offset:3904
    buffer_load_dwordx4 v13, s[24:27], s34 offen offset:1024 lds
    s_waitcnt lgkmcnt(12)
    v_mfma_f32_32x32x16_bf16 v[48:63], v[108:111], v[76:79], v[48:63]
    ds_read_b64_tr_b16 v[100:101], v15 offset:3200
    ds_read_b64_tr_b16 v[102:103], v15 offset:3968
    s_add_u32 m0, s44, 0
    s_add_u32 s33, s49, 294912
    buffer_load_dwordx4 v10, s[20:23], s33 offen lds
    s_waitcnt lgkmcnt(11)
    v_mfma_f32_32x32x16_bf16 v[16:31], v[80:83], v[64:67], v[16:31]
    ds_read_b128 v[72:75], v9 offset:2048
    ds_read_b64_tr_b16 v[104:105], v15 offset:6144
    ds_read_b64_tr_b16 v[106:107], v15 offset:6912
    s_add_u32 m0, s45, 0
    s_nop 0
    buffer_load_dwordx4 v11, s[20:23], s33 offen lds
    s_waitcnt lgkmcnt(12)
    v_mfma_f32_32x32x16_bf16 v[32:47], v[84:87], v[64:67], v[32:47]
    ds_read_b64_tr_b16 v[108:109], v15 offset:6208
    ds_read_b64_tr_b16 v[110:111], v15 offset:6976
    s_add_u32 m0, s46, 0
    s_nop 0
    buffer_load_dwordx4 v12, s[20:23], s33 offen lds
    s_waitcnt lgkmcnt(12)
    v_mfma_f32_32x32x16_bf16 v[48:63], v[88:91], v[64:67], v[48:63]
    ds_read_b64_tr_b16 v[80:81], v15 offset:6272
    ds_read_b64_tr_b16 v[82:83], v15 offset:7040
    s_waitcnt lgkmcnt(11)
    v_mfma_f32_32x32x16_bf16 v[16:31], v[92:95], v[68:71], v[16:31]
    ds_read_b128 v[76:79], v9 offset:3072
    ds_read_b64_tr_b16 v[84:85], v15 offset:9216
    ds_read_b64_tr_b16 v[86:87], v15 offset:9984
    s_waitcnt lgkmcnt(12)
    v_mfma_f32_32x32x16_bf16 v[32:47], v[96:99], v[68:71], v[32:47]
    ds_read_b64_tr_b16 v[88:89], v15 offset:9280
    ds_read_b64_tr_b16 v[90:91], v15 offset:10048
    s_waitcnt lgkmcnt(12)
    v_mfma_f32_32x32x16_bf16 v[48:63], v[100:103], v[68:71], v[48:63]
    ds_read_b64_tr_b16 v[92:93], v15 offset:9344
    ds_read_b64_tr_b16 v[94:95], v15 offset:10112
    s_waitcnt lgkmcnt(11)
    v_mfma_f32_32x32x16_bf16 v[16:31], v[104:107], v[72:75], v[16:31]
    s_waitcnt vmcnt(5)
    s_barrier
    ds_read_b128 v[64:67], v9 offset:40960
    ds_read_b64_tr_b16 v[96:97], v15 offset:40960
    ds_read_b64_tr_b16 v[98:99], v15 offset:41728
    s_waitcnt lgkmcnt(12)
    v_mfma_f32_32x32x16_bf16 v[32:47], v[108:111], v[72:75], v[32:47]
    ds_read_b64_tr_b16 v[100:101], v15 offset:41024
    ds_read_b64_tr_b16 v[102:103], v15 offset:41792
    s_waitcnt lgkmcnt(12)
    v_mfma_f32_32x32x16_bf16 v[48:63], v[80:83], v[72:75], v[48:63]
    ds_read_b64_tr_b16 v[104:105], v15 offset:41088
    ds_read_b64_tr_b16 v[106:107], v15 offset:41856
    s_add_u32 m0, s47, 40960
    s_add_u32 s34, s48, 20480
    buffer_load_dwordx4 v13, s[24:27], s34 offen lds
    s_waitcnt lgkmcnt(11)
    v_mfma_f32_32x32x16_bf16 v[16:31], v[84:87], v[76:79], v[16:31]
    ds_read_b128 v[68:71], v9 offset:41984
    ds_read_b64_tr_b16 v[108:109], v15 offset:44032
    ds_read_b64_tr_b16 v[110:111], v15 offset:44800
    buffer_load_dwordx4 v13, s[24:27], s34 offen offset:1024 lds
    s_waitcnt lgkmcnt(12)
    v_mfma_f32_32x32x16_bf16 v[32:47], v[88:91], v[76:79], v[32:47]
    ds_read_b64_tr_b16 v[80:81], v15 offset:44096
    ds_read_b64_tr_b16 v[82:83], v15 offset:44864
    s_add_u32 m0, s44, 40960
    s_add_u32 s33, s49, 368640
    buffer_load_dwordx4 v10, s[20:23], s33 offen lds
    s_waitcnt lgkmcnt(12)
    v_mfma_f32_32x32x16_bf16 v[48:63], v[92:95], v[76:79], v[48:63]
    ds_read_b64_tr_b16 v[84:85], v15 offset:44160
    ds_read_b64_tr_b16 v[86:87], v15 offset:44928
    s_add_u32 m0, s45, 40960
    s_nop 0
    buffer_load_dwordx4 v11, s[20:23], s33 offen lds
    s_waitcnt lgkmcnt(11)
    v_mfma_f32_32x32x16_bf16 v[16:31], v[96:99], v[64:67], v[16:31]
    ds_read_b128 v[72:75], v9 offset:43008
    ds_read_b64_tr_b16 v[88:89], v15 offset:47104
    ds_read_b64_tr_b16 v[90:91], v15 offset:47872
    s_add_u32 m0, s46, 40960
    s_nop 0
    buffer_load_dwordx4 v12, s[20:23], s33 offen lds
    s_waitcnt lgkmcnt(12)
    v_mfma_f32_32x32x16_bf16 v[32:47], v[100:103], v[64:67], v[32:47]
    ds_read_b64_tr_b16 v[92:93], v15 offset:47168
    ds_read_b64_tr_b16 v[94:95], v15 offset:47936
    s_waitcnt lgkmcnt(12)
    v_mfma_f32_32x32x16_bf16 v[48:63], v[104:107], v[64:67], v[48:63]
    ds_read_b64_tr_b16 v[96:97], v15 offset:47232
    ds_read_b64_tr_b16 v[98:99], v15 offset:48000
    s_waitcnt lgkmcnt(11)
    v_mfma_f32_32x32x16_bf16 v[16:31], v[108:111], v[68:71], v[16:31]
    ds_read_b128 v[76:79], v9 offset:44032
    ds_read_b64_tr_b16 v[100:101], v15 offset:50176
    ds_read_b64_tr_b16 v[102:103], v15 offset:50944
    s_waitcnt lgkmcnt(12)
    v_mfma_f32_32x32x16_bf16 v[32:47], v[80:83], v[68:71], v[32:47]
    ds_read_b64_tr_b16 v[104:105], v15 offset:50240
    ds_read_b64_tr_b16 v[106:107], v15 offset:51008
    s_waitcnt lgkmcnt(12)
    v_mfma_f32_32x32x16_bf16 v[48:63], v[84:87], v[68:71], v[48:63]
    ds_read_b64_tr_b16 v[108:109], v15 offset:50304
    ds_read_b64_tr_b16 v[110:111], v15 offset:51072
    s_waitcnt lgkmcnt(11)
    v_mfma_f32_32x32x16_bf16 v[16:31], v[88:91], v[72:75], v[16:31]
    s_waitcnt vmcnt(5)
    s_barrier
    ds_read_b128 v[64:67], v8 offset:0
    ds_read_b64_tr_b16 v[80:81], v14 offset:0
    ds_read_b64_tr_b16 v[82:83], v14 offset:768
    s_waitcnt lgkmcnt(12)
    v_mfma_f32_32x32x16_bf16 v[32:47], v[92:95], v[72:75], v[32:47]
    ds_read_b64_tr_b16 v[84:85], v14 offset:64
    ds_read_b64_tr_b16 v[86:87], v14 offset:832
    s_add_u32 m0, s47, 81920
    s_add_u32 s34, s48, 24576
    buffer_load_dwordx4 v13, s[24:27], s34 offen lds
    s_waitcnt lgkmcnt(12)
    v_mfma_f32_32x32x16_bf16 v[48:63], v[96:99], v[72:75], v[48:63]
    ds_read_b64_tr_b16 v[88:89], v14 offset:128
    ds_read_b64_tr_b16 v[90:91], v14 offset:896
    buffer_load_dwordx4 v13, s[24:27], s34 offen offset:1024 lds
    s_waitcnt lgkmcnt(11)
    v_mfma_f32_32x32x16_bf16 v[16:31], v[100:103], v[76:79], v[16:31]
    ds_read_b128 v[68:71], v8 offset:1024
    ds_read_b64_tr_b16 v[92:93], v14 offset:3072
    ds_read_b64_tr_b16 v[94:95], v14 offset:3840
    s_add_u32 m0, s44, 81920
    s_add_u32 s33, s49, 442368
    buffer_load_dwordx4 v10, s[20:23], s33 offen lds
    s_waitcnt lgkmcnt(12)
    v_mfma_f32_32x32x16_bf16 v[32:47], v[104:107], v[76:79], v[32:47]
    ds_read_b64_tr_b16 v[96:97], v14 offset:3136
    ds_read_b64_tr_b16 v[98:99], v14 offset:3904
    s_add_u32 m0, s45, 81920
    s_nop 0
    buffer_load_dwordx4 v11, s[20:23], s33 offen lds
    s_waitcnt lgkmcnt(12)
    v_mfma_f32_32x32x16_bf16 v[48:63], v[108:111], v[76:79], v[48:63]
    ds_read_b64_tr_b16 v[100:101], v14 offset:3200
    ds_read_b64_tr_b16 v[102:103], v14 offset:3968
    s_add_u32 m0, s46, 81920
    s_nop 0
    buffer_load_dwordx4 v12, s[20:23], s33 offen lds
    s_waitcnt lgkmcnt(11)
    v_mfma_f32_32x32x16_bf16 v[16:31], v[80:83], v[64:67], v[16:31]
    ds_read_b128 v[72:75], v8 offset:2048
    ds_read_b64_tr_b16 v[104:105], v14 offset:6144
    ds_read_b64_tr_b16 v[106:107], v14 offset:6912
    s_waitcnt lgkmcnt(12)
    v_mfma_f32_32x32x16_bf16 v[32:47], v[84:87], v[64:67], v[32:47]
    ds_read_b64_tr_b16 v[108:109], v14 offset:6208
    ds_read_b64_tr_b16 v[110:111], v14 offset:6976
    s_waitcnt lgkmcnt(12)
    v_mfma_f32_32x32x16_bf16 v[48:63], v[88:91], v[64:67], v[48:63]
    ds_read_b64_tr_b16 v[80:81], v14 offset:6272
    ds_read_b64_tr_b16 v[82:83], v14 offset:7040
    s_waitcnt lgkmcnt(11)
    v_mfma_f32_32x32x16_bf16 v[16:31], v[92:95], v[68:71], v[16:31]
    ds_read_b128 v[76:79], v8 offset:3072
    ds_read_b64_tr_b16 v[84:85], v14 offset:9216
    ds_read_b64_tr_b16 v[86:87], v14 offset:9984
    s_waitcnt lgkmcnt(12)
    v_mfma_f32_32x32x16_bf16 v[32:47], v[96:99], v[68:71], v[32:47]
    ds_read_b64_tr_b16 v[88:89], v14 offset:9280
    ds_read_b64_tr_b16 v[90:91], v14 offset:10048
    s_waitcnt lgkmcnt(12)
    v_mfma_f32_32x32x16_bf16 v[48:63], v[100:103], v[68:71], v[48:63]
    ds_read_b64_tr_b16 v[92:93], v14 offset:9344
    ds_read_b64_tr_b16 v[94:95], v14 offset:10112
    s_waitcnt lgkmcnt(11)
    v_mfma_f32_32x32x16_bf16 v[16:31], v[104:107], v[72:75], v[16:31]
    s_waitcnt vmcnt(5)
    s_barrier
    ds_read_b128 v[64:67], v8 offset:40960
    ds_read_b64_tr_b16 v[96:97], v14 offset:40960
    ds_read_b64_tr_b16 v[98:99], v14 offset:41728
    s_add_u32 m0, s47, 122880
    s_add_u32 s34, s48, 28672
    buffer_load_dwordx4 v13, s[24:27], s34 offen lds
    s_waitcnt lgkmcnt(12)
    v_mfma_f32_32x32x16_bf16 v[32:47], v[108:111], v[72:75], v[32:47]
    ds_read_b64_tr_b16 v[100:101], v14 offset:41024
    ds_read_b64_tr_b16 v[102:103], v14 offset:41792
    buffer_load_dwordx4 v13, s[24:27], s34 offen offset:1024 lds
    s_waitcnt lgkmcnt(12)
    v_mfma_f32_32x32x16_bf16 v[48:63], v[80:83], v[72:75], v[48:63]
    ds_read_b64_tr_b16 v[104:105], v14 offset:41088
    ds_read_b64_tr_b16 v[106:107], v14 offset:41856
    s_add_u32 m0, s44, 122880
    s_add_u32 s33, s49, 516096
    buffer_load_dwordx4 v10, s[20:23], s33 offen lds
    s_waitcnt lgkmcnt(11)
    v_mfma_f32_32x32x16_bf16 v[16:31], v[84:87], v[76:79], v[16:31]
    ds_read_b128 v[68:71], v8 offset:41984
    ds_read_b64_tr_b16 v[108:109], v14 offset:44032
    ds_read_b64_tr_b16 v[110:111], v14 offset:44800
    s_add_u32 m0, s45, 122880
    s_nop 0
    buffer_load_dwordx4 v11, s[20:23], s33 offen lds
    s_waitcnt lgkmcnt(12)
    v_mfma_f32_32x32x16_bf16 v[32:47], v[88:91], v[76:79], v[32:47]
    ds_read_b64_tr_b16 v[80:81], v14 offset:44096
    ds_read_b64_tr_b16 v[82:83], v14 offset:44864
    s_add_u32 m0, s46, 122880
    s_nop 0
    buffer_load_dwordx4 v12, s[20:23], s33 offen lds
    s_waitcnt lgkmcnt(12)
    v_mfma_f32_32x32x16_bf16 v[48:63], v[92:95], v[76:79], v[48:63]
    ds_read_b64_tr_b16 v[84:85], v14 offset:44160
    ds_read_b64_tr_b16 v[86:87], v14 offset:44928
    s_waitcnt lgkmcnt(11)
    v_mfma_f32_32x32x16_bf16 v[16:31], v[96:99], v[64:67], v[16:31]
    ds_read_b128 v[72:75], v8 offset:43008
    ds_read_b64_tr_b16 v[88:89], v14 offset:47104
    ds_read_b64_tr_b16 v[90:91], v14 offset:47872
    s_waitcnt lgkmcnt(12)
    v_mfma_f32_32x32x16_bf16 v[32:47], v[100:103], v[64:67], v[32:47]
    ds_read_b64_tr_b16 v[92:93], v14 offset:47168
    ds_read_b64_tr_b16 v[94:95], v14 offset:47936
    s_waitcnt lgkmcnt(12)
    v_mfma_f32_32x32x16_bf16 v[48:63], v[104:107], v[64:67], v[48:63]
    ds_read_b64_tr_b16 v[96:97], v14 offset:47232
    ds_read_b64_tr_b16 v[98:99], v14 offset:48000
    s_waitcnt lgkmcnt(11)
    v_mfma_f32_32x32x16_bf16 v[16:31], v[108:111], v[68:71], v[16:31]
    ds_read_b128 v[76:79], v8 offset:44032
    ds_read_b64_tr_b16 v[100:101], v14 offset:50176
    ds_read_b64_tr_b16 v[102:103], v14 offset:50944
    s_waitcnt lgkmcnt(12)
    v_mfma_f32_32x32x16_bf16 v[32:47], v[80:83], v[68:71], v[32:47]
    ds_read_b64_tr_b16 v[104:105], v14 offset:50240
    ds_read_b64_tr_b16 v[106:107], v14 offset:51008
    s_waitcnt lgkmcnt(12)
    v_mfma_f32_32x32x16_bf16 v[48:63], v[84:87], v[68:71], v[48:63]
    ds_read_b64_tr_b16 v[108:109], v14 offset:50304
    ds_read_b64_tr_b16 v[110:111], v14 offset:51072
    s_add_u32 m0, s47, 0
    s_add_u32 s34, s48, 32768
    buffer_load_dwordx4 v13, s[24:27], s34 offen lds
    s_waitcnt lgkmcnt(11)
    v_mfma_f32_32x32x16_bf16 v[16:31], v[88:91], v[72:75], v[16:31]
    s_waitcnt vmcnt(6)
    s_barrier
    ds_read_b128 v[64:67], v9 offset:0
    ds_read_b64_tr_b16 v[80:81], v15 offset:0
    ds_read_b64_tr_b16 v[82:83], v15 offset:768
    buffer_load_dwordx4 v13, s[24:27], s34 offen offset:1024 lds
    s_waitcnt lgkmcnt(12)
    v_mfma_f32_32x32x16_bf16 v[32:47], v[92:95], v[72:75], v[32:47]
    ds_read_b64_tr_b16 v[84:85], v15 offset:64
    ds_read_b64_tr_b16 v[86:87], v15 offset:832
    s_add_u32 m0, s44, 0
    s_add_u32 s33, s49, 589824
    buffer_load_dwordx4 v10, s[20:23], s33 offen lds
    s_waitcnt lgkmcnt(12)
    v_mfma_f32_32x32x16_bf16 v[48:63], v[96:99], v[72:75], v[48:63]
    ds_read_b64_tr_b16 v[88:89], v15 offset:128
    ds_read_b64_tr_b16 v[90:91], v15 offset:896
    s_add_u32 m0, s45, 0
    s_nop 0
    buffer_load_dwordx4 v11, s[20:23], s33 offen lds
    s_waitcnt lgkmcnt(11)
    v_mfma_f32_32x32x16_bf16 v[16:31], v[100:103], v[76:79], v[16:31]
    ds_read_b128 v[68:71], v9 offset:1024
    ds_read_b64_tr_b16 v[92:93], v15 offset:3072
    ds_read_b64_tr_b16 v[94:95], v15 offset:3840
    s_add_u32 m0, s46, 0
    s_nop 0
    buffer_load_dwordx4 v12, s[20:23], s33 offen lds
    s_waitcnt lgkmcnt(12)
    v_mfma_f32_32x32x16_bf16 v[32:47], v[104:107], v[76:79], v[32:47]
    ds_read_b64_tr_b16 v[96:97], v15 offset:3136
    ds_read_b64_tr_b16 v[98:99], v15 offset:3904
    s_waitcnt lgkmcnt(12)
    v_mfma_f32_32x32x16_bf16 v[48:63], v[108:111], v[76:79], v[48:63]
    ds_read_b64_tr_b16 v[100:101], v15 offset:3200
    ds_read_b64_tr_b16 v[102:103], v15 offset:3968
    s_waitcnt lgkmcnt(11)
    v_mfma_f32_32x32x16_bf16 v[16:31], v[80:83], v[64:67], v[16:31]
    ds_read_b128 v[72:75], v9 offset:2048
    ds_read_b64_tr_b16 v[104:105], v15 offset:6144
    ds_read_b64_tr_b16 v[106:107], v15 offset:6912
    s_waitcnt lgkmcnt(12)
    v_mfma_f32_32x32x16_bf16 v[32:47], v[84:87], v[64:67], v[32:47]
    ds_read_b64_tr_b16 v[108:109], v15 offset:6208
    ds_read_b64_tr_b16 v[110:111], v15 offset:6976
    s_waitcnt lgkmcnt(12)
    v_mfma_f32_32x32x16_bf16 v[48:63], v[88:91], v[64:67], v[48:63]
    ds_read_b64_tr_b16 v[80:81], v15 offset:6272
    ds_read_b64_tr_b16 v[82:83], v15 offset:7040
    s_waitcnt lgkmcnt(11)
    v_mfma_f32_32x32x16_bf16 v[16:31], v[92:95], v[68:71], v[16:31]
    ds_read_b128 v[76:79], v9 offset:3072
    ds_read_b64_tr_b16 v[84:85], v15 offset:9216
    ds_read_b64_tr_b16 v[86:87], v15 offset:9984
    s_waitcnt lgkmcnt(12)
    v_mfma_f32_32x32x16_bf16 v[32:47], v[96:99], v[68:71], v[32:47]
    ds_read_b64_tr_b16 v[88:89], v15 offset:9280
    ds_read_b64_tr_b16 v[90:91], v15 offset:10048
    s_add_u32 m0, s47, 40960
    s_add_u32 s34, s48, 36864
    buffer_load_dwordx4 v13, s[24:27], s34 offen lds
    s_waitcnt lgkmcnt(12)
    v_mfma_f32_32x32x16_bf16 v[48:63], v[100:103], v[68:71], v[48:63]
    ds_read_b64_tr_b16 v[92:93], v15 offset:9344
    ds_read_b64_tr_b16 v[94:95], v15 offset:10112
    buffer_load_dwordx4 v13, s[24:27], s34 offen offset:1024 lds
    s_waitcnt lgkmcnt(11)
    v_mfma_f32_32x32x16_bf16 v[16:31], v[104:107], v[72:75], v[16:31]
    s_waitcnt vmcnt(7)
    s_barrier
    ds_read_b128 v[64:67], v9 offset:40960
    ds_read_b64_tr_b16 v[96:97], v15 offset:40960
    ds_read_b64_tr_b16 v[98:99], v15 offset:41728
    s_add_u32 m0, s44, 40960
    s_add_u32 s33, s49, 663552
    buffer_load_dwordx4 v10, s[20:23], s33 offen lds
    s_waitcnt lgkmcnt(12)
    v_mfma_f32_32x32x16_bf16 v[32:47], v[108:111], v[72:75], v[32:47]
    ds_read_b64_tr_b16 v[100:101], v15 offset:41024
    ds_read_b64_tr_b16 v[102:103], v15 offset:41792
    s_add_u32 m0, s45, 40960
    s_nop 0
    buffer_load_dwordx4 v11, s[20:23], s33 offen lds
    s_waitcnt lgkmcnt(12)
    v_mfma_f32_32x32x16_bf16 v[48:63], v[80:83], v[72:75], v[48:63]
    ds_read_b64_tr_b16 v[104:105], v15 offset:41088
    ds_read_b64_tr_b16 v[106:107], v15 offset:41856
    s_add_u32 m0, s46, 40960
    s_nop 0
    buffer_load_dwordx4 v12, s[20:23], s33 offen lds
    s_waitcnt lgkmcnt(11)
    v_mfma_f32_32x32x16_bf16 v[16:31], v[84:87], v[76:79], v[16:31]
    ds_read_b128 v[68:71], v9 offset:41984
    ds_read_b64_tr_b16 v[108:109], v15 offset:44032
    ds_read_b64_tr_b16 v[110:111], v15 offset:44800
    s_waitcnt lgkmcnt(12)
    v_mfma_f32_32x32x16_bf16 v[32:47], v[88:91], v[76:79], v[32:47]
    ds_read_b64_tr_b16 v[80:81], v15 offset:44096
    ds_read_b64_tr_b16 v[82:83], v15 offset:44864
    s_waitcnt lgkmcnt(12)
    v_mfma_f32_32x32x16_bf16 v[48:63], v[92:95], v[76:79], v[48:63]
    ds_read_b64_tr_b16 v[84:85], v15 offset:44160
    ds_read_b64_tr_b16 v[86:87], v15 offset:44928
    s_waitcnt lgkmcnt(11)
    v_mfma_f32_32x32x16_bf16 v[16:31], v[96:99], v[64:67], v[16:31]
    ds_read_b128 v[72:75], v9 offset:43008
    ds_read_b64_tr_b16 v[88:89], v15 offset:47104
    ds_read_b64_tr_b16 v[90:91], v15 offset:47872
    s_waitcnt lgkmcnt(12)
    v_mfma_f32_32x32x16_bf16 v[32:47], v[100:103], v[64:67], v[32:47]
    ds_read_b64_tr_b16 v[92:93], v15 offset:47168
    ds_read_b64_tr_b16 v[94:95], v15 offset:47936
    s_waitcnt lgkmcnt(12)
    v_mfma_f32_32x32x16_bf16 v[48:63], v[104:107], v[64:67], v[48:63]
    ds_read_b64_tr_b16 v[96:97], v15 offset:47232
    ds_read_b64_tr_b16 v[98:99], v15 offset:48000
    s_waitcnt lgkmcnt(11)
    v_mfma_f32_32x32x16_bf16 v[16:31], v[108:111], v[68:71], v[16:31]
    ds_read_b128 v[76:79], v9 offset:44032
    ds_read_b64_tr_b16 v[100:101], v15 offset:50176
    ds_read_b64_tr_b16 v[102:103], v15 offset:50944
    s_add_u32 m0, s47, 81920
    s_add_u32 s34, s48, 40960
    buffer_load_dwordx4 v13, s[24:27], s34 offen lds
    s_waitcnt lgkmcnt(12)
    v_mfma_f32_32x32x16_bf16 v[32:47], v[80:83], v[68:71], v[32:47]
    ds_read_b64_tr_b16 v[104:105], v15 offset:50240
    ds_read_b64_tr_b16 v[106:107], v15 offset:51008
    buffer_load_dwordx4 v13, s[24:27], s34 offen offset:1024 lds
    s_waitcnt lgkmcnt(12)
    v_mfma_f32_32x32x16_bf16 v[48:63], v[84:87], v[68:71], v[48:63]
    ds_read_b64_tr_b16 v[108:109], v15 offset:50304
    ds_read_b64_tr_b16 v[110:111], v15 offset:51072
    s_add_u32 m0, s44, 81920
    s_add_u32 s33, s49, 737280
    buffer_load_dwordx4 v10, s[20:23], s33 offen lds
    s_waitcnt lgkmcnt(11)
    v_mfma_f32_32x32x16_bf16 v[16:31], v[88:91], v[72:75], v[16:31]
    s_waitcnt vmcnt(8)
    s_barrier
    ds_read_b128 v[64:67], v8 offset:0
    ds_read_b64_tr_b16 v[80:81], v14 offset:0
    ds_read_b64_tr_b16 v[82:83], v14 offset:768
    s_add_u32 m0, s45, 81920
    s_nop 0
    buffer_load_dwordx4 v11, s[20:23], s33 offen lds
    s_waitcnt lgkmcnt(12)
    v_mfma_f32_32x32x16_bf16 v[32:47], v[92:95], v[72:75], v[32:47]
    ds_read_b64_tr_b16 v[84:85], v14 offset:64
    ds_read_b64_tr_b16 v[86:87], v14 offset:832
    s_add_u32 m0, s46, 81920
    s_nop 0
    buffer_load_dwordx4 v12, s[20:23], s33 offen lds
    s_waitcnt lgkmcnt(12)
    v_mfma_f32_32x32x16_bf16 v[48:63], v[96:99], v[72:75], v[48:63]
    ds_read_b64_tr_b16 v[88:89], v14 offset:128
    ds_read_b64_tr_b16 v[90:91], v14 offset:896
    s_waitcnt lgkmcnt(11)
    v_mfma_f32_32x32x16_bf16 v[16:31], v[100:103], v[76:79], v[16:31]
    ds_read_b128 v[68:71], v8 offset:1024
    ds_read_b64_tr_b16 v[92:93], v14 offset:3072
    ds_read_b64_tr_b16 v[94:95], v14 offset:3840
    s_waitcnt lgkmcnt(12)
    v_mfma_f32_32x32x16_bf16 v[32:47], v[104:107], v[76:79], v[32:47]
    ds_read_b64_tr_b16 v[96:97], v14 offset:3136
    ds_read_b64_tr_b16 v[98:99], v14 offset:3904
    s_waitcnt lgkmcnt(12)
    v_mfma_f32_32x32x16_bf16 v[48:63], v[108:111], v[76:79], v[48:63]
    ds_read_b64_tr_b16 v[100:101], v14 offset:3200
    ds_read_b64_tr_b16 v[102:103], v14 offset:3968
    s_waitcnt lgkmcnt(11)
    v_mfma_f32_32x32x16_bf16 v[16:31], v[80:83], v[64:67], v[16:31]
    ds_read_b128 v[72:75], v8 offset:2048
    ds_read_b64_tr_b16 v[104:105], v14 offset:6144
    ds_read_b64_tr_b16 v[106:107], v14 offset:6912
    s_waitcnt lgkmcnt(12)
    v_mfma_f32_32x32x16_bf16 v[32:47], v[84:87], v[64:67], v[32:47]
    ds_read_b64_tr_b16 v[108:109], v14 offset:6208
    ds_read_b64_tr_b16 v[110:111], v14 offset:6976
    s_waitcnt lgkmcnt(12)
    v_mfma_f32_32x32x16_bf16 v[48:63], v[88:91], v[64:67], v[48:63]
    ds_read_b64_tr_b16 v[80:81], v14 offset:6272
    ds_read_b64_tr_b16 v[82:83], v14 offset:7040
    s_add_u32 m0, s47, 122880
    s_add_u32 s34, s48, 45056
    buffer_load_dwordx4 v13, s[24:27], s34 offen lds
    s_waitcnt lgkmcnt(11)
    v_mfma_f32_32x32x16_bf16 v[16:31], v[92:95], v[68:71], v[16:31]
    ds_read_b128 v[76:79], v8 offset:3072
    ds_read_b64_tr_b16 v[84:85], v14 offset:9216
    ds_read_b64_tr_b16 v[86:87], v14 offset:9984
    buffer_load_dwordx4 v13, s[24:27], s34 offen offset:1024 lds
    s_waitcnt lgkmcnt(12)
    v_mfma_f32_32x32x16_bf16 v[32:47], v[96:99], v[68:71], v[32:47]
    ds_read_b64_tr_b16 v[88:89], v14 offset:9280
    ds_read_b64_tr_b16 v[90:91], v14 offset:10048
    s_add_u32 m0, s44, 122880
    s_add_u32 s33, s49, 811008
    buffer_load_dwordx4 v10, s[20:23], s33 offen lds
    s_waitcnt lgkmcnt(12)
    v_mfma_f32_32x32x16_bf16 v[48:63], v[100:103], v[68:71], v[48:63]
    ds_read_b64_tr_b16 v[92:93], v14 offset:9344
    ds_read_b64_tr_b16 v[94:95], v14 offset:10112
    s_add_u32 m0, s45, 122880
    s_nop 0
    buffer_load_dwordx4 v11, s[20:23], s33 offen lds
    s_waitcnt lgkmcnt(11)
    v_mfma_f32_32x32x16_bf16 v[16:31], v[104:107], v[72:75], v[16:31]
    s_waitcnt vmcnt(9)
    s_barrier
    ds_read_b128 v[64:67], v8 offset:40960
    ds_read_b64_tr_b16 v[96:97], v14 offset:40960
    ds_read_b64_tr_b16 v[98:99], v14 offset:41728
    s_add_u32 m0, s46, 122880
    s_nop 0
    buffer_load_dwordx4 v12, s[20:23], s33 offen lds
    s_waitcnt lgkmcnt(12)
    v_mfma_f32_32x32x16_bf16 v[32:47], v[108:111], v[72:75], v[32:47]
    ds_read_b64_tr_b16 v[100:101], v14 offset:41024
    ds_read_b64_tr_b16 v[102:103], v14 offset:41792
    s_waitcnt lgkmcnt(12)
    v_mfma_f32_32x32x16_bf16 v[48:63], v[80:83], v[72:75], v[48:63]
    ds_read_b64_tr_b16 v[104:105], v14 offset:41088
    ds_read_b64_tr_b16 v[106:107], v14 offset:41856
    s_waitcnt lgkmcnt(11)
    v_mfma_f32_32x32x16_bf16 v[16:31], v[84:87], v[76:79], v[16:31]
    ds_read_b128 v[68:71], v8 offset:41984
    ds_read_b64_tr_b16 v[108:109], v14 offset:44032
    ds_read_b64_tr_b16 v[110:111], v14 offset:44800
    s_waitcnt lgkmcnt(12)
    v_mfma_f32_32x32x16_bf16 v[32:47], v[88:91], v[76:79], v[32:47]
    ds_read_b64_tr_b16 v[80:81], v14 offset:44096
    ds_read_b64_tr_b16 v[82:83], v14 offset:44864
    s_waitcnt lgkmcnt(12)
    v_mfma_f32_32x32x16_bf16 v[48:63], v[92:95], v[76:79], v[48:63]
    ds_read_b64_tr_b16 v[84:85], v14 offset:44160
    ds_read_b64_tr_b16 v[86:87], v14 offset:44928
    s_waitcnt lgkmcnt(11)
    v_mfma_f32_32x32x16_bf16 v[16:31], v[96:99], v[64:67], v[16:31]
    ds_read_b128 v[72:75], v8 offset:43008
    ds_read_b64_tr_b16 v[88:89], v14 offset:47104
    ds_read_b64_tr_b16 v[90:91], v14 offset:47872
    s_waitcnt lgkmcnt(12)
    v_mfma_f32_32x32x16_bf16 v[32:47], v[100:103], v[64:67], v[32:47]
    ds_read_b64_tr_b16 v[92:93], v14 offset:47168
    ds_read_b64_tr_b16 v[94:95], v14 offset:47936
    s_add_u32 m0, s47, 0
    s_add_u32 s34, s48, 49152
    buffer_load_dwordx4 v13, s[24:27], s34 offen lds
    s_waitcnt lgkmcnt(12)
    v_mfma_f32_32x32x16_bf16 v[48:63], v[104:107], v[64:67], v[48:63]
    ds_read_b64_tr_b16 v[96:97], v14 offset:47232
    ds_read_b64_tr_b16 v[98:99], v14 offset:48000
    buffer_load_dwordx4 v13, s[24:27], s34 offen offset:1024 lds
    s_waitcnt lgkmcnt(11)
    v_mfma_f32_32x32x16_bf16 v[16:31], v[108:111], v[68:71], v[16:31]
    ds_read_b128 v[76:79], v8 offset:44032
    ds_read_b64_tr_b16 v[100:101], v14 offset:50176
    ds_read_b64_tr_b16 v[102:103], v14 offset:50944
    s_add_u32 m0, s44, 0
    s_add_u32 s33, s49, 884736
    buffer_load_dwordx4 v10, s[20:23], s33 offen lds
    s_waitcnt lgkmcnt(12)
    v_mfma_f32_32x32x16_bf16 v[32:47], v[80:83], v[68:71], v[32:47]
    ds_read_b64_tr_b16 v[104:105], v14 offset:50240
    ds_read_b64_tr_b16 v[106:107], v14 offset:51008
    s_add_u32 m0, s45, 0
    s_nop 0
    buffer_load_dwordx4 v11, s[20:23], s33 offen lds
    s_waitcnt lgkmcnt(12)
    v_mfma_f32_32x32x16_bf16 v[48:63], v[84:87], v[68:71], v[48:63]
    ds_read_b64_tr_b16 v[108:109], v14 offset:50304
    ds_read_b64_tr_b16 v[110:111], v14 offset:51072
    s_add_u32 m0, s46, 0
    s_nop 0
    buffer_load_dwordx4 v12, s[20:23], s33 offen lds
    s_waitcnt lgkmcnt(11)
    v_mfma_f32_32x32x16_bf16 v[16:31], v[88:91], v[72:75], v[16:31]
    s_waitcnt vmcnt(10)
    s_barrier
    ds_read_b128 v[64:67], v9 offset:0
    ds_read_b64_tr_b16 v[80:81], v15 offset:0
    ds_read_b64_tr_b16 v[82:83], v15 offset:768
    s_waitcnt lgkmcnt(12)
    v_mfma_f32_32x32x16_bf16 v[32:47], v[92:95], v[72:75], v[32:47]
    ds_read_b64_tr_b16 v[84:85], v15 offset:64
    ds_read_b64_tr_b16 v[86:87], v15 offset:832
    s_waitcnt lgkmcnt(12)
    v_mfma_f32_32x32x16_bf16 v[48:63], v[96:99], v[72:75], v[48:63]
    ds_read_b64_tr_b16 v[88:89], v15 offset:128
    ds_read_b64_tr_b16 v[90:91], v15 offset:896
    s_waitcnt lgkmcnt(11)
    v_mfma_f32_32x32x16_bf16 v[16:31], v[100:103], v[76:79], v[16:31]
    ds_read_b128 v[68:71], v9 offset:1024
    ds_read_b64_tr_b16 v[92:93], v15 offset:3072
    ds_read_b64_tr_b16 v[94:95], v15 offset:3840
    s_waitcnt lgkmcnt(12)
    v_mfma_f32_32x32x16_bf16 v[32:47], v[104:107], v[76:79], v[32:47]
    ds_read_b64_tr_b16 v[96:97], v15 offset:3136
    ds_read_b64_tr_b16 v[98:99], v15 offset:3904
    s_waitcnt lgkmcnt(12)
    v_mfma_f32_32x32x16_bf16 v[48:63], v[108:111], v[76:79], v[48:63]
    ds_read_b64_tr_b16 v[100:101], v15 offset:3200
    ds_read_b64_tr_b16 v[102:103], v15 offset:3968
    s_waitcnt lgkmcnt(11)
    v_mfma_f32_32x32x16_bf16 v[16:31], v[80:83], v[64:67], v[16:31]
    ds_read_b128 v[72:75], v9 offset:2048
    ds_read_b64_tr_b16 v[104:105], v15 offset:6144
    ds_read_b64_tr_b16 v[106:107], v15 offset:6912
    s_waitcnt lgkmcnt(12)
    v_mfma_f32_32x32x16_bf16 v[32:47], v[84:87], v[64:67], v[32:47]
    ds_read_b64_tr_b16 v[108:109], v15 offset:6208
    ds_read_b64_tr_b16 v[110:111], v15 offset:6976
    s_waitcnt lgkmcnt(12)
    v_mfma_f32_32x32x16_bf16 v[48:63], v[88:91], v[64:67], v[48:63]
    ds_read_b64_tr_b16 v[80:81], v15 offset:6272
    ds_read_b64_tr_b16 v[82:83], v15 offset:7040
    s_waitcnt lgkmcnt(11)
    v_mfma_f32_32x32x16_bf16 v[16:31], v[92:95], v[68:71], v[16:31]
    ds_read_b128 v[76:79], v9 offset:3072
    ds_read_b64_tr_b16 v[84:85], v15 offset:9216
    ds_read_b64_tr_b16 v[86:87], v15 offset:9984
    s_waitcnt lgkmcnt(12)
    v_mfma_f32_32x32x16_bf16 v[32:47], v[96:99], v[68:71], v[32:47]
    ds_read_b64_tr_b16 v[88:89], v15 offset:9280
    ds_read_b64_tr_b16 v[90:91], v15 offset:10048
    s_waitcnt lgkmcnt(12)
    v_mfma_f32_32x32x16_bf16 v[48:63], v[100:103], v[68:71], v[48:63]
    ds_read_b64_tr_b16 v[92:93], v15 offset:9344
    ds_read_b64_tr_b16 v[94:95], v15 offset:10112
    s_waitcnt lgkmcnt(11)
    v_mfma_f32_32x32x16_bf16 v[16:31], v[104:107], v[72:75], v[16:31]
    s_waitcnt vmcnt(5)
    s_barrier
    ds_read_b128 v[64:67], v9 offset:40960
    ds_read_b64_tr_b16 v[96:97], v15 offset:40960
    ds_read_b64_tr_b16 v[98:99], v15 offset:41728
    s_waitcnt lgkmcnt(12)
    v_mfma_f32_32x32x16_bf16 v[32:47], v[108:111], v[72:75], v[32:47]
    ds_read_b64_tr_b16 v[100:101], v15 offset:41024
    ds_read_b64_tr_b16 v[102:103], v15 offset:41792
    s_waitcnt lgkmcnt(12)
    v_mfma_f32_32x32x16_bf16 v[48:63], v[80:83], v[72:75], v[48:63]
    ds_read_b64_tr_b16 v[104:105], v15 offset:41088
    ds_read_b64_tr_b16 v[106:107], v15 offset:41856
    s_waitcnt lgkmcnt(11)
    v_mfma_f32_32x32x16_bf16 v[16:31], v[84:87], v[76:79], v[16:31]
    ds_read_b128 v[68:71], v9 offset:41984
    ds_read_b64_tr_b16 v[108:109], v15 offset:44032
    ds_read_b64_tr_b16 v[110:111], v15 offset:44800
    s_waitcnt lgkmcnt(12)
    v_mfma_f32_32x32x16_bf16 v[32:47], v[88:91], v[76:79], v[32:47]
    ds_read_b64_tr_b16 v[80:81], v15 offset:44096
    ds_read_b64_tr_b16 v[82:83], v15 offset:44864
    s_waitcnt lgkmcnt(12)
    v_mfma_f32_32x32x16_bf16 v[48:63], v[92:95], v[76:79], v[48:63]
    ds_read_b64_tr_b16 v[84:85], v15 offset:44160
    ds_read_b64_tr_b16 v[86:87], v15 offset:44928
    s_waitcnt lgkmcnt(11)
    v_mfma_f32_32x32x16_bf16 v[16:31], v[96:99], v[64:67], v[16:31]
    ds_read_b128 v[72:75], v9 offset:43008
    ds_read_b64_tr_b16 v[88:89], v15 offset:47104
    ds_read_b64_tr_b16 v[90:91], v15 offset:47872
    s_waitcnt lgkmcnt(12)
    v_mfma_f32_32x32x16_bf16 v[32:47], v[100:103], v[64:67], v[32:47]
    ds_read_b64_tr_b16 v[92:93], v15 offset:47168
    ds_read_b64_tr_b16 v[94:95], v15 offset:47936
    s_waitcnt lgkmcnt(12)
    v_mfma_f32_32x32x16_bf16 v[48:63], v[104:107], v[64:67], v[48:63]
    ds_read_b64_tr_b16 v[96:97], v15 offset:47232
    ds_read_b64_tr_b16 v[98:99], v15 offset:48000
    s_waitcnt lgkmcnt(11)
    v_mfma_f32_32x32x16_bf16 v[16:31], v[108:111], v[68:71], v[16:31]
    ds_read_b128 v[76:79], v9 offset:44032
    ds_read_b64_tr_b16 v[100:101], v15 offset:50176
    ds_read_b64_tr_b16 v[102:103], v15 offset:50944
    s_waitcnt lgkmcnt(12)
    v_mfma_f32_32x32x16_bf16 v[32:47], v[80:83], v[68:71], v[32:47]
    ds_read_b64_tr_b16 v[104:105], v15 offset:50240
    ds_read_b64_tr_b16 v[106:107], v15 offset:51008
    s_waitcnt lgkmcnt(12)
    v_mfma_f32_32x32x16_bf16 v[48:63], v[84:87], v[68:71], v[48:63]
    ds_read_b64_tr_b16 v[108:109], v15 offset:50304
    ds_read_b64_tr_b16 v[110:111], v15 offset:51072
    s_waitcnt lgkmcnt(11)
    v_mfma_f32_32x32x16_bf16 v[16:31], v[88:91], v[72:75], v[16:31]
    s_waitcnt vmcnt(0)
    s_barrier
    ds_read_b128 v[64:67], v8 offset:0
    ds_read_b64_tr_b16 v[80:81], v14 offset:0
    ds_read_b64_tr_b16 v[82:83], v14 offset:768
    s_waitcnt lgkmcnt(12)
    v_mfma_f32_32x32x16_bf16 v[32:47], v[92:95], v[72:75], v[32:47]
    ds_read_b64_tr_b16 v[84:85], v14 offset:64
    ds_read_b64_tr_b16 v[86:87], v14 offset:832
    s_waitcnt lgkmcnt(12)
    v_mfma_f32_32x32x16_bf16 v[48:63], v[96:99], v[72:75], v[48:63]
    ds_read_b64_tr_b16 v[88:89], v14 offset:128
    ds_read_b64_tr_b16 v[90:91], v14 offset:896
    s_waitcnt lgkmcnt(11)
    v_mfma_f32_32x32x16_bf16 v[16:31], v[100:103], v[76:79], v[16:31]
    ds_read_b128 v[68:71], v8 offset:1024
    ds_read_b64_tr_b16 v[92:93], v14 offset:3072
    ds_read_b64_tr_b16 v[94:95], v14 offset:3840
    s_waitcnt lgkmcnt(12)
    v_mfma_f32_32x32x16_bf16 v[32:47], v[104:107], v[76:79], v[32:47]
    ds_read_b64_tr_b16 v[96:97], v14 offset:3136
    ds_read_b64_tr_b16 v[98:99], v14 offset:3904
    s_waitcnt lgkmcnt(12)
    v_mfma_f32_32x32x16_bf16 v[48:63], v[108:111], v[76:79], v[48:63]
    ds_read_b64_tr_b16 v[100:101], v14 offset:3200
    ds_read_b64_tr_b16 v[102:103], v14 offset:3968
    s_waitcnt lgkmcnt(11)
    v_mfma_f32_32x32x16_bf16 v[16:31], v[80:83], v[64:67], v[16:31]
    ds_read_b128 v[72:75], v8 offset:2048
    ds_read_b64_tr_b16 v[104:105], v14 offset:6144
    ds_read_b64_tr_b16 v[106:107], v14 offset:6912
    s_waitcnt lgkmcnt(12)
    v_mfma_f32_32x32x16_bf16 v[32:47], v[84:87], v[64:67], v[32:47]
    ds_read_b64_tr_b16 v[108:109], v14 offset:6208
    ds_read_b64_tr_b16 v[110:111], v14 offset:6976
    s_waitcnt lgkmcnt(12)
    v_mfma_f32_32x32x16_bf16 v[48:63], v[88:91], v[64:67], v[48:63]
    ds_read_b64_tr_b16 v[80:81], v14 offset:6272
    ds_read_b64_tr_b16 v[82:83], v14 offset:7040
    s_waitcnt lgkmcnt(11)
    v_mfma_f32_32x32x16_bf16 v[16:31], v[92:95], v[68:71], v[16:31]
    ds_read_b128 v[76:79], v8 offset:3072
    ds_read_b64_tr_b16 v[84:85], v14 offset:9216
    ds_read_b64_tr_b16 v[86:87], v14 offset:9984
    s_waitcnt lgkmcnt(12)
    v_mfma_f32_32x32x16_bf16 v[32:47], v[96:99], v[68:71], v[32:47]
    ds_read_b64_tr_b16 v[88:89], v14 offset:9280
    ds_read_b64_tr_b16 v[90:91], v14 offset:10048
    s_waitcnt lgkmcnt(12)
    v_mfma_f32_32x32x16_bf16 v[48:63], v[100:103], v[68:71], v[48:63]
    ds_read_b64_tr_b16 v[92:93], v14 offset:9344
    ds_read_b64_tr_b16 v[94:95], v14 offset:10112
    s_waitcnt lgkmcnt(11)
    v_mfma_f32_32x32x16_bf16 v[16:31], v[104:107], v[72:75], v[16:31]
    s_waitcnt lgkmcnt(9)
    v_mfma_f32_32x32x16_bf16 v[32:47], v[108:111], v[72:75], v[32:47]
    s_waitcnt lgkmcnt(7)
    v_mfma_f32_32x32x16_bf16 v[48:63], v[80:83], v[72:75], v[48:63]
    s_waitcnt lgkmcnt(4)
    v_mfma_f32_32x32x16_bf16 v[16:31], v[84:87], v[76:79], v[16:31]
    s_waitcnt lgkmcnt(2)
    v_mfma_f32_32x32x16_bf16 v[32:47], v[88:91], v[76:79], v[32:47]
    s_waitcnt lgkmcnt(0)
    v_mfma_f32_32x32x16_bf16 v[48:63], v[92:95], v[76:79], v[48:63]
    s_mul_i32 s17, s14, 36
    s_mul_i32 s13, s11, 12
    s_add_u32 s17, s17, s13
    s_mul_i32 s13, s18, 6
    s_add_u32 s17, s17, s13
    s_lshl_b32 s17, s17, 10
    s_mul_i32 s13, s12, 2359296
    s_add_u32 s17, s17, s13
    v_lshlrev_b32 v13, 4, v1
    s_nop 15
    v_cvt_pk_bf16_f32 v64, v16, v17
    v_cvt_pk_bf16_f32 v65, v18, v19
    v_cvt_pk_bf16_f32 v66, v20, v21
    v_cvt_pk_bf16_f32 v67, v22, v23
    s_add_u32 s13, s17, 0
    buffer_store_dwordx4 v[64:67], v13, s[28:31], s13 offen sc1
    v_cvt_pk_bf16_f32 v68, v24, v25
    v_cvt_pk_bf16_f32 v69, v26, v27
    v_cvt_pk_bf16_f32 v70, v28, v29
    v_cvt_pk_bf16_f32 v71, v30, v31
    s_add_u32 s13, s17, 1024
    buffer_store_dwordx4 v[68:71], v13, s[28:31], s13 offen sc1
    v_cvt_pk_bf16_f32 v72, v32, v33
    v_cvt_pk_bf16_f32 v73, v34, v35
    v_cvt_pk_bf16_f32 v74, v36, v37
    v_cvt_pk_bf16_f32 v75, v38, v39
    s_add_u32 s13, s17, 2048
    buffer_store_dwordx4 v[72:75], v13, s[28:31], s13 offen sc1
    v_cvt_pk_bf16_f32 v76, v40, v41
    v_cvt_pk_bf16_f32 v77, v42, v43
    v_cvt_pk_bf16_f32 v78, v44, v45
    v_cvt_pk_bf16_f32 v79, v46, v47
    s_add_u32 s13, s17, 3072
    buffer_store_dwordx4 v[76:79], v13, s[28:31], s13 offen sc1
    v_cvt_pk_bf16_f32 v80, v48, v49
    v_cvt_pk_bf16_f32 v81, v50, v51
    v_cvt_pk_bf16_f32 v82, v52, v53
    v_cvt_pk_bf16_f32 v83, v54, v55
    s_add_u32 s13, s17, 4096
    buffer_store_dwordx4 v[80:83], v13, s[28:31], s13 offen sc1
    v_cvt_pk_bf16_f32 v84, v56, v57
    v_cvt_pk_bf16_f32 v85, v58, v59
    v_cvt_pk_bf16_f32 v86, v60, v61
    v_cvt_pk_bf16_f32 v87, v62, v63
    s_add_u32 s13, s17, 5120
    buffer_store_dwordx4 v[84:87], v13, s[28:31], s13 offen sc1
    s_waitcnt vmcnt(0)
k3_oproj_kernel_end:
    s_endpgm
.section .rodata,"a"
.p2align 6
.amdhsa_kernel k3_oproj_kernel
  .amdhsa_next_free_vgpr 128
  .amdhsa_next_free_sgpr 96
  .amdhsa_accum_offset 128
  .amdhsa_group_segment_fixed_size 0
  .amdhsa_kernarg_size 112
  .amdhsa_user_sgpr_count 2
  .amdhsa_user_sgpr_kernarg_segment_ptr 1
  .amdhsa_system_sgpr_workgroup_id_x 1
.end_amdhsa_kernel
.text
.globl k4_mid_kernel
.p2align 8
.type k4_mid_kernel,@function
k4_mid_kernel:
    s_cmp_ge_u32 s2, 256
    s_cbranch_scc1 k4_mid_kernel_end
    s_load_dwordx2 s[4:5], s[0:1], 0
    s_load_dwordx2 s[6:7], s[0:1], 104
    s_load_dwordx2 s[8:9], s[0:1], 88
    v_and_b32 v1, 63, v0
    v_lshrrev_b32 v2, 6, v0
    v_and_b32 v3, 7, v1
    v_bfe_u32 v4, v1, 3, 1
    v_bfe_u32 v5, v1, 4, 1
    v_lshrrev_b32 v6, 5, v1
    v_lshl_add_u32 v6, v2, 1, v6
    s_lshr_b32 s10, s2, 2
    s_and_b32 s11, s2, 3
    s_lshl_b32 s11, s11, 3
    v_lshlrev_b32 v7, 5, v6
    v_lshl_add_u32 v7, v5, 4, v7
    v_lshl_add_u32 v7, v4, 3, v7
    s_lshl_b32 s3, s2, 3
    v_add_u32 v8, s3, v3
    v_mul_u32_u24 v8, 1152, v8
    v_lshl_add_u32 v8, v7, 1, v8
    v_lshlrev_b32 v9, 5, v4
    v_add_u32 v9, s11, v9
    v_add_u32 v9, v9, v3
    v_lshlrev_b32 v10, 5, v2
    v_lshl_add_u32 v10, v3, 2, v10
    v_lshlrev_b32 v11, 2, v3
    v_lshlrev_b32 v12, 2, v7
    s_mul_i32 s12, s10, 18
    v_add_u32 v13, s12, v6
    v_lshlrev_b32 v13, 2, v13
    v_lshl_add_u32 v13, v5, 1, v13
    v_lshlrev_b32 v13, 10, v13
    v_lshl_add_u32 v13, v9, 4, v13
    s_mul_i32 s12, s10, 36
    v_lshl_add_u32 v14, v6, 1, v5
    v_add_u32 v14, s12, v14
    v_lshlrev_b32 v14, 10, v14
    v_lshl_add_u32 v14, v9, 4, v14
    s_waitcnt lgkmcnt(0)
    s_add_u32 s16, s6, 0
    s_addc_u32 s17, s7, 0
    s_mov_b32 s18, 13824
    s_mov_b32 s19, 0x20000
    s_add_u32 s20, s6, 67108864
    s_addc_u32 s21, s7, 0
    s_mov_b32 s22, 11796480
    s_mov_b32 s23, 0x20000
    s_add_u32 s24, s6, 6291456
    s_addc_u32 s25, s7, 0
    s_mov_b32 s26, 2359296
    s_mov_b32 s27, 0x20000
    s_add_u32 s28, s6, 3145728
    s_addc_u32 s29, s7, 0
    s_mov_b32 s30, 2359296
    s_mov_b32 s31, 0x20000
    s_add_u32 s32, s4, 0
    s_addc_u32 s33, s5, 0
    s_mov_b32 s34, 2359296
    s_mov_b32 s35, 0x20000
    buffer_load_dwordx4 v[16:19], v8, s[32:35], 0 offen
    s_mov_b32 s36, 4608
    buffer_load_dwordx4 v[20:23], v12, s[16:19], s36 offen
    buffer_load_dwordx4 v[24:27], v12, s[16:19], s36 offen offset:16
    s_mov_b32 s37, 0
    buffer_load_dwordx4 v[64:67], v14, s[20:23], s37 offen
    s_mov_b32 s37, 2359296
    buffer_load_dwordx4 v[68:71], v14, s[20:23], s37 offen
    s_mov_b32 s37, 4718592
    buffer_load_dwordx4 v[72:75], v14, s[20:23], s37 offen
    s_mov_b32 s37, 7077888
    buffer_load_dwordx4 v[76:79], v14, s[20:23], s37 offen
    s_mov_b32 s37, 9437184
    buffer_load_dwordx4 v[80:83], v14, s[20:23], s37 offen
    s_mov_b32 s36, 6912
    buffer_load_dwordx4 v[28:31], v12, s[16:19], s36 offen
    buffer_load_dwordx4 v[32:35], v12, s[16:19], s36 offen offset:16
    s_mov_b32 s36, 9216
    buffer_load_dwordx4 v[36:39], v12, s[16:19], s36 offen
    buffer_load_dwordx4 v[40:43], v12, s[16:19], s36 offen offset:16
    s_waitcnt vmcnt(0)
    v_lshlrev_b32 v96, 16, v16
    v_and_b32 v97, 0xffff0000, v16
    v_lshlrev_b32 v98, 16, v17
    v_and_b32 v99, 0xffff0000, v17
    v_lshlrev_b32 v100, 16, v18
    v_and_b32 v101, 0xffff0000, v18
    v_lshlrev_b32 v102, 16, v19
    v_and_b32 v103, 0xffff0000, v19
    v_lshlrev_b32 v48, 16, v64
    v_and_b32 v49, 0xffff0000, v64
    v_lshlrev_b32 v50, 16, v65
    v_and_b32 v51, 0xffff0000, v65
    v_lshlrev_b32 v52, 16, v66
    v_and_b32 v53, 0xffff0000, v66
    v_lshlrev_b32 v54, 16, v67
    v_and_b32 v55, 0xffff0000, v67
    v_lshlrev_b32 v56, 16, v68
    v_and_b32 v57, 0xffff0000, v68
    v_lshlrev_b32 v58, 16, v69
    v_and_b32 v59, 0xffff0000, v69
    v_lshlrev_b32 v60, 16, v70
    v_and_b32 v61, 0xffff0000, v70
    v_lshlrev_b32 v62, 16, v71
    v_and_b32 v63, 0xffff0000, v71
    v_add_f32 v48, v48, v56
    v_add_f32 v49, v49, v57
    v_add_f32 v50, v50, v58
    v_add_f32 v51, v51, v59
    v_add_f32 v52, v52, v60
    v_add_f32 v53, v53, v61
    v_add_f32 v54, v54, v62
    v_add_f32 v55, v55, v63
    v_lshlrev_b32 v56, 16, v72
    v_and_b32 v57, 0xffff0000, v72
    v_lshlrev_b32 v58, 16, v73
    v_and_b32 v59, 0xffff0000, v73
    v_lshlrev_b32 v60, 16, v74
    v_and_b32 v61, 0xffff0000, v74
    v_lshlrev_b32 v62, 16, v75
    v_and_b32 v63, 0xffff0000, v75
    v_add_f32 v48, v48, v56
    v_add_f32 v49, v49, v57
    v_add_f32 v50, v50, v58
    v_add_f32 v51, v51, v59
    v_add_f32 v52, v52, v60
    v_add_f32 v53, v53, v61
    v_add_f32 v54, v54, v62
    v_add_f32 v55, v55, v63
    v_lshlrev_b32 v56, 16, v76
    v_and_b32 v57, 0xffff0000, v76
    v_lshlrev_b32 v58, 16, v77
    v_and_b32 v59, 0xffff0000, v77
    v_lshlrev_b32 v60, 16, v78
    v_and_b32 v61, 0xffff0000, v78
    v_lshlrev_b32 v62, 16, v79
    v_and_b32 v63, 0xffff0000, v79
    v_add_f32 v48, v48, v56
    v_add_f32 v49, v49, v57
    v_add_f32 v50, v50, v58
    v_add_f32 v51, v51, v59
    v_add_f32 v52, v52, v60
    v_add_f32 v53, v53, v61
    v_add_f32 v54, v54, v62
    v_add_f32 v55, v55, v63
    v_lshlrev_b32 v56, 16, v80
    v_and_b32 v57, 0xffff0000, v80
    v_lshlrev_b32 v58, 16, v81
    v_and_b32 v59, 0xffff0000, v81
    v_lshlrev_b32 v60, 16, v82
    v_and_b32 v61, 0xffff0000, v82
    v_lshlrev_b32 v62, 16, v83
    v_and_b32 v63, 0xffff0000, v83
    v_add_f32 v48, v48, v56
    v_add_f32 v49, v49, v57
    v_add_f32 v50, v50, v58
    v_add_f32 v51, v51, v59
    v_add_f32 v52, v52, v60
    v_add_f32 v53, v53, v61
    v_add_f32 v54, v54, v62
    v_add_f32 v55, v55, v63
    v_cvt_pk_bf16_f32 v104, v48, v49
    v_cvt_pk_bf16_f32 v105, v50, v51
    v_cvt_pk_bf16_f32 v106, v52, v53
    v_cvt_pk_bf16_f32 v107, v54, v55
    v_lshlrev_b32 v48, 16, v104
    v_and_b32 v49, 0xffff0000, v104
    v_lshlrev_b32 v50, 16, v105
    v_and_b32 v51, 0xffff0000, v105
    v_lshlrev_b32 v52, 16, v106
    v_and_b32 v53, 0xffff0000, v106
    v_lshlrev_b32 v54, 16, v107
    v_and_b32 v55, 0xffff0000, v107
    v_mul_f32 v48, v48, v20
    v_mul_f32 v49, v49, v21
    v_mul_f32 v50, v50, v22
    v_mul_f32 v51, v51, v23
    v_mul_f32 v52, v52, v24
    v_mul_f32 v53, v53, v25
    v_mul_f32 v54, v54, v26
    v_mul_f32 v55, v55, v27
    v_cvt_pk_bf16_f32 v104, v48, v49
    v_cvt_pk_bf16_f32 v105, v50, v51
    v_cvt_pk_bf16_f32 v106, v52, v53
    v_cvt_pk_bf16_f32 v107, v54, v55
    v_lshlrev_b32 v48, 16, v104
    v_and_b32 v49, 0xffff0000, v104
    v_lshlrev_b32 v50, 16, v105
    v_and_b32 v51, 0xffff0000, v105
    v_lshlrev_b32 v52, 16, v106
    v_and_b32 v53, 0xffff0000, v106
    v_lshlrev_b32 v54, 16, v107
    v_and_b32 v55, 0xffff0000, v107
    v_add_f32 v96, v96, v48
    v_add_f32 v97, v97, v49
    v_add_f32 v98, v98, v50
    v_add_f32 v99, v99, v51
    v_add_f32 v100, v100, v52
    v_add_f32 v101, v101, v53
    v_add_f32 v102, v102, v54
    v_add_f32 v103, v103, v55
    v_cvt_pk_bf16_f32 v104, v96, v97
    v_cvt_pk_bf16_f32 v105, v98, v99
    v_cvt_pk_bf16_f32 v106, v100, v101
    v_cvt_pk_bf16_f32 v107, v102, v103
    v_lshlrev_b32 v96, 16, v104
    v_and_b32 v97, 0xffff0000, v104
    v_lshlrev_b32 v98, 16, v105
    v_and_b32 v99, 0xffff0000, v105
    v_lshlrev_b32 v100, 16, v106
    v_and_b32 v101, 0xffff0000, v106
    v_lshlrev_b32 v102, 16, v107
    v_and_b32 v103, 0xffff0000, v107
    buffer_store_dwordx4 v[104:107], v8, s[24:27], 0 offen sc1
    v_add_f32 v108, v96, v97
    v_add_f32 v108, v108, v98
    v_add_f32 v108, v108, v99
    v_add_f32 v108, v108, v100
    v_add_f32 v108, v108, v101
    v_add_f32 v108, v108, v102
    v_add_f32 v108, v108, v103
    s_nop 1
    v_add_f32_dpp v108, v108, v108 row_ror:8 row_mask:0xf bank_mask:0xf
    ds_swizzle_b32 v112, v108 offset:0x401F
    s_waitcnt lgkmcnt(0)
    v_add_f32 v108, v108, v112
    v_mov_b32 v112, v108
    s_nop 1
    v_permlane32_swap_b32 v108, v112
    s_nop 1
    v_add_f32 v108, v108, v112
    ds_write_b32 v10, v108 offset:0
    s_waitcnt lgkmcnt(0)
    s_barrier
    ds_read_b32 v112, v11 offset:0
    ds_read_b32 v113, v11 offset:32
    ds_read_b32 v114, v11 offset:64
    ds_read_b32 v115, v11 offset:96
    ds_read_b32 v116, v11 offset:128
    ds_read_b32 v117, v11 offset:160
    ds_read_b32 v118, v11 offset:192
    ds_read_b32 v119, v11 offset:224
    ds_read_b32 v120, v11 offset:256
    s_waitcnt lgkmcnt(0)
    v_add_f32 v112, v112, v113
    v_add_f32 v112, v112, v114
    v_add_f32 v112, v112, v115
    v_add_f32 v112, v112, v116
    v_add_f32 v112, v112, v117
    v_add_f32 v112, v112, v118
    v_add_f32 v112, v112, v119
    v_add_f32 v112, v112, v120
    v_mov_b32 v108, v112
    v_mul_f32 v108, 0x3ae38e39, v108
    v_sub_f32 v96, v96, v108
    v_sub_f32 v97, v97, v108
    v_sub_f32 v98, v98, v108
    v_sub_f32 v99, v99, v108
    v_sub_f32 v100, v100, v108
    v_sub_f32 v101, v101, v108
    v_sub_f32 v102, v102, v108
    v_sub_f32 v103, v103, v108
    v_mul_f32 v109, v96, v96
    v_fmac_f32 v109, v97, v97
    v_fmac_f32 v109, v98, v98
    v_fmac_f32 v109, v99, v99
    v_fmac_f32 v109, v100, v100
    v_fmac_f32 v109, v101, v101
    v_fmac_f32 v109, v102, v102
    v_fmac_f32 v109, v103, v103
    s_nop 1
    v_add_f32_dpp v109, v109, v109 row_ror:8 row_mask:0xf bank_mask:0xf
    ds_swizzle_b32 v112, v109 offset:0x401F
    s_waitcnt lgkmcnt(0)
    v_add_f32 v109, v109, v112
    v_mov_b32 v112, v109
    s_nop 1
    v_permlane32_swap_b32 v109, v112
    s_nop 1
    v_add_f32 v109, v109, v112
    ds_write_b32 v10, v109 offset:512
    s_waitcnt lgkmcnt(0)
    s_barrier
    ds_read_b32 v112, v11 offset:512
    ds_read_b32 v113, v11 offset:544
    ds_read_b32 v114, v11 offset:576
    ds_read_b32 v115, v11 offset:608
    ds_read_b32 v116, v11 offset:640
    ds_read_b32 v117, v11 offset:672
    ds_read_b32 v118, v11 offset:704
    ds_read_b32 v119, v11 offset:736
    ds_read_b32 v120, v11 offset:768
    s_waitcnt lgkmcnt(0)
    v_add_f32 v112, v112, v113
    v_add_f32 v112, v112, v114
    v_add_f32 v112, v112, v115
    v_add_f32 v112, v112, v116
    v_add_f32 v112, v112, v117
    v_add_f32 v112, v112, v118
    v_add_f32 v112, v112, v119
    v_add_f32 v112, v112, v120
    v_mov_b32 v109, v112
    v_mov_b32 v110, 0x3727c5ac
    v_fmac_f32 v110, 0x3ae38e39, v109
    v_rsq_f32 v110, v110
    s_nop 0
    v_add_f32 v36, 1.0, v36
    v_add_f32 v37, 1.0, v37
    v_add_f32 v38, 1.0, v38
    v_add_f32 v39, 1.0, v39
    v_add_f32 v40, 1.0, v40
    v_add_f32 v41, 1.0, v41
    v_add_f32 v42, 1.0, v42
    v_add_f32 v43, 1.0, v43
    v_cvt_pk_bf16_f32 v112, v36, v37
    v_cvt_pk_bf16_f32 v113, v38, v39
    v_cvt_pk_bf16_f32 v114, v40, v41
    v_cvt_pk_bf16_f32 v115, v42, v43
    v_lshlrev_b32 v36, 16, v112
    v_and_b32 v37, 0xffff0000, v112
    v_lshlrev_b32 v38, 16, v113
    v_and_b32 v39, 0xffff0000, v113
    v_lshlrev_b32 v40, 16, v114
    v_and_b32 v41, 0xffff0000, v114
    v_lshlrev_b32 v42, 16, v115
    v_and_b32 v43, 0xffff0000, v115
    v_mul_f32 v96, v96, v110
    v_fma_f32 v96, v96, v36, v28
    v_mul_f32 v97, v97, v110
    v_fma_f32 v97, v97, v37, v29
    v_mul_f32 v98, v98, v110
    v_fma_f32 v98, v98, v38, v30
    v_mul_f32 v99, v99, v110
    v_fma_f32 v99, v99, v39, v31
    v_mul_f32 v100, v100, v110
    v_fma_f32 v100, v100, v40, v32
    v_mul_f32 v101, v101, v110
    v_fma_f32 v101, v101, v41, v33
    v_mul_f32 v102, v102, v110
    v_fma_f32 v102, v102, v42, v34
    v_mul_f32 v103, v103, v110
    v_fma_f32 v103, v103, v43, v35
    v_cvt_pk_bf16_f32 v112, v96, v97
    v_cvt_pk_bf16_f32 v113, v98, v99
    v_cvt_pk_bf16_f32 v114, v100, v101
    v_cvt_pk_bf16_f32 v115, v102, v103
    buffer_store_dwordx4 v[112:115], v14, s[28:31], 0 offen sc1
    s_mov_b32 s40, s94
k4_mid_kernel_end:
    s_endpgm
.section .rodata,"a"
.p2align 6
.amdhsa_kernel k4_mid_kernel
  .amdhsa_next_free_vgpr 128
  .amdhsa_next_free_sgpr 96
  .amdhsa_accum_offset 128
  .amdhsa_group_segment_fixed_size 0
  .amdhsa_kernarg_size 112
  .amdhsa_user_sgpr_count 2
  .amdhsa_user_sgpr_kernarg_segment_ptr 1
  .amdhsa_system_sgpr_workgroup_id_x 1
.end_amdhsa_kernel
.text
.globl k5_gateup_kernel
.p2align 8
.type k5_gateup_kernel,@function
k5_gateup_kernel:
    s_cmp_ge_u32 s2, 256
    s_cbranch_scc1 k5_gateup_kernel_end
    s_load_dwordx2 s[4:5], s[0:1], 48
    s_load_dwordx2 s[6:7], s[0:1], 56
    s_load_dwordx2 s[8:9], s[0:1], 104
    v_and_b32 v1, 63, v0
    v_lshrrev_b32 v6, 6, v0
    s_nop 0
    v_readfirstlane_b32 s40, v6
    v_lshrrev_b32 v2, 5, v1
    v_bfe_u32 v3, v1, 2, 2
    v_bfe_u32 v4, v1, 4, 1
    v_and_b32 v5, 1, v1
    v_lshlrev_b32 v5, 4, v5
    v_bfe_u32 v6, v1, 1, 1
    v_lshl_add_u32 v5, v6, 3, v5
    s_and_b32 s10, s2, 7
    s_bfe_u32 s11, s2, 0x20003
    s_lshl_b32 s11, s11, 3
    s_add_u32 s11, s11, s10
    s_lshr_b32 s12, s2, 5
    s_lshl_b32 s14, s12, 3
    s_add_u32 s14, s14, s40
    s_mul_i32 s15, s11, 288
    s_add_u32 s16, s40, 0
    s_cmp_ge_u32 s16, 18
    s_cselect_b32 s17, 18, 0
    s_cselect_b32 s18, 18560, 0
    s_sub_u32 s16, s16, s17
    s_lshl_b32 s17, s16, 10
    s_add_u32 s44, s17, s18
    s_lshl_b32 s17, s16, 6
    v_add_u32 v7, s17, v1
    v_mul_u32_u24 v8, 58255, v7
    v_lshrrev_b32 v8, 20, v8
    v_mul_u32_u24 v9, 18, v8
    v_sub_u32 v9, v7, v9
    v_mul_u32_u24 v8, 9216, v8
    v_lshl_add_u32 v8, v9, 4, v8
    v_add_u32 v10, s15, v8
    s_add_u32 s16, s40, 8
    s_cmp_ge_u32 s16, 18
    s_cselect_b32 s17, 18, 0
    s_cselect_b32 s18, 18560, 0
    s_sub_u32 s16, s16, s17
    s_lshl_b32 s17, s16, 10
    s_add_u32 s45, s17, s18
    s_lshl_b32 s17, s16, 6
    v_add_u32 v7, s17, v1
    v_mul_u32_u24 v8, 58255, v7
    v_lshrrev_b32 v8, 20, v8
    v_mul_u32_u24 v9, 18, v8
    v_sub_u32 v9, v7, v9
    v_mul_u32_u24 v8, 9216, v8
    v_lshl_add_u32 v8, v9, 4, v8
    v_add_u32 v11, s15, v8
    s_add_u32 s16, s40, 16
    s_cmp_ge_u32 s16, 18
    s_cselect_b32 s17, 18, 0
    s_cselect_b32 s18, 18560, 0
    s_sub_u32 s16, s16, s17
    s_lshl_b32 s17, s16, 10
    s_add_u32 s46, s17, s18
    s_lshl_b32 s17, s16, 6
    v_add_u32 v7, s17, v1
    v_mul_u32_u24 v8, 58255, v7
    v_lshrrev_b32 v8, 20, v8
    v_mul_u32_u24 v9, 18, v8
    v_sub_u32 v9, v7, v9
    v_mul_u32_u24 v8, 9216, v8
    v_lshl_add_u32 v8, v9, 4, v8
    v_add_u32 v12, s15, v8
    s_add_u32 s16, s40, 24
    s_cmp_ge_u32 s16, 18
    s_cselect_b32 s17, 18, 0
    s_cselect_b32 s18, 18560, 0
    s_sub_u32 s16, s16, s17
    s_lshl_b32 s17, s16, 10
    s_add_u32 s47, s17, s18
    s_lshl_b32 s17, s16, 6
    v_add_u32 v7, s17, v1
    v_mul_u32_u24 v8, 58255, v7
    v_lshrrev_b32 v8, 20, v8
    v_mul_u32_u24 v9, 18, v8
    v_sub_u32 v9, v7, v9
    v_mul_u32_u24 v8, 9216, v8
    v_lshl_add_u32 v8, v9, 4, v8
    v_add_u32 v13, s15, v8
    s_and_b32 s16, s40, 3
    s_add_u32 s16, s16, 32
    s_cmp_ge_u32 s16, 18
    s_cselect_b32 s17, 18, 0
    s_cselect_b32 s18, 18560, 0
    s_sub_u32 s16, s16, s17
    s_lshl_b32 s17, s16, 10
    s_add_u32 s48, s17, s18
    s_lshl_b32 s17, s16, 6
    v_add_u32 v7, s17, v1
    v_mul_u32_u24 v8, 58255, v7
    v_lshrrev_b32 v8, 20, v8
    v_mul_u32_u24 v9, 18, v8
    v_sub_u32 v9, v7, v9
    v_mul_u32_u24 v8, 9216, v8
    v_lshl_add_u32 v8, v9, 4, v8
    v_add_u32 v14, s15, v8
    v_lshl_add_u32 v7, v2, 3, v3
    v_mul_u32_u24 v7, 288, v7
    v_mul_u32_u24 v8, 18560, v4
    v_add3_u32 v15, v7, v8, v5
    v_add_u32 v9, 74240, v15
    s_mul_i32 s17, s14, 36864
    v_lshlrev_b32 v6, 4, v1
    v_add_u32 v6, s17, v6
    s_waitcnt lgkmcnt(0)
    s_add_u32 s20, s4, 0
    s_addc_u32 s21, s5, 0
    s_mov_b32 s22, 5308416
    s_mov_b32 s23, 0x20000
    s_add_u32 s24, s6, 0
    s_addc_u32 s25, s7, 0
    s_mov_b32 s26, 5308416
    s_mov_b32 s27, 0x20000
    s_add_u32 s28, s8, 3145728
    s_addc_u32 s29, s9, 0
    s_mov_b32 s30, 2359296
    s_mov_b32 s31, 0x20000
    s_add_u32 s36, s8, 33554432
    s_addc_u32 s37, s9, 0
    s_mov_b32 s38, 18874368
    s_mov_b32 s39, 0x20000
    s_cmp_lt_u32 s40, 2
    s_cselect_b32 s52, s20, s24
    s_cselect_b32 s53, s21, s25
    s_cselect_b32 s54, s22, s26
    s_cselect_b32 s55, s23, s27
    s_mov_b32 s56, 0xbfb8aa3b
    s_mov_b32 s57, 0xbfb8aa3b
    s_mov_b32 s58, 1.0
    s_mov_b32 s59, 1.0
    s_add_u32 m0, s44, 0
    s_mov_b32 s33, 0
    buffer_load_dwordx4 v10, s[20:23], s33 offen lds
    s_add_u32 m0, s45, 0
    s_nop 0
    buffer_load_dwordx4 v11, s[20:23], s33 offen lds
    s_add_u32 m0, s46, 0
    s_nop 0
    buffer_load_dwordx4 v12, s[52:55], s33 offen lds
    s_add_u32 m0, s47, 0
    s_nop 0
    buffer_load_dwordx4 v13, s[24:27], s33 offen lds
    s_add_u32 m0, s48, 0
    s_nop 0
    buffer_load_dwordx4 v14, s[24:27], s33 offen lds
    s_mov_b32 s34, 0
    buffer_load_dwordx4 v[160:163], v6, s[28:31], s34 offen offset:0
    s_mov_b32 s34, 0
    buffer_load_dwordx4 v[164:167], v6, s[28:31], s34 offen offset:1024
    s_waitcnt vmcnt(2)
    s_barrier
    ds_read_b64_tr_b16 v[176:177], v15 offset:0
    ds_read_b64_tr_b16 v[178:179], v15 offset:1152
    ds_read_b64_tr_b16 v[180:181], v15 offset:32
    ds_read_b64_tr_b16 v[182:183], v15 offset:1184
    ds_read_b64_tr_b16 v[184:185], v15 offset:64
    ds_read_b64_tr_b16 v[186:187], v15 offset:1216
    ds_read_b64_tr_b16 v[188:189], v15 offset:96
    ds_read_b64_tr_b16 v[190:191], v15 offset:1248
    ds_read_b64_tr_b16 v[192:193], v15 offset:128
    ds_read_b64_tr_b16 v[194:195], v15 offset:1280
    ds_read_b64_tr_b16 v[196:197], v15 offset:160
    ds_read_b64_tr_b16 v[198:199], v15 offset:1312
    s_mov_b32 s34, 0
    buffer_load_dwordx4 v[168:171], v6, s[28:31], s34 offen offset:2048
    s_waitcnt vmcnt(2)
    s_waitcnt lgkmcnt(10)
    v_mfma_f32_32x32x16_bf16 v[16:31], v[176:179], v[160:163], 0
    ds_read_b64_tr_b16 v[200:201], v15 offset:192
    ds_read_b64_tr_b16 v[202:203], v15 offset:1344
    s_mov_b32 s34, 0
    buffer_load_dwordx4 v[172:175], v6, s[28:31], s34 offen offset:3072
    s_waitcnt lgkmcnt(10)
    v_mfma_f32_32x32x16_bf16 v[32:47], v[180:183], v[160:163], 0
    ds_read_b64_tr_b16 v[204:205], v15 offset:224
    ds_read_b64_tr_b16 v[206:207], v15 offset:1376
    s_add_u32 m0, s44, 37120
    s_mov_b32 s33, 589824
    buffer_load_dwordx4 v10, s[20:23], s33 offen lds
    s_waitcnt lgkmcnt(10)
    v_mfma_f32_32x32x16_bf16 v[48:63], v[184:187], v[160:163], 0
    ds_read_b64_tr_b16 v[176:177], v15 offset:256
    ds_read_b64_tr_b16 v[178:179], v15 offset:1408
    s_add_u32 m0, s45, 37120
    s_nop 0
    buffer_load_dwordx4 v11, s[20:23], s33 offen lds
    s_waitcnt lgkmcnt(10)
    v_mfma_f32_32x32x16_bf16 v[64:79], v[188:191], v[160:163], 0
    ds_read_b64_tr_b16 v[180:181], v15 offset:4608
    ds_read_b64_tr_b16 v[182:183], v15 offset:5760
    s_add_u32 m0, s46, 37120
    s_nop 0
    buffer_load_dwordx4 v12, s[52:55], s33 offen lds
    s_waitcnt lgkmcnt(10)
    v_mfma_f32_32x32x16_bf16 v[80:95], v[192:195], v[160:163], 0
    ds_read_b64_tr_b16 v[184:185], v15 offset:4640
    ds_read_b64_tr_b16 v[186:187], v15 offset:5792
    s_add_u32 m0, s47, 37120
    s_nop 0
    buffer_load_dwordx4 v13, s[24:27], s33 offen lds
    s_waitcnt lgkmcnt(10)
    v_mfma_f32_32x32x16_bf16 v[96:111], v[196:199], v[160:163], 0
    ds_read_b64_tr_b16 v[188:189], v15 offset:4672
    ds_read_b64_tr_b16 v[190:191], v15 offset:5824
    s_add_u32 m0, s48, 37120
    s_nop 0
    buffer_load_dwordx4 v14, s[24:27], s33 offen lds
    s_waitcnt lgkmcnt(10)
    v_mfma_f32_32x32x16_bf16 v[112:127], v[200:203], v[160:163], 0
    ds_read_b64_tr_b16 v[192:193], v15 offset:4704
    ds_read_b64_tr_b16 v[194:195], v15 offset:5856
    s_add_u32 m0, s44, 74240
    s_mov_b32 s33, 1179648
    buffer_load_dwordx4 v10, s[20:23], s33 offen lds
    s_waitcnt lgkmcnt(10)
    v_mfma_f32_32x32x16_bf16 v[128:143], v[204:207], v[160:163], 0
    ds_read_b64_tr_b16 v[196:197], v15 offset:4736
    ds_read_b64_tr_b16 v[198:199], v15 offset:5888
    s_add_u32 m0, s45, 74240
    s_nop 0
    buffer_load_dwordx4 v11, s[20:23], s33 offen lds
    s_waitcnt lgkmcnt(10)
    v_mfma_f32_32x32x16_bf16 v[144:159], v[176:179], v[160:163], 0
    ds_read_b64_tr_b16 v[200:201], v15 offset:4768
    ds_read_b64_tr_b16 v[202:203], v15 offset:5920
    s_add_u32 m0, s46, 74240
    s_nop 0
    buffer_load_dwordx4 v12, s[52:55], s33 offen lds
    s_waitcnt vmcnt(10)
    s_waitcnt lgkmcnt(10)
    v_mfma_f32_32x32x16_bf16 v[16:31], v[180:183], v[164:167], v[16:31]
    ds_read_b64_tr_b16 v[204:205], v15 offset:4800
    ds_read_b64_tr_b16 v[206:207], v15 offset:5952
    s_add_u32 m0, s47, 74240
    s_nop 0
    buffer_load_dwordx4 v13, s[24:27], s33 offen lds
    s_waitcnt lgkmcnt(10)
    v_mfma_f32_32x32x16_bf16 v[32:47], v[184:187], v[164:167], v[32:47]
    ds_read_b64_tr_b16 v[176:177], v15 offset:4832
    ds_read_b64_tr_b16 v[178:179], v15 offset:5984
    s_add_u32 m0, s48, 74240
    s_nop 0
    buffer_load_dwordx4 v14, s[24:27], s33 offen lds
    s_waitcnt lgkmcnt(10)
    v_mfma_f32_32x32x16_bf16 v[48:63], v[188:191], v[164:167], v[48:63]
    ds_read_b64_tr_b16 v[180:181], v15 offset:4864
    ds_read_b64_tr_b16 v[182:183], v15 offset:6016
    s_mov_b32 s34, 4096
    buffer_load_dwordx4 v[160:163], v6, s[28:31], s34 offen offset:0
    s_waitcnt lgkmcnt(10)
    v_mfma_f32_32x32x16_bf16 v[64:79], v[192:195], v[164:167], v[64:79]
    ds_read_b64_tr_b16 v[184:185], v15 offset:9216
    ds_read_b64_tr_b16 v[186:187], v15 offset:10368
    s_waitcnt lgkmcnt(10)
    v_mfma_f32_32x32x16_bf16 v[80:95], v[196:199], v[164:167], v[80:95]
    ds_read_b64_tr_b16 v[188:189], v15 offset:9248
    ds_read_b64_tr_b16 v[190:191], v15 offset:10400
    s_waitcnt lgkmcnt(10)
    v_mfma_f32_32x32x16_bf16 v[96:111], v[200:203], v[164:167], v[96:111]
    ds_read_b64_tr_b16 v[192:193], v15 offset:9280
    ds_read_b64_tr_b16 v[194:195], v15 offset:10432
    s_waitcnt lgkmcnt(10)
    v_mfma_f32_32x32x16_bf16 v[112:127], v[204:207], v[164:167], v[112:127]
    ds_read_b64_tr_b16 v[196:197], v15 offset:9312
    ds_read_b64_tr_b16 v[198:199], v15 offset:10464
    s_waitcnt lgkmcnt(10)
    v_mfma_f32_32x32x16_bf16 v[128:143], v[176:179], v[164:167], v[128:143]
    ds_read_b64_tr_b16 v[200:201], v15 offset:9344
    ds_read_b64_tr_b16 v[202:203], v15 offset:10496
    s_waitcnt lgkmcnt(10)
    v_mfma_f32_32x32x16_bf16 v[144:159], v[180:183], v[164:167], v[144:159]
    ds_read_b64_tr_b16 v[204:205], v15 offset:9376
    ds_read_b64_tr_b16 v[206:207], v15 offset:10528
    s_mov_b32 s34, 4096
    buffer_load_dwordx4 v[164:167], v6, s[28:31], s34 offen offset:1024
    s_waitcnt vmcnt(13)
    s_waitcnt lgkmcnt(10)
    v_mfma_f32_32x32x16_bf16 v[16:31], v[184:187], v[168:171], v[16:31]
    ds_read_b64_tr_b16 v[176:177], v15 offset:9408
    ds_read_b64_tr_b16 v[178:179], v15 offset:10560
    s_waitcnt lgkmcnt(10)
    v_mfma_f32_32x32x16_bf16 v[32:47], v[188:191], v[168:171], v[32:47]
    ds_read_b64_tr_b16 v[180:181], v15 offset:9440
    ds_read_b64_tr_b16 v[182:183], v15 offset:10592
    s_waitcnt lgkmcnt(10)
    v_mfma_f32_32x32x16_bf16 v[48:63], v[192:195], v[168:171], v[48:63]
    ds_read_b64_tr_b16 v[184:185], v15 offset:9472
    ds_read_b64_tr_b16 v[186:187], v15 offset:10624
    s_waitcnt lgkmcnt(10)
    v_mfma_f32_32x32x16_bf16 v[64:79], v[196:199], v[168:171], v[64:79]
    ds_read_b64_tr_b16 v[188:189], v15 offset:13824
    ds_read_b64_tr_b16 v[190:191], v15 offset:14976
    s_waitcnt lgkmcnt(10)
    v_mfma_f32_32x32x16_bf16 v[80:95], v[200:203], v[168:171], v[80:95]
    ds_read_b64_tr_b16 v[192:193], v15 offset:13856
    ds_read_b64_tr_b16 v[194:195], v15 offset:15008
    s_waitcnt lgkmcnt(10)
    v_mfma_f32_32x32x16_bf16 v[96:111], v[204:207], v[168:171], v[96:111]
    ds_read_b64_tr_b16 v[196:197], v15 offset:13888
    ds_read_b64_tr_b16 v[198:199], v15 offset:15040
    s_waitcnt lgkmcnt(10)
    v_mfma_f32_32x32x16_bf16 v[112:127], v[176:179], v[168:171], v[112:127]
    ds_read_b64_tr_b16 v[200:201], v15 offset:13920
    ds_read_b64_tr_b16 v[202:203], v15 offset:15072
    s_waitcnt lgkmcnt(10)
    v_mfma_f32_32x32x16_bf16 v[128:143], v[180:183], v[168:171], v[128:143]
    ds_read_b64_tr_b16 v[204:205], v15 offset:13952
    ds_read_b64_tr_b16 v[206:207], v15 offset:15104
    s_waitcnt lgkmcnt(10)
    v_mfma_f32_32x32x16_bf16 v[144:159], v[184:187], v[168:171], v[144:159]
    ds_read_b64_tr_b16 v[176:177], v15 offset:13984
    ds_read_b64_tr_b16 v[178:179], v15 offset:15136
    s_mov_b32 s34, 4096
    buffer_load_dwordx4 v[168:171], v6, s[28:31], s34 offen offset:2048
    s_waitcnt vmcnt(13)
    s_waitcnt lgkmcnt(10)
    v_mfma_f32_32x32x16_bf16 v[16:31], v[188:191], v[172:175], v[16:31]
    ds_read_b64_tr_b16 v[180:181], v15 offset:14016
    ds_read_b64_tr_b16 v[182:183], v15 offset:15168
    s_waitcnt lgkmcnt(10)
    v_mfma_f32_32x32x16_bf16 v[32:47], v[192:195], v[172:175], v[32:47]
    ds_read_b64_tr_b16 v[184:185], v15 offset:14048
    ds_read_b64_tr_b16 v[186:187], v15 offset:15200
    s_waitcnt lgkmcnt(10)
    v_mfma_f32_32x32x16_bf16 v[48:63], v[196:199], v[172:175], v[48:63]
    ds_read_b64_tr_b16 v[188:189], v15 offset:14080
    ds_read_b64_tr_b16 v[190:191], v15 offset:15232
    s_waitcnt lgkmcnt(10)
    v_mfma_f32_32x32x16_bf16 v[64:79], v[200:203], v[172:175], v[64:79]
    s_waitcnt vmcnt(8)
    s_barrier
    ds_read_b64_tr_b16 v[192:193], v15 offset:37120
    ds_read_b64_tr_b16 v[194:195], v15 offset:38272
    s_add_u32 m0, s44, 111360
    s_mov_b32 s33, 1769472
    buffer_load_dwordx4 v10, s[20:23], s33 offen lds
    s_waitcnt lgkmcnt(10)
    v_mfma_f32_32x32x16_bf16 v[80:95], v[204:207], v[172:175], v[80:95]
    ds_read_b64_tr_b16 v[196:197], v15 offset:37152
    ds_read_b64_tr_b16 v[198:199], v15 offset:38304
    s_add_u32 m0, s45, 111360
    s_nop 0
    buffer_load_dwordx4 v11, s[20:23], s33 offen lds
    s_waitcnt lgkmcnt(10)
    v_mfma_f32_32x32x16_bf16 v[96:111], v[176:179], v[172:175], v[96:111]
    ds_read_b64_tr_b16 v[200:201], v15 offset:37184
    ds_read_b64_tr_b16 v[202:203], v15 offset:38336
    s_add_u32 m0, s46, 111360
    s_nop 0
    buffer_load_dwordx4 v12, s[52:55], s33 offen lds
    s_waitcnt lgkmcnt(10)
    v_mfma_f32_32x32x16_bf16 v[112:127], v[180:183], v[172:175], v[112:127]
    ds_read_b64_tr_b16 v[204:205], v15 offset:37216
    ds_read_b64_tr_b16 v[206:207], v15 offset:38368
    s_add_u32 m0, s47, 111360
    s_nop 0
    buffer_load_dwordx4 v13, s[24:27], s33 offen lds
    s_waitcnt lgkmcnt(10)
    v_mfma_f32_32x32x16_bf16 v[128:143], v[184:187], v[172:175], v[128:143]
    ds_read_b64_tr_b16 v[176:177], v15 offset:37248
    ds_read_b64_tr_b16 v[178:179], v15 offset:38400
    s_add_u32 m0, s48, 111360
    s_nop 0
    buffer_load_dwordx4 v14, s[24:27], s33 offen lds
    s_waitcnt lgkmcnt(10)
    v_mfma_f32_32x32x16_bf16 v[144:159], v[188:191], v[172:175], v[144:159]
    ds_read_b64_tr_b16 v[180:181], v15 offset:37280
    ds_read_b64_tr_b16 v[182:183], v15 offset:38432
    s_mov_b32 s34, 4096
    buffer_load_dwordx4 v[172:175], v6, s[28:31], s34 offen offset:3072
    s_waitcnt vmcnt(8)
    s_waitcnt lgkmcnt(10)
    v_mfma_f32_32x32x16_bf16 v[16:31], v[192:195], v[160:163], v[16:31]
    ds_read_b64_tr_b16 v[184:185], v15 offset:37312
    ds_read_b64_tr_b16 v[186:187], v15 offset:38464
    s_waitcnt lgkmcnt(10)
    v_mfma_f32_32x32x16_bf16 v[32:47], v[196:199], v[160:163], v[32:47]
    ds_read_b64_tr_b16 v[188:189], v15 offset:37344
    ds_read_b64_tr_b16 v[190:191], v15 offset:38496
    s_waitcnt lgkmcnt(10)
    v_mfma_f32_32x32x16_bf16 v[48:63], v[200:203], v[160:163], v[48:63]
    ds_read_b64_tr_b16 v[192:193], v15 offset:37376
    ds_read_b64_tr_b16 v[194:195], v15 offset:38528
    s_waitcnt lgkmcnt(10)
    v_mfma_f32_32x32x16_bf16 v[64:79], v[204:207], v[160:163], v[64:79]
    ds_read_b64_tr_b16 v[196:197], v15 offset:41728
    ds_read_b64_tr_b16 v[198:199], v15 offset:42880
    s_waitcnt lgkmcnt(10)
    v_mfma_f32_32x32x16_bf16 v[80:95], v[176:179], v[160:163], v[80:95]
    ds_read_b64_tr_b16 v[200:201], v15 offset:41760
    ds_read_b64_tr_b16 v[202:203], v15 offset:42912
    s_waitcnt lgkmcnt(10)
    v_mfma_f32_32x32x16_bf16 v[96:111], v[180:183], v[160:163], v[96:111]
    ds_read_b64_tr_b16 v[204:205], v15 offset:41792
    ds_read_b64_tr_b16 v[206:207], v15 offset:42944
    s_waitcnt lgkmcnt(10)
    v_mfma_f32_32x32x16_bf16 v[112:127], v[184:187], v[160:163], v[112:127]
    ds_read_b64_tr_b16 v[176:177], v15 offset:41824
    ds_read_b64_tr_b16 v[178:179], v15 offset:42976
    s_waitcnt lgkmcnt(10)
    v_mfma_f32_32x32x16_bf16 v[128:143], v[188:191], v[160:163], v[128:143]
    ds_read_b64_tr_b16 v[180:181], v15 offset:41856
    ds_read_b64_tr_b16 v[182:183], v15 offset:43008
    s_waitcnt lgkmcnt(10)
    v_mfma_f32_32x32x16_bf16 v[144:159], v[192:195], v[160:163], v[144:159]
    ds_read_b64_tr_b16 v[184:185], v15 offset:41888
    ds_read_b64_tr_b16 v[186:187], v15 offset:43040
    s_mov_b32 s34, 8192
    buffer_load_dwordx4 v[160:163], v6, s[28:31], s34 offen offset:0
    s_waitcnt vmcnt(8)
    s_waitcnt lgkmcnt(10)
    v_mfma_f32_32x32x16_bf16 v[16:31], v[196:199], v[164:167], v[16:31]
    ds_read_b64_tr_b16 v[188:189], v15 offset:41920
    ds_read_b64_tr_b16 v[190:191], v15 offset:43072
    s_waitcnt lgkmcnt(10)
    v_mfma_f32_32x32x16_bf16 v[32:47], v[200:203], v[164:167], v[32:47]
    ds_read_b64_tr_b16 v[192:193], v15 offset:41952
    ds_read_b64_tr_b16 v[194:195], v15 offset:43104
    s_waitcnt lgkmcnt(10)
    v_mfma_f32_32x32x16_bf16 v[48:63], v[204:207], v[164:167], v[48:63]
    ds_read_b64_tr_b16 v[196:197], v15 offset:41984
    ds_read_b64_tr_b16 v[198:199], v15 offset:43136
    s_waitcnt lgkmcnt(10)
    v_mfma_f32_32x32x16_bf16 v[64:79], v[176:179], v[164:167], v[64:79]
    ds_read_b64_tr_b16 v[200:201], v15 offset:46336
    ds_read_b64_tr_b16 v[202:203], v15 offset:47488
    s_waitcnt lgkmcnt(10)
    v_mfma_f32_32x32x16_bf16 v[80:95], v[180:183], v[164:167], v[80:95]
    ds_read_b64_tr_b16 v[204:205], v15 offset:46368
    ds_read_b64_tr_b16 v[206:207], v15 offset:47520
    s_waitcnt lgkmcnt(10)
    v_mfma_f32_32x32x16_bf16 v[96:111], v[184:187], v[164:167], v[96:111]
    ds_read_b64_tr_b16 v[176:177], v15 offset:46400
    ds_read_b64_tr_b16 v[178:179], v15 offset:47552
    s_waitcnt lgkmcnt(10)
    v_mfma_f32_32x32x16_bf16 v[112:127], v[188:191], v[164:167], v[112:127]
    ds_read_b64_tr_b16 v[180:181], v15 offset:46432
    ds_read_b64_tr_b16 v[182:183], v15 offset:47584
    s_waitcnt lgkmcnt(10)
    v_mfma_f32_32x32x16_bf16 v[128:143], v[192:195], v[164:167], v[128:143]
    ds_read_b64_tr_b16 v[184:185], v15 offset:46464
    ds_read_b64_tr_b16 v[186:187], v15 offset:47616
    s_waitcnt lgkmcnt(10)
    v_mfma_f32_32x32x16_bf16 v[144:159], v[196:199], v[164:167], v[144:159]
    ds_read_b64_tr_b16 v[188:189], v15 offset:46496
    ds_read_b64_tr_b16 v[190:191], v15 offset:47648
    s_mov_b32 s34, 8192
    buffer_load_dwordx4 v[164:167], v6, s[28:31], s34 offen offset:1024
    s_waitcnt vmcnt(8)
    s_waitcnt lgkmcnt(10)
    v_mfma_f32_32x32x16_bf16 v[16:31], v[200:203], v[168:171], v[16:31]
    ds_read_b64_tr_b16 v[192:193], v15 offset:46528
    ds_read_b64_tr_b16 v[194:195], v15 offset:47680
    s_waitcnt lgkmcnt(10)
    v_mfma_f32_32x32x16_bf16 v[32:47], v[204:207], v[168:171], v[32:47]
    ds_read_b64_tr_b16 v[196:197], v15 offset:46560
    ds_read_b64_tr_b16 v[198:199], v15 offset:47712
    s_waitcnt lgkmcnt(10)
    v_mfma_f32_32x32x16_bf16 v[48:63], v[176:179], v[168:171], v[48:63]
    ds_read_b64_tr_b16 v[200:201], v15 offset:46592
    ds_read_b64_tr_b16 v[202:203], v15 offset:47744
    s_waitcnt lgkmcnt(10)
    v_mfma_f32_32x32x16_bf16 v[64:79], v[180:183], v[168:171], v[64:79]
    ds_read_b64_tr_b16 v[204:205], v15 offset:50944
    ds_read_b64_tr_b16 v[206:207], v15 offset:52096
    s_waitcnt lgkmcnt(10)
    v_mfma_f32_32x32x16_bf16 v[80:95], v[184:187], v[168:171], v[80:95]
    ds_read_b64_tr_b16 v[176:177], v15 offset:50976
    ds_read_b64_tr_b16 v[178:179], v15 offset:52128
    s_waitcnt lgkmcnt(10)
    v_mfma_f32_32x32x16_bf16 v[96:111], v[188:191], v[168:171], v[96:111]
    ds_read_b64_tr_b16 v[180:181], v15 offset:51008
    ds_read_b64_tr_b16 v[182:183], v15 offset:52160
    s_waitcnt lgkmcnt(10)
    v_mfma_f32_32x32x16_bf16 v[112:127], v[192:195], v[168:171], v[112:127]
    ds_read_b64_tr_b16 v[184:185], v15 offset:51040
    ds_read_b64_tr_b16 v[186:187], v15 offset:52192
    s_waitcnt lgkmcnt(10)
    v_mfma_f32_32x32x16_bf16 v[128:143], v[196:199], v[168:171], v[128:143]
    ds_read_b64_tr_b16 v[188:189], v15 offset:51072
    ds_read_b64_tr_b16 v[190:191], v15 offset:52224
    s_waitcnt lgkmcnt(10)
    v_mfma_f32_32x32x16_bf16 v[144:159], v[200:203], v[168:171], v[144:159]
    ds_read_b64_tr_b16 v[192:193], v15 offset:51104
    ds_read_b64_tr_b16 v[194:195], v15 offset:52256
    s_mov_b32 s34, 8192
    buffer_load_dwordx4 v[168:171], v6, s[28:31], s34 offen offset:2048
    s_waitcnt vmcnt(3)
    s_waitcnt lgkmcnt(10)
    v_mfma_f32_32x32x16_bf16 v[16:31], v[204:207], v[172:175], v[16:31]
    ds_read_b64_tr_b16 v[196:197], v15 offset:51136
    ds_read_b64_tr_b16 v[198:199], v15 offset:52288
    s_waitcnt lgkmcnt(10)
    v_mfma_f32_32x32x16_bf16 v[32:47], v[176:179], v[172:175], v[32:47]
    ds_read_b64_tr_b16 v[200:201], v15 offset:51168
    ds_read_b64_tr_b16 v[202:203], v15 offset:52320
    s_waitcnt lgkmcnt(10)
    v_mfma_f32_32x32x16_bf16 v[48:63], v[180:183], v[172:175], v[48:63]
    ds_read_b64_tr_b16 v[204:205], v15 offset:51200
    ds_read_b64_tr_b16 v[206:207], v15 offset:52352
    s_waitcnt lgkmcnt(10)
    v_mfma_f32_32x32x16_bf16 v[64:79], v[184:187], v[172:175], v[64:79]
    s_barrier
    ds_read_b64_tr_b16 v[176:177], v9 offset:0
    ds_read_b64_tr_b16 v[178:179], v9 offset:1152
    s_add_u32 m0, s44, 0
    s_mov_b32 s33, 2359296
    buffer_load_dwordx4 v10, s[20:23], s33 offen lds
    s_waitcnt lgkmcnt(10)
    v_mfma_f32_32x32x16_bf16 v[80:95], v[188:191], v[172:175], v[80:95]
    ds_read_b64_tr_b16 v[180:181], v9 offset:32
    ds_read_b64_tr_b16 v[182:183], v9 offset:1184
    s_add_u32 m0, s45, 0
    s_nop 0
    buffer_load_dwordx4 v11, s[20:23], s33 offen lds
    s_waitcnt lgkmcnt(10)
    v_mfma_f32_32x32x16_bf16 v[96:111], v[192:195], v[172:175], v[96:111]
    ds_read_b64_tr_b16 v[184:185], v9 offset:64
    ds_read_b64_tr_b16 v[186:187], v9 offset:1216
    s_add_u32 m0, s46, 0
    s_nop 0
    buffer_load_dwordx4 v12, s[52:55], s33 offen lds
    s_waitcnt lgkmcnt(10)
    v_mfma_f32_32x32x16_bf16 v[112:127], v[196:199], v[172:175], v[112:127]
    ds_read_b64_tr_b16 v[188:189], v9 offset:96
    ds_read_b64_tr_b16 v[190:191], v9 offset:1248
    s_add_u32 m0, s47, 0
    s_nop 0
    buffer_load_dwordx4 v13, s[24:27], s33 offen lds
    s_waitcnt lgkmcnt(10)
    v_mfma_f32_32x32x16_bf16 v[128:143], v[200:203], v[172:175], v[128:143]
    ds_read_b64_tr_b16 v[192:193], v9 offset:128
    ds_read_b64_tr_b16 v[194:195], v9 offset:1280
    s_add_u32 m0, s48, 0
    s_nop 0
    buffer_load_dwordx4 v14, s[24:27], s33 offen lds
    s_waitcnt lgkmcnt(10)
    v_mfma_f32_32x32x16_bf16 v[144:159], v[204:207], v[172:175], v[144:159]
    ds_read_b64_tr_b16 v[196:197], v9 offset:160
    ds_read_b64_tr_b16 v[198:199], v9 offset:1312
    s_mov_b32 s34, 8192
    buffer_load_dwordx4 v[172:175], v6, s[28:31], s34 offen offset:3072
    s_waitcnt vmcnt(8)
    s_waitcnt lgkmcnt(10)
    v_mfma_f32_32x32x16_bf16 v[16:31], v[176:179], v[160:163], v[16:31]
    ds_read_b64_tr_b16 v[200:201], v9 offset:192
    ds_read_b64_tr_b16 v[202:203], v9 offset:1344
    s_waitcnt lgkmcnt(10)
    v_mfma_f32_32x32x16_bf16 v[32:47], v[180:183], v[160:163], v[32:47]
    ds_read_b64_tr_b16 v[204:205], v9 offset:224
    ds_read_b64_tr_b16 v[206:207], v9 offset:1376
    s_waitcnt lgkmcnt(10)
    v_mfma_f32_32x32x16_bf16 v[48:63], v[184:187], v[160:163], v[48:63]
    ds_read_b64_tr_b16 v[176:177], v9 offset:256
    ds_read_b64_tr_b16 v[178:179], v9 offset:1408
    s_waitcnt lgkmcnt(10)
    v_mfma_f32_32x32x16_bf16 v[64:79], v[188:191], v[160:163], v[64:79]
    ds_read_b64_tr_b16 v[180:181], v9 offset:4608
    ds_read_b64_tr_b16 v[182:183], v9 offset:5760
    s_waitcnt lgkmcnt(10)
    v_mfma_f32_32x32x16_bf16 v[80:95], v[192:195], v[160:163], v[80:95]
    ds_read_b64_tr_b16 v[184:185], v9 offset:4640
    ds_read_b64_tr_b16 v[186:187], v9 offset:5792
    s_waitcnt lgkmcnt(10)
    v_mfma_f32_32x32x16_bf16 v[96:111], v[196:199], v[160:163], v[96:111]
    ds_read_b64_tr_b16 v[188:189], v9 offset:4672
    ds_read_b64_tr_b16 v[190:191], v9 offset:5824
    s_waitcnt lgkmcnt(10)
    v_mfma_f32_32x32x16_bf16 v[112:127], v[200:203], v[160:163], v[112:127]
    ds_read_b64_tr_b16 v[192:193], v9 offset:4704
    ds_read_b64_tr_b16 v[194:195], v9 offset:5856
    s_waitcnt lgkmcnt(10)
    v_mfma_f32_32x32x16_bf16 v[128:143], v[204:207], v[160:163], v[128:143]
    ds_read_b64_tr_b16 v[196:197], v9 offset:4736
    ds_read_b64_tr_b16 v[198:199], v9 offset:5888
    s_waitcnt lgkmcnt(10)
    v_mfma_f32_32x32x16_bf16 v[144:159], v[176:179], v[160:163], v[144:159]
    ds_read_b64_tr_b16 v[200:201], v9 offset:4768
    ds_read_b64_tr_b16 v[202:203], v9 offset:5920
    s_mov_b32 s34, 12288
    buffer_load_dwordx4 v[160:163], v6, s[28:31], s34 offen offset:0
    s_waitcnt vmcnt(8)
    s_waitcnt lgkmcnt(10)
    v_mfma_f32_32x32x16_bf16 v[16:31], v[180:183], v[164:167], v[16:31]
    ds_read_b64_tr_b16 v[204:205], v9 offset:4800
    ds_read_b64_tr_b16 v[206:207], v9 offset:5952
    s_waitcnt lgkmcnt(10)
    v_mfma_f32_32x32x16_bf16 v[32:47], v[184:187], v[164:167], v[32:47]
    ds_read_b64_tr_b16 v[176:177], v9 offset:4832
    ds_read_b64_tr_b16 v[178:179], v9 offset:5984
    s_waitcnt lgkmcnt(10)
    v_mfma_f32_32x32x16_bf16 v[48:63], v[188:191], v[164:167], v[48:63]
    ds_read_b64_tr_b16 v[180:181], v9 offset:4864
    ds_read_b64_tr_b16 v[182:183], v9 offset:6016
    s_waitcnt lgkmcnt(10)
    v_mfma_f32_32x32x16_bf16 v[64:79], v[192:195], v[164:167], v[64:79]
    ds_read_b64_tr_b16 v[184:185], v9 offset:9216
    ds_read_b64_tr_b16 v[186:187], v9 offset:10368
    s_waitcnt lgkmcnt(10)
    v_mfma_f32_32x32x16_bf16 v[80:95], v[196:199], v[164:167], v[80:95]
    ds_read_b64_tr_b16 v[188:189], v9 offset:9248
    ds_read_b64_tr_b16 v[190:191], v9 offset:10400
    s_waitcnt lgkmcnt(10)
    v_mfma_f32_32x32x16_bf16 v[96:111], v[200:203], v[164:167], v[96:111]
    ds_read_b64_tr_b16 v[192:193], v9 offset:9280
    ds_read_b64_tr_b16 v[194:195], v9 offset:10432
    s_waitcnt lgkmcnt(10)
    v_mfma_f32_32x32x16_bf16 v[112:127], v[204:207], v[164:167], v[112:127]
    ds_read_b64_tr_b16 v[196:197], v9 offset:9312
    ds_read_b64_tr_b16 v[198:199], v9 offset:10464
    s_waitcnt lgkmcnt(10)
    v_mfma_f32_32x32x16_bf16 v[128:143], v[176:179], v[164:167], v[128:143]
    ds_read_b64_tr_b16 v[200:201], v9 offset:9344
    ds_read_b64_tr_b16 v[202:203], v9 offset:10496
    s_waitcnt lgkmcnt(10)
    v_mfma_f32_32x32x16_bf16 v[144:159], v[180:183], v[164:167], v[144:159]
    ds_read_b64_tr_b16 v[204:205], v9 offset:9376
    ds_read_b64_tr_b16 v[206:207], v9 offset:10528
    s_mov_b32 s34, 12288
    buffer_load_dwordx4 v[164:167], v6, s[28:31], s34 offen offset:1024
    s_waitcnt vmcnt(8)
    s_waitcnt lgkmcnt(10)
    v_mfma_f32_32x32x16_bf16 v[16:31], v[184:187], v[168:171], v[16:31]
    ds_read_b64_tr_b16 v[176:177], v9 offset:9408
    ds_read_b64_tr_b16 v[178:179], v9 offset:10560
    s_waitcnt lgkmcnt(10)
    v_mfma_f32_32x32x16_bf16 v[32:47], v[188:191], v[168:171], v[32:47]
    ds_read_b64_tr_b16 v[180:181], v9 offset:9440
    ds_read_b64_tr_b16 v[182:183], v9 offset:10592
    s_waitcnt lgkmcnt(10)
    v_mfma_f32_32x32x16_bf16 v[48:63], v[192:195], v[168:171], v[48:63]
    ds_read_b64_tr_b16 v[184:185], v9 offset:9472
    ds_read_b64_tr_b16 v[186:187], v9 offset:10624
    s_waitcnt lgkmcnt(10)
    v_mfma_f32_32x32x16_bf16 v[64:79], v[196:199], v[168:171], v[64:79]
    ds_read_b64_tr_b16 v[188:189], v9 offset:13824
    ds_read_b64_tr_b16 v[190:191], v9 offset:14976
    s_waitcnt lgkmcnt(10)
    v_mfma_f32_32x32x16_bf16 v[80:95], v[200:203], v[168:171], v[80:95]
    ds_read_b64_tr_b16 v[192:193], v9 offset:13856
    ds_read_b64_tr_b16 v[194:195], v9 offset:15008
    s_waitcnt lgkmcnt(10)
    v_mfma_f32_32x32x16_bf16 v[96:111], v[204:207], v[168:171], v[96:111]
    ds_read_b64_tr_b16 v[196:197], v9 offset:13888
    ds_read_b64_tr_b16 v[198:199], v9 offset:15040
    s_waitcnt lgkmcnt(10)
    v_mfma_f32_32x32x16_bf16 v[112:127], v[176:179], v[168:171], v[112:127]
    ds_read_b64_tr_b16 v[200:201], v9 offset:13920
    ds_read_b64_tr_b16 v[202:203], v9 offset:15072
    s_waitcnt lgkmcnt(10)
    v_mfma_f32_32x32x16_bf16 v[128:143], v[180:183], v[168:171], v[128:143]
    ds_read_b64_tr_b16 v[204:205], v9 offset:13952
    ds_read_b64_tr_b16 v[206:207], v9 offset:15104
    s_waitcnt lgkmcnt(10)
    v_mfma_f32_32x32x16_bf16 v[144:159], v[184:187], v[168:171], v[144:159]
    ds_read_b64_tr_b16 v[176:177], v9 offset:13984
    ds_read_b64_tr_b16 v[178:179], v9 offset:15136
    s_mov_b32 s34, 12288
    buffer_load_dwordx4 v[168:171], v6, s[28:31], s34 offen offset:2048
    s_waitcnt vmcnt(3)
    s_waitcnt lgkmcnt(10)
    v_mfma_f32_32x32x16_bf16 v[16:31], v[188:191], v[172:175], v[16:31]
    ds_read_b64_tr_b16 v[180:181], v9 offset:14016
    ds_read_b64_tr_b16 v[182:183], v9 offset:15168
    s_waitcnt lgkmcnt(10)
    v_mfma_f32_32x32x16_bf16 v[32:47], v[192:195], v[172:175], v[32:47]
    ds_read_b64_tr_b16 v[184:185], v9 offset:14048
    ds_read_b64_tr_b16 v[186:187], v9 offset:15200
    s_waitcnt lgkmcnt(10)
    v_mfma_f32_32x32x16_bf16 v[48:63], v[196:199], v[172:175], v[48:63]
    ds_read_b64_tr_b16 v[188:189], v9 offset:14080
    ds_read_b64_tr_b16 v[190:191], v9 offset:15232
    s_waitcnt lgkmcnt(10)
    v_mfma_f32_32x32x16_bf16 v[64:79], v[200:203], v[172:175], v[64:79]
    s_barrier
    ds_read_b64_tr_b16 v[192:193], v9 offset:37120
    ds_read_b64_tr_b16 v[194:195], v9 offset:38272
    s_add_u32 m0, s44, 37120
    s_mov_b32 s33, 2949120
    buffer_load_dwordx4 v10, s[20:23], s33 offen lds
    s_waitcnt lgkmcnt(10)
    v_mfma_f32_32x32x16_bf16 v[80:95], v[204:207], v[172:175], v[80:95]
    ds_read_b64_tr_b16 v[196:197], v9 offset:37152
    ds_read_b64_tr_b16 v[198:199], v9 offset:38304
    s_add_u32 m0, s45, 37120
    s_nop 0
    buffer_load_dwordx4 v11, s[20:23], s33 offen lds
    s_waitcnt lgkmcnt(10)
    v_mfma_f32_32x32x16_bf16 v[96:111], v[176:179], v[172:175], v[96:111]
    ds_read_b64_tr_b16 v[200:201], v9 offset:37184
    ds_read_b64_tr_b16 v[202:203], v9 offset:38336
    s_add_u32 m0, s46, 37120
    s_nop 0
    buffer_load_dwordx4 v12, s[52:55], s33 offen lds
    s_waitcnt lgkmcnt(10)
    v_mfma_f32_32x32x16_bf16 v[112:127], v[180:183], v[172:175], v[112:127]
    ds_read_b64_tr_b16 v[204:205], v9 offset:37216
    ds_read_b64_tr_b16 v[206:207], v9 offset:38368
    s_add_u32 m0, s47, 37120
    s_nop 0
    buffer_load_dwordx4 v13, s[24:27], s33 offen lds
    s_waitcnt lgkmcnt(10)
    v_mfma_f32_32x32x16_bf16 v[128:143], v[184:187], v[172:175], v[128:143]
    ds_read_b64_tr_b16 v[176:177], v9 offset:37248
    ds_read_b64_tr_b16 v[178:179], v9 offset:38400
    s_add_u32 m0, s48, 37120
    s_nop 0
    buffer_load_dwordx4 v14, s[24:27], s33 offen lds
    s_waitcnt lgkmcnt(10)
    v_mfma_f32_32x32x16_bf16 v[144:159], v[188:191], v[172:175], v[144:159]
    ds_read_b64_tr_b16 v[180:181], v9 offset:37280
    ds_read_b64_tr_b16 v[182:183], v9 offset:38432
    s_mov_b32 s34, 12288
    buffer_load_dwordx4 v[172:175], v6, s[28:31], s34 offen offset:3072
    s_waitcnt vmcnt(8)
    s_waitcnt lgkmcnt(10)
    v_mfma_f32_32x32x16_bf16 v[16:31], v[192:195], v[160:163], v[16:31]
    ds_read_b64_tr_b16 v[184:185], v9 offset:37312
    ds_read_b64_tr_b16 v[186:187], v9 offset:38464
    s_waitcnt lgkmcnt(10)
    v_mfma_f32_32x32x16_bf16 v[32:47], v[196:199], v[160:163], v[32:47]
    ds_read_b64_tr_b16 v[188:189], v9 offset:37344
    ds_read_b64_tr_b16 v[190:191], v9 offset:38496
    s_waitcnt lgkmcnt(10)
    v_mfma_f32_32x32x16_bf16 v[48:63], v[200:203], v[160:163], v[48:63]
    ds_read_b64_tr_b16 v[192:193], v9 offset:37376
    ds_read_b64_tr_b16 v[194:195], v9 offset:38528
    s_waitcnt lgkmcnt(10)
    v_mfma_f32_32x32x16_bf16 v[64:79], v[204:207], v[160:163], v[64:79]
    ds_read_b64_tr_b16 v[196:197], v9 offset:41728
    ds_read_b64_tr_b16 v[198:199], v9 offset:42880
    s_waitcnt lgkmcnt(10)
    v_mfma_f32_32x32x16_bf16 v[80:95], v[176:179], v[160:163], v[80:95]
    ds_read_b64_tr_b16 v[200:201], v9 offset:41760
    ds_read_b64_tr_b16 v[202:203], v9 offset:42912
    s_waitcnt lgkmcnt(10)
    v_mfma_f32_32x32x16_bf16 v[96:111], v[180:183], v[160:163], v[96:111]
    ds_read_b64_tr_b16 v[204:205], v9 offset:41792
    ds_read_b64_tr_b16 v[206:207], v9 offset:42944
    s_waitcnt lgkmcnt(10)
    v_mfma_f32_32x32x16_bf16 v[112:127], v[184:187], v[160:163], v[112:127]
    ds_read_b64_tr_b16 v[176:177], v9 offset:41824
    ds_read_b64_tr_b16 v[178:179], v9 offset:42976
    s_waitcnt lgkmcnt(10)
    v_mfma_f32_32x32x16_bf16 v[128:143], v[188:191], v[160:163], v[128:143]
    ds_read_b64_tr_b16 v[180:181], v9 offset:41856
    ds_read_b64_tr_b16 v[182:183], v9 offset:43008
    s_waitcnt lgkmcnt(10)
    v_mfma_f32_32x32x16_bf16 v[144:159], v[192:195], v[160:163], v[144:159]
    ds_read_b64_tr_b16 v[184:185], v9 offset:41888
    ds_read_b64_tr_b16 v[186:187], v9 offset:43040
    s_mov_b32 s34, 16384
    buffer_load_dwordx4 v[160:163], v6, s[28:31], s34 offen offset:0
    s_waitcnt vmcnt(8)
    s_waitcnt lgkmcnt(10)
    v_mfma_f32_32x32x16_bf16 v[16:31], v[196:199], v[164:167], v[16:31]
    ds_read_b64_tr_b16 v[188:189], v9 offset:41920
    ds_read_b64_tr_b16 v[190:191], v9 offset:43072
    s_waitcnt lgkmcnt(10)
    v_mfma_f32_32x32x16_bf16 v[32:47], v[200:203], v[164:167], v[32:47]
    ds_read_b64_tr_b16 v[192:193], v9 offset:41952
    ds_read_b64_tr_b16 v[194:195], v9 offset:43104
    s_waitcnt lgkmcnt(10)
    v_mfma_f32_32x32x16_bf16 v[48:63], v[204:207], v[164:167], v[48:63]
    ds_read_b64_tr_b16 v[196:197], v9 offset:41984
    ds_read_b64_tr_b16 v[198:199], v9 offset:43136
    s_waitcnt lgkmcnt(10)
    v_mfma_f32_32x32x16_bf16 v[64:79], v[176:179], v[164:167], v[64:79]
    ds_read_b64_tr_b16 v[200:201], v9 offset:46336
    ds_read_b64_tr_b16 v[202:203], v9 offset:47488
    s_waitcnt lgkmcnt(10)
    v_mfma_f32_32x32x16_bf16 v[80:95], v[180:183], v[164:167], v[80:95]
    ds_read_b64_tr_b16 v[204:205], v9 offset:46368
    ds_read_b64_tr_b16 v[206:207], v9 offset:47520
    s_waitcnt lgkmcnt(10)
    v_mfma_f32_32x32x16_bf16 v[96:111], v[184:187], v[164:167], v[96:111]
    ds_read_b64_tr_b16 v[176:177], v9 offset:46400
    ds_read_b64_tr_b16 v[178:179], v9 offset:47552
    s_waitcnt lgkmcnt(10)
    v_mfma_f32_32x32x16_bf16 v[112:127], v[188:191], v[164:167], v[112:127]
    ds_read_b64_tr_b16 v[180:181], v9 offset:46432
    ds_read_b64_tr_b16 v[182:183], v9 offset:47584
    s_waitcnt lgkmcnt(10)
    v_mfma_f32_32x32x16_bf16 v[128:143], v[192:195], v[164:167], v[128:143]
    ds_read_b64_tr_b16 v[184:185], v9 offset:46464
    ds_read_b64_tr_b16 v[186:187], v9 offset:47616
    s_waitcnt lgkmcnt(10)
    v_mfma_f32_32x32x16_bf16 v[144:159], v[196:199], v[164:167], v[144:159]
    ds_read_b64_tr_b16 v[188:189], v9 offset:46496
    ds_read_b64_tr_b16 v[190:191], v9 offset:47648
    s_mov_b32 s34, 16384
    buffer_load_dwordx4 v[164:167], v6, s[28:31], s34 offen offset:1024
    s_waitcnt vmcnt(8)
    s_waitcnt lgkmcnt(10)
    v_mfma_f32_32x32x16_bf16 v[16:31], v[200:203], v[168:171], v[16:31]
    ds_read_b64_tr_b16 v[192:193], v9 offset:46528
    ds_read_b64_tr_b16 v[194:195], v9 offset:47680
    s_waitcnt lgkmcnt(10)
    v_mfma_f32_32x32x16_bf16 v[32:47], v[204:207], v[168:171], v[32:47]
    ds_read_b64_tr_b16 v[196:197], v9 offset:46560
    ds_read_b64_tr_b16 v[198:199], v9 offset:47712
    s_waitcnt lgkmcnt(10)
    v_mfma_f32_32x32x16_bf16 v[48:63], v[176:179], v[168:171], v[48:63]
    ds_read_b64_tr_b16 v[200:201], v9 offset:46592
    ds_read_b64_tr_b16 v[202:203], v9 offset:47744
    s_waitcnt lgkmcnt(10)
    v_mfma_f32_32x32x16_bf16 v[64:79], v[180:183], v[168:171], v[64:79]
    ds_read_b64_tr_b16 v[204:205], v9 offset:50944
    ds_read_b64_tr_b16 v[206:207], v9 offset:52096
    s_waitcnt lgkmcnt(10)
    v_mfma_f32_32x32x16_bf16 v[80:95], v[184:187], v[168:171], v[80:95]
    ds_read_b64_tr_b16 v[176:177], v9 offset:50976
    ds_read_b64_tr_b16 v[178:179], v9 offset:52128
    s_waitcnt lgkmcnt(10)
    v_mfma_f32_32x32x16_bf16 v[96:111], v[188:191], v[168:171], v[96:111]
    ds_read_b64_tr_b16 v[180:181], v9 offset:51008
    ds_read_b64_tr_b16 v[182:183], v9 offset:52160
    s_waitcnt lgkmcnt(10)
    v_mfma_f32_32x32x16_bf16 v[112:127], v[192:195], v[168:171], v[112:127]
    ds_read_b64_tr_b16 v[184:185], v9 offset:51040
    ds_read_b64_tr_b16 v[186:187], v9 offset:52192
    s_waitcnt lgkmcnt(10)
    v_mfma_f32_32x32x16_bf16 v[128:143], v[196:199], v[168:171], v[128:143]
    ds_read_b64_tr_b16 v[188:189], v9 offset:51072
    ds_read_b64_tr_b16 v[190:191], v9 offset:52224
    s_waitcnt lgkmcnt(10)
    v_mfma_f32_32x32x16_bf16 v[144:159], v[200:203], v[168:171], v[144:159]
    ds_read_b64_tr_b16 v[192:193], v9 offset:51104
    ds_read_b64_tr_b16 v[194:195], v9 offset:52256
    s_mov_b32 s34, 16384
    buffer_load_dwordx4 v[168:171], v6, s[28:31], s34 offen offset:2048
    s_waitcnt vmcnt(3)
    s_waitcnt lgkmcnt(10)
    v_mfma_f32_32x32x16_bf16 v[16:31], v[204:207], v[172:175], v[16:31]
    ds_read_b64_tr_b16 v[196:197], v9 offset:51136
    ds_read_b64_tr_b16 v[198:199], v9 offset:52288
    s_waitcnt lgkmcnt(10)
    v_mfma_f32_32x32x16_bf16 v[32:47], v[176:179], v[172:175], v[32:47]
    ds_read_b64_tr_b16 v[200:201], v9 offset:51168
    ds_read_b64_tr_b16 v[202:203], v9 offset:52320
    s_waitcnt lgkmcnt(10)
    v_mfma_f32_32x32x16_bf16 v[48:63], v[180:183], v[172:175], v[48:63]
    ds_read_b64_tr_b16 v[204:205], v9 offset:51200
    ds_read_b64_tr_b16 v[206:207], v9 offset:52352
    s_waitcnt lgkmcnt(10)
    v_mfma_f32_32x32x16_bf16 v[64:79], v[184:187], v[172:175], v[64:79]
    s_barrier
    ds_read_b64_tr_b16 v[176:177], v15 offset:0
    ds_read_b64_tr_b16 v[178:179], v15 offset:1152
    s_add_u32 m0, s44, 74240
    s_mov_b32 s33, 3538944
    buffer_load_dwordx4 v10, s[20:23], s33 offen lds
    s_waitcnt lgkmcnt(10)
    v_mfma_f32_32x32x16_bf16 v[80:95], v[188:191], v[172:175], v[80:95]
    ds_read_b64_tr_b16 v[180:181], v15 offset:32
    ds_read_b64_tr_b16 v[182:183], v15 offset:1184
    s_add_u32 m0, s45, 74240
    s_nop 0
    buffer_load_dwordx4 v11, s[20:23], s33 offen lds
    s_waitcnt lgkmcnt(10)
    v_mfma_f32_32x32x16_bf16 v[96:111], v[192:195], v[172:175], v[96:111]
    ds_read_b64_tr_b16 v[184:185], v15 offset:64
    ds_read_b64_tr_b16 v[186:187], v15 offset:1216
    s_add_u32 m0, s46, 74240
    s_nop 0
    buffer_load_dwordx4 v12, s[52:55], s33 offen lds
    s_waitcnt lgkmcnt(10)
    v_mfma_f32_32x32x16_bf16 v[112:127], v[196:199], v[172:175], v[112:127]
    ds_read_b64_tr_b16 v[188:189], v15 offset:96
    ds_read_b64_tr_b16 v[190:191], v15 offset:1248
    s_add_u32 m0, s47, 74240
    s_nop 0
    buffer_load_dwordx4 v13, s[24:27], s33 offen lds
    s_waitcnt lgkmcnt(10)
    v_mfma_f32_32x32x16_bf16 v[128:143], v[200:203], v[172:175], v[128:143]
    ds_read_b64_tr_b16 v[192:193], v15 offset:128
    ds_read_b64_tr_b16 v[194:195], v15 offset:1280
    s_add_u32 m0, s48, 74240
    s_nop 0
    buffer_load_dwordx4 v14, s[24:27], s33 offen lds
    s_waitcnt lgkmcnt(10)
    v_mfma_f32_32x32x16_bf16 v[144:159], v[204:207], v[172:175], v[144:159]
    ds_read_b64_tr_b16 v[196:197], v15 offset:160
    ds_read_b64_tr_b16 v[198:199], v15 offset:1312
    s_mov_b32 s34, 16384
    buffer_load_dwordx4 v[172:175], v6, s[28:31], s34 offen offset:3072
    s_waitcnt vmcnt(8)
    s_waitcnt lgkmcnt(10)
    v_mfma_f32_32x32x16_bf16 v[16:31], v[176:179], v[160:163], v[16:31]
    ds_read_b64_tr_b16 v[200:201], v15 offset:192
    ds_read_b64_tr_b16 v[202:203], v15 offset:1344
    s_waitcnt lgkmcnt(10)
    v_mfma_f32_32x32x16_bf16 v[32:47], v[180:183], v[160:163], v[32:47]
    ds_read_b64_tr_b16 v[204:205], v15 offset:224
    ds_read_b64_tr_b16 v[206:207], v15 offset:1376
    s_waitcnt lgkmcnt(10)
    v_mfma_f32_32x32x16_bf16 v[48:63], v[184:187], v[160:163], v[48:63]
    ds_read_b64_tr_b16 v[176:177], v15 offset:256
    ds_read_b64_tr_b16 v[178:179], v15 offset:1408
    s_waitcnt lgkmcnt(10)
    v_mfma_f32_32x32x16_bf16 v[64:79], v[188:191], v[160:163], v[64:79]
    ds_read_b64_tr_b16 v[180:181], v15 offset:4608
    ds_read_b64_tr_b16 v[182:183], v15 offset:5760
    s_waitcnt lgkmcnt(10)
    v_mfma_f32_32x32x16_bf16 v[80:95], v[192:195], v[160:163], v[80:95]
    ds_read_b64_tr_b16 v[184:185], v15 offset:4640
    ds_read_b64_tr_b16 v[186:187], v15 offset:5792
    s_waitcnt lgkmcnt(10)
    v_mfma_f32_32x32x16_bf16 v[96:111], v[196:199], v[160:163], v[96:111]
    ds_read_b64_tr_b16 v[188:189], v15 offset:4672
    ds_read_b64_tr_b16 v[190:191], v15 offset:5824
    s_waitcnt lgkmcnt(10)
    v_mfma_f32_32x32x16_bf16 v[112:127], v[200:203], v[160:163], v[112:127]
    ds_read_b64_tr_b16 v[192:193], v15 offset:4704
    ds_read_b64_tr_b16 v[194:195], v15 offset:5856
    s_waitcnt lgkmcnt(10)
    v_mfma_f32_32x32x16_bf16 v[128:143], v[204:207], v[160:163], v[128:143]
    ds_read_b64_tr_b16 v[196:197], v15 offset:4736
    ds_read_b64_tr_b16 v[198:199], v15 offset:5888
    s_waitcnt lgkmcnt(10)
    v_mfma_f32_32x32x16_bf16 v[144:159], v[176:179], v[160:163], v[144:159]
    ds_read_b64_tr_b16 v[200:201], v15 offset:4768
    ds_read_b64_tr_b16 v[202:203], v15 offset:5920
    s_mov_b32 s34, 20480
    buffer_load_dwordx4 v[160:163], v6, s[28:31], s34 offen offset:0
    s_waitcnt vmcnt(8)
    s_waitcnt lgkmcnt(10)
    v_mfma_f32_32x32x16_bf16 v[16:31], v[180:183], v[164:167], v[16:31]
    ds_read_b64_tr_b16 v[204:205], v15 offset:4800
    ds_read_b64_tr_b16 v[206:207], v15 offset:5952
    s_waitcnt lgkmcnt(10)
    v_mfma_f32_32x32x16_bf16 v[32:47], v[184:187], v[164:167], v[32:47]
    ds_read_b64_tr_b16 v[176:177], v15 offset:4832
    ds_read_b64_tr_b16 v[178:179], v15 offset:5984
    s_waitcnt lgkmcnt(10)
    v_mfma_f32_32x32x16_bf16 v[48:63], v[188:191], v[164:167], v[48:63]
    ds_read_b64_tr_b16 v[180:181], v15 offset:4864
    ds_read_b64_tr_b16 v[182:183], v15 offset:6016
    s_waitcnt lgkmcnt(10)
    v_mfma_f32_32x32x16_bf16 v[64:79], v[192:195], v[164:167], v[64:79]
    ds_read_b64_tr_b16 v[184:185], v15 offset:9216
    ds_read_b64_tr_b16 v[186:187], v15 offset:10368
    s_waitcnt lgkmcnt(10)
    v_mfma_f32_32x32x16_bf16 v[80:95], v[196:199], v[164:167], v[80:95]
    ds_read_b64_tr_b16 v[188:189], v15 offset:9248
    ds_read_b64_tr_b16 v[190:191], v15 offset:10400
    s_waitcnt lgkmcnt(10)
    v_mfma_f32_32x32x16_bf16 v[96:111], v[200:203], v[164:167], v[96:111]
    ds_read_b64_tr_b16 v[192:193], v15 offset:9280
    ds_read_b64_tr_b16 v[194:195], v15 offset:10432
    s_waitcnt lgkmcnt(10)
    v_mfma_f32_32x32x16_bf16 v[112:127], v[204:207], v[164:167], v[112:127]
    ds_read_b64_tr_b16 v[196:197], v15 offset:9312
    ds_read_b64_tr_b16 v[198:199], v15 offset:10464
    s_waitcnt lgkmcnt(10)
    v_mfma_f32_32x32x16_bf16 v[128:143], v[176:179], v[164:167], v[128:143]
    ds_read_b64_tr_b16 v[200:201], v15 offset:9344
    ds_read_b64_tr_b16 v[202:203], v15 offset:10496
    s_waitcnt lgkmcnt(10)
    v_mfma_f32_32x32x16_bf16 v[144:159], v[180:183], v[164:167], v[144:159]
    ds_read_b64_tr_b16 v[204:205], v15 offset:9376
    ds_read_b64_tr_b16 v[206:207], v15 offset:10528
    s_mov_b32 s34, 20480
    buffer_load_dwordx4 v[164:167], v6, s[28:31], s34 offen offset:1024
    s_waitcnt vmcnt(8)
    s_waitcnt lgkmcnt(10)
    v_mfma_f32_32x32x16_bf16 v[16:31], v[184:187], v[168:171], v[16:31]
    ds_read_b64_tr_b16 v[176:177], v15 offset:9408
    ds_read_b64_tr_b16 v[178:179], v15 offset:10560
    s_waitcnt lgkmcnt(10)
    v_mfma_f32_32x32x16_bf16 v[32:47], v[188:191], v[168:171], v[32:47]
    ds_read_b64_tr_b16 v[180:181], v15 offset:9440
    ds_read_b64_tr_b16 v[182:183], v15 offset:10592
    s_waitcnt lgkmcnt(10)
    v_mfma_f32_32x32x16_bf16 v[48:63], v[192:195], v[168:171], v[48:63]
    ds_read_b64_tr_b16 v[184:185], v15 offset:9472
    ds_read_b64_tr_b16 v[186:187], v15 offset:10624
    s_waitcnt lgkmcnt(10)
    v_mfma_f32_32x32x16_bf16 v[64:79], v[196:199], v[168:171], v[64:79]
    ds_read_b64_tr_b16 v[188:189], v15 offset:13824
    ds_read_b64_tr_b16 v[190:191], v15 offset:14976
    s_waitcnt lgkmcnt(10)
    v_mfma_f32_32x32x16_bf16 v[80:95], v[200:203], v[168:171], v[80:95]
    ds_read_b64_tr_b16 v[192:193], v15 offset:13856
    ds_read_b64_tr_b16 v[194:195], v15 offset:15008
    s_waitcnt lgkmcnt(10)
    v_mfma_f32_32x32x16_bf16 v[96:111], v[204:207], v[168:171], v[96:111]
    ds_read_b64_tr_b16 v[196:197], v15 offset:13888
    ds_read_b64_tr_b16 v[198:199], v15 offset:15040
    s_waitcnt lgkmcnt(10)
    v_mfma_f32_32x32x16_bf16 v[112:127], v[176:179], v[168:171], v[112:127]
    ds_read_b64_tr_b16 v[200:201], v15 offset:13920
    ds_read_b64_tr_b16 v[202:203], v15 offset:15072
    s_waitcnt lgkmcnt(10)
    v_mfma_f32_32x32x16_bf16 v[128:143], v[180:183], v[168:171], v[128:143]
    ds_read_b64_tr_b16 v[204:205], v15 offset:13952
    ds_read_b64_tr_b16 v[206:207], v15 offset:15104
    s_waitcnt lgkmcnt(10)
    v_mfma_f32_32x32x16_bf16 v[144:159], v[184:187], v[168:171], v[144:159]
    ds_read_b64_tr_b16 v[176:177], v15 offset:13984
    ds_read_b64_tr_b16 v[178:179], v15 offset:15136
    s_mov_b32 s34, 20480
    buffer_load_dwordx4 v[168:171], v6, s[28:31], s34 offen offset:2048
    s_waitcnt vmcnt(3)
    s_waitcnt lgkmcnt(10)
    v_mfma_f32_32x32x16_bf16 v[16:31], v[188:191], v[172:175], v[16:31]
    ds_read_b64_tr_b16 v[180:181], v15 offset:14016
    ds_read_b64_tr_b16 v[182:183], v15 offset:15168
    s_waitcnt lgkmcnt(10)
    v_mfma_f32_32x32x16_bf16 v[32:47], v[192:195], v[172:175], v[32:47]
    ds_read_b64_tr_b16 v[184:185], v15 offset:14048
    ds_read_b64_tr_b16 v[186:187], v15 offset:15200
    s_waitcnt lgkmcnt(10)
    v_mfma_f32_32x32x16_bf16 v[48:63], v[196:199], v[172:175], v[48:63]
    ds_read_b64_tr_b16 v[188:189], v15 offset:14080
    ds_read_b64_tr_b16 v[190:191], v15 offset:15232
    s_waitcnt lgkmcnt(10)
    v_mfma_f32_32x32x16_bf16 v[64:79], v[200:203], v[172:175], v[64:79]
    s_waitcnt lgkmcnt(0)
    s_barrier
    ds_read_b64_tr_b16 v[192:193], v15 offset:37120
    ds_read_b64_tr_b16 v[194:195], v15 offset:38272
    s_add_u32 m0, s44, 111360
    s_mov_b32 s33, 4128768
    buffer_load_dwordx4 v10, s[20:23], s33 offen lds
    v_mfma_f32_32x32x16_bf16 v[80:95], v[204:207], v[172:175], v[80:95]
    ds_read_b64_tr_b16 v[196:197], v15 offset:37152
    ds_read_b64_tr_b16 v[198:199], v15 offset:38304
    s_add_u32 m0, s45, 111360
    s_nop 0
    buffer_load_dwordx4 v11, s[20:23], s33 offen lds
    v_mfma_f32_32x32x16_bf16 v[96:111], v[176:179], v[172:175], v[96:111]
    ds_read_b64_tr_b16 v[200:201], v15 offset:37184
    ds_read_b64_tr_b16 v[202:203], v15 offset:38336
    s_add_u32 m0, s46, 111360
    s_nop 0
    buffer_load_dwordx4 v12, s[52:55], s33 offen lds
    v_mfma_f32_32x32x16_bf16 v[112:127], v[180:183], v[172:175], v[112:127]
    ds_read_b64_tr_b16 v[204:205], v15 offset:37216
    ds_read_b64_tr_b16 v[206:207], v15 offset:38368
    s_add_u32 m0, s47, 111360
    s_nop 0
    buffer_load_dwordx4 v13, s[24:27], s33 offen lds
    v_mfma_f32_32x32x16_bf16 v[128:143], v[184:187], v[172:175], v[128:143]
    ds_read_b64_tr_b16 v[176:177], v15 offset:37248
    ds_read_b64_tr_b16 v[178:179], v15 offset:38400
    s_add_u32 m0, s48, 111360
    s_nop 0
    buffer_load_dwordx4 v14, s[24:27], s33 offen lds
    v_mfma_f32_32x32x16_bf16 v[144:159], v[188:191], v[172:175], v[144:159]
    ds_read_b64_tr_b16 v[180:181], v15 offset:37280
    ds_read_b64_tr_b16 v[182:183], v15 offset:38432
    s_add_u32 m0, s44, 0
    s_mov_b32 s33, 4718592
    buffer_load_dwordx4 v10, s[20:23], s33 offen lds
    s_waitcnt vmcnt(8)
    s_waitcnt lgkmcnt(10)
    v_mfma_f32_32x32x16_bf16 v[16:31], v[192:195], v[160:163], v[16:31]
    ds_read_b64_tr_b16 v[184:185], v15 offset:37312
    ds_read_b64_tr_b16 v[186:187], v15 offset:38464
    s_add_u32 m0, s45, 0
    s_nop 0
    buffer_load_dwordx4 v11, s[20:23], s33 offen lds
    s_waitcnt lgkmcnt(10)
    v_mfma_f32_32x32x16_bf16 v[32:47], v[196:199], v[160:163], v[32:47]
    ds_read_b64_tr_b16 v[188:189], v15 offset:37344
    ds_read_b64_tr_b16 v[190:191], v15 offset:38496
    s_add_u32 m0, s46, 0
    s_nop 0
    buffer_load_dwordx4 v12, s[52:55], s33 offen lds
    s_waitcnt lgkmcnt(10)
    v_mfma_f32_32x32x16_bf16 v[48:63], v[200:203], v[160:163], v[48:63]
    ds_read_b64_tr_b16 v[192:193], v15 offset:37376
    ds_read_b64_tr_b16 v[194:195], v15 offset:38528
    s_add_u32 m0, s47, 0
    s_nop 0
    buffer_load_dwordx4 v13, s[24:27], s33 offen lds
    s_waitcnt lgkmcnt(10)
    v_mfma_f32_32x32x16_bf16 v[64:79], v[204:207], v[160:163], v[64:79]
    ds_read_b64_tr_b16 v[196:197], v15 offset:41728
    ds_read_b64_tr_b16 v[198:199], v15 offset:42880
    s_add_u32 m0, s48, 0
    s_nop 0
    buffer_load_dwordx4 v14, s[24:27], s33 offen lds
    s_waitcnt lgkmcnt(10)
    v_mfma_f32_32x32x16_bf16 v[80:95], v[176:179], v[160:163], v[80:95]
    ds_read_b64_tr_b16 v[200:201], v15 offset:41760
    ds_read_b64_tr_b16 v[202:203], v15 offset:42912
    s_mov_b32 s34, 28672
    buffer_load_dwordx4 v[240:243], v6, s[28:31], s34 offen offset:0
    s_waitcnt lgkmcnt(10)
    v_mfma_f32_32x32x16_bf16 v[96:111], v[180:183], v[160:163], v[96:111]
    ds_read_b64_tr_b16 v[204:205], v15 offset:41792
    ds_read_b64_tr_b16 v[206:207], v15 offset:42944
    s_mov_b32 s34, 28672
    buffer_load_dwordx4 v[244:247], v6, s[28:31], s34 offen offset:1024
    s_waitcnt lgkmcnt(10)
    v_mfma_f32_32x32x16_bf16 v[112:127], v[184:187], v[160:163], v[112:127]
    ds_read_b64_tr_b16 v[176:177], v15 offset:41824
    ds_read_b64_tr_b16 v[178:179], v15 offset:42976
    s_mov_b32 s34, 28672
    buffer_load_dwordx4 v[248:251], v6, s[28:31], s34 offen offset:2048
    s_waitcnt lgkmcnt(10)
    v_mfma_f32_32x32x16_bf16 v[128:143], v[188:191], v[160:163], v[128:143]
    ds_read_b64_tr_b16 v[180:181], v15 offset:41856
    ds_read_b64_tr_b16 v[182:183], v15 offset:43008
    s_mov_b32 s34, 28672
    buffer_load_dwordx4 v[252:255], v6, s[28:31], s34 offen offset:3072
    s_waitcnt lgkmcnt(10)
    v_mfma_f32_32x32x16_bf16 v[144:159], v[192:195], v[160:163], v[144:159]
    ds_read_b64_tr_b16 v[184:185], v15 offset:41888
    ds_read_b64_tr_b16 v[186:187], v15 offset:43040
    s_mov_b32 s34, 32768
    buffer_load_dwordx4 v[220:223], v6, s[28:31], s34 offen offset:0
    s_waitcnt vmcnt(16)
    s_waitcnt lgkmcnt(10)
    v_mfma_f32_32x32x16_bf16 v[16:31], v[196:199], v[164:167], v[16:31]
    ds_read_b64_tr_b16 v[188:189], v15 offset:41920
    ds_read_b64_tr_b16 v[190:191], v15 offset:43072
    s_mov_b32 s34, 32768
    buffer_load_dwordx4 v[224:227], v6, s[28:31], s34 offen offset:1024
    s_waitcnt lgkmcnt(10)
    v_mfma_f32_32x32x16_bf16 v[32:47], v[200:203], v[164:167], v[32:47]
    ds_read_b64_tr_b16 v[192:193], v15 offset:41952
    ds_read_b64_tr_b16 v[194:195], v15 offset:43104
    s_mov_b32 s34, 32768
    buffer_load_dwordx4 v[228:231], v6, s[28:31], s34 offen offset:2048
    s_waitcnt lgkmcnt(10)
    v_mfma_f32_32x32x16_bf16 v[48:63], v[204:207], v[164:167], v[48:63]
    ds_read_b64_tr_b16 v[196:197], v15 offset:41984
    ds_read_b64_tr_b16 v[198:199], v15 offset:43136
    s_mov_b32 s34, 32768
    buffer_load_dwordx4 v[232:235], v6, s[28:31], s34 offen offset:3072
    s_waitcnt lgkmcnt(10)
    v_mfma_f32_32x32x16_bf16 v[64:79], v[176:179], v[164:167], v[64:79]
    ds_read_b64_tr_b16 v[200:201], v15 offset:46336
    ds_read_b64_tr_b16 v[202:203], v15 offset:47488
    s_mov_b32 s34, 20480
    buffer_load_dwordx4 v[172:175], v6, s[28:31], s34 offen offset:3072
    s_waitcnt lgkmcnt(10)
    v_mfma_f32_32x32x16_bf16 v[80:95], v[180:183], v[164:167], v[80:95]
    ds_read_b64_tr_b16 v[204:205], v15 offset:46368
    ds_read_b64_tr_b16 v[206:207], v15 offset:47520
    s_mov_b32 s34, 24576
    buffer_load_dwordx4 v[160:163], v6, s[28:31], s34 offen offset:0
    s_waitcnt lgkmcnt(10)
    v_mfma_f32_32x32x16_bf16 v[96:111], v[184:187], v[164:167], v[96:111]
    ds_read_b64_tr_b16 v[176:177], v15 offset:46400
    ds_read_b64_tr_b16 v[178:179], v15 offset:47552
    s_waitcnt lgkmcnt(10)
    v_mfma_f32_32x32x16_bf16 v[112:127], v[188:191], v[164:167], v[112:127]
    ds_read_b64_tr_b16 v[180:181], v15 offset:46432
    ds_read_b64_tr_b16 v[182:183], v15 offset:47584
    s_waitcnt lgkmcnt(10)
    v_mfma_f32_32x32x16_bf16 v[128:143], v[192:195], v[164:167], v[128:143]
    ds_read_b64_tr_b16 v[184:185], v15 offset:46464
    ds_read_b64_tr_b16 v[186:187], v15 offset:47616
    s_waitcnt lgkmcnt(10)
    v_mfma_f32_32x32x16_bf16 v[144:159], v[196:199], v[164:167], v[144:159]
    ds_read_b64_tr_b16 v[188:189], v15 offset:46496
    ds_read_b64_tr_b16 v[190:191], v15 offset:47648
    s_mov_b32 s34, 24576
    buffer_load_dwordx4 v[164:167], v6, s[28:31], s34 offen offset:1024
    s_waitcnt vmcnt(21)
    s_waitcnt lgkmcnt(10)
    v_mfma_f32_32x32x16_bf16 v[16:31], v[200:203], v[168:171], v[16:31]
    ds_read_b64_tr_b16 v[192:193], v15 offset:46528
    ds_read_b64_tr_b16 v[194:195], v15 offset:47680
    s_waitcnt lgkmcnt(10)
    v_mfma_f32_32x32x16_bf16 v[32:47], v[204:207], v[168:171], v[32:47]
    ds_read_b64_tr_b16 v[196:197], v15 offset:46560
    ds_read_b64_tr_b16 v[198:199], v15 offset:47712
    s_waitcnt lgkmcnt(10)
    v_mfma_f32_32x32x16_bf16 v[48:63], v[176:179], v[168:171], v[48:63]
    ds_read_b64_tr_b16 v[200:201], v15 offset:46592
    ds_read_b64_tr_b16 v[202:203], v15 offset:47744
    s_waitcnt lgkmcnt(10)
    v_mfma_f32_32x32x16_bf16 v[64:79], v[180:183], v[168:171], v[64:79]
    ds_read_b64_tr_b16 v[204:205], v15 offset:50944
    ds_read_b64_tr_b16 v[206:207], v15 offset:52096
    s_waitcnt lgkmcnt(10)
    v_mfma_f32_32x32x16_bf16 v[80:95], v[184:187], v[168:171], v[80:95]
    ds_read_b64_tr_b16 v[176:177], v15 offset:50976
    ds_read_b64_tr_b16 v[178:179], v15 offset:52128
    s_waitcnt lgkmcnt(10)
    v_mfma_f32_32x32x16_bf16 v[96:111], v[188:191], v[168:171], v[96:111]
    ds_read_b64_tr_b16 v[180:181], v15 offset:51008
    ds_read_b64_tr_b16 v[182:183], v15 offset:52160
    s_waitcnt lgkmcnt(10)
    v_mfma_f32_32x32x16_bf16 v[112:127], v[192:195], v[168:171], v[112:127]
    ds_read_b64_tr_b16 v[184:185], v15 offset:51040
    ds_read_b64_tr_b16 v[186:187], v15 offset:52192
    s_waitcnt lgkmcnt(10)
    v_mfma_f32_32x32x16_bf16 v[128:143], v[196:199], v[168:171], v[128:143]
    ds_read_b64_tr_b16 v[188:189], v15 offset:51072
    ds_read_b64_tr_b16 v[190:191], v15 offset:52224
    s_waitcnt lgkmcnt(10)
    v_mfma_f32_32x32x16_bf16 v[144:159], v[200:203], v[168:171], v[144:159]
    ds_read_b64_tr_b16 v[192:193], v15 offset:51104
    ds_read_b64_tr_b16 v[194:195], v15 offset:52256
    s_mov_b32 s34, 24576
    buffer_load_dwordx4 v[168:171], v6, s[28:31], s34 offen offset:2048
    s_waitcnt vmcnt(3)
    s_waitcnt lgkmcnt(10)
    v_mfma_f32_32x32x16_bf16 v[16:31], v[204:207], v[172:175], v[16:31]
    ds_read_b64_tr_b16 v[196:197], v15 offset:51136
    ds_read_b64_tr_b16 v[198:199], v15 offset:52288
    s_waitcnt lgkmcnt(10)
    v_mfma_f32_32x32x16_bf16 v[32:47], v[176:179], v[172:175], v[32:47]
    ds_read_b64_tr_b16 v[200:201], v15 offset:51168
    ds_read_b64_tr_b16 v[202:203], v15 offset:52320
    s_waitcnt lgkmcnt(10)
    v_mfma_f32_32x32x16_bf16 v[48:63], v[180:183], v[172:175], v[48:63]
    ds_read_b64_tr_b16 v[204:205], v15 offset:51200
    ds_read_b64_tr_b16 v[206:207], v15 offset:52352
    s_waitcnt lgkmcnt(10)
    v_mfma_f32_32x32x16_bf16 v[64:79], v[184:187], v[172:175], v[64:79]
    s_barrier
    ds_read_b64_tr_b16 v[176:177], v9 offset:37120
    ds_read_b64_tr_b16 v[178:179], v9 offset:38272
    s_waitcnt lgkmcnt(10)
    v_mfma_f32_32x32x16_bf16 v[80:95], v[188:191], v[172:175], v[80:95]
    ds_read_b64_tr_b16 v[180:181], v9 offset:41728
    ds_read_b64_tr_b16 v[182:183], v9 offset:42880
    s_waitcnt lgkmcnt(10)
    v_mfma_f32_32x32x16_bf16 v[96:111], v[192:195], v[172:175], v[96:111]
    ds_read_b64_tr_b16 v[184:185], v9 offset:46336
    ds_read_b64_tr_b16 v[186:187], v9 offset:47488
    s_waitcnt lgkmcnt(10)
    v_mfma_f32_32x32x16_bf16 v[112:127], v[196:199], v[172:175], v[112:127]
    ds_read_b64_tr_b16 v[188:189], v9 offset:50944
    ds_read_b64_tr_b16 v[190:191], v9 offset:52096
    s_waitcnt lgkmcnt(10)
    v_mfma_f32_32x32x16_bf16 v[128:143], v[200:203], v[172:175], v[128:143]
    ds_read_b64_tr_b16 v[192:193], v15 offset:0
    ds_read_b64_tr_b16 v[194:195], v15 offset:1152
    s_waitcnt lgkmcnt(10)
    v_mfma_f32_32x32x16_bf16 v[144:159], v[204:207], v[172:175], v[144:159]
    ds_read_b64_tr_b16 v[196:197], v15 offset:4608
    ds_read_b64_tr_b16 v[198:199], v15 offset:5760
    s_mov_b32 s34, 24576
    buffer_load_dwordx4 v[172:175], v6, s[28:31], s34 offen offset:3072
    s_mul_i32 s17, s14, 288
    s_mul_i32 s13, s11, 9
    s_add_u32 s17, s17, s13
    s_lshl_b32 s17, s17, 10
    v_lshlrev_b32 v13, 4, v1
    s_waitcnt lgkmcnt(10)
    v_mfma_f32_32x32x16_bf16 v[16:31], v[176:179], v[240:243], v[16:31]
    ds_read_b64_tr_b16 v[200:201], v15 offset:9216
    ds_read_b64_tr_b16 v[202:203], v15 offset:10368
    s_waitcnt lgkmcnt(10)
    v_mfma_f32_32x32x16_bf16 v[16:31], v[180:183], v[244:247], v[16:31]
    ds_read_b64_tr_b16 v[204:205], v15 offset:13824
    ds_read_b64_tr_b16 v[206:207], v15 offset:14976
    s_waitcnt lgkmcnt(10)
    v_mfma_f32_32x32x16_bf16 v[16:31], v[184:187], v[248:251], v[16:31]
    ds_read_b64_tr_b16 v[176:177], v9 offset:0
    ds_read_b64_tr_b16 v[178:179], v9 offset:1152
    s_waitcnt lgkmcnt(10)
    v_mfma_f32_32x32x16_bf16 v[16:31], v[188:191], v[252:255], v[16:31]
    ds_read_b64_tr_b16 v[180:181], v9 offset:4608
    ds_read_b64_tr_b16 v[182:183], v9 offset:5760
    s_waitcnt lgkmcnt(10)
    v_mfma_f32_32x32x16_bf16 v[16:31], v[192:195], v[220:223], v[16:31]
    ds_read_b64_tr_b16 v[184:185], v9 offset:9216
    ds_read_b64_tr_b16 v[186:187], v9 offset:10368
    s_waitcnt lgkmcnt(10)
    v_mfma_f32_32x32x16_bf16 v[16:31], v[196:199], v[224:227], v[16:31]
    ds_read_b64_tr_b16 v[188:189], v9 offset:13824
    ds_read_b64_tr_b16 v[190:191], v9 offset:14976
    s_waitcnt lgkmcnt(10)
    v_mfma_f32_32x32x16_bf16 v[16:31], v[200:203], v[228:231], v[16:31]
    ds_read_b64_tr_b16 v[192:193], v9 offset:37152
    ds_read_b64_tr_b16 v[194:195], v9 offset:38304
    s_waitcnt lgkmcnt(10)
    v_mfma_f32_32x32x16_bf16 v[16:31], v[204:207], v[232:235], v[16:31]
    ds_read_b64_tr_b16 v[196:197], v9 offset:41760
    ds_read_b64_tr_b16 v[198:199], v9 offset:42912
    s_waitcnt vmcnt(3)
    s_waitcnt lgkmcnt(10)
    v_mfma_f32_32x32x16_bf16 v[16:31], v[176:179], v[160:163], v[16:31]
    ds_read_b64_tr_b16 v[200:201], v9 offset:46368
    ds_read_b64_tr_b16 v[202:203], v9 offset:47520
    s_waitcnt vmcnt(2)
    s_waitcnt lgkmcnt(10)
    v_mfma_f32_32x32x16_bf16 v[16:31], v[180:183], v[164:167], v[16:31]
    ds_read_b64_tr_b16 v[204:205], v9 offset:50976
    ds_read_b64_tr_b16 v[206:207], v9 offset:52128
    s_waitcnt vmcnt(1)
    s_waitcnt lgkmcnt(10)
    v_mfma_f32_32x32x16_bf16 v[16:31], v[184:187], v[168:171], v[16:31]
    ds_read_b64_tr_b16 v[176:177], v15 offset:32
    ds_read_b64_tr_b16 v[178:179], v15 offset:1184
    s_waitcnt vmcnt(0)
    s_waitcnt lgkmcnt(10)
    v_mfma_f32_32x32x16_bf16 v[16:31], v[188:191], v[172:175], v[16:31]
    ds_read_b64_tr_b16 v[180:181], v15 offset:4640
    ds_read_b64_tr_b16 v[182:183], v15 offset:5792
    s_waitcnt lgkmcnt(10)
    v_mfma_f32_32x32x16_bf16 v[32:47], v[192:195], v[240:243], v[32:47]
    ds_read_b64_tr_b16 v[184:185], v15 offset:9248
    ds_read_b64_tr_b16 v[186:187], v15 offset:10400
    s_waitcnt lgkmcnt(10)
    v_mfma_f32_32x32x16_bf16 v[32:47], v[196:199], v[244:247], v[32:47]
    ds_read_b64_tr_b16 v[188:189], v15 offset:13856
    ds_read_b64_tr_b16 v[190:191], v15 offset:15008
    s_waitcnt lgkmcnt(10)
    v_mfma_f32_32x32x16_bf16 v[32:47], v[200:203], v[248:251], v[32:47]
    ds_read_b64_tr_b16 v[192:193], v9 offset:32
    ds_read_b64_tr_b16 v[194:195], v9 offset:1184
    s_waitcnt lgkmcnt(10)
    v_mfma_f32_32x32x16_bf16 v[32:47], v[204:207], v[252:255], v[32:47]
    ds_read_b64_tr_b16 v[196:197], v9 offset:4640
    ds_read_b64_tr_b16 v[198:199], v9 offset:5792
    v_pk_mul_f32 v[208:209], v[16:17], s[56:57]
    v_pk_mul_f32 v[210:211], v[18:19], s[56:57]
    v_pk_mul_f32 v[212:213], v[20:21], s[56:57]
    v_pk_mul_f32 v[214:215], v[22:23], s[56:57]
    s_waitcnt lgkmcnt(10)
    v_mfma_f32_32x32x16_bf16 v[32:47], v[176:179], v[220:223], v[32:47]
    ds_read_b64_tr_b16 v[200:201], v9 offset:9248
    ds_read_b64_tr_b16 v[202:203], v9 offset:10400
    v_exp_f32 v208, v208
    v_exp_f32 v209, v209
    v_exp_f32 v210, v210
    v_exp_f32 v211, v211
    s_waitcnt lgkmcnt(10)
    v_mfma_f32_32x32x16_bf16 v[32:47], v[180:183], v[224:227], v[32:47]
    ds_read_b64_tr_b16 v[204:205], v9 offset:13856
    ds_read_b64_tr_b16 v[206:207], v9 offset:15008
    v_exp_f32 v212, v212
    v_exp_f32 v213, v213
    v_exp_f32 v214, v214
    v_exp_f32 v215, v215
    s_waitcnt lgkmcnt(10)
    v_mfma_f32_32x32x16_bf16 v[32:47], v[184:187], v[228:231], v[32:47]
    ds_read_b64_tr_b16 v[176:177], v9 offset:37184
    ds_read_b64_tr_b16 v[178:179], v9 offset:38336
    v_pk_mul_f32 v[16:17], v[16:17], v[24:25]
    v_pk_mul_f32 v[18:19], v[18:19], v[26:27]
    v_pk_mul_f32 v[20:21], v[20:21], v[28:29]
    s_waitcnt lgkmcnt(10)
    v_mfma_f32_32x32x16_bf16 v[32:47], v[188:191], v[232:235], v[32:47]
    ds_read_b64_tr_b16 v[180:181], v9 offset:41792
    ds_read_b64_tr_b16 v[182:183], v9 offset:42944
    v_pk_mul_f32 v[22:23], v[22:23], v[30:31]
    v_pk_add_f32 v[208:209], v[208:209], s[58:59]
    v_pk_add_f32 v[210:211], v[210:211], s[58:59]
    s_waitcnt lgkmcnt(10)
    v_mfma_f32_32x32x16_bf16 v[32:47], v[192:195], v[160:163], v[32:47]
    ds_read_b64_tr_b16 v[184:185], v9 offset:46400
    ds_read_b64_tr_b16 v[186:187], v9 offset:47552
    v_pk_add_f32 v[212:213], v[212:213], s[58:59]
    v_pk_add_f32 v[214:215], v[214:215], s[58:59]
    v_rcp_f32 v208, v208
    s_waitcnt lgkmcnt(10)
    v_mfma_f32_32x32x16_bf16 v[32:47], v[196:199], v[164:167], v[32:47]
    ds_read_b64_tr_b16 v[188:189], v9 offset:51008
    ds_read_b64_tr_b16 v[190:191], v9 offset:52160
    v_rcp_f32 v209, v209
    v_rcp_f32 v210, v210
    v_rcp_f32 v211, v211
    s_waitcnt lgkmcnt(10)
    v_mfma_f32_32x32x16_bf16 v[32:47], v[200:203], v[168:171], v[32:47]
    ds_read_b64_tr_b16 v[192:193], v15 offset:64
    ds_read_b64_tr_b16 v[194:195], v15 offset:1216
    v_rcp_f32 v212, v212
    v_rcp_f32 v213, v213
    v_rcp_f32 v214, v214
    s_waitcnt lgkmcnt(10)
    v_mfma_f32_32x32x16_bf16 v[32:47], v[204:207], v[172:175], v[32:47]
    ds_read_b64_tr_b16 v[196:197], v15 offset:4672
    ds_read_b64_tr_b16 v[198:199], v15 offset:5824
    v_rcp_f32 v215, v215
    s_add_u32 s13, s17, 0
    v_pk_mul_f32 v[16:17], v[16:17], v[208:209]
    s_waitcnt lgkmcnt(10)
    v_mfma_f32_32x32x16_bf16 v[48:63], v[176:179], v[240:243], v[48:63]
    ds_read_b64_tr_b16 v[200:201], v15 offset:9280
    ds_read_b64_tr_b16 v[202:203], v15 offset:10432
    v_pk_mul_f32 v[18:19], v[18:19], v[210:211]
    v_pk_mul_f32 v[20:21], v[20:21], v[212:213]
    v_pk_mul_f32 v[22:23], v[22:23], v[214:215]
    s_waitcnt lgkmcnt(10)
    v_mfma_f32_32x32x16_bf16 v[48:63], v[180:183], v[244:247], v[48:63]
    ds_read_b64_tr_b16 v[204:205], v15 offset:13888
    ds_read_b64_tr_b16 v[206:207], v15 offset:15040
    v_cvt_pk_bf16_f32 v216, v16, v17
    v_cvt_pk_bf16_f32 v217, v18, v19
    v_cvt_pk_bf16_f32 v218, v20, v21
    s_waitcnt lgkmcnt(10)
    v_mfma_f32_32x32x16_bf16 v[48:63], v[184:187], v[248:251], v[48:63]
    ds_read_b64_tr_b16 v[176:177], v9 offset:64
    ds_read_b64_tr_b16 v[178:179], v9 offset:1216
    v_cvt_pk_bf16_f32 v219, v22, v23
    s_nop 0
    buffer_store_dwordx4 v[216:219], v13, s[36:39], s13 offen sc1
    s_waitcnt lgkmcnt(10)
    v_mfma_f32_32x32x16_bf16 v[48:63], v[188:191], v[252:255], v[48:63]
    ds_read_b64_tr_b16 v[180:181], v9 offset:4672
    ds_read_b64_tr_b16 v[182:183], v9 offset:5824
    v_pk_mul_f32 v[208:209], v[32:33], s[56:57]
    v_pk_mul_f32 v[210:211], v[34:35], s[56:57]
    v_pk_mul_f32 v[212:213], v[36:37], s[56:57]
    v_pk_mul_f32 v[214:215], v[38:39], s[56:57]
    s_waitcnt lgkmcnt(10)
    v_mfma_f32_32x32x16_bf16 v[48:63], v[192:195], v[220:223], v[48:63]
    ds_read_b64_tr_b16 v[184:185], v9 offset:9280
    ds_read_b64_tr_b16 v[186:187], v9 offset:10432
    v_exp_f32 v208, v208
    v_exp_f32 v209, v209
    v_exp_f32 v210, v210
    v_exp_f32 v211, v211
    s_waitcnt lgkmcnt(10)
    v_mfma_f32_32x32x16_bf16 v[48:63], v[196:199], v[224:227], v[48:63]
    ds_read_b64_tr_b16 v[188:189], v9 offset:13888
    ds_read_b64_tr_b16 v[190:191], v9 offset:15040
    v_exp_f32 v212, v212
    v_exp_f32 v213, v213
    v_exp_f32 v214, v214
    v_exp_f32 v215, v215
    s_waitcnt lgkmcnt(10)
    v_mfma_f32_32x32x16_bf16 v[48:63], v[200:203], v[228:231], v[48:63]
    ds_read_b64_tr_b16 v[192:193], v9 offset:37216
    ds_read_b64_tr_b16 v[194:195], v9 offset:38368
    v_pk_mul_f32 v[32:33], v[32:33], v[40:41]
    v_pk_mul_f32 v[34:35], v[34:35], v[42:43]
    v_pk_mul_f32 v[36:37], v[36:37], v[44:45]
    s_waitcnt lgkmcnt(10)
    v_mfma_f32_32x32x16_bf16 v[48:63], v[204:207], v[232:235], v[48:63]
    ds_read_b64_tr_b16 v[196:197], v9 offset:41824
    ds_read_b64_tr_b16 v[198:199], v9 offset:42976
    v_pk_mul_f32 v[38:39], v[38:39], v[46:47]
    v_pk_add_f32 v[208:209], v[208:209], s[58:59]
    v_pk_add_f32 v[210:211], v[210:211], s[58:59]
    s_waitcnt lgkmcnt(10)
    v_mfma_f32_32x32x16_bf16 v[48:63], v[176:179], v[160:163], v[48:63]
    ds_read_b64_tr_b16 v[200:201], v9 offset:46432
    ds_read_b64_tr_b16 v[202:203], v9 offset:47584
    v_pk_add_f32 v[212:213], v[212:213], s[58:59]
    v_pk_add_f32 v[214:215], v[214:215], s[58:59]
    v_rcp_f32 v208, v208
    s_waitcnt lgkmcnt(10)
    v_mfma_f32_32x32x16_bf16 v[48:63], v[180:183], v[164:167], v[48:63]
    ds_read_b64_tr_b16 v[204:205], v9 offset:51040
    ds_read_b64_tr_b16 v[206:207], v9 offset:52192
    v_rcp_f32 v209, v209
    v_rcp_f32 v210, v210
    v_rcp_f32 v211, v211
    s_waitcnt lgkmcnt(10)
    v_mfma_f32_32x32x16_bf16 v[48:63], v[184:187], v[168:171], v[48:63]
    ds_read_b64_tr_b16 v[176:177], v15 offset:96
    ds_read_b64_tr_b16 v[178:179], v15 offset:1248
    v_rcp_f32 v212, v212
    v_rcp_f32 v213, v213
    v_rcp_f32 v214, v214
    s_waitcnt lgkmcnt(10)
    v_mfma_f32_32x32x16_bf16 v[48:63], v[188:191], v[172:175], v[48:63]
    ds_read_b64_tr_b16 v[180:181], v15 offset:4704
    ds_read_b64_tr_b16 v[182:183], v15 offset:5856
    v_rcp_f32 v215, v215
    s_add_u32 s13, s17, 1024
    v_pk_mul_f32 v[32:33], v[32:33], v[208:209]
    s_waitcnt lgkmcnt(10)
    v_mfma_f32_32x32x16_bf16 v[64:79], v[192:195], v[240:243], v[64:79]
    ds_read_b64_tr_b16 v[184:185], v15 offset:9312
    ds_read_b64_tr_b16 v[186:187], v15 offset:10464
    v_pk_mul_f32 v[34:35], v[34:35], v[210:211]
    v_pk_mul_f32 v[36:37], v[36:37], v[212:213]
    v_pk_mul_f32 v[38:39], v[38:39], v[214:215]
    s_waitcnt lgkmcnt(10)
    v_mfma_f32_32x32x16_bf16 v[64:79], v[196:199], v[244:247], v[64:79]
    ds_read_b64_tr_b16 v[188:189], v15 offset:13920
    ds_read_b64_tr_b16 v[190:191], v15 offset:15072
    v_cvt_pk_bf16_f32 v216, v32, v33
    v_cvt_pk_bf16_f32 v217, v34, v35
    v_cvt_pk_bf16_f32 v218, v36, v37
    s_waitcnt lgkmcnt(10)
    v_mfma_f32_32x32x16_bf16 v[64:79], v[200:203], v[248:251], v[64:79]
    ds_read_b64_tr_b16 v[192:193], v9 offset:96
    ds_read_b64_tr_b16 v[194:195], v9 offset:1248
    v_cvt_pk_bf16_f32 v219, v38, v39
    s_nop 0
    buffer_store_dwordx4 v[216:219], v13, s[36:39], s13 offen sc1
    s_waitcnt lgkmcnt(10)
    v_mfma_f32_32x32x16_bf16 v[64:79], v[204:207], v[252:255], v[64:79]
    ds_read_b64_tr_b16 v[196:197], v9 offset:4704
    ds_read_b64_tr_b16 v[198:199], v9 offset:5856
    v_pk_mul_f32 v[208:209], v[48:49], s[56:57]
    v_pk_mul_f32 v[210:211], v[50:51], s[56:57]
    v_pk_mul_f32 v[212:213], v[52:53], s[56:57]
    v_pk_mul_f32 v[214:215], v[54:55], s[56:57]
    s_waitcnt lgkmcnt(10)
    v_mfma_f32_32x32x16_bf16 v[64:79], v[176:179], v[220:223], v[64:79]
    ds_read_b64_tr_b16 v[200:201], v9 offset:9312
    ds_read_b64_tr_b16 v[202:203], v9 offset:10464
    v_exp_f32 v208, v208
    v_exp_f32 v209, v209
    v_exp_f32 v210, v210
    v_exp_f32 v211, v211
    s_waitcnt lgkmcnt(10)
    v_mfma_f32_32x32x16_bf16 v[64:79], v[180:183], v[224:227], v[64:79]
    ds_read_b64_tr_b16 v[204:205], v9 offset:13920
    ds_read_b64_tr_b16 v[206:207], v9 offset:15072
    v_exp_f32 v212, v212
    v_exp_f32 v213, v213
    v_exp_f32 v214, v214
    v_exp_f32 v215, v215
    s_waitcnt lgkmcnt(10)
    v_mfma_f32_32x32x16_bf16 v[64:79], v[184:187], v[228:231], v[64:79]
    ds_read_b64_tr_b16 v[176:177], v9 offset:37248
    ds_read_b64_tr_b16 v[178:179], v9 offset:38400
    v_pk_mul_f32 v[48:49], v[48:49], v[56:57]
    v_pk_mul_f32 v[50:51], v[50:51], v[58:59]
    v_pk_mul_f32 v[52:53], v[52:53], v[60:61]
    s_waitcnt lgkmcnt(10)
    v_mfma_f32_32x32x16_bf16 v[64:79], v[188:191], v[232:235], v[64:79]
    ds_read_b64_tr_b16 v[180:181], v9 offset:41856
    ds_read_b64_tr_b16 v[182:183], v9 offset:43008
    v_pk_mul_f32 v[54:55], v[54:55], v[62:63]
    v_pk_add_f32 v[208:209], v[208:209], s[58:59]
    v_pk_add_f32 v[210:211], v[210:211], s[58:59]
    s_waitcnt lgkmcnt(10)
    v_mfma_f32_32x32x16_bf16 v[64:79], v[192:195], v[160:163], v[64:79]
    ds_read_b64_tr_b16 v[184:185], v9 offset:46464
    ds_read_b64_tr_b16 v[186:187], v9 offset:47616
    v_pk_add_f32 v[212:213], v[212:213], s[58:59]
    v_pk_add_f32 v[214:215], v[214:215], s[58:59]
    v_rcp_f32 v208, v208
    s_waitcnt lgkmcnt(10)
    v_mfma_f32_32x32x16_bf16 v[64:79], v[196:199], v[164:167], v[64:79]
    ds_read_b64_tr_b16 v[188:189], v9 offset:51072
    ds_read_b64_tr_b16 v[190:191], v9 offset:52224
    v_rcp_f32 v209, v209
    v_rcp_f32 v210, v210
    v_rcp_f32 v211, v211
    s_waitcnt lgkmcnt(10)
    v_mfma_f32_32x32x16_bf16 v[64:79], v[200:203], v[168:171], v[64:79]
    ds_read_b64_tr_b16 v[192:193], v15 offset:128
    ds_read_b64_tr_b16 v[194:195], v15 offset:1280
    v_rcp_f32 v212, v212
    v_rcp_f32 v213, v213
    v_rcp_f32 v214, v214
    s_waitcnt lgkmcnt(10)
    v_mfma_f32_32x32x16_bf16 v[64:79], v[204:207], v[172:175], v[64:79]
    ds_read_b64_tr_b16 v[196:197], v15 offset:4736
    ds_read_b64_tr_b16 v[198:199], v15 offset:5888
    v_rcp_f32 v215, v215
    s_add_u32 s13, s17, 2048
    v_pk_mul_f32 v[48:49], v[48:49], v[208:209]
    s_waitcnt lgkmcnt(10)
    v_mfma_f32_32x32x16_bf16 v[80:95], v[176:179], v[240:243], v[80:95]
    ds_read_b64_tr_b16 v[200:201], v15 offset:9344
    ds_read_b64_tr_b16 v[202:203], v15 offset:10496
    v_pk_mul_f32 v[50:51], v[50:51], v[210:211]
    v_pk_mul_f32 v[52:53], v[52:53], v[212:213]
    v_pk_mul_f32 v[54:55], v[54:55], v[214:215]
    s_waitcnt lgkmcnt(10)
    v_mfma_f32_32x32x16_bf16 v[80:95], v[180:183], v[244:247], v[80:95]
    ds_read_b64_tr_b16 v[204:205], v15 offset:13952
    ds_read_b64_tr_b16 v[206:207], v15 offset:15104
    v_cvt_pk_bf16_f32 v216, v48, v49
    v_cvt_pk_bf16_f32 v217, v50, v51
    v_cvt_pk_bf16_f32 v218, v52, v53
    s_waitcnt lgkmcnt(10)
    v_mfma_f32_32x32x16_bf16 v[80:95], v[184:187], v[248:251], v[80:95]
    ds_read_b64_tr_b16 v[176:177], v9 offset:128
    ds_read_b64_tr_b16 v[178:179], v9 offset:1280
    v_cvt_pk_bf16_f32 v219, v54, v55
    s_nop 0
    buffer_store_dwordx4 v[216:219], v13, s[36:39], s13 offen sc1
    s_waitcnt lgkmcnt(10)
    v_mfma_f32_32x32x16_bf16 v[80:95], v[188:191], v[252:255], v[80:95]
    ds_read_b64_tr_b16 v[180:181], v9 offset:4736
    ds_read_b64_tr_b16 v[182:183], v9 offset:5888
    v_pk_mul_f32 v[208:209], v[64:65], s[56:57]
    v_pk_mul_f32 v[210:211], v[66:67], s[56:57]
    v_pk_mul_f32 v[212:213], v[68:69], s[56:57]
    v_pk_mul_f32 v[214:215], v[70:71], s[56:57]
    s_waitcnt lgkmcnt(10)
    v_mfma_f32_32x32x16_bf16 v[80:95], v[192:195], v[220:223], v[80:95]
    ds_read_b64_tr_b16 v[184:185], v9 offset:9344
    ds_read_b64_tr_b16 v[186:187], v9 offset:10496
    v_exp_f32 v208, v208
    v_exp_f32 v209, v209
    v_exp_f32 v210, v210
    v_exp_f32 v211, v211
    s_waitcnt lgkmcnt(10)
    v_mfma_f32_32x32x16_bf16 v[80:95], v[196:199], v[224:227], v[80:95]
    ds_read_b64_tr_b16 v[188:189], v9 offset:13952
    ds_read_b64_tr_b16 v[190:191], v9 offset:15104
    v_exp_f32 v212, v212
    v_exp_f32 v213, v213
    v_exp_f32 v214, v214
    v_exp_f32 v215, v215
    s_waitcnt lgkmcnt(10)
    v_mfma_f32_32x32x16_bf16 v[80:95], v[200:203], v[228:231], v[80:95]
    ds_read_b64_tr_b16 v[192:193], v9 offset:37280
    ds_read_b64_tr_b16 v[194:195], v9 offset:38432
    v_pk_mul_f32 v[64:65], v[64:65], v[72:73]
    v_pk_mul_f32 v[66:67], v[66:67], v[74:75]
    v_pk_mul_f32 v[68:69], v[68:69], v[76:77]
    s_waitcnt lgkmcnt(10)
    v_mfma_f32_32x32x16_bf16 v[80:95], v[204:207], v[232:235], v[80:95]
    ds_read_b64_tr_b16 v[196:197], v9 offset:41888
    ds_read_b64_tr_b16 v[198:199], v9 offset:43040
    v_pk_mul_f32 v[70:71], v[70:71], v[78:79]
    v_pk_add_f32 v[208:209], v[208:209], s[58:59]
    v_pk_add_f32 v[210:211], v[210:211], s[58:59]
    s_waitcnt lgkmcnt(10)
    v_mfma_f32_32x32x16_bf16 v[80:95], v[176:179], v[160:163], v[80:95]
    ds_read_b64_tr_b16 v[200:201], v9 offset:46496
    ds_read_b64_tr_b16 v[202:203], v9 offset:47648
    v_pk_add_f32 v[212:213], v[212:213], s[58:59]
    v_pk_add_f32 v[214:215], v[214:215], s[58:59]
    v_rcp_f32 v208, v208
    s_waitcnt lgkmcnt(10)
    v_mfma_f32_32x32x16_bf16 v[80:95], v[180:183], v[164:167], v[80:95]
    ds_read_b64_tr_b16 v[204:205], v9 offset:51104
    ds_read_b64_tr_b16 v[206:207], v9 offset:52256
    v_rcp_f32 v209, v209
    v_rcp_f32 v210, v210
    v_rcp_f32 v211, v211
    s_waitcnt lgkmcnt(10)
    v_mfma_f32_32x32x16_bf16 v[80:95], v[184:187], v[168:171], v[80:95]
    ds_read_b64_tr_b16 v[176:177], v15 offset:160
    ds_read_b64_tr_b16 v[178:179], v15 offset:1312
    v_rcp_f32 v212, v212
    v_rcp_f32 v213, v213
    v_rcp_f32 v214, v214
    s_waitcnt lgkmcnt(10)
    v_mfma_f32_32x32x16_bf16 v[80:95], v[188:191], v[172:175], v[80:95]
    ds_read_b64_tr_b16 v[180:181], v15 offset:4768
    ds_read_b64_tr_b16 v[182:183], v15 offset:5920
    v_rcp_f32 v215, v215
    s_add_u32 s13, s17, 3072
    v_pk_mul_f32 v[64:65], v[64:65], v[208:209]
    s_waitcnt lgkmcnt(10)
    v_mfma_f32_32x32x16_bf16 v[96:111], v[192:195], v[240:243], v[96:111]
    ds_read_b64_tr_b16 v[184:185], v15 offset:9376
    ds_read_b64_tr_b16 v[186:187], v15 offset:10528
    v_pk_mul_f32 v[66:67], v[66:67], v[210:211]
    v_pk_mul_f32 v[68:69], v[68:69], v[212:213]
    v_pk_mul_f32 v[70:71], v[70:71], v[214:215]
    s_waitcnt lgkmcnt(10)
    v_mfma_f32_32x32x16_bf16 v[96:111], v[196:199], v[244:247], v[96:111]
    ds_read_b64_tr_b16 v[188:189], v15 offset:13984
    ds_read_b64_tr_b16 v[190:191], v15 offset:15136
    v_cvt_pk_bf16_f32 v216, v64, v65
    v_cvt_pk_bf16_f32 v217, v66, v67
    v_cvt_pk_bf16_f32 v218, v68, v69
    s_waitcnt lgkmcnt(10)
    v_mfma_f32_32x32x16_bf16 v[96:111], v[200:203], v[248:251], v[96:111]
    ds_read_b64_tr_b16 v[192:193], v9 offset:160
    ds_read_b64_tr_b16 v[194:195], v9 offset:1312
    v_cvt_pk_bf16_f32 v219, v70, v71
    s_nop 0
    buffer_store_dwordx4 v[216:219], v13, s[36:39], s13 offen sc1
    s_waitcnt lgkmcnt(10)
    v_mfma_f32_32x32x16_bf16 v[96:111], v[204:207], v[252:255], v[96:111]
    ds_read_b64_tr_b16 v[196:197], v9 offset:4768
    ds_read_b64_tr_b16 v[198:199], v9 offset:5920
    v_pk_mul_f32 v[208:209], v[80:81], s[56:57]
    v_pk_mul_f32 v[210:211], v[82:83], s[56:57]
    v_pk_mul_f32 v[212:213], v[84:85], s[56:57]
    v_pk_mul_f32 v[214:215], v[86:87], s[56:57]
    s_waitcnt lgkmcnt(10)
    v_mfma_f32_32x32x16_bf16 v[96:111], v[176:179], v[220:223], v[96:111]
    ds_read_b64_tr_b16 v[200:201], v9 offset:9376
    ds_read_b64_tr_b16 v[202:203], v9 offset:10528
    v_exp_f32 v208, v208
    v_exp_f32 v209, v209
    v_exp_f32 v210, v210
    v_exp_f32 v211, v211
    s_waitcnt lgkmcnt(10)
    v_mfma_f32_32x32x16_bf16 v[96:111], v[180:183], v[224:227], v[96:111]
    ds_read_b64_tr_b16 v[204:205], v9 offset:13984
    ds_read_b64_tr_b16 v[206:207], v9 offset:15136
    v_exp_f32 v212, v212
    v_exp_f32 v213, v213
    v_exp_f32 v214, v214
    v_exp_f32 v215, v215
    s_waitcnt lgkmcnt(10)
    v_mfma_f32_32x32x16_bf16 v[96:111], v[184:187], v[228:231], v[96:111]
    ds_read_b64_tr_b16 v[176:177], v9 offset:37312
    ds_read_b64_tr_b16 v[178:179], v9 offset:38464
    v_pk_mul_f32 v[80:81], v[80:81], v[88:89]
    v_pk_mul_f32 v[82:83], v[82:83], v[90:91]
    v_pk_mul_f32 v[84:85], v[84:85], v[92:93]
    s_waitcnt lgkmcnt(10)
    v_mfma_f32_32x32x16_bf16 v[96:111], v[188:191], v[232:235], v[96:111]
    ds_read_b64_tr_b16 v[180:181], v9 offset:41920
    ds_read_b64_tr_b16 v[182:183], v9 offset:43072
    v_pk_mul_f32 v[86:87], v[86:87], v[94:95]
    v_pk_add_f32 v[208:209], v[208:209], s[58:59]
    v_pk_add_f32 v[210:211], v[210:211], s[58:59]
    s_waitcnt lgkmcnt(10)
    v_mfma_f32_32x32x16_bf16 v[96:111], v[192:195], v[160:163], v[96:111]
    ds_read_b64_tr_b16 v[184:185], v9 offset:46528
    ds_read_b64_tr_b16 v[186:187], v9 offset:47680
    v_pk_add_f32 v[212:213], v[212:213], s[58:59]
    v_pk_add_f32 v[214:215], v[214:215], s[58:59]
    v_rcp_f32 v208, v208
    s_waitcnt lgkmcnt(10)
    v_mfma_f32_32x32x16_bf16 v[96:111], v[196:199], v[164:167], v[96:111]
    ds_read_b64_tr_b16 v[188:189], v9 offset:51136
    ds_read_b64_tr_b16 v[190:191], v9 offset:52288
    v_rcp_f32 v209, v209
    v_rcp_f32 v210, v210
    v_rcp_f32 v211, v211
    s_waitcnt lgkmcnt(10)
    v_mfma_f32_32x32x16_bf16 v[96:111], v[200:203], v[168:171], v[96:111]
    ds_read_b64_tr_b16 v[192:193], v15 offset:192
    ds_read_b64_tr_b16 v[194:195], v15 offset:1344
    v_rcp_f32 v212, v212
    v_rcp_f32 v213, v213
    v_rcp_f32 v214, v214
    s_waitcnt lgkmcnt(10)
    v_mfma_f32_32x32x16_bf16 v[96:111], v[204:207], v[172:175], v[96:111]
    ds_read_b64_tr_b16 v[196:197], v15 offset:4800
    ds_read_b64_tr_b16 v[198:199], v15 offset:5952
    v_rcp_f32 v215, v215
    s_add_u32 s13, s17, 4096
    v_pk_mul_f32 v[80:81], v[80:81], v[208:209]
    s_waitcnt lgkmcnt(10)
    v_mfma_f32_32x32x16_bf16 v[112:127], v[176:179], v[240:243], v[112:127]
    ds_read_b64_tr_b16 v[200:201], v15 offset:9408
    ds_read_b64_tr_b16 v[202:203], v15 offset:10560
    v_pk_mul_f32 v[82:83], v[82:83], v[210:211]
    v_pk_mul_f32 v[84:85], v[84:85], v[212:213]
    v_pk_mul_f32 v[86:87], v[86:87], v[214:215]
    s_waitcnt lgkmcnt(10)
    v_mfma_f32_32x32x16_bf16 v[112:127], v[180:183], v[244:247], v[112:127]
    ds_read_b64_tr_b16 v[204:205], v15 offset:14016
    ds_read_b64_tr_b16 v[206:207], v15 offset:15168
    v_cvt_pk_bf16_f32 v216, v80, v81
    v_cvt_pk_bf16_f32 v217, v82, v83
    v_cvt_pk_bf16_f32 v218, v84, v85
    s_waitcnt lgkmcnt(10)
    v_mfma_f32_32x32x16_bf16 v[112:127], v[184:187], v[248:251], v[112:127]
    ds_read_b64_tr_b16 v[176:177], v9 offset:192
    ds_read_b64_tr_b16 v[178:179], v9 offset:1344
    v_cvt_pk_bf16_f32 v219, v86, v87
    s_nop 0
    buffer_store_dwordx4 v[216:219], v13, s[36:39], s13 offen sc1
    s_waitcnt lgkmcnt(10)
    v_mfma_f32_32x32x16_bf16 v[112:127], v[188:191], v[252:255], v[112:127]
    ds_read_b64_tr_b16 v[180:181], v9 offset:4800
    ds_read_b64_tr_b16 v[182:183], v9 offset:5952
    v_pk_mul_f32 v[208:209], v[96:97], s[56:57]
    v_pk_mul_f32 v[210:211], v[98:99], s[56:57]
    v_pk_mul_f32 v[212:213], v[100:101], s[56:57]
    v_pk_mul_f32 v[214:215], v[102:103], s[56:57]
    s_waitcnt lgkmcnt(10)
    v_mfma_f32_32x32x16_bf16 v[112:127], v[192:195], v[220:223], v[112:127]
    ds_read_b64_tr_b16 v[184:185], v9 offset:9408
    ds_read_b64_tr_b16 v[186:187], v9 offset:10560
    v_exp_f32 v208, v208
    v_exp_f32 v209, v209
    v_exp_f32 v210, v210
    v_exp_f32 v211, v211
    s_waitcnt lgkmcnt(10)
    v_mfma_f32_32x32x16_bf16 v[112:127], v[196:199], v[224:227], v[112:127]
    ds_read_b64_tr_b16 v[188:189], v9 offset:14016
    ds_read_b64_tr_b16 v[190:191], v9 offset:15168
    v_exp_f32 v212, v212
    v_exp_f32 v213, v213
    v_exp_f32 v214, v214
    v_exp_f32 v215, v215
    s_waitcnt lgkmcnt(10)
    v_mfma_f32_32x32x16_bf16 v[112:127], v[200:203], v[228:231], v[112:127]
    ds_read_b64_tr_b16 v[192:193], v9 offset:37344
    ds_read_b64_tr_b16 v[194:195], v9 offset:38496
    v_pk_mul_f32 v[96:97], v[96:97], v[104:105]
    v_pk_mul_f32 v[98:99], v[98:99], v[106:107]
    v_pk_mul_f32 v[100:101], v[100:101], v[108:109]
    s_waitcnt lgkmcnt(10)
    v_mfma_f32_32x32x16_bf16 v[112:127], v[204:207], v[232:235], v[112:127]
    ds_read_b64_tr_b16 v[196:197], v9 offset:41952
    ds_read_b64_tr_b16 v[198:199], v9 offset:43104
    v_pk_mul_f32 v[102:103], v[102:103], v[110:111]
    v_pk_add_f32 v[208:209], v[208:209], s[58:59]
    v_pk_add_f32 v[210:211], v[210:211], s[58:59]
    s_waitcnt lgkmcnt(10)
    v_mfma_f32_32x32x16_bf16 v[112:127], v[176:179], v[160:163], v[112:127]
    ds_read_b64_tr_b16 v[200:201], v9 offset:46560
    ds_read_b64_tr_b16 v[202:203], v9 offset:47712
    v_pk_add_f32 v[212:213], v[212:213], s[58:59]
    v_pk_add_f32 v[214:215], v[214:215], s[58:59]
    v_rcp_f32 v208, v208
    s_waitcnt lgkmcnt(10)
    v_mfma_f32_32x32x16_bf16 v[112:127], v[180:183], v[164:167], v[112:127]
    ds_read_b64_tr_b16 v[204:205], v9 offset:51168
    ds_read_b64_tr_b16 v[206:207], v9 offset:52320
    v_rcp_f32 v209, v209
    v_rcp_f32 v210, v210
    v_rcp_f32 v211, v211
    s_waitcnt lgkmcnt(10)
    v_mfma_f32_32x32x16_bf16 v[112:127], v[184:187], v[168:171], v[112:127]
    ds_read_b64_tr_b16 v[176:177], v15 offset:224
    ds_read_b64_tr_b16 v[178:179], v15 offset:1376
    v_rcp_f32 v212, v212
    v_rcp_f32 v213, v213
    v_rcp_f32 v214, v214
    s_waitcnt lgkmcnt(10)
    v_mfma_f32_32x32x16_bf16 v[112:127], v[188:191], v[172:175], v[112:127]
    ds_read_b64_tr_b16 v[180:181], v15 offset:4832
    ds_read_b64_tr_b16 v[182:183], v15 offset:5984
    v_rcp_f32 v215, v215
    s_add_u32 s13, s17, 5120
    v_pk_mul_f32 v[96:97], v[96:97], v[208:209]
    s_waitcnt lgkmcnt(10)
    v_mfma_f32_32x32x16_bf16 v[128:143], v[192:195], v[240:243], v[128:143]
    ds_read_b64_tr_b16 v[184:185], v15 offset:9440
    ds_read_b64_tr_b16 v[186:187], v15 offset:10592
    v_pk_mul_f32 v[98:99], v[98:99], v[210:211]
    v_pk_mul_f32 v[100:101], v[100:101], v[212:213]
    v_pk_mul_f32 v[102:103], v[102:103], v[214:215]
    s_waitcnt lgkmcnt(10)
    v_mfma_f32_32x32x16_bf16 v[128:143], v[196:199], v[244:247], v[128:143]
    ds_read_b64_tr_b16 v[188:189], v15 offset:14048
    ds_read_b64_tr_b16 v[190:191], v15 offset:15200
    v_cvt_pk_bf16_f32 v216, v96, v97
    v_cvt_pk_bf16_f32 v217, v98, v99
    v_cvt_pk_bf16_f32 v218, v100, v101
    s_waitcnt lgkmcnt(10)
    v_mfma_f32_32x32x16_bf16 v[128:143], v[200:203], v[248:251], v[128:143]
    ds_read_b64_tr_b16 v[192:193], v9 offset:224
    ds_read_b64_tr_b16 v[194:195], v9 offset:1376
    v_cvt_pk_bf16_f32 v219, v102, v103
    s_nop 0
    buffer_store_dwordx4 v[216:219], v13, s[36:39], s13 offen sc1
    s_waitcnt lgkmcnt(10)
    v_mfma_f32_32x32x16_bf16 v[128:143], v[204:207], v[252:255], v[128:143]
    ds_read_b64_tr_b16 v[196:197], v9 offset:4832
    ds_read_b64_tr_b16 v[198:199], v9 offset:5984
    v_pk_mul_f32 v[208:209], v[112:113], s[56:57]
    v_pk_mul_f32 v[210:211], v[114:115], s[56:57]
    v_pk_mul_f32 v[212:213], v[116:117], s[56:57]
    v_pk_mul_f32 v[214:215], v[118:119], s[56:57]
    s_waitcnt lgkmcnt(10)
    v_mfma_f32_32x32x16_bf16 v[128:143], v[176:179], v[220:223], v[128:143]
    ds_read_b64_tr_b16 v[200:201], v9 offset:9440
    ds_read_b64_tr_b16 v[202:203], v9 offset:10592
    v_exp_f32 v208, v208
    v_exp_f32 v209, v209
    v_exp_f32 v210, v210
    v_exp_f32 v211, v211
    s_waitcnt lgkmcnt(10)
    v_mfma_f32_32x32x16_bf16 v[128:143], v[180:183], v[224:227], v[128:143]
    ds_read_b64_tr_b16 v[204:205], v9 offset:14048
    ds_read_b64_tr_b16 v[206:207], v9 offset:15200
    v_exp_f32 v212, v212
    v_exp_f32 v213, v213
    v_exp_f32 v214, v214
    v_exp_f32 v215, v215
    s_waitcnt lgkmcnt(10)
    v_mfma_f32_32x32x16_bf16 v[128:143], v[184:187], v[228:231], v[128:143]
    ds_read_b64_tr_b16 v[176:177], v9 offset:37376
    ds_read_b64_tr_b16 v[178:179], v9 offset:38528
    v_pk_mul_f32 v[112:113], v[112:113], v[120:121]
    v_pk_mul_f32 v[114:115], v[114:115], v[122:123]
    v_pk_mul_f32 v[116:117], v[116:117], v[124:125]
    s_waitcnt lgkmcnt(10)
    v_mfma_f32_32x32x16_bf16 v[128:143], v[188:191], v[232:235], v[128:143]
    ds_read_b64_tr_b16 v[180:181], v9 offset:41984
    ds_read_b64_tr_b16 v[182:183], v9 offset:43136
    v_pk_mul_f32 v[118:119], v[118:119], v[126:127]
    v_pk_add_f32 v[208:209], v[208:209], s[58:59]
    v_pk_add_f32 v[210:211], v[210:211], s[58:59]
    s_waitcnt lgkmcnt(10)
    v_mfma_f32_32x32x16_bf16 v[128:143], v[192:195], v[160:163], v[128:143]
    ds_read_b64_tr_b16 v[184:185], v9 offset:46592
    ds_read_b64_tr_b16 v[186:187], v9 offset:47744
    v_pk_add_f32 v[212:213], v[212:213], s[58:59]
    v_pk_add_f32 v[214:215], v[214:215], s[58:59]
    v_rcp_f32 v208, v208
    s_waitcnt lgkmcnt(10)
    v_mfma_f32_32x32x16_bf16 v[128:143], v[196:199], v[164:167], v[128:143]
    ds_read_b64_tr_b16 v[188:189], v9 offset:51200
    ds_read_b64_tr_b16 v[190:191], v9 offset:52352
    v_rcp_f32 v209, v209
    v_rcp_f32 v210, v210
    v_rcp_f32 v211, v211
    s_waitcnt lgkmcnt(10)
    v_mfma_f32_32x32x16_bf16 v[128:143], v[200:203], v[168:171], v[128:143]
    ds_read_b64_tr_b16 v[192:193], v15 offset:256
    ds_read_b64_tr_b16 v[194:195], v15 offset:1408
    v_rcp_f32 v212, v212
    v_rcp_f32 v213, v213
    v_rcp_f32 v214, v214
    s_waitcnt lgkmcnt(10)
    v_mfma_f32_32x32x16_bf16 v[128:143], v[204:207], v[172:175], v[128:143]
    ds_read_b64_tr_b16 v[196:197], v15 offset:4864
    ds_read_b64_tr_b16 v[198:199], v15 offset:6016
    v_rcp_f32 v215, v215
    s_add_u32 s13, s17, 6144
    v_pk_mul_f32 v[112:113], v[112:113], v[208:209]
    s_waitcnt lgkmcnt(10)
    v_mfma_f32_32x32x16_bf16 v[144:159], v[176:179], v[240:243], v[144:159]
    ds_read_b64_tr_b16 v[200:201], v15 offset:9472
    ds_read_b64_tr_b16 v[202:203], v15 offset:10624
    v_pk_mul_f32 v[114:115], v[114:115], v[210:211]
    v_pk_mul_f32 v[116:117], v[116:117], v[212:213]
    v_pk_mul_f32 v[118:119], v[118:119], v[214:215]
    s_waitcnt lgkmcnt(10)
    v_mfma_f32_32x32x16_bf16 v[144:159], v[180:183], v[244:247], v[144:159]
    ds_read_b64_tr_b16 v[204:205], v15 offset:14080
    ds_read_b64_tr_b16 v[206:207], v15 offset:15232
    v_cvt_pk_bf16_f32 v216, v112, v113
    v_cvt_pk_bf16_f32 v217, v114, v115
    v_cvt_pk_bf16_f32 v218, v116, v117
    s_waitcnt lgkmcnt(10)
    v_mfma_f32_32x32x16_bf16 v[144:159], v[184:187], v[248:251], v[144:159]
    ds_read_b64_tr_b16 v[176:177], v9 offset:256
    ds_read_b64_tr_b16 v[178:179], v9 offset:1408
    v_cvt_pk_bf16_f32 v219, v118, v119
    s_nop 0
    buffer_store_dwordx4 v[216:219], v13, s[36:39], s13 offen sc1
    s_waitcnt lgkmcnt(10)
    v_mfma_f32_32x32x16_bf16 v[144:159], v[188:191], v[252:255], v[144:159]
    ds_read_b64_tr_b16 v[180:181], v9 offset:4864
    ds_read_b64_tr_b16 v[182:183], v9 offset:6016
    v_pk_mul_f32 v[208:209], v[128:129], s[56:57]
    v_pk_mul_f32 v[210:211], v[130:131], s[56:57]
    v_pk_mul_f32 v[212:213], v[132:133], s[56:57]
    v_pk_mul_f32 v[214:215], v[134:135], s[56:57]
    s_waitcnt lgkmcnt(10)
    v_mfma_f32_32x32x16_bf16 v[144:159], v[192:195], v[220:223], v[144:159]
    ds_read_b64_tr_b16 v[184:185], v9 offset:9472
    ds_read_b64_tr_b16 v[186:187], v9 offset:10624
    v_exp_f32 v208, v208
    v_exp_f32 v209, v209
    v_exp_f32 v210, v210
    v_exp_f32 v211, v211
    s_waitcnt lgkmcnt(10)
    v_mfma_f32_32x32x16_bf16 v[144:159], v[196:199], v[224:227], v[144:159]
    ds_read_b64_tr_b16 v[188:189], v9 offset:14080
    ds_read_b64_tr_b16 v[190:191], v9 offset:15232
    v_exp_f32 v212, v212
    v_exp_f32 v213, v213
    v_exp_f32 v214, v214
    v_exp_f32 v215, v215
    s_waitcnt lgkmcnt(10)
    v_mfma_f32_32x32x16_bf16 v[144:159], v[200:203], v[228:231], v[144:159]
    v_pk_mul_f32 v[128:129], v[128:129], v[136:137]
    v_pk_mul_f32 v[130:131], v[130:131], v[138:139]
    v_pk_mul_f32 v[132:133], v[132:133], v[140:141]
    s_waitcnt lgkmcnt(8)
    v_mfma_f32_32x32x16_bf16 v[144:159], v[204:207], v[232:235], v[144:159]
    v_pk_mul_f32 v[134:135], v[134:135], v[142:143]
    v_pk_add_f32 v[208:209], v[208:209], s[58:59]
    v_pk_add_f32 v[210:211], v[210:211], s[58:59]
    s_waitcnt lgkmcnt(6)
    v_mfma_f32_32x32x16_bf16 v[144:159], v[176:179], v[160:163], v[144:159]
    v_pk_add_f32 v[212:213], v[212:213], s[58:59]
    v_pk_add_f32 v[214:215], v[214:215], s[58:59]
    v_rcp_f32 v208, v208
    s_waitcnt lgkmcnt(4)
    v_mfma_f32_32x32x16_bf16 v[144:159], v[180:183], v[164:167], v[144:159]
    v_rcp_f32 v209, v209
    v_rcp_f32 v210, v210
    v_rcp_f32 v211, v211
    s_waitcnt lgkmcnt(2)
    v_mfma_f32_32x32x16_bf16 v[144:159], v[184:187], v[168:171], v[144:159]
    v_rcp_f32 v212, v212
    v_rcp_f32 v213, v213
    v_rcp_f32 v214, v214
    s_waitcnt lgkmcnt(0)
    v_mfma_f32_32x32x16_bf16 v[144:159], v[188:191], v[172:175], v[144:159]
    v_rcp_f32 v215, v215
    s_add_u32 s13, s17, 7168
    v_pk_mul_f32 v[128:129], v[128:129], v[208:209]
    v_pk_mul_f32 v[130:131], v[130:131], v[210:211]
    v_pk_mul_f32 v[132:133], v[132:133], v[212:213]
    v_pk_mul_f32 v[134:135], v[134:135], v[214:215]
    v_cvt_pk_bf16_f32 v216, v128, v129
    v_cvt_pk_bf16_f32 v217, v130, v131
    v_cvt_pk_bf16_f32 v218, v132, v133
    v_cvt_pk_bf16_f32 v219, v134, v135
    s_nop 0
    buffer_store_dwordx4 v[216:219], v13, s[36:39], s13 offen sc1
    s_nop 15
    v_pk_mul_f32 v[208:209], v[144:145], s[56:57]
    v_pk_mul_f32 v[210:211], v[146:147], s[56:57]
    v_pk_mul_f32 v[212:213], v[148:149], s[56:57]
    v_pk_mul_f32 v[214:215], v[150:151], s[56:57]
    v_exp_f32 v208, v208
    v_exp_f32 v209, v209
    v_exp_f32 v210, v210
    v_exp_f32 v211, v211
    v_exp_f32 v212, v212
    v_exp_f32 v213, v213
    v_exp_f32 v214, v214
    v_exp_f32 v215, v215
    v_pk_mul_f32 v[144:145], v[144:145], v[152:153]
    v_pk_mul_f32 v[146:147], v[146:147], v[154:155]
    v_pk_mul_f32 v[148:149], v[148:149], v[156:157]
    v_pk_mul_f32 v[150:151], v[150:151], v[158:159]
    v_pk_add_f32 v[208:209], v[208:209], s[58:59]
    v_pk_add_f32 v[210:211], v[210:211], s[58:59]
    v_pk_add_f32 v[212:213], v[212:213], s[58:59]
    v_pk_add_f32 v[214:215], v[214:215], s[58:59]
    v_rcp_f32 v208, v208
    v_rcp_f32 v209, v209
    v_rcp_f32 v210, v210
    v_rcp_f32 v211, v211
    v_rcp_f32 v212, v212
    v_rcp_f32 v213, v213
    v_rcp_f32 v214, v214
    v_rcp_f32 v215, v215
    s_add_u32 s13, s17, 8192
    v_pk_mul_f32 v[144:145], v[144:145], v[208:209]
    v_pk_mul_f32 v[146:147], v[146:147], v[210:211]
    v_pk_mul_f32 v[148:149], v[148:149], v[212:213]
    v_pk_mul_f32 v[150:151], v[150:151], v[214:215]
    v_cvt_pk_bf16_f32 v216, v144, v145
    v_cvt_pk_bf16_f32 v217, v146, v147
    v_cvt_pk_bf16_f32 v218, v148, v149
    v_cvt_pk_bf16_f32 v219, v150, v151
    s_nop 0
    buffer_store_dwordx4 v[216:219], v13, s[36:39], s13 offen sc1
    s_waitcnt vmcnt(0)
k5_gateup_kernel_end:
    s_endpgm
.section .rodata,"a"
.p2align 6
.amdhsa_kernel k5_gateup_kernel
  .amdhsa_next_free_vgpr 256
  .amdhsa_next_free_sgpr 96
  .amdhsa_accum_offset 256
  .amdhsa_group_segment_fixed_size 0
  .amdhsa_kernarg_size 112
  .amdhsa_user_sgpr_count 2
  .amdhsa_user_sgpr_kernarg_segment_ptr 1
  .amdhsa_system_sgpr_workgroup_id_x 1
.end_amdhsa_kernel
.text
.globl k6_down_kernel
.p2align 8
.type k6_down_kernel,@function
k6_down_kernel:
    s_cmp_ge_u32 s2, 240
    s_cbranch_scc1 k6_down_kernel_end
    s_load_dwordx2 s[4:5], s[0:1], 64
    s_load_dwordx2 s[6:7], s[0:1], 104
    v_and_b32 v1, 63, v0
    v_lshrrev_b32 v6, 6, v0
    s_nop 0
    v_readfirstlane_b32 s40, v6
    v_lshrrev_b32 v2, 5, v1
    v_bfe_u32 v3, v1, 2, 2
    v_bfe_u32 v4, v1, 4, 1
    v_and_b32 v5, 1, v1
    v_lshlrev_b32 v5, 4, v5
    v_bfe_u32 v6, v1, 1, 1
    v_lshl_add_u32 v5, v6, 3, v5
    s_and_b32 s10, s2, 7
    s_lshr_b32 s11, s2, 3
    s_mul_hi_u32 s12, s11, 0x55555556
    s_mul_i32 s13, s12, 3
    s_sub_u32 s11, s11, s13
    s_mul_i32 s10, s10, 10
    s_add_u32 s10, s10, s12
    s_lshr_b32 s12, s10, 4
    s_and_b32 s10, s10, 15
    s_and_b32 s16, s40, 3
    s_lshr_b32 s18, s40, 2
    s_lshl_b32 s14, s10, 2
    s_add_u32 s14, s14, s16
    s_mul_i32 s15, s11, 384
    s_mul_i32 s17, s18, 192
    s_add_u32 s15, s15, s17
    s_mul_i32 s17, s16, 3
    s_add_u32 s17, s17, 0
    s_lshl_b32 s19, s17, 6
    v_add_u32 v7, s19, v1
    v_mul_u32_u24 v8, 43691, v7
    v_lshrrev_b32 v8, 19, v8
    v_mul_u32_u24 v9, 12, v8
    v_sub_u32 v9, v7, v9
    v_mul_u32_u24 v8, 1152, v8
    v_lshl_add_u32 v8, v9, 4, v8
    v_add_u32 v10, s15, v8
    s_lshl_b32 s17, s17, 10
    s_mul_i32 s19, s18, 12288
    s_add_u32 s44, s17, s19
    s_mul_i32 s17, s16, 3
    s_add_u32 s17, s17, 1
    s_lshl_b32 s19, s17, 6
    v_add_u32 v7, s19, v1
    v_mul_u32_u24 v8, 43691, v7
    v_lshrrev_b32 v8, 19, v8
    v_mul_u32_u24 v9, 12, v8
    v_sub_u32 v9, v7, v9
    v_mul_u32_u24 v8, 1152, v8
    v_lshl_add_u32 v8, v9, 4, v8
    v_add_u32 v11, s15, v8
    s_lshl_b32 s17, s17, 10
    s_mul_i32 s19, s18, 12288
    s_add_u32 s45, s17, s19
    s_mul_i32 s17, s16, 3
    s_add_u32 s17, s17, 2
    s_lshl_b32 s19, s17, 6
    v_add_u32 v7, s19, v1
    v_mul_u32_u24 v8, 43691, v7
    v_lshrrev_b32 v8, 19, v8
    v_mul_u32_u24 v9, 12, v8
    v_sub_u32 v9, v7, v9
    v_mul_u32_u24 v8, 1152, v8
    v_lshl_add_u32 v8, v9, 4, v8
    v_add_u32 v12, s15, v8
    s_lshl_b32 s17, s17, 10
    s_mul_i32 s19, s18, 12288
    s_add_u32 s46, s17, s19
    s_lshr_b32 s17, s40, 1
    s_lshl_b32 s19, s10, 2
    s_add_u32 s17, s17, s19
    s_mul_i32 s17, s17, 294912
    s_and_b32 s19, s40, 1
    s_lshl_b32 s19, s19, 11
    s_add_u32 s17, s17, s19
    v_lshlrev_b32 v13, 4, v1
    v_add_u32 v13, s17, v13
    s_lshl_b32 s47, s40, 11
    s_add_u32 s47, s47, 24576
    v_lshl_add_u32 v7, v2, 3, v3
    v_mul_u32_u24 v7, 192, v7
    v_lshl_add_u32 v7, v4, 5, v7
    v_add_u32 v7, v7, v5
    s_mul_i32 s19, s18, 12288
    v_add_u32 v14, s19, v7
    v_add_u32 v15, 81920, v14
    s_lshl_b32 s19, s16, 12
    s_add_u32 s19, s19, 24576
    v_lshlrev_b32 v7, 4, v1
    v_add_u32 v8, s19, v7
    v_add_u32 v9, 81920, v8
    s_mul_i32 s48, s12, 61440
    s_mul_i32 s49, s12, 1105920
    s_waitcnt lgkmcnt(0)
    s_add_u32 s20, s4, 0
    s_addc_u32 s21, s5, 0
    s_mov_b32 s22, 5308416
    s_mov_b32 s23, 0x20000
    s_add_u32 s24, s6, 33554432
    s_addc_u32 s25, s7, 0
    s_mov_b32 s26, 18874368
    s_mov_b32 s27, 0x20000
    s_add_u32 s28, s6, 67108864
    s_addc_u32 s29, s7, 0
    s_mov_b32 s30, 11796480
    s_mov_b32 s31, 0x20000
    s_add_u32 m0, s47, 0
    s_add_u32 s34, s48, 0
    buffer_load_dwordx4 v13, s[24:27], s34 offen lds
    buffer_load_dwordx4 v13, s[24:27], s34 offen offset:1024 lds
    s_add_u32 m0, s44, 0
    s_add_u32 s33, s49, 0
    buffer_load_dwordx4 v10, s[20:23], s33 offen lds
    s_add_u32 m0, s45, 0
    s_nop 0
    buffer_load_dwordx4 v11, s[20:23], s33 offen lds
    s_add_u32 m0, s46, 0
    s_nop 0
    buffer_load_dwordx4 v12, s[20:23], s33 offen lds
    s_add_u32 m0, s47, 40960
    s_add_u32 s34, s48, 4096
    buffer_load_dwordx4 v13, s[24:27], s34 offen lds
    buffer_load_dwordx4 v13, s[24:27], s34 offen offset:1024 lds
    s_add_u32 m0, s44, 40960
    s_add_u32 s33, s49, 73728
    buffer_load_dwordx4 v10, s[20:23], s33 offen lds
    s_add_u32 m0, s45, 40960
    s_nop 0
    buffer_load_dwordx4 v11, s[20:23], s33 offen lds
    s_add_u32 m0, s46, 40960
    s_nop 0
    buffer_load_dwordx4 v12, s[20:23], s33 offen lds
    s_waitcnt vmcnt(5)
    s_barrier
    ds_read_b128 v[64:67], v8 offset:0
    ds_read_b64_tr_b16 v[80:81], v14 offset:0
    ds_read_b64_tr_b16 v[82:83], v14 offset:768
    ds_read_b64_tr_b16 v[84:85], v14 offset:64
    ds_read_b64_tr_b16 v[86:87], v14 offset:832
    ds_read_b64_tr_b16 v[88:89], v14 offset:128
    ds_read_b64_tr_b16 v[90:91], v14 offset:896
    ds_read_b128 v[68:71], v8 offset:1024
    ds_read_b64_tr_b16 v[92:93], v14 offset:3072
    ds_read_b64_tr_b16 v[94:95], v14 offset:3840
    ds_read_b64_tr_b16 v[96:97], v14 offset:3136
    ds_read_b64_tr_b16 v[98:99], v14 offset:3904
    ds_read_b64_tr_b16 v[100:101], v14 offset:3200
    ds_read_b64_tr_b16 v[102:103], v14 offset:3968
    s_add_u32 m0, s47, 81920
    s_add_u32 s34, s48, 8192
    buffer_load_dwordx4 v13, s[24:27], s34 offen lds
    s_waitcnt lgkmcnt(11)
    v_mfma_f32_32x32x16_bf16 v[16:31], v[80:83], v[64:67], 0
    ds_read_b128 v[72:75], v8 offset:2048
    ds_read_b64_tr_b16 v[104:105], v14 offset:6144
    ds_read_b64_tr_b16 v[106:107], v14 offset:6912
    buffer_load_dwordx4 v13, s[24:27], s34 offen offset:1024 lds
    s_waitcnt lgkmcnt(12)
    v_mfma_f32_32x32x16_bf16 v[32:47], v[84:87], v[64:67], 0
    ds_read_b64_tr_b16 v[108:109], v14 offset:6208
    ds_read_b64_tr_b16 v[110:111], v14 offset:6976
    s_add_u32 m0, s44, 81920
    s_add_u32 s33, s49, 147456
    buffer_load_dwordx4 v10, s[20:23], s33 offen lds
    s_waitcnt lgkmcnt(12)
    v_mfma_f32_32x32x16_bf16 v[48:63], v[88:91], v[64:67], 0
    ds_read_b64_tr_b16 v[80:81], v14 offset:6272
    ds_read_b64_tr_b16 v[82:83], v14 offset:7040
    s_add_u32 m0, s45, 81920
    s_nop 0
    buffer_load_dwordx4 v11, s[20:23], s33 offen lds
    s_waitcnt lgkmcnt(11)
    v_mfma_f32_32x32x16_bf16 v[16:31], v[92:95], v[68:71], v[16:31]
    ds_read_b128 v[76:79], v8 offset:3072
    ds_read_b64_tr_b16 v[84:85], v14 offset:9216
    ds_read_b64_tr_b16 v[86:87], v14 offset:9984
    s_add_u32 m0, s46, 81920
    s_nop 0
    buffer_load_dwordx4 v12, s[20:23], s33 offen lds
    s_waitcnt lgkmcnt(12)
    v_mfma_f32_32x32x16_bf16 v[32:47], v[96:99], v[68:71], v[32:47]
    ds_read_b64_tr_b16 v[88:89], v14 offset:9280
    ds_read_b64_tr_b16 v[90:91], v14 offset:10048
    s_waitcnt lgkmcnt(12)
    v_mfma_f32_32x32x16_bf16 v[48:63], v[100:103], v[68:71], v[48:63]
    ds_read_b64_tr_b16 v[92:93], v14 offset:9344
    ds_read_b64_tr_b16 v[94:95], v14 offset:10112
    s_waitcnt lgkmcnt(11)
    v_mfma_f32_32x32x16_bf16 v[16:31], v[104:107], v[72:75], v[16:31]
    s_waitcnt vmcnt(5)
    s_barrier
    ds_read_b128 v[64:67], v8 offset:40960
    ds_read_b64_tr_b16 v[96:97], v14 offset:40960
    ds_read_b64_tr_b16 v[98:99], v14 offset:41728
    s_waitcnt lgkmcnt(12)
    v_mfma_f32_32x32x16_bf16 v[32:47], v[108:111], v[72:75], v[32:47]
    ds_read_b64_tr_b16 v[100:101], v14 offset:41024
    ds_read_b64_tr_b16 v[102:103], v14 offset:41792
    s_waitcnt lgkmcnt(12)
    v_mfma_f32_32x32x16_bf16 v[48:63], v[80:83], v[72:75], v[48:63]
    ds_read_b64_tr_b16 v[104:105], v14 offset:41088
    ds_read_b64_tr_b16 v[106:107], v14 offset:41856
    s_waitcnt lgkmcnt(11)
    v_mfma_f32_32x32x16_bf16 v[16:31], v[84:87], v[76:79], v[16:31]
    ds_read_b128 v[68:71], v8 offset:41984
    ds_read_b64_tr_b16 v[108:109], v14 offset:44032
    ds_read_b64_tr_b16 v[110:111], v14 offset:44800
    s_waitcnt lgkmcnt(12)
    v_mfma_f32_32x32x16_bf16 v[32:47], v[88:91], v[76:79], v[32:47]
    ds_read_b64_tr_b16 v[80:81], v14 offset:44096
    ds_read_b64_tr_b16 v[82:83], v14 offset:44864
    s_add_u32 m0, s47, 122880
    s_add_u32 s34, s48, 12288
    buffer_load_dwordx4 v13, s[24:27], s34 offen lds
    s_waitcnt lgkmcnt(12)
    v_mfma_f32_32x32x16_bf16 v[48:63], v[92:95], v[76:79], v[48:63]
    ds_read_b64_tr_b16 v[84:85], v14 offset:44160
    ds_read_b64_tr_b16 v[86:87], v14 offset:44928
    buffer_load_dwordx4 v13, s[24:27], s34 offen offset:1024 lds
    s_waitcnt lgkmcnt(11)
    v_mfma_f32_32x32x16_bf16 v[16:31], v[96:99], v[64:67], v[16:31]
    ds_read_b128 v[72:75], v8 offset:43008
    ds_read_b64_tr_b16 v[88:89], v14 offset:47104
    ds_read_b64_tr_b16 v[90:91], v14 offset:47872
    s_add_u32 m0, s44, 122880
    s_add_u32 s33, s49, 221184
    buffer_load_dwordx4 v10, s[20:23], s33 offen lds
    s_waitcnt lgkmcnt(12)
    v_mfma_f32_32x32x16_bf16 v[32:47], v[100:103], v[64:67], v[32:47]
    ds_read_b64_tr_b16 v[92:93], v14 offset:47168
    ds_read_b64_tr_b16 v[94:95], v14 offset:47936
    s_add_u32 m0, s45, 122880
    s_nop 0
    buffer_load_dwordx4 v11, s[20:23], s33 offen lds
    s_waitcnt lgkmcnt(12)
    v_mfma_f32_32x32x16_bf16 v[48:63], v[104:107], v[64:67], v[48:63]
    ds_read_b64_tr_b16 v[96:97], v14 offset:47232
    ds_read_b64_tr_b16 v[98:99], v14 offset:48000
    s_add_u32 m0, s46, 122880
    s_nop 0
    buffer_load_dwordx4 v12, s[20:23], s33 offen lds
    s_waitcnt lgkmcnt(11)
    v_mfma_f32_32x32x16_bf16 v[16:31], v[108:111], v[68:71], v[16:31]
    ds_read_b128 v[76:79], v8 offset:44032
    ds_read_b64_tr_b16 v[100:101], v14 offset:50176
    ds_read_b64_tr_b16 v[102:103], v14 offset:50944
    s_waitcnt lgkmcnt(12)
    v_mfma_f32_32x32x16_bf16 v[32:47], v[80:83], v[68:71], v[32:47]
    ds_read_b64_tr_b16 v[104:105], v14 offset:50240
    ds_read_b64_tr_b16 v[106:107], v14 offset:51008
    s_waitcnt lgkmcnt(12)
    v_mfma_f32_32x32x16_bf16 v[48:63], v[84:87], v[68:71], v[48:63]
    ds_read_b64_tr_b16 v[108:109], v14 offset:50304
    ds_read_b64_tr_b16 v[110:111], v14 offset:51072
    s_waitcnt lgkmcnt(11)
    v_mfma_f32_32x32x16_bf16 v[16:31], v[88:91], v[72:75], v[16:31]
    s_waitcnt vmcnt(5)
    s_barrier
    ds_read_b128 v[64:67], v9 offset:0
    ds_read_b64_tr_b16 v[80:81], v15 offset:0
    ds_read_b64_tr_b16 v[82:83], v15 offset:768
    s_waitcnt lgkmcnt(12)
    v_mfma_f32_32x32x16_bf16 v[32:47], v[92:95], v[72:75], v[32:47]
    ds_read_b64_tr_b16 v[84:85], v15 offset:64
    ds_read_b64_tr_b16 v[86:87], v15 offset:832
    s_waitcnt lgkmcnt(12)
    v_mfma_f32_32x32x16_bf16 v[48:63], v[96:99], v[72:75], v[48:63]
    ds_read_b64_tr_b16 v[88:89], v15 offset:128
    ds_read_b64_tr_b16 v[90:91], v15 offset:896
    s_waitcnt lgkmcnt(11)
    v_mfma_f32_32x32x16_bf16 v[16:31], v[100:103], v[76:79], v[16:31]
    ds_read_b128 v[68:71], v9 offset:1024
    ds_read_b64_tr_b16 v[92:93], v15 offset:3072
    ds_read_b64_tr_b16 v[94:95], v15 offset:3840
    s_add_u32 m0, s47, 0
    s_add_u32 s34, s48, 16384
    buffer_load_dwordx4 v13, s[24:27], s34 offen lds
    s_waitcnt lgkmcnt(12)
    v_mfma_f32_32x32x16_bf16 v[32:47], v[104:107], v[76:79], v[32:47]
    ds_read_b64_tr_b16 v[96:97], v15 offset:3136
    ds_read_b64_tr_b16 v[98:99], v15 offset:3904
    buffer_load_dwordx4 v13, s[24:27], s34 offen offset:1024 lds
    s_waitcnt lgkmcnt(12)
    v_mfma_f32_32x32x16_bf16 v[48:63], v[108:111], v[76:79], v[48:63]
    ds_read_b64_tr_b16 v[100:101], v15 offset:3200
    ds_read_b64_tr_b16 v[102:103], v15 offset:3968
    s_add_u32 m0, s44, 0
    s_add_u32 s33, s49, 294912
    buffer_load_dwordx4 v10, s[20:23], s33 offen lds
    s_waitcnt lgkmcnt(11)
    v_mfma_f32_32x32x16_bf16 v[16:31], v[80:83], v[64:67], v[16:31]
    ds_read_b128 v[72:75], v9 offset:2048
    ds_read_b64_tr_b16 v[104:105], v15 offset:6144
    ds_read_b64_tr_b16 v[106:107], v15 offset:6912
    s_add_u32 m0, s45, 0
    s_nop 0
    buffer_load_dwordx4 v11, s[20:23], s33 offen lds
    s_waitcnt lgkmcnt(12)
    v_mfma_f32_32x32x16_bf16 v[32:47], v[84:87], v[64:67], v[32:47]
    ds_read_b64_tr_b16 v[108:109], v15 offset:6208
    ds_read_b64_tr_b16 v[110:111], v15 offset:6976
    s_add_u32 m0, s46, 0
    s_nop 0
    buffer_load_dwordx4 v12, s[20:23], s33 offen lds
    s_waitcnt lgkmcnt(12)
    v_mfma_f32_32x32x16_bf16 v[48:63], v[88:91], v[64:67], v[48:63]
    ds_read_b64_tr_b16 v[80:81], v15 offset:6272
    ds_read_b64_tr_b16 v[82:83], v15 offset:7040
    s_waitcnt lgkmcnt(11)
    v_mfma_f32_32x32x16_bf16 v[16:31], v[92:95], v[68:71], v[16:31]
    ds_read_b128 v[76:79], v9 offset:3072
    ds_read_b64_tr_b16 v[84:85], v15 offset:9216
    ds_read_b64_tr_b16 v[86:87], v15 offset:9984
    s_waitcnt lgkmcnt(12)
    v_mfma_f32_32x32x16_bf16 v[32:47], v[96:99], v[68:71], v[32:47]
    ds_read_b64_tr_b16 v[88:89], v15 offset:9280
    ds_read_b64_tr_b16 v[90:91], v15 offset:10048
    s_waitcnt lgkmcnt(12)
    v_mfma_f32_32x32x16_bf16 v[48:63], v[100:103], v[68:71], v[48:63]
    ds_read_b64_tr_b16 v[92:93], v15 offset:9344
    ds_read_b64_tr_b16 v[94:95], v15 offset:10112
    s_waitcnt lgkmcnt(11)
    v_mfma_f32_32x32x16_bf16 v[16:31], v[104:107], v[72:75], v[16:31]
    s_waitcnt vmcnt(5)
    s_barrier
    ds_read_b128 v[64:67], v9 offset:40960
    ds_read_b64_tr_b16 v[96:97], v15 offset:40960
    ds_read_b64_tr_b16 v[98:99], v15 offset:41728
    s_waitcnt lgkmcnt(12)
    v_mfma_f32_32x32x16_bf16 v[32:47], v[108:111], v[72:75], v[32:47]
    ds_read_b64_tr_b16 v[100:101], v15 offset:41024
    ds_read_b64_tr_b16 v[102:103], v15 offset:41792
    s_waitcnt lgkmcnt(12)
    v_mfma_f32_32x32x16_bf16 v[48:63], v[80:83], v[72:75], v[48:63]
    ds_read_b64_tr_b16 v[104:105], v15 offset:41088
    ds_read_b64_tr_b16 v[106:107], v15 offset:41856
    s_add_u32 m0, s47, 40960
    s_add_u32 s34, s48, 20480
    buffer_load_dwordx4 v13, s[24:27], s34 offen lds
    s_waitcnt lgkmcnt(11)
    v_mfma_f32_32x32x16_bf16 v[16:31], v[84:87], v[76:79], v[16:31]
    ds_read_b128 v[68:71], v9 offset:41984
    ds_read_b64_tr_b16 v[108:109], v15 offset:44032
    ds_read_b64_tr_b16 v[110:111], v15 offset:44800
    buffer_load_dwordx4 v13, s[24:27], s34 offen offset:1024 lds
    s_waitcnt lgkmcnt(12)
    v_mfma_f32_32x32x16_bf16 v[32:47], v[88:91], v[76:79], v[32:47]
    ds_read_b64_tr_b16 v[80:81], v15 offset:44096
    ds_read_b64_tr_b16 v[82:83], v15 offset:44864
    s_add_u32 m0, s44, 40960
    s_add_u32 s33, s49, 368640
    buffer_load_dwordx4 v10, s[20:23], s33 offen lds
    s_waitcnt lgkmcnt(12)
    v_mfma_f32_32x32x16_bf16 v[48:63], v[92:95], v[76:79], v[48:63]
    ds_read_b64_tr_b16 v[84:85], v15 offset:44160
    ds_read_b64_tr_b16 v[86:87], v15 offset:44928
    s_add_u32 m0, s45, 40960
    s_nop 0
    buffer_load_dwordx4 v11, s[20:23], s33 offen lds
    s_waitcnt lgkmcnt(11)
    v_mfma_f32_32x32x16_bf16 v[16:31], v[96:99], v[64:67], v[16:31]
    ds_read_b128 v[72:75], v9 offset:43008
    ds_read_b64_tr_b16 v[88:89], v15 offset:47104
    ds_read_b64_tr_b16 v[90:91], v15 offset:47872
    s_add_u32 m0, s46, 40960
    s_nop 0
    buffer_load_dwordx4 v12, s[20:23], s33 offen lds
    s_waitcnt lgkmcnt(12)
    v_mfma_f32_32x32x16_bf16 v[32:47], v[100:103], v[64:67], v[32:47]
    ds_read_b64_tr_b16 v[92:93], v15 offset:47168
    ds_read_b64_tr_b16 v[94:95], v15 offset:47936
    s_waitcnt lgkmcnt(12)
    v_mfma_f32_32x32x16_bf16 v[48:63], v[104:107], v[64:67], v[48:63]
    ds_read_b64_tr_b16 v[96:97], v15 offset:47232
    ds_read_b64_tr_b16 v[98:99], v15 offset:48000
    s_waitcnt lgkmcnt(11)
    v_mfma_f32_32x32x16_bf16 v[16:31], v[108:111], v[68:71], v[16:31]
    ds_read_b128 v[76:79], v9 offset:44032
    ds_read_b64_tr_b16 v[100:101], v15 offset:50176
    ds_read_b64_tr_b16 v[102:103], v15 offset:50944
    s_waitcnt lgkmcnt(12)
    v_mfma_f32_32x32x16_bf16 v[32:47], v[80:83], v[68:71], v[32:47]
    ds_read_b64_tr_b16 v[104:105], v15 offset:50240
    ds_read_b64_tr_b16 v[106:107], v15 offset:51008
    s_waitcnt lgkmcnt(12)
    v_mfma_f32_32x32x16_bf16 v[48:63], v[84:87], v[68:71], v[48:63]
    ds_read_b64_tr_b16 v[108:109], v15 offset:50304
    ds_read_b64_tr_b16 v[110:111], v15 offset:51072
    s_waitcnt lgkmcnt(11)
    v_mfma_f32_32x32x16_bf16 v[16:31], v[88:91], v[72:75], v[16:31]
    s_waitcnt vmcnt(5)
    s_barrier
    ds_read_b128 v[64:67], v8 offset:0
    ds_read_b64_tr_b16 v[80:81], v14 offset:0
    ds_read_b64_tr_b16 v[82:83], v14 offset:768
    s_waitcnt lgkmcnt(12)
    v_mfma_f32_32x32x16_bf16 v[32:47], v[92:95], v[72:75], v[32:47]
    ds_read_b64_tr_b16 v[84:85], v14 offset:64
    ds_read_b64_tr_b16 v[86:87], v14 offset:832
    s_add_u32 m0, s47, 81920
    s_add_u32 s34, s48, 24576
    buffer_load_dwordx4 v13, s[24:27], s34 offen lds
    s_waitcnt lgkmcnt(12)
    v_mfma_f32_32x32x16_bf16 v[48:63], v[96:99], v[72:75], v[48:63]
    ds_read_b64_tr_b16 v[88:89], v14 offset:128
    ds_read_b64_tr_b16 v[90:91], v14 offset:896
    buffer_load_dwordx4 v13, s[24:27], s34 offen offset:1024 lds
    s_waitcnt lgkmcnt(11)
    v_mfma_f32_32x32x16_bf16 v[16:31], v[100:103], v[76:79], v[16:31]
    ds_read_b128 v[68:71], v8 offset:1024
    ds_read_b64_tr_b16 v[92:93], v14 offset:3072
    ds_read_b64_tr_b16 v[94:95], v14 offset:3840
    s_add_u32 m0, s44, 81920
    s_add_u32 s33, s49, 442368
    buffer_load_dwordx4 v10, s[20:23], s33 offen lds
    s_waitcnt lgkmcnt(12)
    v_mfma_f32_32x32x16_bf16 v[32:47], v[104:107], v[76:79], v[32:47]
    ds_read_b64_tr_b16 v[96:97], v14 offset:3136
    ds_read_b64_tr_b16 v[98:99], v14 offset:3904
    s_add_u32 m0, s45, 81920
    s_nop 0
    buffer_load_dwordx4 v11, s[20:23], s33 offen lds
    s_waitcnt lgkmcnt(12)
    v_mfma_f32_32x32x16_bf16 v[48:63], v[108:111], v[76:79], v[48:63]
    ds_read_b64_tr_b16 v[100:101], v14 offset:3200
    ds_read_b64_tr_b16 v[102:103], v14 offset:3968
    s_add_u32 m0, s46, 81920
    s_nop 0
    buffer_load_dwordx4 v12, s[20:23], s33 offen lds
    s_waitcnt lgkmcnt(11)
    v_mfma_f32_32x32x16_bf16 v[16:31], v[80:83], v[64:67], v[16:31]
    ds_read_b128 v[72:75], v8 offset:2048
    ds_read_b64_tr_b16 v[104:105], v14 offset:6144
    ds_read_b64_tr_b16 v[106:107], v14 offset:6912
    s_waitcnt lgkmcnt(12)
    v_mfma_f32_32x32x16_bf16 v[32:47], v[84:87], v[64:67], v[32:47]
    ds_read_b64_tr_b16 v[108:109], v14 offset:6208
    ds_read_b64_tr_b16 v[110:111], v14 offset:6976
    s_waitcnt lgkmcnt(12)
    v_mfma_f32_32x32x16_bf16 v[48:63], v[88:91], v[64:67], v[48:63]
    ds_read_b64_tr_b16 v[80:81], v14 offset:6272
    ds_read_b64_tr_b16 v[82:83], v14 offset:7040
    s_waitcnt lgkmcnt(11)
    v_mfma_f32_32x32x16_bf16 v[16:31], v[92:95], v[68:71], v[16:31]
    ds_read_b128 v[76:79], v8 offset:3072
    ds_read_b64_tr_b16 v[84:85], v14 offset:9216
    ds_read_b64_tr_b16 v[86:87], v14 offset:9984
    s_waitcnt lgkmcnt(12)
    v_mfma_f32_32x32x16_bf16 v[32:47], v[96:99], v[68:71], v[32:47]
    ds_read_b64_tr_b16 v[88:89], v14 offset:9280
    ds_read_b64_tr_b16 v[90:91], v14 offset:10048
    s_waitcnt lgkmcnt(12)
    v_mfma_f32_32x32x16_bf16 v[48:63], v[100:103], v[68:71], v[48:63]
    ds_read_b64_tr_b16 v[92:93], v14 offset:9344
    ds_read_b64_tr_b16 v[94:95], v14 offset:10112
    s_waitcnt lgkmcnt(11)
    v_mfma_f32_32x32x16_bf16 v[16:31], v[104:107], v[72:75], v[16:31]
    s_waitcnt vmcnt(5)
    s_barrier
    ds_read_b128 v[64:67], v8 offset:40960
    ds_read_b64_tr_b16 v[96:97], v14 offset:40960
    ds_read_b64_tr_b16 v[98:99], v14 offset:41728
    s_add_u32 m0, s47, 122880
    s_add_u32 s34, s48, 28672
    buffer_load_dwordx4 v13, s[24:27], s34 offen lds
    s_waitcnt lgkmcnt(12)
    v_mfma_f32_32x32x16_bf16 v[32:47], v[108:111], v[72:75], v[32:47]
    ds_read_b64_tr_b16 v[100:101], v14 offset:41024
    ds_read_b64_tr_b16 v[102:103], v14 offset:41792
    buffer_load_dwordx4 v13, s[24:27], s34 offen offset:1024 lds
    s_waitcnt lgkmcnt(12)
    v_mfma_f32_32x32x16_bf16 v[48:63], v[80:83], v[72:75], v[48:63]
    ds_read_b64_tr_b16 v[104:105], v14 offset:41088
    ds_read_b64_tr_b16 v[106:107], v14 offset:41856
    s_add_u32 m0, s44, 122880
    s_add_u32 s33, s49, 516096
    buffer_load_dwordx4 v10, s[20:23], s33 offen lds
    s_waitcnt lgkmcnt(11)
    v_mfma_f32_32x32x16_bf16 v[16:31], v[84:87], v[76:79], v[16:31]
    ds_read_b128 v[68:71], v8 offset:41984
    ds_read_b64_tr_b16 v[108:109], v14 offset:44032
    ds_read_b64_tr_b16 v[110:111], v14 offset:44800
    s_add_u32 m0, s45, 122880
    s_nop 0
    buffer_load_dwordx4 v11, s[20:23], s33 offen lds
    s_waitcnt lgkmcnt(12)
    v_mfma_f32_32x32x16_bf16 v[32:47], v[88:91], v[76:79], v[32:47]
    ds_read_b64_tr_b16 v[80:81], v14 offset:44096
    ds_read_b64_tr_b16 v[82:83], v14 offset:44864
    s_add_u32 m0, s46, 122880
    s_nop 0
    buffer_load_dwordx4 v12, s[20:23], s33 offen lds
    s_waitcnt lgkmcnt(12)
    v_mfma_f32_32x32x16_bf16 v[48:63], v[92:95], v[76:79], v[48:63]
    ds_read_b64_tr_b16 v[84:85], v14 offset:44160
    ds_read_b64_tr_b16 v[86:87], v14 offset:44928
    s_waitcnt lgkmcnt(11)
    v_mfma_f32_32x32x16_bf16 v[16:31], v[96:99], v[64:67], v[16:31]
    ds_read_b128 v[72:75], v8 offset:43008
    ds_read_b64_tr_b16 v[88:89], v14 offset:47104
    ds_read_b64_tr_b16 v[90:91], v14 offset:47872
    s_waitcnt lgkmcnt(12)
    v_mfma_f32_32x32x16_bf16 v[32:47], v[100:103], v[64:67], v[32:47]
    ds_read_b64_tr_b16 v[92:93], v14 offset:47168
    ds_read_b64_tr_b16 v[94:95], v14 offset:47936
    s_waitcnt lgkmcnt(12)
    v_mfma_f32_32x32x16_bf16 v[48:63], v[104:107], v[64:67], v[48:63]
    ds_read_b64_tr_b16 v[96:97], v14 offset:47232
    ds_read_b64_tr_b16 v[98:99], v14 offset:48000
    s_waitcnt lgkmcnt(11)
    v_mfma_f32_32x32x16_bf16 v[16:31], v[108:111], v[68:71], v[16:31]
    ds_read_b128 v[76:79], v8 offset:44032
    ds_read_b64_tr_b16 v[100:101], v14 offset:50176
    ds_read_b64_tr_b16 v[102:103], v14 offset:50944
    s_waitcnt lgkmcnt(12)
    v_mfma_f32_32x32x16_bf16 v[32:47], v[80:83], v[68:71], v[32:47]
    ds_read_b64_tr_b16 v[104:105], v14 offset:50240
    ds_read_b64_tr_b16 v[106:107], v14 offset:51008
    s_waitcnt lgkmcnt(12)
    v_mfma_f32_32x32x16_bf16 v[48:63], v[84:87], v[68:71], v[48:63]
    ds_read_b64_tr_b16 v[108:109], v14 offset:50304
    ds_read_b64_tr_b16 v[110:111], v14 offset:51072
    s_add_u32 m0, s47, 0
    s_add_u32 s34, s48, 32768
    buffer_load_dwordx4 v13, s[24:27], s34 offen lds
    s_waitcnt lgkmcnt(11)
    v_mfma_f32_32x32x16_bf16 v[16:31], v[88:91], v[72:75], v[16:31]
    s_waitcnt vmcnt(6)
    s_barrier
    ds_read_b128 v[64:67], v9 offset:0
    ds_read_b64_tr_b16 v[80:81], v15 offset:0
    ds_read_b64_tr_b16 v[82:83], v15 offset:768
    buffer_load_dwordx4 v13, s[24:27], s34 offen offset:1024 lds
    s_waitcnt lgkmcnt(12)
    v_mfma_f32_32x32x16_bf16 v[32:47], v[92:95], v[72:75], v[32:47]
    ds_read_b64_tr_b16 v[84:85], v15 offset:64
    ds_read_b64_tr_b16 v[86:87], v15 offset:832
    s_add_u32 m0, s44, 0
    s_add_u32 s33, s49, 589824
    buffer_load_dwordx4 v10, s[20:23], s33 offen lds
    s_waitcnt lgkmcnt(12)
    v_mfma_f32_32x32x16_bf16 v[48:63], v[96:99], v[72:75], v[48:63]
    ds_read_b64_tr_b16 v[88:89], v15 offset:128
    ds_read_b64_tr_b16 v[90:91], v15 offset:896
    s_add_u32 m0, s45, 0
    s_nop 0
    buffer_load_dwordx4 v11, s[20:23], s33 offen lds
    s_waitcnt lgkmcnt(11)
    v_mfma_f32_32x32x16_bf16 v[16:31], v[100:103], v[76:79], v[16:31]
    ds_read_b128 v[68:71], v9 offset:1024
    ds_read_b64_tr_b16 v[92:93], v15 offset:3072
    ds_read_b64_tr_b16 v[94:95], v15 offset:3840
    s_add_u32 m0, s46, 0
    s_nop 0
    buffer_load_dwordx4 v12, s[20:23], s33 offen lds
    s_waitcnt lgkmcnt(12)
    v_mfma_f32_32x32x16_bf16 v[32:47], v[104:107], v[76:79], v[32:47]
    ds_read_b64_tr_b16 v[96:97], v15 offset:3136
    ds_read_b64_tr_b16 v[98:99], v15 offset:3904
    s_waitcnt lgkmcnt(12)
    v_mfma_f32_32x32x16_bf16 v[48:63], v[108:111], v[76:79], v[48:63]
    ds_read_b64_tr_b16 v[100:101], v15 offset:3200
    ds_read_b64_tr_b16 v[102:103], v15 offset:3968
    s_waitcnt lgkmcnt(11)
    v_mfma_f32_32x32x16_bf16 v[16:31], v[80:83], v[64:67], v[16:31]
    ds_read_b128 v[72:75], v9 offset:2048
    ds_read_b64_tr_b16 v[104:105], v15 offset:6144
    ds_read_b64_tr_b16 v[106:107], v15 offset:6912
    s_waitcnt lgkmcnt(12)
    v_mfma_f32_32x32x16_bf16 v[32:47], v[84:87], v[64:67], v[32:47]
    ds_read_b64_tr_b16 v[108:109], v15 offset:6208
    ds_read_b64_tr_b16 v[110:111], v15 offset:6976
    s_waitcnt lgkmcnt(12)
    v_mfma_f32_32x32x16_bf16 v[48:63], v[88:91], v[64:67], v[48:63]
    ds_read_b64_tr_b16 v[80:81], v15 offset:6272
    ds_read_b64_tr_b16 v[82:83], v15 offset:7040
    s_waitcnt lgkmcnt(11)
    v_mfma_f32_32x32x16_bf16 v[16:31], v[92:95], v[68:71], v[16:31]
    ds_read_b128 v[76:79], v9 offset:3072
    ds_read_b64_tr_b16 v[84:85], v15 offset:9216
    ds_read_b64_tr_b16 v[86:87], v15 offset:9984
    s_waitcnt lgkmcnt(12)
    v_mfma_f32_32x32x16_bf16 v[32:47], v[96:99], v[68:71], v[32:47]
    ds_read_b64_tr_b16 v[88:89], v15 offset:9280
    ds_read_b64_tr_b16 v[90:91], v15 offset:10048
    s_add_u32 m0, s47, 40960
    s_add_u32 s34, s48, 36864
    buffer_load_dwordx4 v13, s[24:27], s34 offen lds
    s_waitcnt lgkmcnt(12)
    v_mfma_f32_32x32x16_bf16 v[48:63], v[100:103], v[68:71], v[48:63]
    ds_read_b64_tr_b16 v[92:93], v15 offset:9344
    ds_read_b64_tr_b16 v[94:95], v15 offset:10112
    buffer_load_dwordx4 v13, s[24:27], s34 offen offset:1024 lds
    s_waitcnt lgkmcnt(11)
    v_mfma_f32_32x32x16_bf16 v[16:31], v[104:107], v[72:75], v[16:31]
    s_waitcnt vmcnt(7)
    s_barrier
    ds_read_b128 v[64:67], v9 offset:40960
    ds_read_b64_tr_b16 v[96:97], v15 offset:40960
    ds_read_b64_tr_b16 v[98:99], v15 offset:41728
    s_add_u32 m0, s44, 40960
    s_add_u32 s33, s49, 663552
    buffer_load_dwordx4 v10, s[20:23], s33 offen lds
    s_waitcnt lgkmcnt(12)
    v_mfma_f32_32x32x16_bf16 v[32:47], v[108:111], v[72:75], v[32:47]
    ds_read_b64_tr_b16 v[100:101], v15 offset:41024
    ds_read_b64_tr_b16 v[102:103], v15 offset:41792
    s_add_u32 m0, s45, 40960
    s_nop 0
    buffer_load_dwordx4 v11, s[20:23], s33 offen lds
    s_waitcnt lgkmcnt(12)
    v_mfma_f32_32x32x16_bf16 v[48:63], v[80:83], v[72:75], v[48:63]
    ds_read_b64_tr_b16 v[104:105], v15 offset:41088
    ds_read_b64_tr_b16 v[106:107], v15 offset:41856
    s_add_u32 m0, s46, 40960
    s_nop 0
    buffer_load_dwordx4 v12, s[20:23], s33 offen lds
    s_waitcnt lgkmcnt(11)
    v_mfma_f32_32x32x16_bf16 v[16:31], v[84:87], v[76:79], v[16:31]
    ds_read_b128 v[68:71], v9 offset:41984
    ds_read_b64_tr_b16 v[108:109], v15 offset:44032
    ds_read_b64_tr_b16 v[110:111], v15 offset:44800
    s_waitcnt lgkmcnt(12)
    v_mfma_f32_32x32x16_bf16 v[32:47], v[88:91], v[76:79], v[32:47]
    ds_read_b64_tr_b16 v[80:81], v15 offset:44096
    ds_read_b64_tr_b16 v[82:83], v15 offset:44864
    s_waitcnt lgkmcnt(12)
    v_mfma_f32_32x32x16_bf16 v[48:63], v[92:95], v[76:79], v[48:63]
    ds_read_b64_tr_b16 v[84:85], v15 offset:44160
    ds_read_b64_tr_b16 v[86:87], v15 offset:44928
    s_waitcnt lgkmcnt(11)
    v_mfma_f32_32x32x16_bf16 v[16:31], v[96:99], v[64:67], v[16:31]
    ds_read_b128 v[72:75], v9 offset:43008
    ds_read_b64_tr_b16 v[88:89], v15 offset:47104
    ds_read_b64_tr_b16 v[90:91], v15 offset:47872
    s_waitcnt lgkmcnt(12)
    v_mfma_f32_32x32x16_bf16 v[32:47], v[100:103], v[64:67], v[32:47]
    ds_read_b64_tr_b16 v[92:93], v15 offset:47168
    ds_read_b64_tr_b16 v[94:95], v15 offset:47936
    s_waitcnt lgkmcnt(12)
    v_mfma_f32_32x32x16_bf16 v[48:63], v[104:107], v[64:67], v[48:63]
    ds_read_b64_tr_b16 v[96:97], v15 offset:47232
    ds_read_b64_tr_b16 v[98:99], v15 offset:48000
    s_waitcnt lgkmcnt(11)
    v_mfma_f32_32x32x16_bf16 v[16:31], v[108:111], v[68:71], v[16:31]
    ds_read_b128 v[76:79], v9 offset:44032
    ds_read_b64_tr_b16 v[100:101], v15 offset:50176
    ds_read_b64_tr_b16 v[102:103], v15 offset:50944
    s_add_u32 m0, s47, 81920
    s_add_u32 s34, s48, 40960
    buffer_load_dwordx4 v13, s[24:27], s34 offen lds
    s_waitcnt lgkmcnt(12)
    v_mfma_f32_32x32x16_bf16 v[32:47], v[80:83], v[68:71], v[32:47]
    ds_read_b64_tr_b16 v[104:105], v15 offset:50240
    ds_read_b64_tr_b16 v[106:107], v15 offset:51008
    buffer_load_dwordx4 v13, s[24:27], s34 offen offset:1024 lds
    s_waitcnt lgkmcnt(12)
    v_mfma_f32_32x32x16_bf16 v[48:63], v[84:87], v[68:71], v[48:63]
    ds_read_b64_tr_b16 v[108:109], v15 offset:50304
    ds_read_b64_tr_b16 v[110:111], v15 offset:51072
    s_add_u32 m0, s44, 81920
    s_add_u32 s33, s49, 737280
    buffer_load_dwordx4 v10, s[20:23], s33 offen lds
    s_waitcnt lgkmcnt(11)
    v_mfma_f32_32x32x16_bf16 v[16:31], v[88:91], v[72:75], v[16:31]
    s_waitcnt vmcnt(8)
    s_barrier
    ds_read_b128 v[64:67], v8 offset:0
    ds_read_b64_tr_b16 v[80:81], v14 offset:0
    ds_read_b64_tr_b16 v[82:83], v14 offset:768
    s_add_u32 m0, s45, 81920
    s_nop 0
    buffer_load_dwordx4 v11, s[20:23], s33 offen lds
    s_waitcnt lgkmcnt(12)
    v_mfma_f32_32x32x16_bf16 v[32:47], v[92:95], v[72:75], v[32:47]
    ds_read_b64_tr_b16 v[84:85], v14 offset:64
    ds_read_b64_tr_b16 v[86:87], v14 offset:832
    s_add_u32 m0, s46, 81920
    s_nop 0
    buffer_load_dwordx4 v12, s[20:23], s33 offen lds
    s_waitcnt lgkmcnt(12)
    v_mfma_f32_32x32x16_bf16 v[48:63], v[96:99], v[72:75], v[48:63]
    ds_read_b64_tr_b16 v[88:89], v14 offset:128
    ds_read_b64_tr_b16 v[90:91], v14 offset:896
    s_waitcnt lgkmcnt(11)
    v_mfma_f32_32x32x16_bf16 v[16:31], v[100:103], v[76:79], v[16:31]
    ds_read_b128 v[68:71], v8 offset:1024
    ds_read_b64_tr_b16 v[92:93], v14 offset:3072
    ds_read_b64_tr_b16 v[94:95], v14 offset:3840
    s_waitcnt lgkmcnt(12)
    v_mfma_f32_32x32x16_bf16 v[32:47], v[104:107], v[76:79], v[32:47]
    ds_read_b64_tr_b16 v[96:97], v14 offset:3136
    ds_read_b64_tr_b16 v[98:99], v14 offset:3904
    s_waitcnt lgkmcnt(12)
    v_mfma_f32_32x32x16_bf16 v[48:63], v[108:111], v[76:79], v[48:63]
    ds_read_b64_tr_b16 v[100:101], v14 offset:3200
    ds_read_b64_tr_b16 v[102:103], v14 offset:3968
    s_waitcnt lgkmcnt(11)
    v_mfma_f32_32x32x16_bf16 v[16:31], v[80:83], v[64:67], v[16:31]
    ds_read_b128 v[72:75], v8 offset:2048
    ds_read_b64_tr_b16 v[104:105], v14 offset:6144
    ds_read_b64_tr_b16 v[106:107], v14 offset:6912
    s_waitcnt lgkmcnt(12)
    v_mfma_f32_32x32x16_bf16 v[32:47], v[84:87], v[64:67], v[32:47]
    ds_read_b64_tr_b16 v[108:109], v14 offset:6208
    ds_read_b64_tr_b16 v[110:111], v14 offset:6976
    s_waitcnt lgkmcnt(12)
    v_mfma_f32_32x32x16_bf16 v[48:63], v[88:91], v[64:67], v[48:63]
    ds_read_b64_tr_b16 v[80:81], v14 offset:6272
    ds_read_b64_tr_b16 v[82:83], v14 offset:7040
    s_add_u32 m0, s47, 122880
    s_add_u32 s34, s48, 45056
    buffer_load_dwordx4 v13, s[24:27], s34 offen lds
    s_waitcnt lgkmcnt(11)
    v_mfma_f32_32x32x16_bf16 v[16:31], v[92:95], v[68:71], v[16:31]
    ds_read_b128 v[76:79], v8 offset:3072
    ds_read_b64_tr_b16 v[84:85], v14 offset:9216
    ds_read_b64_tr_b16 v[86:87], v14 offset:9984
    buffer_load_dwordx4 v13, s[24:27], s34 offen offset:1024 lds
    s_waitcnt lgkmcnt(12)
    v_mfma_f32_32x32x16_bf16 v[32:47], v[96:99], v[68:71], v[32:47]
    ds_read_b64_tr_b16 v[88:89], v14 offset:9280
    ds_read_b64_tr_b16 v[90:91], v14 offset:10048
    s_add_u32 m0, s44, 122880
    s_add_u32 s33, s49, 811008
    buffer_load_dwordx4 v10, s[20:23], s33 offen lds
    s_waitcnt lgkmcnt(12)
    v_mfma_f32_32x32x16_bf16 v[48:63], v[100:103], v[68:71], v[48:63]
    ds_read_b64_tr_b16 v[92:93], v14 offset:9344
    ds_read_b64_tr_b16 v[94:95], v14 offset:10112
    s_add_u32 m0, s45, 122880
    s_nop 0
    buffer_load_dwordx4 v11, s[20:23], s33 offen lds
    s_waitcnt lgkmcnt(11)
    v_mfma_f32_32x32x16_bf16 v[16:31], v[104:107], v[72:75], v[16:31]
    s_waitcnt vmcnt(9)
    s_barrier
    ds_read_b128 v[64:67], v8 offset:40960
    ds_read_b64_tr_b16 v[96:97], v14 offset:40960
    ds_read_b64_tr_b16 v[98:99], v14 offset:41728
    s_add_u32 m0, s46, 122880
    s_nop 0
    buffer_load_dwordx4 v12, s[20:23], s33 offen lds
    s_waitcnt lgkmcnt(12)
    v_mfma_f32_32x32x16_bf16 v[32:47], v[108:111], v[72:75], v[32:47]
    ds_read_b64_tr_b16 v[100:101], v14 offset:41024
    ds_read_b64_tr_b16 v[102:103], v14 offset:41792
    s_waitcnt lgkmcnt(12)
    v_mfma_f32_32x32x16_bf16 v[48:63], v[80:83], v[72:75], v[48:63]
    ds_read_b64_tr_b16 v[104:105], v14 offset:41088
    ds_read_b64_tr_b16 v[106:107], v14 offset:41856
    s_waitcnt lgkmcnt(11)
    v_mfma_f32_32x32x16_bf16 v[16:31], v[84:87], v[76:79], v[16:31]
    ds_read_b128 v[68:71], v8 offset:41984
    ds_read_b64_tr_b16 v[108:109], v14 offset:44032
    ds_read_b64_tr_b16 v[110:111], v14 offset:44800
    s_waitcnt lgkmcnt(12)
    v_mfma_f32_32x32x16_bf16 v[32:47], v[88:91], v[76:79], v[32:47]
    ds_read_b64_tr_b16 v[80:81], v14 offset:44096
    ds_read_b64_tr_b16 v[82:83], v14 offset:44864
    s_waitcnt lgkmcnt(12)
    v_mfma_f32_32x32x16_bf16 v[48:63], v[92:95], v[76:79], v[48:63]
    ds_read_b64_tr_b16 v[84:85], v14 offset:44160
    ds_read_b64_tr_b16 v[86:87], v14 offset:44928
    s_waitcnt lgkmcnt(11)
    v_mfma_f32_32x32x16_bf16 v[16:31], v[96:99], v[64:67], v[16:31]
    ds_read_b128 v[72:75], v8 offset:43008
    ds_read_b64_tr_b16 v[88:89], v14 offset:47104
    ds_read_b64_tr_b16 v[90:91], v14 offset:47872
    s_waitcnt lgkmcnt(12)
    v_mfma_f32_32x32x16_bf16 v[32:47], v[100:103], v[64:67], v[32:47]
    ds_read_b64_tr_b16 v[92:93], v14 offset:47168
    ds_read_b64_tr_b16 v[94:95], v14 offset:47936
    s_add_u32 m0, s47, 0
    s_add_u32 s34, s48, 49152
    buffer_load_dwordx4 v13, s[24:27], s34 offen lds
    s_waitcnt lgkmcnt(12)
    v_mfma_f32_32x32x16_bf16 v[48:63], v[104:107], v[64:67], v[48:63]
    ds_read_b64_tr_b16 v[96:97], v14 offset:47232
    ds_read_b64_tr_b16 v[98:99], v14 offset:48000
    buffer_load_dwordx4 v13, s[24:27], s34 offen offset:1024 lds
    s_waitcnt lgkmcnt(11)
    v_mfma_f32_32x32x16_bf16 v[16:31], v[108:111], v[68:71], v[16:31]
    ds_read_b128 v[76:79], v8 offset:44032
    ds_read_b64_tr_b16 v[100:101], v14 offset:50176
    ds_read_b64_tr_b16 v[102:103], v14 offset:50944
    s_add_u32 m0, s44, 0
    s_add_u32 s33, s49, 884736
    buffer_load_dwordx4 v10, s[20:23], s33 offen lds
    s_waitcnt lgkmcnt(12)
    v_mfma_f32_32x32x16_bf16 v[32:47], v[80:83], v[68:71], v[32:47]
    ds_read_b64_tr_b16 v[104:105], v14 offset:50240
    ds_read_b64_tr_b16 v[106:107], v14 offset:51008
    s_add_u32 m0, s45, 0
    s_nop 0
    buffer_load_dwordx4 v11, s[20:23], s33 offen lds
    s_waitcnt lgkmcnt(12)
    v_mfma_f32_32x32x16_bf16 v[48:63], v[84:87], v[68:71], v[48:63]
    ds_read_b64_tr_b16 v[108:109], v14 offset:50304
    ds_read_b64_tr_b16 v[110:111], v14 offset:51072
    s_add_u32 m0, s46, 0
    s_nop 0
    buffer_load_dwordx4 v12, s[20:23], s33 offen lds
    s_waitcnt lgkmcnt(11)
    v_mfma_f32_32x32x16_bf16 v[16:31], v[88:91], v[72:75], v[16:31]
    s_waitcnt vmcnt(10)
    s_barrier
    ds_read_b128 v[64:67], v9 offset:0
    ds_read_b64_tr_b16 v[80:81], v15 offset:0
    ds_read_b64_tr_b16 v[82:83], v15 offset:768
    s_waitcnt lgkmcnt(12)
    v_mfma_f32_32x32x16_bf16 v[32:47], v[92:95], v[72:75], v[32:47]
    ds_read_b64_tr_b16 v[84:85], v15 offset:64
    ds_read_b64_tr_b16 v[86:87], v15 offset:832
    s_waitcnt lgkmcnt(12)
    v_mfma_f32_32x32x16_bf16 v[48:63], v[96:99], v[72:75], v[48:63]
    ds_read_b64_tr_b16 v[88:89], v15 offset:128
    ds_read_b64_tr_b16 v[90:91], v15 offset:896
    s_waitcnt lgkmcnt(11)
    v_mfma_f32_32x32x16_bf16 v[16:31], v[100:103], v[76:79], v[16:31]
    ds_read_b128 v[68:71], v9 offset:1024
    ds_read_b64_tr_b16 v[92:93], v15 offset:3072
    ds_read_b64_tr_b16 v[94:95], v15 offset:3840
    s_waitcnt lgkmcnt(12)
    v_mfma_f32_32x32x16_bf16 v[32:47], v[104:107], v[76:79], v[32:47]
    ds_read_b64_tr_b16 v[96:97], v15 offset:3136
    ds_read_b64_tr_b16 v[98:99], v15 offset:3904
    s_waitcnt lgkmcnt(12)
    v_mfma_f32_32x32x16_bf16 v[48:63], v[108:111], v[76:79], v[48:63]
    ds_read_b64_tr_b16 v[100:101], v15 offset:3200
    ds_read_b64_tr_b16 v[102:103], v15 offset:3968
    s_waitcnt lgkmcnt(11)
    v_mfma_f32_32x32x16_bf16 v[16:31], v[80:83], v[64:67], v[16:31]
    ds_read_b128 v[72:75], v9 offset:2048
    ds_read_b64_tr_b16 v[104:105], v15 offset:6144
    ds_read_b64_tr_b16 v[106:107], v15 offset:6912
    s_add_u32 m0, s47, 40960
    s_add_u32 s34, s48, 53248
    buffer_load_dwordx4 v13, s[24:27], s34 offen lds
    s_waitcnt lgkmcnt(12)
    v_mfma_f32_32x32x16_bf16 v[32:47], v[84:87], v[64:67], v[32:47]
    ds_read_b64_tr_b16 v[108:109], v15 offset:6208
    ds_read_b64_tr_b16 v[110:111], v15 offset:6976
    buffer_load_dwordx4 v13, s[24:27], s34 offen offset:1024 lds
    s_waitcnt lgkmcnt(12)
    v_mfma_f32_32x32x16_bf16 v[48:63], v[88:91], v[64:67], v[48:63]
    ds_read_b64_tr_b16 v[80:81], v15 offset:6272
    ds_read_b64_tr_b16 v[82:83], v15 offset:7040
    s_add_u32 m0, s44, 40960
    s_add_u32 s33, s49, 958464
    buffer_load_dwordx4 v10, s[20:23], s33 offen lds
    s_waitcnt lgkmcnt(11)
    v_mfma_f32_32x32x16_bf16 v[16:31], v[92:95], v[68:71], v[16:31]
    ds_read_b128 v[76:79], v9 offset:3072
    ds_read_b64_tr_b16 v[84:85], v15 offset:9216
    ds_read_b64_tr_b16 v[86:87], v15 offset:9984
    s_add_u32 m0, s45, 40960
    s_nop 0
    buffer_load_dwordx4 v11, s[20:23], s33 offen lds
    s_waitcnt lgkmcnt(12)
    v_mfma_f32_32x32x16_bf16 v[32:47], v[96:99], v[68:71], v[32:47]
    ds_read_b64_tr_b16 v[88:89], v15 offset:9280
    ds_read_b64_tr_b16 v[90:91], v15 offset:10048
    s_add_u32 m0, s46, 40960
    s_nop 0
    buffer_load_dwordx4 v12, s[20:23], s33 offen lds
    s_waitcnt lgkmcnt(12)
    v_mfma_f32_32x32x16_bf16 v[48:63], v[100:103], v[68:71], v[48:63]
    ds_read_b64_tr_b16 v[92:93], v15 offset:9344
    ds_read_b64_tr_b16 v[94:95], v15 offset:10112
    s_waitcnt lgkmcnt(11)
    v_mfma_f32_32x32x16_bf16 v[16:31], v[104:107], v[72:75], v[16:31]
    s_waitcnt vmcnt(10)
    s_barrier
    ds_read_b128 v[64:67], v9 offset:40960
    ds_read_b64_tr_b16 v[96:97], v15 offset:40960
    ds_read_b64_tr_b16 v[98:99], v15 offset:41728
    s_waitcnt lgkmcnt(12)
    v_mfma_f32_32x32x16_bf16 v[32:47], v[108:111], v[72:75], v[32:47]
    ds_read_b64_tr_b16 v[100:101], v15 offset:41024
    ds_read_b64_tr_b16 v[102:103], v15 offset:41792
    s_waitcnt lgkmcnt(12)
    v_mfma_f32_32x32x16_bf16 v[48:63], v[80:83], v[72:75], v[48:63]
    ds_read_b64_tr_b16 v[104:105], v15 offset:41088
    ds_read_b64_tr_b16 v[106:107], v15 offset:41856
    s_waitcnt lgkmcnt(11)
    v_mfma_f32_32x32x16_bf16 v[16:31], v[84:87], v[76:79], v[16:31]
    ds_read_b128 v[68:71], v9 offset:41984
    ds_read_b64_tr_b16 v[108:109], v15 offset:44032
    ds_read_b64_tr_b16 v[110:111], v15 offset:44800
    s_waitcnt lgkmcnt(12)
    v_mfma_f32_32x32x16_bf16 v[32:47], v[88:91], v[76:79], v[32:47]
    ds_read_b64_tr_b16 v[80:81], v15 offset:44096
    ds_read_b64_tr_b16 v[82:83], v15 offset:44864
    s_waitcnt lgkmcnt(12)
    v_mfma_f32_32x32x16_bf16 v[48:63], v[92:95], v[76:79], v[48:63]
    ds_read_b64_tr_b16 v[84:85], v15 offset:44160
    ds_read_b64_tr_b16 v[86:87], v15 offset:44928
    s_waitcnt lgkmcnt(11)
    v_mfma_f32_32x32x16_bf16 v[16:31], v[96:99], v[64:67], v[16:31]
    ds_read_b128 v[72:75], v9 offset:43008
    ds_read_b64_tr_b16 v[88:89], v15 offset:47104
    ds_read_b64_tr_b16 v[90:91], v15 offset:47872
    s_add_u32 m0, s47, 81920
    s_add_u32 s34, s48, 57344
    buffer_load_dwordx4 v13, s[24:27], s34 offen lds
    s_waitcnt lgkmcnt(12)
    v_mfma_f32_32x32x16_bf16 v[32:47], v[100:103], v[64:67], v[32:47]
    ds_read_b64_tr_b16 v[92:93], v15 offset:47168
    ds_read_b64_tr_b16 v[94:95], v15 offset:47936
    buffer_load_dwordx4 v13, s[24:27], s34 offen offset:1024 lds
    s_waitcnt lgkmcnt(12)
    v_mfma_f32_32x32x16_bf16 v[48:63], v[104:107], v[64:67], v[48:63]
    ds_read_b64_tr_b16 v[96:97], v15 offset:47232
    ds_read_b64_tr_b16 v[98:99], v15 offset:48000
    s_add_u32 m0, s44, 81920
    s_add_u32 s33, s49, 1032192
    buffer_load_dwordx4 v10, s[20:23], s33 offen lds
    s_waitcnt lgkmcnt(11)
    v_mfma_f32_32x32x16_bf16 v[16:31], v[108:111], v[68:71], v[16:31]
    ds_read_b128 v[76:79], v9 offset:44032
    ds_read_b64_tr_b16 v[100:101], v15 offset:50176
    ds_read_b64_tr_b16 v[102:103], v15 offset:50944
    s_add_u32 m0, s45, 81920
    s_nop 0
    buffer_load_dwordx4 v11, s[20:23], s33 offen lds
    s_waitcnt lgkmcnt(12)
    v_mfma_f32_32x32x16_bf16 v[32:47], v[80:83], v[68:71], v[32:47]
    ds_read_b64_tr_b16 v[104:105], v15 offset:50240
    ds_read_b64_tr_b16 v[106:107], v15 offset:51008
    s_add_u32 m0, s46, 81920
    s_nop 0
    buffer_load_dwordx4 v12, s[20:23], s33 offen lds
    s_waitcnt lgkmcnt(12)
    v_mfma_f32_32x32x16_bf16 v[48:63], v[84:87], v[68:71], v[48:63]
    ds_read_b64_tr_b16 v[108:109], v15 offset:50304
    ds_read_b64_tr_b16 v[110:111], v15 offset:51072
    s_waitcnt lgkmcnt(11)
    v_mfma_f32_32x32x16_bf16 v[16:31], v[88:91], v[72:75], v[16:31]
    s_waitcnt vmcnt(10)
    s_barrier
    ds_read_b128 v[64:67], v8 offset:0
    ds_read_b64_tr_b16 v[80:81], v14 offset:0
    ds_read_b64_tr_b16 v[82:83], v14 offset:768
    s_waitcnt lgkmcnt(12)
    v_mfma_f32_32x32x16_bf16 v[32:47], v[92:95], v[72:75], v[32:47]
    ds_read_b64_tr_b16 v[84:85], v14 offset:64
    ds_read_b64_tr_b16 v[86:87], v14 offset:832
    s_waitcnt lgkmcnt(12)
    v_mfma_f32_32x32x16_bf16 v[48:63], v[96:99], v[72:75], v[48:63]
    ds_read_b64_tr_b16 v[88:89], v14 offset:128
    ds_read_b64_tr_b16 v[90:91], v14 offset:896
    s_waitcnt lgkmcnt(11)
    v_mfma_f32_32x32x16_bf16 v[16:31], v[100:103], v[76:79], v[16:31]
    ds_read_b128 v[68:71], v8 offset:1024
    ds_read_b64_tr_b16 v[92:93], v14 offset:3072
    ds_read_b64_tr_b16 v[94:95], v14 offset:3840
    s_waitcnt lgkmcnt(12)
    v_mfma_f32_32x32x16_bf16 v[32:47], v[104:107], v[76:79], v[32:47]
    ds_read_b64_tr_b16 v[96:97], v14 offset:3136
    ds_read_b64_tr_b16 v[98:99], v14 offset:3904
    s_waitcnt lgkmcnt(12)
    v_mfma_f32_32x32x16_bf16 v[48:63], v[108:111], v[76:79], v[48:63]
    ds_read_b64_tr_b16 v[100:101], v14 offset:3200
    ds_read_b64_tr_b16 v[102:103], v14 offset:3968
    s_waitcnt lgkmcnt(11)
    v_mfma_f32_32x32x16_bf16 v[16:31], v[80:83], v[64:67], v[16:31]
    ds_read_b128 v[72:75], v8 offset:2048
    ds_read_b64_tr_b16 v[104:105], v14 offset:6144
    ds_read_b64_tr_b16 v[106:107], v14 offset:6912
    s_waitcnt lgkmcnt(12)
    v_mfma_f32_32x32x16_bf16 v[32:47], v[84:87], v[64:67], v[32:47]
    ds_read_b64_tr_b16 v[108:109], v14 offset:6208
    ds_read_b64_tr_b16 v[110:111], v14 offset:6976
    s_waitcnt lgkmcnt(12)
    v_mfma_f32_32x32x16_bf16 v[48:63], v[88:91], v[64:67], v[48:63]
    ds_read_b64_tr_b16 v[80:81], v14 offset:6272
    ds_read_b64_tr_b16 v[82:83], v14 offset:7040
    s_waitcnt lgkmcnt(11)
    v_mfma_f32_32x32x16_bf16 v[16:31], v[92:95], v[68:71], v[16:31]
    ds_read_b128 v[76:79], v8 offset:3072
    ds_read_b64_tr_b16 v[84:85], v14 offset:9216
    ds_read_b64_tr_b16 v[86:87], v14 offset:9984
    s_waitcnt lgkmcnt(12)
    v_mfma_f32_32x32x16_bf16 v[32:47], v[96:99], v[68:71], v[32:47]
    ds_read_b64_tr_b16 v[88:89], v14 offset:9280
    ds_read_b64_tr_b16 v[90:91], v14 offset:10048
    s_waitcnt lgkmcnt(12)
    v_mfma_f32_32x32x16_bf16 v[48:63], v[100:103], v[68:71], v[48:63]
    ds_read_b64_tr_b16 v[92:93], v14 offset:9344
    ds_read_b64_tr_b16 v[94:95], v14 offset:10112
    s_waitcnt lgkmcnt(11)
    v_mfma_f32_32x32x16_bf16 v[16:31], v[104:107], v[72:75], v[16:31]
    s_waitcnt vmcnt(5)
    s_barrier
    ds_read_b128 v[64:67], v8 offset:40960
    ds_read_b64_tr_b16 v[96:97], v14 offset:40960
    ds_read_b64_tr_b16 v[98:99], v14 offset:41728
    s_waitcnt lgkmcnt(12)
    v_mfma_f32_32x32x16_bf16 v[32:47], v[108:111], v[72:75], v[32:47]
    ds_read_b64_tr_b16 v[100:101], v14 offset:41024
    ds_read_b64_tr_b16 v[102:103], v14 offset:41792
    s_waitcnt lgkmcnt(12)
    v_mfma_f32_32x32x16_bf16 v[48:63], v[80:83], v[72:75], v[48:63]
    ds_read_b64_tr_b16 v[104:105], v14 offset:41088
    ds_read_b64_tr_b16 v[106:107], v14 offset:41856
    s_waitcnt lgkmcnt(11)
    v_mfma_f32_32x32x16_bf16 v[16:31], v[84:87], v[76:79], v[16:31]
    ds_read_b128 v[68:71], v8 offset:41984
    ds_read_b64_tr_b16 v[108:109], v14 offset:44032
    ds_read_b64_tr_b16 v[110:111], v14 offset:44800
    s_waitcnt lgkmcnt(12)
    v_mfma_f32_32x32x16_bf16 v[32:47], v[88:91], v[76:79], v[32:47]
    ds_read_b64_tr_b16 v[80:81], v14 offset:44096
    ds_read_b64_tr_b16 v[82:83], v14 offset:44864
    s_waitcnt lgkmcnt(12)
    v_mfma_f32_32x32x16_bf16 v[48:63], v[92:95], v[76:79], v[48:63]
    ds_read_b64_tr_b16 v[84:85], v14 offset:44160
    ds_read_b64_tr_b16 v[86:87], v14 offset:44928
    s_waitcnt lgkmcnt(11)
    v_mfma_f32_32x32x16_bf16 v[16:31], v[96:99], v[64:67], v[16:31]
    ds_read_b128 v[72:75], v8 offset:43008
    ds_read_b64_tr_b16 v[88:89], v14 offset:47104
    ds_read_b64_tr_b16 v[90:91], v14 offset:47872
    s_waitcnt lgkmcnt(12)
    v_mfma_f32_32x32x16_bf16 v[32:47], v[100:103], v[64:67], v[32:47]
    ds_read_b64_tr_b16 v[92:93], v14 offset:47168
    ds_read_b64_tr_b16 v[94:95], v14 offset:47936
    s_waitcnt lgkmcnt(12)
    v_mfma_f32_32x32x16_bf16 v[48:63], v[104:107], v[64:67], v[48:63]
    ds_read_b64_tr_b16 v[96:97], v14 offset:47232
    ds_read_b64_tr_b16 v[98:99], v14 offset:48000
    s_waitcnt lgkmcnt(11)
    v_mfma_f32_32x32x16_bf16 v[16:31], v[108:111], v[68:71], v[16:31]
    ds_read_b128 v[76:79], v8 offset:44032
    ds_read_b64_tr_b16 v[100:101], v14 offset:50176
    ds_read_b64_tr_b16 v[102:103], v14 offset:50944
    s_waitcnt lgkmcnt(12)
    v_mfma_f32_32x32x16_bf16 v[32:47], v[80:83], v[68:71], v[32:47]
    ds_read_b64_tr_b16 v[104:105], v14 offset:50240
    ds_read_b64_tr_b16 v[106:107], v14 offset:51008
    s_waitcnt lgkmcnt(12)
    v_mfma_f32_32x32x16_bf16 v[48:63], v[84:87], v[68:71], v[48:63]
    ds_read_b64_tr_b16 v[108:109], v14 offset:50304
    ds_read_b64_tr_b16 v[110:111], v14 offset:51072
    s_waitcnt lgkmcnt(11)
    v_mfma_f32_32x32x16_bf16 v[16:31], v[88:91], v[72:75], v[16:31]
    s_waitcnt vmcnt(0)
    s_barrier
    ds_read_b128 v[64:67], v9 offset:0
    ds_read_b64_tr_b16 v[80:81], v15 offset:0
    ds_read_b64_tr_b16 v[82:83], v15 offset:768
    s_waitcnt lgkmcnt(12)
    v_mfma_f32_32x32x16_bf16 v[32:47], v[92:95], v[72:75], v[32:47]
    ds_read_b64_tr_b16 v[84:85], v15 offset:64
    ds_read_b64_tr_b16 v[86:87], v15 offset:832
    s_waitcnt lgkmcnt(12)
    v_mfma_f32_32x32x16_bf16 v[48:63], v[96:99], v[72:75], v[48:63]
    ds_read_b64_tr_b16 v[88:89], v15 offset:128
    ds_read_b64_tr_b16 v[90:91], v15 offset:896
    s_waitcnt lgkmcnt(11)
    v_mfma_f32_32x32x16_bf16 v[16:31], v[100:103], v[76:79], v[16:31]
    ds_read_b128 v[68:71], v9 offset:1024
    ds_read_b64_tr_b16 v[92:93], v15 offset:3072
    ds_read_b64_tr_b16 v[94:95], v15 offset:3840
    s_waitcnt lgkmcnt(12)
    v_mfma_f32_32x32x16_bf16 v[32:47], v[104:107], v[76:79], v[32:47]
    ds_read_b64_tr_b16 v[96:97], v15 offset:3136
    ds_read_b64_tr_b16 v[98:99], v15 offset:3904
    s_waitcnt lgkmcnt(12)
    v_mfma_f32_32x32x16_bf16 v[48:63], v[108:111], v[76:79], v[48:63]
    ds_read_b64_tr_b16 v[100:101], v15 offset:3200
    ds_read_b64_tr_b16 v[102:103], v15 offset:3968
    s_waitcnt lgkmcnt(11)
    v_mfma_f32_32x32x16_bf16 v[16:31], v[80:83], v[64:67], v[16:31]
    ds_read_b128 v[72:75], v9 offset:2048
    ds_read_b64_tr_b16 v[104:105], v15 offset:6144
    ds_read_b64_tr_b16 v[106:107], v15 offset:6912
    s_waitcnt lgkmcnt(12)
    v_mfma_f32_32x32x16_bf16 v[32:47], v[84:87], v[64:67], v[32:47]
    ds_read_b64_tr_b16 v[108:109], v15 offset:6208
    ds_read_b64_tr_b16 v[110:111], v15 offset:6976
    s_waitcnt lgkmcnt(12)
    v_mfma_f32_32x32x16_bf16 v[48:63], v[88:91], v[64:67], v[48:63]
    ds_read_b64_tr_b16 v[80:81], v15 offset:6272
    ds_read_b64_tr_b16 v[82:83], v15 offset:7040
    s_waitcnt lgkmcnt(11)
    v_mfma_f32_32x32x16_bf16 v[16:31], v[92:95], v[68:71], v[16:31]
    ds_read_b128 v[76:79], v9 offset:3072
    ds_read_b64_tr_b16 v[84:85], v15 offset:9216
    ds_read_b64_tr_b16 v[86:87], v15 offset:9984
    s_waitcnt lgkmcnt(12)
    v_mfma_f32_32x32x16_bf16 v[32:47], v[96:99], v[68:71], v[32:47]
    ds_read_b64_tr_b16 v[88:89], v15 offset:9280
    ds_read_b64_tr_b16 v[90:91], v15 offset:10048
    s_waitcnt lgkmcnt(12)
    v_mfma_f32_32x32x16_bf16 v[48:63], v[100:103], v[68:71], v[48:63]
    ds_read_b64_tr_b16 v[92:93], v15 offset:9344
    ds_read_b64_tr_b16 v[94:95], v15 offset:10112
    s_waitcnt lgkmcnt(11)
    v_mfma_f32_32x32x16_bf16 v[16:31], v[104:107], v[72:75], v[16:31]
    s_waitcnt lgkmcnt(9)
    v_mfma_f32_32x32x16_bf16 v[32:47], v[108:111], v[72:75], v[32:47]
    s_waitcnt lgkmcnt(7)
    v_mfma_f32_32x32x16_bf16 v[48:63], v[80:83], v[72:75], v[48:63]
    s_waitcnt lgkmcnt(4)
    v_mfma_f32_32x32x16_bf16 v[16:31], v[84:87], v[76:79], v[16:31]
    s_waitcnt lgkmcnt(2)
    v_mfma_f32_32x32x16_bf16 v[32:47], v[88:91], v[76:79], v[32:47]
    s_waitcnt lgkmcnt(0)
    v_mfma_f32_32x32x16_bf16 v[48:63], v[92:95], v[76:79], v[48:63]
    s_mul_i32 s17, s14, 36
    s_mul_i32 s13, s11, 12
    s_add_u32 s17, s17, s13
    s_mul_i32 s13, s18, 6
    s_add_u32 s17, s17, s13
    s_lshl_b32 s17, s17, 10
    s_mul_i32 s13, s12, 2359296
    s_add_u32 s17, s17, s13
    v_lshlrev_b32 v13, 4, v1
    s_nop 15
    v_cvt_pk_bf16_f32 v64, v16, v17
    v_cvt_pk_bf16_f32 v65, v18, v19
    v_cvt_pk_bf16_f32 v66, v20, v21
    v_cvt_pk_bf16_f32 v67, v22, v23
    s_add_u32 s13, s17, 0
    buffer_store_dwordx4 v[64:67], v13, s[28:31], s13 offen sc1
    v_cvt_pk_bf16_f32 v68, v24, v25
    v_cvt_pk_bf16_f32 v69, v26, v27
    v_cvt_pk_bf16_f32 v70, v28, v29
    v_cvt_pk_bf16_f32 v71, v30, v31
    s_add_u32 s13, s17, 1024
    buffer_store_dwordx4 v[68:71], v13, s[28:31], s13 offen sc1
    v_cvt_pk_bf16_f32 v72, v32, v33
    v_cvt_pk_bf16_f32 v73, v34, v35
    v_cvt_pk_bf16_f32 v74, v36, v37
    v_cvt_pk_bf16_f32 v75, v38, v39
    s_add_u32 s13, s17, 2048
    buffer_store_dwordx4 v[72:75], v13, s[28:31], s13 offen sc1
    v_cvt_pk_bf16_f32 v76, v40, v41
    v_cvt_pk_bf16_f32 v77, v42, v43
    v_cvt_pk_bf16_f32 v78, v44, v45
    v_cvt_pk_bf16_f32 v79, v46, v47
    s_add_u32 s13, s17, 3072
    buffer_store_dwordx4 v[76:79], v13, s[28:31], s13 offen sc1
    v_cvt_pk_bf16_f32 v80, v48, v49
    v_cvt_pk_bf16_f32 v81, v50, v51
    v_cvt_pk_bf16_f32 v82, v52, v53
    v_cvt_pk_bf16_f32 v83, v54, v55
    s_add_u32 s13, s17, 4096
    buffer_store_dwordx4 v[80:83], v13, s[28:31], s13 offen sc1
    v_cvt_pk_bf16_f32 v84, v56, v57
    v_cvt_pk_bf16_f32 v85, v58, v59
    v_cvt_pk_bf16_f32 v86, v60, v61
    v_cvt_pk_bf16_f32 v87, v62, v63
    s_add_u32 s13, s17, 5120
    buffer_store_dwordx4 v[84:87], v13, s[28:31], s13 offen sc1
    s_waitcnt vmcnt(0)
k6_down_kernel_end:
    s_endpgm
.section .rodata,"a"
.p2align 6
.amdhsa_kernel k6_down_kernel
  .amdhsa_next_free_vgpr 128
  .amdhsa_next_free_sgpr 96
  .amdhsa_accum_offset 128
  .amdhsa_group_segment_fixed_size 0
  .amdhsa_kernarg_size 112
  .amdhsa_user_sgpr_count 2
  .amdhsa_user_sgpr_kernarg_segment_ptr 1
  .amdhsa_system_sgpr_workgroup_id_x 1
.end_amdhsa_kernel
.text
.globl k7_final_kernel
.p2align 8
.type k7_final_kernel,@function
k7_final_kernel:
    s_cmp_ge_u32 s2, 256
    s_cbranch_scc1 k7_final_kernel_end
    s_load_dwordx2 s[4:5], s[0:1], 0
    s_load_dwordx2 s[6:7], s[0:1], 104
    s_load_dwordx2 s[8:9], s[0:1], 88
    v_and_b32 v1, 63, v0
    v_lshrrev_b32 v2, 6, v0
    v_and_b32 v3, 7, v1
    v_bfe_u32 v4, v1, 3, 1
    v_bfe_u32 v5, v1, 4, 1
    v_lshrrev_b32 v6, 5, v1
    v_lshl_add_u32 v6, v2, 1, v6
    s_lshr_b32 s10, s2, 2
    s_and_b32 s11, s2, 3
    s_lshl_b32 s11, s11, 3
    v_lshlrev_b32 v7, 5, v6
    v_lshl_add_u32 v7, v5, 4, v7
    v_lshl_add_u32 v7, v4, 3, v7
    s_lshl_b32 s3, s2, 3
    v_add_u32 v8, s3, v3
    v_mul_u32_u24 v8, 1152, v8
    v_lshl_add_u32 v8, v7, 1, v8
    v_lshlrev_b32 v9, 5, v4
    v_add_u32 v9, s11, v9
    v_add_u32 v9, v9, v3
    v_lshlrev_b32 v10, 5, v2
    v_lshl_add_u32 v10, v3, 2, v10
    v_lshlrev_b32 v11, 2, v3
    v_lshlrev_b32 v12, 2, v7
    s_mul_i32 s12, s10, 18
    v_add_u32 v13, s12, v6
    v_lshlrev_b32 v13, 2, v13
    v_lshl_add_u32 v13, v5, 1, v13
    v_lshlrev_b32 v13, 10, v13
    v_lshl_add_u32 v13, v9, 4, v13
    s_mul_i32 s12, s10, 36
    v_lshl_add_u32 v14, v6, 1, v5
    v_add_u32 v14, s12, v14
    v_lshlrev_b32 v14, 10, v14
    v_lshl_add_u32 v14, v9, 4, v14
    s_waitcnt lgkmcnt(0)
    s_add_u32 s16, s6, 0
    s_addc_u32 s17, s7, 0
    s_mov_b32 s18, 13824
    s_mov_b32 s19, 0x20000
    s_add_u32 s20, s6, 67108864
    s_addc_u32 s21, s7, 0
    s_mov_b32 s22, 11796480
    s_mov_b32 s23, 0x20000
    s_add_u32 s24, s6, 6291456
    s_addc_u32 s25, s7, 0
    s_mov_b32 s26, 2359296
    s_mov_b32 s27, 0x20000
    s_add_u32 s28, s8, 0
    s_addc_u32 s29, s9, 0
    s_mov_b32 s30, 2359296
    s_mov_b32 s31, 0x20000
    s_add_u32 s32, s4, 0
    s_addc_u32 s33, s5, 0
    s_mov_b32 s34, 2359296
    s_mov_b32 s35, 0x20000
    buffer_load_dwordx4 v[16:19], v8, s[24:27], 0 offen
    s_mov_b32 s36, 11520
    buffer_load_dwordx4 v[20:23], v12, s[16:19], s36 offen
    buffer_load_dwordx4 v[24:27], v12, s[16:19], s36 offen offset:16
    s_mov_b32 s37, 0
    buffer_load_dwordx4 v[64:67], v14, s[20:23], s37 offen
    s_mov_b32 s37, 2359296
    buffer_load_dwordx4 v[68:71], v14, s[20:23], s37 offen
    s_mov_b32 s37, 4718592
    buffer_load_dwordx4 v[72:75], v14, s[20:23], s37 offen
    s_mov_b32 s37, 7077888
    buffer_load_dwordx4 v[76:79], v14, s[20:23], s37 offen
    s_mov_b32 s37, 9437184
    buffer_load_dwordx4 v[80:83], v14, s[20:23], s37 offen
    s_waitcnt vmcnt(0)
    v_lshlrev_b32 v96, 16, v16
    v_and_b32 v97, 0xffff0000, v16
    v_lshlrev_b32 v98, 16, v17
    v_and_b32 v99, 0xffff0000, v17
    v_lshlrev_b32 v100, 16, v18
    v_and_b32 v101, 0xffff0000, v18
    v_lshlrev_b32 v102, 16, v19
    v_and_b32 v103, 0xffff0000, v19
    v_lshlrev_b32 v48, 16, v64
    v_and_b32 v49, 0xffff0000, v64
    v_lshlrev_b32 v50, 16, v65
    v_and_b32 v51, 0xffff0000, v65
    v_lshlrev_b32 v52, 16, v66
    v_and_b32 v53, 0xffff0000, v66
    v_lshlrev_b32 v54, 16, v67
    v_and_b32 v55, 0xffff0000, v67
    v_lshlrev_b32 v56, 16, v68
    v_and_b32 v57, 0xffff0000, v68
    v_lshlrev_b32 v58, 16, v69
    v_and_b32 v59, 0xffff0000, v69
    v_lshlrev_b32 v60, 16, v70
    v_and_b32 v61, 0xffff0000, v70
    v_lshlrev_b32 v62, 16, v71
    v_and_b32 v63, 0xffff0000, v71
    v_add_f32 v48, v48, v56
    v_add_f32 v49, v49, v57
    v_add_f32 v50, v50, v58
    v_add_f32 v51, v51, v59
    v_add_f32 v52, v52, v60
    v_add_f32 v53, v53, v61
    v_add_f32 v54, v54, v62
    v_add_f32 v55, v55, v63
    v_lshlrev_b32 v56, 16, v72
    v_and_b32 v57, 0xffff0000, v72
    v_lshlrev_b32 v58, 16, v73
    v_and_b32 v59, 0xffff0000, v73
    v_lshlrev_b32 v60, 16, v74
    v_and_b32 v61, 0xffff0000, v74
    v_lshlrev_b32 v62, 16, v75
    v_and_b32 v63, 0xffff0000, v75
    v_add_f32 v48, v48, v56
    v_add_f32 v49, v49, v57
    v_add_f32 v50, v50, v58
    v_add_f32 v51, v51, v59
    v_add_f32 v52, v52, v60
    v_add_f32 v53, v53, v61
    v_add_f32 v54, v54, v62
    v_add_f32 v55, v55, v63
    v_lshlrev_b32 v56, 16, v76
    v_and_b32 v57, 0xffff0000, v76
    v_lshlrev_b32 v58, 16, v77
    v_and_b32 v59, 0xffff0000, v77
    v_lshlrev_b32 v60, 16, v78
    v_and_b32 v61, 0xffff0000, v78
    v_lshlrev_b32 v62, 16, v79
    v_and_b32 v63, 0xffff0000, v79
    v_add_f32 v48, v48, v56
    v_add_f32 v49, v49, v57
    v_add_f32 v50, v50, v58
    v_add_f32 v51, v51, v59
    v_add_f32 v52, v52, v60
    v_add_f32 v53, v53, v61
    v_add_f32 v54, v54, v62
    v_add_f32 v55, v55, v63
    v_lshlrev_b32 v56, 16, v80
    v_and_b32 v57, 0xffff0000, v80
    v_lshlrev_b32 v58, 16, v81
    v_and_b32 v59, 0xffff0000, v81
    v_lshlrev_b32 v60, 16, v82
    v_and_b32 v61, 0xffff0000, v82
    v_lshlrev_b32 v62, 16, v83
    v_and_b32 v63, 0xffff0000, v83
    v_add_f32 v48, v48, v56
    v_add_f32 v49, v49, v57
    v_add_f32 v50, v50, v58
    v_add_f32 v51, v51, v59
    v_add_f32 v52, v52, v60
    v_add_f32 v53, v53, v61
    v_add_f32 v54, v54, v62
    v_add_f32 v55, v55, v63
    v_cvt_pk_bf16_f32 v104, v48, v49
    v_cvt_pk_bf16_f32 v105, v50, v51
    v_cvt_pk_bf16_f32 v106, v52, v53
    v_cvt_pk_bf16_f32 v107, v54, v55
    v_lshlrev_b32 v48, 16, v104
    v_and_b32 v49, 0xffff0000, v104
    v_lshlrev_b32 v50, 16, v105
    v_and_b32 v51, 0xffff0000, v105
    v_lshlrev_b32 v52, 16, v106
    v_and_b32 v53, 0xffff0000, v106
    v_lshlrev_b32 v54, 16, v107
    v_and_b32 v55, 0xffff0000, v107
    v_mul_f32 v48, v48, v20
    v_mul_f32 v49, v49, v21
    v_mul_f32 v50, v50, v22
    v_mul_f32 v51, v51, v23
    v_mul_f32 v52, v52, v24
    v_mul_f32 v53, v53, v25
    v_mul_f32 v54, v54, v26
    v_mul_f32 v55, v55, v27
    v_cvt_pk_bf16_f32 v104, v48, v49
    v_cvt_pk_bf16_f32 v105, v50, v51
    v_cvt_pk_bf16_f32 v106, v52, v53
    v_cvt_pk_bf16_f32 v107, v54, v55
    v_lshlrev_b32 v48, 16, v104
    v_and_b32 v49, 0xffff0000, v104
    v_lshlrev_b32 v50, 16, v105
    v_and_b32 v51, 0xffff0000, v105
    v_lshlrev_b32 v52, 16, v106
    v_and_b32 v53, 0xffff0000, v106
    v_lshlrev_b32 v54, 16, v107
    v_and_b32 v55, 0xffff0000, v107
    v_add_f32 v96, v96, v48
    v_add_f32 v97, v97, v49
    v_add_f32 v98, v98, v50
    v_add_f32 v99, v99, v51
    v_add_f32 v100, v100, v52
    v_add_f32 v101, v101, v53
    v_add_f32 v102, v102, v54
    v_add_f32 v103, v103, v55
    v_cvt_pk_bf16_f32 v104, v96, v97
    v_cvt_pk_bf16_f32 v105, v98, v99
    v_cvt_pk_bf16_f32 v106, v100, v101
    v_cvt_pk_bf16_f32 v107, v102, v103
    v_lshlrev_b32 v96, 16, v104
    v_and_b32 v97, 0xffff0000, v104
    v_lshlrev_b32 v98, 16, v105
    v_and_b32 v99, 0xffff0000, v105
    v_lshlrev_b32 v100, 16, v106
    v_and_b32 v101, 0xffff0000, v106
    v_lshlrev_b32 v102, 16, v107
    v_and_b32 v103, 0xffff0000, v107
    buffer_store_dwordx4 v[104:107], v8, s[28:31], 0 offen sc1
    s_waitcnt vmcnt(0)
    s_mov_b32 s40, s94
k7_final_kernel_end:
    s_endpgm
.section .rodata,"a"
.p2align 6
.amdhsa_kernel k7_final_kernel
  .amdhsa_next_free_vgpr 128
  .amdhsa_next_free_sgpr 96
  .amdhsa_accum_offset 128
  .amdhsa_group_segment_fixed_size 0
  .amdhsa_kernarg_size 112
  .amdhsa_user_sgpr_count 2
  .amdhsa_user_sgpr_kernarg_segment_ptr 1
  .amdhsa_system_sgpr_workgroup_id_x 1
.end_amdhsa_kernel
```
